```python
import torch

def _softmax(x, axis=-1):
    return torch.softmax(x, dim=axis)
def _gelu(x):
    return torch.nn.functional.gelu(x, approximate="tanh")
def _silu(x):
    return torch.nn.functional.silu(x)
def _sigmoid(x):
    return torch.sigmoid(x)
def _layernorm(x, axis=-1, eps=1e-5):
    m = x.mean(dim=axis, keepdim=True)
    v = x.var(dim=axis, keepdim=True, unbiased=False)
    return (x - m) / torch.sqrt(v + eps)
def _scatter_add(tgt, idx, src, axis=0):
    return tgt.clone().index_add_(axis, idx, src)
def _segment_sum(src, seg, n):
    out = torch.zeros((n,) + src.shape[1:], dtype=src.dtype)
    return out.index_add_(0, seg, src)
def _pad(x, pw):
    flat = tuple(v for pair in reversed(pw) for v in pair)
    return torch.nn.functional.pad(x, flat)

kernel_name = 'interleave_layers__linear_kernel_hedgehog__softmax_full_mha__prompt'

def setup_inputs():

    _w = (lambda a: (lambda t: t.to(torch.bfloat16) if t.is_floating_point() else t)(torch.as_tensor(a)))
    def _A_setup():
        B, S, D, H = 1, 2048, 576, 32
        Dh = D // H
        return {
            "x": _w((lambda *s: torch.randn(*s, dtype=torch.bfloat16) * 0.05)(B, S, D)),
            "wqkv": _w((lambda *s: torch.randn(*s, dtype=torch.bfloat16) * 0.4)(D, 3 * D)),
            "w_phi": _w((lambda *s: torch.randn(*s, dtype=torch.bfloat16) * 0.4)(H, Dh, Dh) * (Dh ** -0.5)),
            "wo": _w((lambda *s: torch.randn(*s, dtype=torch.bfloat16) * 0.05)(D, D)),
        }
    _A_in = _A_setup()

    def _B_setup():
        B, S, D = 1, 2048, 576
        return {
            "x": _w((lambda *s: torch.randn(*s, dtype=torch.bfloat16) * 0.05)(B, S, D)),
            "wqkv": _w((lambda *s: torch.randn(*s, dtype=torch.bfloat16) * 0.1)(D, 3 * D)),
            "wo": _w((lambda *s: torch.randn(*s, dtype=torch.bfloat16) * 0.05)(D, D)),
        }
    _B_in = _B_setup()

    return {
        "A_x": _A_in["x"],
        "A_wqkv": _A_in["wqkv"],
        "A_w_phi": _A_in["w_phi"],
        "A_wo": _A_in["wo"],
        "B_x": _B_in["x"],
        "B_wqkv": _B_in["wqkv"],
        "B_wo": _B_in["wo"],
    }

def reference(A_x, A_wqkv, A_w_phi, A_wo, B_x, B_wqkv, B_wo):
    def _A_ref(x, wqkv, w_phi, wo):
        B, S, D = x.shape
        H = 32; Dh = D // H
        qkv = (lambda x, *d: x.permute(*d))((x @ wqkv).reshape(B, S, 3, H, Dh), 2, 0, 3, 1, 4)
        q, k, v = qkv[0], qkv[1], qkv[2]
        pq = torch.einsum("bhsd,hdf->bhsf", q, w_phi)
        pk = torch.einsum("bhsd,hdf->bhsf", k, w_phi)
        phi_q = torch.concatenate([_softmax(pq, axis=-1), _softmax(-pq, axis=-1)], axis=-1)
        phi_k = torch.concatenate([_softmax(pk, axis=-1), _softmax(-pk, axis=-1)], axis=-1)
        kv = torch.einsum("bhsf,bhsd->bhfd", phi_k, v)
        z  = torch.einsum("bhsf->bhf", phi_k)
        num = torch.einsum("bhqf,bhfd->bhqd", phi_q, kv)
        den = torch.einsum("bhqf,bhf->bhq", phi_q, z)[..., None] + 1e-6
        o = num / den
        return (lambda x, *d: x.permute(*d))(o, 0, 2, 1, 3).reshape(B, S, D) @ wo

    def _B_ref(x, wqkv, wo):
        B, S, D = x.shape
        H = 32; Dh = D // H
        qkv = (lambda x, *d: x.permute(*d))((x @ wqkv).reshape(B, S, 3, H, Dh), 2, 0, 3, 1, 4)
        q, k, v = qkv[0], qkv[1], qkv[2]
        scale = Dh ** -0.5
        scores = torch.einsum("bhqd,bhkd->bhqk", q, k) * scale
        p = _softmax(scores, axis=-1)
        o = torch.einsum("bhqk,bhkd->bhqd", p, v)
        return (lambda x, *d: x.permute(*d))(o, 0, 2, 1, 3).reshape(B, S, D) @ wo

    x = A_x
    x = x + _A_ref(_layernorm(x, axis=-1), A_wqkv, A_w_phi, A_wo)
    x = x + _B_ref(_layernorm(x, axis=-1), B_wqkv, B_wo)
    x = x + _A_ref(_layernorm(x, axis=-1), A_wqkv, A_w_phi, A_wo)
    x = x + _B_ref(_layernorm(x, axis=-1), B_wqkv, B_wo)
    return x
```

```asm
; @launch kernel=prep_kernel grid=(2068,1,1) block=(256,1,1) lds=0
; @launch kernel=a1_l0_kernel grid=(256,1,1) block=(256,1,1) lds=94208
; @launch kernel=a2_l0_kernel grid=(256,1,1) block=(256,1,1) lds=32768
; @launch kernel=outa_l0_kernel grid=(288,1,1) block=(256,1,1) lds=0
; @launch kernel=b1_l0_kernel grid=(256,1,1) block=(256,1,1) lds=94208
; @launch kernel=b2_l0_kernel grid=(256,1,1) block=(512,1,1) lds=65536
; @launch kernel=outb_l0_kernel grid=(288,1,1) block=(256,1,1) lds=0
; @launch kernel=a1_l1_kernel grid=(256,1,1) block=(256,1,1) lds=94208
; @launch kernel=a2_l1_kernel grid=(256,1,1) block=(256,1,1) lds=32768
; @launch kernel=outa_l1_kernel grid=(288,1,1) block=(256,1,1) lds=0
; @launch kernel=b1_l1_kernel grid=(256,1,1) block=(256,1,1) lds=94208
; @launch kernel=b2_l1_kernel grid=(256,1,1) block=(512,1,1) lds=65536
; @launch kernel=outb_l1_kernel grid=(288,1,1) block=(256,1,1) lds=0
.amdgcn_target "amdgcn-amd-amdhsa--gfx950"
.text
.globl prep_kernel
.p2align 8
.type prep_kernel,@function
prep_kernel:
    s_cmp_ge_u32 s2, 2068
    s_cbranch_scc1 L_prep_end
    s_load_dwordx4 s[4:7], s[0:1], 8
    s_load_dwordx2 s[8:9], s[0:1], 24
    s_load_dwordx4 s[12:15], s[0:1], 40
    s_load_dwordx2 s[10:11], s[0:1], 72
    v_lshrrev_b32 v1, 6, v0
    s_nop 0
    v_readfirstlane_b32 s3, v1
    v_and_b32 v1, 63, v0
    v_and_b32 v2, 31, v1
    v_lshrrev_b32 v3, 5, v1
    s_lshl_b32 s16, s2, 2
    s_add_u32 s16, s16, s3
    s_waitcnt lgkmcnt(0)
    s_mov_b32 s44, s10
    s_mov_b32 s45, s11
    s_mov_b32 s46, 268435456
    s_mov_b32 s47, 0x00020000
    s_lshl_b32 s17, s16, 10
    v_lshlrev_b32 v4, 4, v1
    s_cmp_ge_u32 s16, 8208
    s_cbranch_scc1 L_prep_phi
    s_cmp_ge_u32 s16, 6912
    s_cbranch_scc1 L_prep_wo
    s_cmp_ge_u32 s16, 3456
    s_cselect_b32 s20, s12, s4
    s_cselect_b32 s21, s13, s5
    s_cselect_b32 s18, 3456, 0
    s_sub_u32 s16, s16, s18
    s_mul_i32 s18, s16, 3641
    s_lshr_b32 s18, s18, 17
    s_mul_i32 s19, s18, 36
    s_sub_u32 s19, s16, s19
    s_lshr_b32 s22, s18, 5
    s_and_b32 s23, s18, 31
    s_mul_i32 s22, s22, 576
    s_mul_i32 s23, s23, 18
    s_add_u32 s22, s22, s23
    s_lshl_b32 s19, s19, 4
    s_mov_b32 s22, s22
    s_mov_b32 s23, 3456
    s_mov_b32 s40, s20
    s_mov_b32 s41, s21
    s_mov_b32 s42, 1990656
    s_mov_b32 s43, 0x00020000
    v_cmp_gt_u32 vcc, 18, v2
    s_branch L_prep_common
L_prep_wo:
    s_sub_u32 s16, s16, 6912
    s_cmp_ge_u32 s16, 648
    s_cselect_b32 s20, s14, s8
    s_cselect_b32 s21, s15, s9
    s_cselect_b32 s18, 648, 0
    s_sub_u32 s16, s16, s18
    s_mul_i32 s18, s16, 3641
    s_lshr_b32 s18, s18, 17
    s_mul_i32 s19, s18, 36
    s_sub_u32 s19, s16, s19
    s_lshl_b32 s22, s18, 5
    s_lshl_b32 s19, s19, 4
    s_mov_b32 s23, 1152
    s_mov_b32 s40, s20
    s_mov_b32 s41, s21
    s_mov_b32 s42, 663552
    s_mov_b32 s43, 0x00020000
    v_cmp_gt_u32 vcc, 32, v2
L_prep_common:
    v_lshlrev_b32 v5, 3, v3
    v_add_u32 v5, s19, v5
    v_mul_lo_u32 v5, v5, s23
    v_add_u32 v6, s22, v2
    v_lshl_add_u32 v5, v6, 1, v5
    v_mov_b32 v6, 0x40000000
    v_cndmask_b32 v5, v6, v5, vcc
    buffer_load_ushort v8, v5, s[40:43], 0 offen
    v_add_u32 v5, s23, v5
    buffer_load_ushort v9, v5, s[40:43], 0 offen
    v_add_u32 v5, s23, v5
    buffer_load_ushort v10, v5, s[40:43], 0 offen
    v_add_u32 v5, s23, v5
    buffer_load_ushort v11, v5, s[40:43], 0 offen
    v_add_u32 v5, s23, v5
    buffer_load_ushort v12, v5, s[40:43], 0 offen
    v_add_u32 v5, s23, v5
    buffer_load_ushort v13, v5, s[40:43], 0 offen
    v_add_u32 v5, s23, v5
    buffer_load_ushort v14, v5, s[40:43], 0 offen
    v_add_u32 v5, s23, v5
    buffer_load_ushort v15, v5, s[40:43], 0 offen
    s_branch L_prep_pack
L_prep_phi:
    s_sub_u32 s16, s16, 8208
    s_lshr_b32 s18, s16, 1
    s_and_b32 s19, s16, 1
    s_mul_i32 s18, s18, 648
    s_lshl_b32 s19, s19, 4
    s_mov_b32 s40, s6
    s_mov_b32 s41, s7
    s_mov_b32 s42, 20736
    s_mov_b32 s43, 0x00020000
    v_lshlrev_b32 v5, 2, v3
    v_add_u32 v5, 0, v5
    v_add_u32 v5, s19, v5
    v_cmp_gt_u32 vcc, 18, v5
    v_cmp_gt_u32 s[24:25], 18, v2
    s_and_b64 vcc, vcc, s[24:25]
    v_mul_u32_u24 v6, 36, v5
    v_add_u32 v6, s18, v6
    v_lshl_add_u32 v6, v2, 1, v6
    v_mov_b32 v7, 0x40000000
    v_cndmask_b32 v6, v7, v6, vcc
    buffer_load_ushort v8, v6, s[40:43], 0 offen
    v_lshlrev_b32 v5, 2, v3
    v_add_u32 v5, 1, v5
    v_add_u32 v5, s19, v5
    v_cmp_gt_u32 vcc, 18, v5
    v_cmp_gt_u32 s[24:25], 18, v2
    s_and_b64 vcc, vcc, s[24:25]
    v_mul_u32_u24 v6, 36, v5
    v_add_u32 v6, s18, v6
    v_lshl_add_u32 v6, v2, 1, v6
    v_mov_b32 v7, 0x40000000
    v_cndmask_b32 v6, v7, v6, vcc
    buffer_load_ushort v9, v6, s[40:43], 0 offen
    v_lshlrev_b32 v5, 2, v3
    v_add_u32 v5, 2, v5
    v_add_u32 v5, s19, v5
    v_cmp_gt_u32 vcc, 18, v5
    v_cmp_gt_u32 s[24:25], 18, v2
    s_and_b64 vcc, vcc, s[24:25]
    v_mul_u32_u24 v6, 36, v5
    v_add_u32 v6, s18, v6
    v_lshl_add_u32 v6, v2, 1, v6
    v_mov_b32 v7, 0x40000000
    v_cndmask_b32 v6, v7, v6, vcc
    buffer_load_ushort v10, v6, s[40:43], 0 offen
    v_lshlrev_b32 v5, 2, v3
    v_add_u32 v5, 3, v5
    v_add_u32 v5, s19, v5
    v_cmp_gt_u32 vcc, 18, v5
    v_cmp_gt_u32 s[24:25], 18, v2
    s_and_b64 vcc, vcc, s[24:25]
    v_mul_u32_u24 v6, 36, v5
    v_add_u32 v6, s18, v6
    v_lshl_add_u32 v6, v2, 1, v6
    v_mov_b32 v7, 0x40000000
    v_cndmask_b32 v6, v7, v6, vcc
    buffer_load_ushort v11, v6, s[40:43], 0 offen
    v_lshlrev_b32 v5, 2, v3
    v_add_u32 v5, 8, v5
    v_add_u32 v5, s19, v5
    v_cmp_gt_u32 vcc, 18, v5
    v_cmp_gt_u32 s[24:25], 18, v2
    s_and_b64 vcc, vcc, s[24:25]
    v_mul_u32_u24 v6, 36, v5
    v_add_u32 v6, s18, v6
    v_lshl_add_u32 v6, v2, 1, v6
    v_mov_b32 v7, 0x40000000
    v_cndmask_b32 v6, v7, v6, vcc
    buffer_load_ushort v12, v6, s[40:43], 0 offen
    v_lshlrev_b32 v5, 2, v3
    v_add_u32 v5, 9, v5
    v_add_u32 v5, s19, v5
    v_cmp_gt_u32 vcc, 18, v5
    v_cmp_gt_u32 s[24:25], 18, v2
    s_and_b64 vcc, vcc, s[24:25]
    v_mul_u32_u24 v6, 36, v5
    v_add_u32 v6, s18, v6
    v_lshl_add_u32 v6, v2, 1, v6
    v_mov_b32 v7, 0x40000000
    v_cndmask_b32 v6, v7, v6, vcc
    buffer_load_ushort v13, v6, s[40:43], 0 offen
    v_lshlrev_b32 v5, 2, v3
    v_add_u32 v5, 10, v5
    v_add_u32 v5, s19, v5
    v_cmp_gt_u32 vcc, 18, v5
    v_cmp_gt_u32 s[24:25], 18, v2
    s_and_b64 vcc, vcc, s[24:25]
    v_mul_u32_u24 v6, 36, v5
    v_add_u32 v6, s18, v6
    v_lshl_add_u32 v6, v2, 1, v6
    v_mov_b32 v7, 0x40000000
    v_cndmask_b32 v6, v7, v6, vcc
    buffer_load_ushort v14, v6, s[40:43], 0 offen
    v_lshlrev_b32 v5, 2, v3
    v_add_u32 v5, 11, v5
    v_add_u32 v5, s19, v5
    v_cmp_gt_u32 vcc, 18, v5
    v_cmp_gt_u32 s[24:25], 18, v2
    s_and_b64 vcc, vcc, s[24:25]
    v_mul_u32_u24 v6, 36, v5
    v_add_u32 v6, s18, v6
    v_lshl_add_u32 v6, v2, 1, v6
    v_mov_b32 v7, 0x40000000
    v_cndmask_b32 v6, v7, v6, vcc
    buffer_load_ushort v15, v6, s[40:43], 0 offen
L_prep_pack:
    s_waitcnt vmcnt(0)
    v_lshl_or_b32 v16, v9, 16, v8
    v_lshl_or_b32 v17, v11, 16, v10
    v_lshl_or_b32 v18, v13, 16, v12
    v_lshl_or_b32 v19, v15, 16, v14
    buffer_store_dwordx4 v[16:19], v4, s[44:47], s17 offen
L_prep_end:
    s_endpgm
.globl a1_l0_kernel
.p2align 8
.type a1_l0_kernel,@function
a1_l0_kernel:
    s_cmp_ge_u32 s2, 256
    s_cbranch_scc1 L_a1_l0_kernel_end
    s_load_dwordx2 s[4:5], s[0:1], 72
    s_load_dwordx2 s[6:7], s[0:1], 0
    v_lshrrev_b32 v1, 6, v0
    s_nop 0
    v_readfirstlane_b32 s3, v1
    v_and_b32 v1, 63, v0
    v_and_b32 v2, 31, v1
    v_lshrrev_b32 v3, 5, v1
    v_lshlrev_b32 v4, 4, v1
    s_lshr_b32 s16, s2, 3
    s_and_b32 s17, s2, 7
    s_lshl_b32 s17, s17, 2
    s_add_u32 s18, s17, s3
    s_mov_b32 s30, -1
    s_mov_b32 s31, 0
    s_waitcnt lgkmcnt(0)
    s_mov_b32 s12, s4
    s_mov_b32 s13, s5
    s_mov_b32 s14, 268435456
    s_mov_b32 s15, 0x00020000
    s_mov_b32 s8, s6
    s_mov_b32 s9, s7
    s_mov_b32 s10, 2359296
    s_mov_b32 s11, 0x00020000
    s_lshl_b32 s19, s16, 6
    s_lshl_b32 s20, s3, 4
    s_add_u32 s19, s19, s20
    v_lshrrev_b32 v5, 3, v1
    v_add_u32 v5, s19, v5
    v_mul_u32_u24 v5, 1152, v5
    v_and_b32 v6, 7, v1
    v_lshl_add_u32 v5, v6, 4, v5
    buffer_load_dwordx4 v[16:19], v5, s[8:11], 0 offen offset:0
    buffer_load_dwordx4 v[20:23], v5, s[8:11], 0 offen offset:128
    buffer_load_dwordx4 v[24:27], v5, s[8:11], 0 offen offset:256
    buffer_load_dwordx4 v[28:31], v5, s[8:11], 0 offen offset:384
    buffer_load_dwordx4 v[32:35], v5, s[8:11], 0 offen offset:512
    buffer_load_dwordx4 v[36:39], v5, s[8:11], 0 offen offset:640
    buffer_load_dwordx4 v[40:43], v5, s[8:11], 0 offen offset:768
    buffer_load_dwordx4 v[44:47], v5, s[8:11], 0 offen offset:896
    buffer_load_dwordx4 v[48:51], v5, s[8:11], 0 offen offset:1024
    v_add_u32 v5, 9216, v5
    buffer_load_dwordx4 v[52:55], v5, s[8:11], 0 offen offset:0
    buffer_load_dwordx4 v[56:59], v5, s[8:11], 0 offen offset:128
    buffer_load_dwordx4 v[60:63], v5, s[8:11], 0 offen offset:256
    buffer_load_dwordx4 v[64:67], v5, s[8:11], 0 offen offset:384
    buffer_load_dwordx4 v[68:71], v5, s[8:11], 0 offen offset:512
    buffer_load_dwordx4 v[72:75], v5, s[8:11], 0 offen offset:640
    buffer_load_dwordx4 v[76:79], v5, s[8:11], 0 offen offset:768
    buffer_load_dwordx4 v[80:83], v5, s[8:11], 0 offen offset:896
    buffer_load_dwordx4 v[84:87], v5, s[8:11], 0 offen offset:1024
    s_mul_i32 s19, s18, 36864
    s_add_u32 s19, s19, 0
    s_add_u32 s20, s19, 1179648
    s_add_u32 s21, s19, 2359296
    s_waitcnt vmcnt(9)
    v_lshlrev_b32 v100, 16, v16
    v_and_b32 v101, 0xffff0000, v16
    v_lshlrev_b32 v102, 16, v17
    v_and_b32 v103, 0xffff0000, v17
    v_lshlrev_b32 v104, 16, v18
    v_and_b32 v105, 0xffff0000, v18
    v_lshlrev_b32 v106, 16, v19
    v_and_b32 v107, 0xffff0000, v19
    v_lshlrev_b32 v108, 16, v20
    v_and_b32 v109, 0xffff0000, v20
    v_lshlrev_b32 v110, 16, v21
    v_and_b32 v111, 0xffff0000, v21
    v_lshlrev_b32 v112, 16, v22
    v_and_b32 v113, 0xffff0000, v22
    v_lshlrev_b32 v114, 16, v23
    v_and_b32 v115, 0xffff0000, v23
    v_lshlrev_b32 v116, 16, v24
    v_and_b32 v117, 0xffff0000, v24
    v_lshlrev_b32 v118, 16, v25
    v_and_b32 v119, 0xffff0000, v25
    v_lshlrev_b32 v120, 16, v26
    v_and_b32 v121, 0xffff0000, v26
    v_lshlrev_b32 v122, 16, v27
    v_and_b32 v123, 0xffff0000, v27
    v_lshlrev_b32 v124, 16, v28
    v_and_b32 v125, 0xffff0000, v28
    v_lshlrev_b32 v126, 16, v29
    v_and_b32 v127, 0xffff0000, v29
    v_lshlrev_b32 v128, 16, v30
    v_and_b32 v129, 0xffff0000, v30
    v_lshlrev_b32 v130, 16, v31
    v_and_b32 v131, 0xffff0000, v31
    v_lshlrev_b32 v132, 16, v32
    v_and_b32 v133, 0xffff0000, v32
    v_lshlrev_b32 v134, 16, v33
    v_and_b32 v135, 0xffff0000, v33
    v_lshlrev_b32 v136, 16, v34
    v_and_b32 v137, 0xffff0000, v34
    v_lshlrev_b32 v138, 16, v35
    v_and_b32 v139, 0xffff0000, v35
    v_lshlrev_b32 v140, 16, v36
    v_and_b32 v141, 0xffff0000, v36
    v_lshlrev_b32 v142, 16, v37
    v_and_b32 v143, 0xffff0000, v37
    v_lshlrev_b32 v144, 16, v38
    v_and_b32 v145, 0xffff0000, v38
    v_lshlrev_b32 v146, 16, v39
    v_and_b32 v147, 0xffff0000, v39
    v_lshlrev_b32 v148, 16, v40
    v_and_b32 v149, 0xffff0000, v40
    v_lshlrev_b32 v150, 16, v41
    v_and_b32 v151, 0xffff0000, v41
    v_lshlrev_b32 v152, 16, v42
    v_and_b32 v153, 0xffff0000, v42
    v_lshlrev_b32 v154, 16, v43
    v_and_b32 v155, 0xffff0000, v43
    v_lshlrev_b32 v156, 16, v44
    v_and_b32 v157, 0xffff0000, v44
    v_lshlrev_b32 v158, 16, v45
    v_and_b32 v159, 0xffff0000, v45
    v_lshlrev_b32 v160, 16, v46
    v_and_b32 v161, 0xffff0000, v46
    v_lshlrev_b32 v162, 16, v47
    v_and_b32 v163, 0xffff0000, v47
    v_lshlrev_b32 v164, 16, v48
    v_and_b32 v165, 0xffff0000, v48
    v_lshlrev_b32 v166, 16, v49
    v_and_b32 v167, 0xffff0000, v49
    v_lshlrev_b32 v168, 16, v50
    v_and_b32 v169, 0xffff0000, v50
    v_lshlrev_b32 v170, 16, v51
    v_and_b32 v171, 0xffff0000, v51
    v_add_f32 v90, v100, v101
    v_add_f32 v91, v102, v103
    v_add_f32 v90, v90, v104
    v_add_f32 v91, v91, v105
    v_add_f32 v90, v90, v106
    v_add_f32 v91, v91, v107
    v_add_f32 v90, v90, v108
    v_add_f32 v91, v91, v109
    v_add_f32 v90, v90, v110
    v_add_f32 v91, v91, v111
    v_add_f32 v90, v90, v112
    v_add_f32 v91, v91, v113
    v_add_f32 v90, v90, v114
    v_add_f32 v91, v91, v115
    v_add_f32 v90, v90, v116
    v_add_f32 v91, v91, v117
    v_add_f32 v90, v90, v118
    v_add_f32 v91, v91, v119
    v_add_f32 v90, v90, v120
    v_add_f32 v91, v91, v121
    v_add_f32 v90, v90, v122
    v_add_f32 v91, v91, v123
    v_add_f32 v90, v90, v124
    v_add_f32 v91, v91, v125
    v_add_f32 v90, v90, v126
    v_add_f32 v91, v91, v127
    v_add_f32 v90, v90, v128
    v_add_f32 v91, v91, v129
    v_add_f32 v90, v90, v130
    v_add_f32 v91, v91, v131
    v_add_f32 v90, v90, v132
    v_add_f32 v91, v91, v133
    v_add_f32 v90, v90, v134
    v_add_f32 v91, v91, v135
    v_add_f32 v90, v90, v136
    v_add_f32 v91, v91, v137
    v_add_f32 v90, v90, v138
    v_add_f32 v91, v91, v139
    v_add_f32 v90, v90, v140
    v_add_f32 v91, v91, v141
    v_add_f32 v90, v90, v142
    v_add_f32 v91, v91, v143
    v_add_f32 v90, v90, v144
    v_add_f32 v91, v91, v145
    v_add_f32 v90, v90, v146
    v_add_f32 v91, v91, v147
    v_add_f32 v90, v90, v148
    v_add_f32 v91, v91, v149
    v_add_f32 v90, v90, v150
    v_add_f32 v91, v91, v151
    v_add_f32 v90, v90, v152
    v_add_f32 v91, v91, v153
    v_add_f32 v90, v90, v154
    v_add_f32 v91, v91, v155
    v_add_f32 v90, v90, v156
    v_add_f32 v91, v91, v157
    v_add_f32 v90, v90, v158
    v_add_f32 v91, v91, v159
    v_add_f32 v90, v90, v160
    v_add_f32 v91, v91, v161
    v_add_f32 v90, v90, v162
    v_add_f32 v91, v91, v163
    v_add_f32 v90, v90, v164
    v_add_f32 v91, v91, v165
    v_add_f32 v90, v90, v166
    v_add_f32 v91, v91, v167
    v_add_f32 v90, v90, v168
    v_add_f32 v91, v91, v169
    v_add_f32 v90, v90, v170
    v_add_f32 v91, v91, v171
    v_add_f32 v90, v90, v91
    s_nop 1
    v_add_f32_dpp v90, v90, v90 quad_perm:[1,0,3,2] row_mask:0xf bank_mask:0xf
    s_nop 1
    v_add_f32_dpp v90, v90, v90 quad_perm:[2,3,0,1] row_mask:0xf bank_mask:0xf
    s_nop 1
    v_add_f32_dpp v90, v90, v90 row_half_mirror row_mask:0xf bank_mask:0xf
    v_mul_f32 v90, 0x3ae38e39, v90
    v_sub_f32 v92, v100, v90
    v_mul_f32 v91, v92, v92
    v_sub_f32 v92, v101, v90
    v_fmac_f32 v91, v92, v92
    v_sub_f32 v92, v102, v90
    v_fmac_f32 v91, v92, v92
    v_sub_f32 v92, v103, v90
    v_fmac_f32 v91, v92, v92
    v_sub_f32 v92, v104, v90
    v_fmac_f32 v91, v92, v92
    v_sub_f32 v92, v105, v90
    v_fmac_f32 v91, v92, v92
    v_sub_f32 v92, v106, v90
    v_fmac_f32 v91, v92, v92
    v_sub_f32 v92, v107, v90
    v_fmac_f32 v91, v92, v92
    v_sub_f32 v92, v108, v90
    v_fmac_f32 v91, v92, v92
    v_sub_f32 v92, v109, v90
    v_fmac_f32 v91, v92, v92
    v_sub_f32 v92, v110, v90
    v_fmac_f32 v91, v92, v92
    v_sub_f32 v92, v111, v90
    v_fmac_f32 v91, v92, v92
    v_sub_f32 v92, v112, v90
    v_fmac_f32 v91, v92, v92
    v_sub_f32 v92, v113, v90
    v_fmac_f32 v91, v92, v92
    v_sub_f32 v92, v114, v90
    v_fmac_f32 v91, v92, v92
    v_sub_f32 v92, v115, v90
    v_fmac_f32 v91, v92, v92
    v_sub_f32 v92, v116, v90
    v_fmac_f32 v91, v92, v92
    v_sub_f32 v92, v117, v90
    v_fmac_f32 v91, v92, v92
    v_sub_f32 v92, v118, v90
    v_fmac_f32 v91, v92, v92
    v_sub_f32 v92, v119, v90
    v_fmac_f32 v91, v92, v92
    v_sub_f32 v92, v120, v90
    v_fmac_f32 v91, v92, v92
    v_sub_f32 v92, v121, v90
    v_fmac_f32 v91, v92, v92
    v_sub_f32 v92, v122, v90
    v_fmac_f32 v91, v92, v92
    v_sub_f32 v92, v123, v90
    v_fmac_f32 v91, v92, v92
    v_sub_f32 v92, v124, v90
    v_fmac_f32 v91, v92, v92
    v_sub_f32 v92, v125, v90
    v_fmac_f32 v91, v92, v92
    v_sub_f32 v92, v126, v90
    v_fmac_f32 v91, v92, v92
    v_sub_f32 v92, v127, v90
    v_fmac_f32 v91, v92, v92
    v_sub_f32 v92, v128, v90
    v_fmac_f32 v91, v92, v92
    v_sub_f32 v92, v129, v90
    v_fmac_f32 v91, v92, v92
    v_sub_f32 v92, v130, v90
    v_fmac_f32 v91, v92, v92
    v_sub_f32 v92, v131, v90
    v_fmac_f32 v91, v92, v92
    v_sub_f32 v92, v132, v90
    v_fmac_f32 v91, v92, v92
    v_sub_f32 v92, v133, v90
    v_fmac_f32 v91, v92, v92
    v_sub_f32 v92, v134, v90
    v_fmac_f32 v91, v92, v92
    v_sub_f32 v92, v135, v90
    v_fmac_f32 v91, v92, v92
    v_sub_f32 v92, v136, v90
    v_fmac_f32 v91, v92, v92
    v_sub_f32 v92, v137, v90
    v_fmac_f32 v91, v92, v92
    v_sub_f32 v92, v138, v90
    v_fmac_f32 v91, v92, v92
    v_sub_f32 v92, v139, v90
    v_fmac_f32 v91, v92, v92
    v_sub_f32 v92, v140, v90
    v_fmac_f32 v91, v92, v92
    v_sub_f32 v92, v141, v90
    v_fmac_f32 v91, v92, v92
    v_sub_f32 v92, v142, v90
    v_fmac_f32 v91, v92, v92
    v_sub_f32 v92, v143, v90
    v_fmac_f32 v91, v92, v92
    v_sub_f32 v92, v144, v90
    v_fmac_f32 v91, v92, v92
    v_sub_f32 v92, v145, v90
    v_fmac_f32 v91, v92, v92
    v_sub_f32 v92, v146, v90
    v_fmac_f32 v91, v92, v92
    v_sub_f32 v92, v147, v90
    v_fmac_f32 v91, v92, v92
    v_sub_f32 v92, v148, v90
    v_fmac_f32 v91, v92, v92
    v_sub_f32 v92, v149, v90
    v_fmac_f32 v91, v92, v92
    v_sub_f32 v92, v150, v90
    v_fmac_f32 v91, v92, v92
    v_sub_f32 v92, v151, v90
    v_fmac_f32 v91, v92, v92
    v_sub_f32 v92, v152, v90
    v_fmac_f32 v91, v92, v92
    v_sub_f32 v92, v153, v90
    v_fmac_f32 v91, v92, v92
    v_sub_f32 v92, v154, v90
    v_fmac_f32 v91, v92, v92
    v_sub_f32 v92, v155, v90
    v_fmac_f32 v91, v92, v92
    v_sub_f32 v92, v156, v90
    v_fmac_f32 v91, v92, v92
    v_sub_f32 v92, v157, v90
    v_fmac_f32 v91, v92, v92
    v_sub_f32 v92, v158, v90
    v_fmac_f32 v91, v92, v92
    v_sub_f32 v92, v159, v90
    v_fmac_f32 v91, v92, v92
    v_sub_f32 v92, v160, v90
    v_fmac_f32 v91, v92, v92
    v_sub_f32 v92, v161, v90
    v_fmac_f32 v91, v92, v92
    v_sub_f32 v92, v162, v90
    v_fmac_f32 v91, v92, v92
    v_sub_f32 v92, v163, v90
    v_fmac_f32 v91, v92, v92
    v_sub_f32 v92, v164, v90
    v_fmac_f32 v91, v92, v92
    v_sub_f32 v92, v165, v90
    v_fmac_f32 v91, v92, v92
    v_sub_f32 v92, v166, v90
    v_fmac_f32 v91, v92, v92
    v_sub_f32 v92, v167, v90
    v_fmac_f32 v91, v92, v92
    v_sub_f32 v92, v168, v90
    v_fmac_f32 v91, v92, v92
    v_sub_f32 v92, v169, v90
    v_fmac_f32 v91, v92, v92
    v_sub_f32 v92, v170, v90
    v_fmac_f32 v91, v92, v92
    v_sub_f32 v92, v171, v90
    v_fmac_f32 v91, v92, v92
    s_nop 1
    v_add_f32_dpp v91, v91, v91 quad_perm:[1,0,3,2] row_mask:0xf bank_mask:0xf
    s_nop 1
    v_add_f32_dpp v91, v91, v91 quad_perm:[2,3,0,1] row_mask:0xf bank_mask:0xf
    s_nop 1
    v_add_f32_dpp v91, v91, v91 row_half_mirror row_mask:0xf bank_mask:0xf
    v_mul_f32 v91, 0x3ae38e39, v91
    v_cvt_pk_bf16_f32 v92, v90, v91
    v_lshlrev_b32 v90, 16, v92
    v_and_b32 v91, 0xffff0000, v92
    v_add_f32 v91, 0x3727c5ac, v91
    v_cvt_pk_bf16_f32 v91, v91, v91
    v_lshlrev_b32 v91, 16, v91
    v_sqrt_f32 v91, v91
    s_nop 0
    v_cvt_pk_bf16_f32 v91, v91, v91
    v_lshlrev_b32 v91, 16, v91
    v_rcp_f32 v91, v91
    s_nop 0
    v_sub_f32 v100, v100, v90
    v_sub_f32 v101, v101, v90
    v_cvt_pk_bf16_f32 v16, v100, v101
    v_lshlrev_b32 v100, 16, v16
    v_and_b32 v101, 0xffff0000, v16
    v_mul_f32 v100, v100, v91
    v_mul_f32 v101, v101, v91
    v_cvt_pk_bf16_f32 v16, v100, v101
    v_sub_f32 v102, v102, v90
    v_sub_f32 v103, v103, v90
    v_cvt_pk_bf16_f32 v17, v102, v103
    v_lshlrev_b32 v102, 16, v17
    v_and_b32 v103, 0xffff0000, v17
    v_mul_f32 v102, v102, v91
    v_mul_f32 v103, v103, v91
    v_cvt_pk_bf16_f32 v17, v102, v103
    v_sub_f32 v104, v104, v90
    v_sub_f32 v105, v105, v90
    v_cvt_pk_bf16_f32 v18, v104, v105
    v_lshlrev_b32 v104, 16, v18
    v_and_b32 v105, 0xffff0000, v18
    v_mul_f32 v104, v104, v91
    v_mul_f32 v105, v105, v91
    v_cvt_pk_bf16_f32 v18, v104, v105
    v_sub_f32 v106, v106, v90
    v_sub_f32 v107, v107, v90
    v_cvt_pk_bf16_f32 v19, v106, v107
    v_lshlrev_b32 v106, 16, v19
    v_and_b32 v107, 0xffff0000, v19
    v_mul_f32 v106, v106, v91
    v_mul_f32 v107, v107, v91
    v_cvt_pk_bf16_f32 v19, v106, v107
    v_sub_f32 v108, v108, v90
    v_sub_f32 v109, v109, v90
    v_cvt_pk_bf16_f32 v20, v108, v109
    v_lshlrev_b32 v108, 16, v20
    v_and_b32 v109, 0xffff0000, v20
    v_mul_f32 v108, v108, v91
    v_mul_f32 v109, v109, v91
    v_cvt_pk_bf16_f32 v20, v108, v109
    v_sub_f32 v110, v110, v90
    v_sub_f32 v111, v111, v90
    v_cvt_pk_bf16_f32 v21, v110, v111
    v_lshlrev_b32 v110, 16, v21
    v_and_b32 v111, 0xffff0000, v21
    v_mul_f32 v110, v110, v91
    v_mul_f32 v111, v111, v91
    v_cvt_pk_bf16_f32 v21, v110, v111
    v_sub_f32 v112, v112, v90
    v_sub_f32 v113, v113, v90
    v_cvt_pk_bf16_f32 v22, v112, v113
    v_lshlrev_b32 v112, 16, v22
    v_and_b32 v113, 0xffff0000, v22
    v_mul_f32 v112, v112, v91
    v_mul_f32 v113, v113, v91
    v_cvt_pk_bf16_f32 v22, v112, v113
    v_sub_f32 v114, v114, v90
    v_sub_f32 v115, v115, v90
    v_cvt_pk_bf16_f32 v23, v114, v115
    v_lshlrev_b32 v114, 16, v23
    v_and_b32 v115, 0xffff0000, v23
    v_mul_f32 v114, v114, v91
    v_mul_f32 v115, v115, v91
    v_cvt_pk_bf16_f32 v23, v114, v115
    v_sub_f32 v116, v116, v90
    v_sub_f32 v117, v117, v90
    v_cvt_pk_bf16_f32 v24, v116, v117
    v_lshlrev_b32 v116, 16, v24
    v_and_b32 v117, 0xffff0000, v24
    v_mul_f32 v116, v116, v91
    v_mul_f32 v117, v117, v91
    v_cvt_pk_bf16_f32 v24, v116, v117
    v_sub_f32 v118, v118, v90
    v_sub_f32 v119, v119, v90
    v_cvt_pk_bf16_f32 v25, v118, v119
    v_lshlrev_b32 v118, 16, v25
    v_and_b32 v119, 0xffff0000, v25
    v_mul_f32 v118, v118, v91
    v_mul_f32 v119, v119, v91
    v_cvt_pk_bf16_f32 v25, v118, v119
    v_sub_f32 v120, v120, v90
    v_sub_f32 v121, v121, v90
    v_cvt_pk_bf16_f32 v26, v120, v121
    v_lshlrev_b32 v120, 16, v26
    v_and_b32 v121, 0xffff0000, v26
    v_mul_f32 v120, v120, v91
    v_mul_f32 v121, v121, v91
    v_cvt_pk_bf16_f32 v26, v120, v121
    v_sub_f32 v122, v122, v90
    v_sub_f32 v123, v123, v90
    v_cvt_pk_bf16_f32 v27, v122, v123
    v_lshlrev_b32 v122, 16, v27
    v_and_b32 v123, 0xffff0000, v27
    v_mul_f32 v122, v122, v91
    v_mul_f32 v123, v123, v91
    v_cvt_pk_bf16_f32 v27, v122, v123
    v_sub_f32 v124, v124, v90
    v_sub_f32 v125, v125, v90
    v_cvt_pk_bf16_f32 v28, v124, v125
    v_lshlrev_b32 v124, 16, v28
    v_and_b32 v125, 0xffff0000, v28
    v_mul_f32 v124, v124, v91
    v_mul_f32 v125, v125, v91
    v_cvt_pk_bf16_f32 v28, v124, v125
    v_sub_f32 v126, v126, v90
    v_sub_f32 v127, v127, v90
    v_cvt_pk_bf16_f32 v29, v126, v127
    v_lshlrev_b32 v126, 16, v29
    v_and_b32 v127, 0xffff0000, v29
    v_mul_f32 v126, v126, v91
    v_mul_f32 v127, v127, v91
    v_cvt_pk_bf16_f32 v29, v126, v127
    v_sub_f32 v128, v128, v90
    v_sub_f32 v129, v129, v90
    v_cvt_pk_bf16_f32 v30, v128, v129
    v_lshlrev_b32 v128, 16, v30
    v_and_b32 v129, 0xffff0000, v30
    v_mul_f32 v128, v128, v91
    v_mul_f32 v129, v129, v91
    v_cvt_pk_bf16_f32 v30, v128, v129
    v_sub_f32 v130, v130, v90
    v_sub_f32 v131, v131, v90
    v_cvt_pk_bf16_f32 v31, v130, v131
    v_lshlrev_b32 v130, 16, v31
    v_and_b32 v131, 0xffff0000, v31
    v_mul_f32 v130, v130, v91
    v_mul_f32 v131, v131, v91
    v_cvt_pk_bf16_f32 v31, v130, v131
    v_sub_f32 v132, v132, v90
    v_sub_f32 v133, v133, v90
    v_cvt_pk_bf16_f32 v32, v132, v133
    v_lshlrev_b32 v132, 16, v32
    v_and_b32 v133, 0xffff0000, v32
    v_mul_f32 v132, v132, v91
    v_mul_f32 v133, v133, v91
    v_cvt_pk_bf16_f32 v32, v132, v133
    v_sub_f32 v134, v134, v90
    v_sub_f32 v135, v135, v90
    v_cvt_pk_bf16_f32 v33, v134, v135
    v_lshlrev_b32 v134, 16, v33
    v_and_b32 v135, 0xffff0000, v33
    v_mul_f32 v134, v134, v91
    v_mul_f32 v135, v135, v91
    v_cvt_pk_bf16_f32 v33, v134, v135
    v_sub_f32 v136, v136, v90
    v_sub_f32 v137, v137, v90
    v_cvt_pk_bf16_f32 v34, v136, v137
    v_lshlrev_b32 v136, 16, v34
    v_and_b32 v137, 0xffff0000, v34
    v_mul_f32 v136, v136, v91
    v_mul_f32 v137, v137, v91
    v_cvt_pk_bf16_f32 v34, v136, v137
    v_sub_f32 v138, v138, v90
    v_sub_f32 v139, v139, v90
    v_cvt_pk_bf16_f32 v35, v138, v139
    v_lshlrev_b32 v138, 16, v35
    v_and_b32 v139, 0xffff0000, v35
    v_mul_f32 v138, v138, v91
    v_mul_f32 v139, v139, v91
    v_cvt_pk_bf16_f32 v35, v138, v139
    v_sub_f32 v140, v140, v90
    v_sub_f32 v141, v141, v90
    v_cvt_pk_bf16_f32 v36, v140, v141
    v_lshlrev_b32 v140, 16, v36
    v_and_b32 v141, 0xffff0000, v36
    v_mul_f32 v140, v140, v91
    v_mul_f32 v141, v141, v91
    v_cvt_pk_bf16_f32 v36, v140, v141
    v_sub_f32 v142, v142, v90
    v_sub_f32 v143, v143, v90
    v_cvt_pk_bf16_f32 v37, v142, v143
    v_lshlrev_b32 v142, 16, v37
    v_and_b32 v143, 0xffff0000, v37
    v_mul_f32 v142, v142, v91
    v_mul_f32 v143, v143, v91
    v_cvt_pk_bf16_f32 v37, v142, v143
    v_sub_f32 v144, v144, v90
    v_sub_f32 v145, v145, v90
    v_cvt_pk_bf16_f32 v38, v144, v145
    v_lshlrev_b32 v144, 16, v38
    v_and_b32 v145, 0xffff0000, v38
    v_mul_f32 v144, v144, v91
    v_mul_f32 v145, v145, v91
    v_cvt_pk_bf16_f32 v38, v144, v145
    v_sub_f32 v146, v146, v90
    v_sub_f32 v147, v147, v90
    v_cvt_pk_bf16_f32 v39, v146, v147
    v_lshlrev_b32 v146, 16, v39
    v_and_b32 v147, 0xffff0000, v39
    v_mul_f32 v146, v146, v91
    v_mul_f32 v147, v147, v91
    v_cvt_pk_bf16_f32 v39, v146, v147
    v_sub_f32 v148, v148, v90
    v_sub_f32 v149, v149, v90
    v_cvt_pk_bf16_f32 v40, v148, v149
    v_lshlrev_b32 v148, 16, v40
    v_and_b32 v149, 0xffff0000, v40
    v_mul_f32 v148, v148, v91
    v_mul_f32 v149, v149, v91
    v_cvt_pk_bf16_f32 v40, v148, v149
    v_sub_f32 v150, v150, v90
    v_sub_f32 v151, v151, v90
    v_cvt_pk_bf16_f32 v41, v150, v151
    v_lshlrev_b32 v150, 16, v41
    v_and_b32 v151, 0xffff0000, v41
    v_mul_f32 v150, v150, v91
    v_mul_f32 v151, v151, v91
    v_cvt_pk_bf16_f32 v41, v150, v151
    v_sub_f32 v152, v152, v90
    v_sub_f32 v153, v153, v90
    v_cvt_pk_bf16_f32 v42, v152, v153
    v_lshlrev_b32 v152, 16, v42
    v_and_b32 v153, 0xffff0000, v42
    v_mul_f32 v152, v152, v91
    v_mul_f32 v153, v153, v91
    v_cvt_pk_bf16_f32 v42, v152, v153
    v_sub_f32 v154, v154, v90
    v_sub_f32 v155, v155, v90
    v_cvt_pk_bf16_f32 v43, v154, v155
    v_lshlrev_b32 v154, 16, v43
    v_and_b32 v155, 0xffff0000, v43
    v_mul_f32 v154, v154, v91
    v_mul_f32 v155, v155, v91
    v_cvt_pk_bf16_f32 v43, v154, v155
    v_sub_f32 v156, v156, v90
    v_sub_f32 v157, v157, v90
    v_cvt_pk_bf16_f32 v44, v156, v157
    v_lshlrev_b32 v156, 16, v44
    v_and_b32 v157, 0xffff0000, v44
    v_mul_f32 v156, v156, v91
    v_mul_f32 v157, v157, v91
    v_cvt_pk_bf16_f32 v44, v156, v157
    v_sub_f32 v158, v158, v90
    v_sub_f32 v159, v159, v90
    v_cvt_pk_bf16_f32 v45, v158, v159
    v_lshlrev_b32 v158, 16, v45
    v_and_b32 v159, 0xffff0000, v45
    v_mul_f32 v158, v158, v91
    v_mul_f32 v159, v159, v91
    v_cvt_pk_bf16_f32 v45, v158, v159
    v_sub_f32 v160, v160, v90
    v_sub_f32 v161, v161, v90
    v_cvt_pk_bf16_f32 v46, v160, v161
    v_lshlrev_b32 v160, 16, v46
    v_and_b32 v161, 0xffff0000, v46
    v_mul_f32 v160, v160, v91
    v_mul_f32 v161, v161, v91
    v_cvt_pk_bf16_f32 v46, v160, v161
    v_sub_f32 v162, v162, v90
    v_sub_f32 v163, v163, v90
    v_cvt_pk_bf16_f32 v47, v162, v163
    v_lshlrev_b32 v162, 16, v47
    v_and_b32 v163, 0xffff0000, v47
    v_mul_f32 v162, v162, v91
    v_mul_f32 v163, v163, v91
    v_cvt_pk_bf16_f32 v47, v162, v163
    v_sub_f32 v164, v164, v90
    v_sub_f32 v165, v165, v90
    v_cvt_pk_bf16_f32 v48, v164, v165
    v_lshlrev_b32 v164, 16, v48
    v_and_b32 v165, 0xffff0000, v48
    v_mul_f32 v164, v164, v91
    v_mul_f32 v165, v165, v91
    v_cvt_pk_bf16_f32 v48, v164, v165
    v_sub_f32 v166, v166, v90
    v_sub_f32 v167, v167, v90
    v_cvt_pk_bf16_f32 v49, v166, v167
    v_lshlrev_b32 v166, 16, v49
    v_and_b32 v167, 0xffff0000, v49
    v_mul_f32 v166, v166, v91
    v_mul_f32 v167, v167, v91
    v_cvt_pk_bf16_f32 v49, v166, v167
    v_sub_f32 v168, v168, v90
    v_sub_f32 v169, v169, v90
    v_cvt_pk_bf16_f32 v50, v168, v169
    v_lshlrev_b32 v168, 16, v50
    v_and_b32 v169, 0xffff0000, v50
    v_mul_f32 v168, v168, v91
    v_mul_f32 v169, v169, v91
    v_cvt_pk_bf16_f32 v50, v168, v169
    v_sub_f32 v170, v170, v90
    v_sub_f32 v171, v171, v90
    v_cvt_pk_bf16_f32 v51, v170, v171
    v_lshlrev_b32 v170, 16, v51
    v_and_b32 v171, 0xffff0000, v51
    v_mul_f32 v170, v170, v91
    v_mul_f32 v171, v171, v91
    v_cvt_pk_bf16_f32 v51, v170, v171
    s_lshl_b32 s22, s3, 4
    s_add_u32 s22, s22, 0
    s_lshr_b32 s23, s22, 5
    s_mul_i32 s23, s23, 36864
    s_and_b32 s22, s22, 31
    v_lshrrev_b32 v7, 3, v1
    v_add_u32 v7, s22, v7
    v_lshlrev_b32 v7, 4, v7
    v_add_u32 v7, s23, v7
    v_and_b32 v6, 7, v1
    v_lshrrev_b32 v8, 1, v6
    v_lshl_add_u32 v7, v8, 10, v7
    v_and_b32 v8, 1, v6
    v_lshl_add_u32 v7, v8, 9, v7
    ds_write_b128 v7, v[16:19] offset:0
    ds_write_b128 v7, v[20:23] offset:4096
    ds_write_b128 v7, v[24:27] offset:8192
    ds_write_b128 v7, v[28:31] offset:12288
    ds_write_b128 v7, v[32:35] offset:16384
    ds_write_b128 v7, v[36:39] offset:20480
    ds_write_b128 v7, v[40:43] offset:24576
    ds_write_b128 v7, v[44:47] offset:28672
    ds_write_b128 v7, v[48:51] offset:32768
    s_waitcnt vmcnt(0)
    v_lshlrev_b32 v100, 16, v52
    v_and_b32 v101, 0xffff0000, v52
    v_lshlrev_b32 v102, 16, v53
    v_and_b32 v103, 0xffff0000, v53
    v_lshlrev_b32 v104, 16, v54
    v_and_b32 v105, 0xffff0000, v54
    v_lshlrev_b32 v106, 16, v55
    v_and_b32 v107, 0xffff0000, v55
    v_lshlrev_b32 v108, 16, v56
    v_and_b32 v109, 0xffff0000, v56
    v_lshlrev_b32 v110, 16, v57
    v_and_b32 v111, 0xffff0000, v57
    v_lshlrev_b32 v112, 16, v58
    v_and_b32 v113, 0xffff0000, v58
    v_lshlrev_b32 v114, 16, v59
    v_and_b32 v115, 0xffff0000, v59
    v_lshlrev_b32 v116, 16, v60
    v_and_b32 v117, 0xffff0000, v60
    v_lshlrev_b32 v118, 16, v61
    v_and_b32 v119, 0xffff0000, v61
    v_lshlrev_b32 v120, 16, v62
    v_and_b32 v121, 0xffff0000, v62
    v_lshlrev_b32 v122, 16, v63
    v_and_b32 v123, 0xffff0000, v63
    v_lshlrev_b32 v124, 16, v64
    v_and_b32 v125, 0xffff0000, v64
    v_lshlrev_b32 v126, 16, v65
    v_and_b32 v127, 0xffff0000, v65
    v_lshlrev_b32 v128, 16, v66
    v_and_b32 v129, 0xffff0000, v66
    v_lshlrev_b32 v130, 16, v67
    v_and_b32 v131, 0xffff0000, v67
    v_lshlrev_b32 v132, 16, v68
    v_and_b32 v133, 0xffff0000, v68
    v_lshlrev_b32 v134, 16, v69
    v_and_b32 v135, 0xffff0000, v69
    v_lshlrev_b32 v136, 16, v70
    v_and_b32 v137, 0xffff0000, v70
    v_lshlrev_b32 v138, 16, v71
    v_and_b32 v139, 0xffff0000, v71
    v_lshlrev_b32 v140, 16, v72
    v_and_b32 v141, 0xffff0000, v72
    v_lshlrev_b32 v142, 16, v73
    v_and_b32 v143, 0xffff0000, v73
    v_lshlrev_b32 v144, 16, v74
    v_and_b32 v145, 0xffff0000, v74
    v_lshlrev_b32 v146, 16, v75
    v_and_b32 v147, 0xffff0000, v75
    v_lshlrev_b32 v148, 16, v76
    v_and_b32 v149, 0xffff0000, v76
    v_lshlrev_b32 v150, 16, v77
    v_and_b32 v151, 0xffff0000, v77
    v_lshlrev_b32 v152, 16, v78
    v_and_b32 v153, 0xffff0000, v78
    v_lshlrev_b32 v154, 16, v79
    v_and_b32 v155, 0xffff0000, v79
    v_lshlrev_b32 v156, 16, v80
    v_and_b32 v157, 0xffff0000, v80
    v_lshlrev_b32 v158, 16, v81
    v_and_b32 v159, 0xffff0000, v81
    v_lshlrev_b32 v160, 16, v82
    v_and_b32 v161, 0xffff0000, v82
    v_lshlrev_b32 v162, 16, v83
    v_and_b32 v163, 0xffff0000, v83
    v_lshlrev_b32 v164, 16, v84
    v_and_b32 v165, 0xffff0000, v84
    v_lshlrev_b32 v166, 16, v85
    v_and_b32 v167, 0xffff0000, v85
    v_lshlrev_b32 v168, 16, v86
    v_and_b32 v169, 0xffff0000, v86
    v_lshlrev_b32 v170, 16, v87
    v_and_b32 v171, 0xffff0000, v87
    v_add_f32 v90, v100, v101
    v_add_f32 v91, v102, v103
    v_add_f32 v90, v90, v104
    v_add_f32 v91, v91, v105
    v_add_f32 v90, v90, v106
    v_add_f32 v91, v91, v107
    v_add_f32 v90, v90, v108
    v_add_f32 v91, v91, v109
    v_add_f32 v90, v90, v110
    v_add_f32 v91, v91, v111
    v_add_f32 v90, v90, v112
    v_add_f32 v91, v91, v113
    v_add_f32 v90, v90, v114
    v_add_f32 v91, v91, v115
    v_add_f32 v90, v90, v116
    v_add_f32 v91, v91, v117
    v_add_f32 v90, v90, v118
    v_add_f32 v91, v91, v119
    v_add_f32 v90, v90, v120
    v_add_f32 v91, v91, v121
    v_add_f32 v90, v90, v122
    v_add_f32 v91, v91, v123
    v_add_f32 v90, v90, v124
    v_add_f32 v91, v91, v125
    v_add_f32 v90, v90, v126
    v_add_f32 v91, v91, v127
    v_add_f32 v90, v90, v128
    v_add_f32 v91, v91, v129
    v_add_f32 v90, v90, v130
    v_add_f32 v91, v91, v131
    v_add_f32 v90, v90, v132
    v_add_f32 v91, v91, v133
    v_add_f32 v90, v90, v134
    v_add_f32 v91, v91, v135
    v_add_f32 v90, v90, v136
    v_add_f32 v91, v91, v137
    v_add_f32 v90, v90, v138
    v_add_f32 v91, v91, v139
    v_add_f32 v90, v90, v140
    v_add_f32 v91, v91, v141
    v_add_f32 v90, v90, v142
    v_add_f32 v91, v91, v143
    v_add_f32 v90, v90, v144
    v_add_f32 v91, v91, v145
    v_add_f32 v90, v90, v146
    v_add_f32 v91, v91, v147
    v_add_f32 v90, v90, v148
    v_add_f32 v91, v91, v149
    v_add_f32 v90, v90, v150
    v_add_f32 v91, v91, v151
    v_add_f32 v90, v90, v152
    v_add_f32 v91, v91, v153
    v_add_f32 v90, v90, v154
    v_add_f32 v91, v91, v155
    v_add_f32 v90, v90, v156
    v_add_f32 v91, v91, v157
    v_add_f32 v90, v90, v158
    v_add_f32 v91, v91, v159
    v_add_f32 v90, v90, v160
    v_add_f32 v91, v91, v161
    v_add_f32 v90, v90, v162
    v_add_f32 v91, v91, v163
    v_add_f32 v90, v90, v164
    v_add_f32 v91, v91, v165
    v_add_f32 v90, v90, v166
    v_add_f32 v91, v91, v167
    v_add_f32 v90, v90, v168
    v_add_f32 v91, v91, v169
    v_add_f32 v90, v90, v170
    v_add_f32 v91, v91, v171
    v_add_f32 v90, v90, v91
    s_nop 1
    v_add_f32_dpp v90, v90, v90 quad_perm:[1,0,3,2] row_mask:0xf bank_mask:0xf
    s_nop 1
    v_add_f32_dpp v90, v90, v90 quad_perm:[2,3,0,1] row_mask:0xf bank_mask:0xf
    s_nop 1
    v_add_f32_dpp v90, v90, v90 row_half_mirror row_mask:0xf bank_mask:0xf
    v_mul_f32 v90, 0x3ae38e39, v90
    v_sub_f32 v92, v100, v90
    v_mul_f32 v91, v92, v92
    v_sub_f32 v92, v101, v90
    v_fmac_f32 v91, v92, v92
    v_sub_f32 v92, v102, v90
    v_fmac_f32 v91, v92, v92
    v_sub_f32 v92, v103, v90
    v_fmac_f32 v91, v92, v92
    v_sub_f32 v92, v104, v90
    v_fmac_f32 v91, v92, v92
    v_sub_f32 v92, v105, v90
    v_fmac_f32 v91, v92, v92
    v_sub_f32 v92, v106, v90
    v_fmac_f32 v91, v92, v92
    v_sub_f32 v92, v107, v90
    v_fmac_f32 v91, v92, v92
    v_sub_f32 v92, v108, v90
    v_fmac_f32 v91, v92, v92
    v_sub_f32 v92, v109, v90
    v_fmac_f32 v91, v92, v92
    v_sub_f32 v92, v110, v90
    v_fmac_f32 v91, v92, v92
    v_sub_f32 v92, v111, v90
    v_fmac_f32 v91, v92, v92
    v_sub_f32 v92, v112, v90
    v_fmac_f32 v91, v92, v92
    v_sub_f32 v92, v113, v90
    v_fmac_f32 v91, v92, v92
    v_sub_f32 v92, v114, v90
    v_fmac_f32 v91, v92, v92
    v_sub_f32 v92, v115, v90
    v_fmac_f32 v91, v92, v92
    v_sub_f32 v92, v116, v90
    v_fmac_f32 v91, v92, v92
    v_sub_f32 v92, v117, v90
    v_fmac_f32 v91, v92, v92
    v_sub_f32 v92, v118, v90
    v_fmac_f32 v91, v92, v92
    v_sub_f32 v92, v119, v90
    v_fmac_f32 v91, v92, v92
    v_sub_f32 v92, v120, v90
    v_fmac_f32 v91, v92, v92
    v_sub_f32 v92, v121, v90
    v_fmac_f32 v91, v92, v92
    v_sub_f32 v92, v122, v90
    v_fmac_f32 v91, v92, v92
    v_sub_f32 v92, v123, v90
    v_fmac_f32 v91, v92, v92
    v_sub_f32 v92, v124, v90
    v_fmac_f32 v91, v92, v92
    v_sub_f32 v92, v125, v90
    v_fmac_f32 v91, v92, v92
    v_sub_f32 v92, v126, v90
    v_fmac_f32 v91, v92, v92
    v_sub_f32 v92, v127, v90
    v_fmac_f32 v91, v92, v92
    v_sub_f32 v92, v128, v90
    v_fmac_f32 v91, v92, v92
    v_sub_f32 v92, v129, v90
    v_fmac_f32 v91, v92, v92
    v_sub_f32 v92, v130, v90
    v_fmac_f32 v91, v92, v92
    v_sub_f32 v92, v131, v90
    v_fmac_f32 v91, v92, v92
    v_sub_f32 v92, v132, v90
    v_fmac_f32 v91, v92, v92
    v_sub_f32 v92, v133, v90
    v_fmac_f32 v91, v92, v92
    v_sub_f32 v92, v134, v90
    v_fmac_f32 v91, v92, v92
    v_sub_f32 v92, v135, v90
    v_fmac_f32 v91, v92, v92
    v_sub_f32 v92, v136, v90
    v_fmac_f32 v91, v92, v92
    v_sub_f32 v92, v137, v90
    v_fmac_f32 v91, v92, v92
    v_sub_f32 v92, v138, v90
    v_fmac_f32 v91, v92, v92
    v_sub_f32 v92, v139, v90
    v_fmac_f32 v91, v92, v92
    v_sub_f32 v92, v140, v90
    v_fmac_f32 v91, v92, v92
    v_sub_f32 v92, v141, v90
    v_fmac_f32 v91, v92, v92
    v_sub_f32 v92, v142, v90
    v_fmac_f32 v91, v92, v92
    v_sub_f32 v92, v143, v90
    v_fmac_f32 v91, v92, v92
    v_sub_f32 v92, v144, v90
    v_fmac_f32 v91, v92, v92
    v_sub_f32 v92, v145, v90
    v_fmac_f32 v91, v92, v92
    v_sub_f32 v92, v146, v90
    v_fmac_f32 v91, v92, v92
    v_sub_f32 v92, v147, v90
    v_fmac_f32 v91, v92, v92
    v_sub_f32 v92, v148, v90
    v_fmac_f32 v91, v92, v92
    v_sub_f32 v92, v149, v90
    v_fmac_f32 v91, v92, v92
    v_sub_f32 v92, v150, v90
    v_fmac_f32 v91, v92, v92
    v_sub_f32 v92, v151, v90
    v_fmac_f32 v91, v92, v92
    v_sub_f32 v92, v152, v90
    v_fmac_f32 v91, v92, v92
    v_sub_f32 v92, v153, v90
    v_fmac_f32 v91, v92, v92
    v_sub_f32 v92, v154, v90
    v_fmac_f32 v91, v92, v92
    v_sub_f32 v92, v155, v90
    v_fmac_f32 v91, v92, v92
    v_sub_f32 v92, v156, v90
    v_fmac_f32 v91, v92, v92
    v_sub_f32 v92, v157, v90
    v_fmac_f32 v91, v92, v92
    v_sub_f32 v92, v158, v90
    v_fmac_f32 v91, v92, v92
    v_sub_f32 v92, v159, v90
    v_fmac_f32 v91, v92, v92
    v_sub_f32 v92, v160, v90
    v_fmac_f32 v91, v92, v92
    v_sub_f32 v92, v161, v90
    v_fmac_f32 v91, v92, v92
    v_sub_f32 v92, v162, v90
    v_fmac_f32 v91, v92, v92
    v_sub_f32 v92, v163, v90
    v_fmac_f32 v91, v92, v92
    v_sub_f32 v92, v164, v90
    v_fmac_f32 v91, v92, v92
    v_sub_f32 v92, v165, v90
    v_fmac_f32 v91, v92, v92
    v_sub_f32 v92, v166, v90
    v_fmac_f32 v91, v92, v92
    v_sub_f32 v92, v167, v90
    v_fmac_f32 v91, v92, v92
    v_sub_f32 v92, v168, v90
    v_fmac_f32 v91, v92, v92
    v_sub_f32 v92, v169, v90
    v_fmac_f32 v91, v92, v92
    v_sub_f32 v92, v170, v90
    v_fmac_f32 v91, v92, v92
    v_sub_f32 v92, v171, v90
    v_fmac_f32 v91, v92, v92
    s_nop 1
    v_add_f32_dpp v91, v91, v91 quad_perm:[1,0,3,2] row_mask:0xf bank_mask:0xf
    s_nop 1
    v_add_f32_dpp v91, v91, v91 quad_perm:[2,3,0,1] row_mask:0xf bank_mask:0xf
    s_nop 1
    v_add_f32_dpp v91, v91, v91 row_half_mirror row_mask:0xf bank_mask:0xf
    v_mul_f32 v91, 0x3ae38e39, v91
    v_cvt_pk_bf16_f32 v92, v90, v91
    v_lshlrev_b32 v90, 16, v92
    v_and_b32 v91, 0xffff0000, v92
    v_add_f32 v91, 0x3727c5ac, v91
    v_cvt_pk_bf16_f32 v91, v91, v91
    v_lshlrev_b32 v91, 16, v91
    v_sqrt_f32 v91, v91
    s_nop 0
    v_cvt_pk_bf16_f32 v91, v91, v91
    v_lshlrev_b32 v91, 16, v91
    v_rcp_f32 v91, v91
    s_nop 0
    v_sub_f32 v100, v100, v90
    v_sub_f32 v101, v101, v90
    v_cvt_pk_bf16_f32 v52, v100, v101
    v_lshlrev_b32 v100, 16, v52
    v_and_b32 v101, 0xffff0000, v52
    v_mul_f32 v100, v100, v91
    v_mul_f32 v101, v101, v91
    v_cvt_pk_bf16_f32 v52, v100, v101
    v_sub_f32 v102, v102, v90
    v_sub_f32 v103, v103, v90
    v_cvt_pk_bf16_f32 v53, v102, v103
    v_lshlrev_b32 v102, 16, v53
    v_and_b32 v103, 0xffff0000, v53
    v_mul_f32 v102, v102, v91
    v_mul_f32 v103, v103, v91
    v_cvt_pk_bf16_f32 v53, v102, v103
    v_sub_f32 v104, v104, v90
    v_sub_f32 v105, v105, v90
    v_cvt_pk_bf16_f32 v54, v104, v105
    v_lshlrev_b32 v104, 16, v54
    v_and_b32 v105, 0xffff0000, v54
    v_mul_f32 v104, v104, v91
    v_mul_f32 v105, v105, v91
    v_cvt_pk_bf16_f32 v54, v104, v105
    v_sub_f32 v106, v106, v90
    v_sub_f32 v107, v107, v90
    v_cvt_pk_bf16_f32 v55, v106, v107
    v_lshlrev_b32 v106, 16, v55
    v_and_b32 v107, 0xffff0000, v55
    v_mul_f32 v106, v106, v91
    v_mul_f32 v107, v107, v91
    v_cvt_pk_bf16_f32 v55, v106, v107
    v_sub_f32 v108, v108, v90
    v_sub_f32 v109, v109, v90
    v_cvt_pk_bf16_f32 v56, v108, v109
    v_lshlrev_b32 v108, 16, v56
    v_and_b32 v109, 0xffff0000, v56
    v_mul_f32 v108, v108, v91
    v_mul_f32 v109, v109, v91
    v_cvt_pk_bf16_f32 v56, v108, v109
    v_sub_f32 v110, v110, v90
    v_sub_f32 v111, v111, v90
    v_cvt_pk_bf16_f32 v57, v110, v111
    v_lshlrev_b32 v110, 16, v57
    v_and_b32 v111, 0xffff0000, v57
    v_mul_f32 v110, v110, v91
    v_mul_f32 v111, v111, v91
    v_cvt_pk_bf16_f32 v57, v110, v111
    v_sub_f32 v112, v112, v90
    v_sub_f32 v113, v113, v90
    v_cvt_pk_bf16_f32 v58, v112, v113
    v_lshlrev_b32 v112, 16, v58
    v_and_b32 v113, 0xffff0000, v58
    v_mul_f32 v112, v112, v91
    v_mul_f32 v113, v113, v91
    v_cvt_pk_bf16_f32 v58, v112, v113
    v_sub_f32 v114, v114, v90
    v_sub_f32 v115, v115, v90
    v_cvt_pk_bf16_f32 v59, v114, v115
    v_lshlrev_b32 v114, 16, v59
    v_and_b32 v115, 0xffff0000, v59
    v_mul_f32 v114, v114, v91
    v_mul_f32 v115, v115, v91
    v_cvt_pk_bf16_f32 v59, v114, v115
    v_sub_f32 v116, v116, v90
    v_sub_f32 v117, v117, v90
    v_cvt_pk_bf16_f32 v60, v116, v117
    v_lshlrev_b32 v116, 16, v60
    v_and_b32 v117, 0xffff0000, v60
    v_mul_f32 v116, v116, v91
    v_mul_f32 v117, v117, v91
    v_cvt_pk_bf16_f32 v60, v116, v117
    v_sub_f32 v118, v118, v90
    v_sub_f32 v119, v119, v90
    v_cvt_pk_bf16_f32 v61, v118, v119
    v_lshlrev_b32 v118, 16, v61
    v_and_b32 v119, 0xffff0000, v61
    v_mul_f32 v118, v118, v91
    v_mul_f32 v119, v119, v91
    v_cvt_pk_bf16_f32 v61, v118, v119
    v_sub_f32 v120, v120, v90
    v_sub_f32 v121, v121, v90
    v_cvt_pk_bf16_f32 v62, v120, v121
    v_lshlrev_b32 v120, 16, v62
    v_and_b32 v121, 0xffff0000, v62
    v_mul_f32 v120, v120, v91
    v_mul_f32 v121, v121, v91
    v_cvt_pk_bf16_f32 v62, v120, v121
    v_sub_f32 v122, v122, v90
    v_sub_f32 v123, v123, v90
    v_cvt_pk_bf16_f32 v63, v122, v123
    v_lshlrev_b32 v122, 16, v63
    v_and_b32 v123, 0xffff0000, v63
    v_mul_f32 v122, v122, v91
    v_mul_f32 v123, v123, v91
    v_cvt_pk_bf16_f32 v63, v122, v123
    v_sub_f32 v124, v124, v90
    v_sub_f32 v125, v125, v90
    v_cvt_pk_bf16_f32 v64, v124, v125
    v_lshlrev_b32 v124, 16, v64
    v_and_b32 v125, 0xffff0000, v64
    v_mul_f32 v124, v124, v91
    v_mul_f32 v125, v125, v91
    v_cvt_pk_bf16_f32 v64, v124, v125
    v_sub_f32 v126, v126, v90
    v_sub_f32 v127, v127, v90
    v_cvt_pk_bf16_f32 v65, v126, v127
    v_lshlrev_b32 v126, 16, v65
    v_and_b32 v127, 0xffff0000, v65
    v_mul_f32 v126, v126, v91
    v_mul_f32 v127, v127, v91
    v_cvt_pk_bf16_f32 v65, v126, v127
    v_sub_f32 v128, v128, v90
    v_sub_f32 v129, v129, v90
    v_cvt_pk_bf16_f32 v66, v128, v129
    v_lshlrev_b32 v128, 16, v66
    v_and_b32 v129, 0xffff0000, v66
    v_mul_f32 v128, v128, v91
    v_mul_f32 v129, v129, v91
    v_cvt_pk_bf16_f32 v66, v128, v129
    v_sub_f32 v130, v130, v90
    v_sub_f32 v131, v131, v90
    v_cvt_pk_bf16_f32 v67, v130, v131
    v_lshlrev_b32 v130, 16, v67
    v_and_b32 v131, 0xffff0000, v67
    v_mul_f32 v130, v130, v91
    v_mul_f32 v131, v131, v91
    v_cvt_pk_bf16_f32 v67, v130, v131
    v_sub_f32 v132, v132, v90
    v_sub_f32 v133, v133, v90
    v_cvt_pk_bf16_f32 v68, v132, v133
    v_lshlrev_b32 v132, 16, v68
    v_and_b32 v133, 0xffff0000, v68
    v_mul_f32 v132, v132, v91
    v_mul_f32 v133, v133, v91
    v_cvt_pk_bf16_f32 v68, v132, v133
    v_sub_f32 v134, v134, v90
    v_sub_f32 v135, v135, v90
    v_cvt_pk_bf16_f32 v69, v134, v135
    v_lshlrev_b32 v134, 16, v69
    v_and_b32 v135, 0xffff0000, v69
    v_mul_f32 v134, v134, v91
    v_mul_f32 v135, v135, v91
    v_cvt_pk_bf16_f32 v69, v134, v135
    v_sub_f32 v136, v136, v90
    v_sub_f32 v137, v137, v90
    v_cvt_pk_bf16_f32 v70, v136, v137
    v_lshlrev_b32 v136, 16, v70
    v_and_b32 v137, 0xffff0000, v70
    v_mul_f32 v136, v136, v91
    v_mul_f32 v137, v137, v91
    v_cvt_pk_bf16_f32 v70, v136, v137
    v_sub_f32 v138, v138, v90
    v_sub_f32 v139, v139, v90
    v_cvt_pk_bf16_f32 v71, v138, v139
    v_lshlrev_b32 v138, 16, v71
    v_and_b32 v139, 0xffff0000, v71
    v_mul_f32 v138, v138, v91
    v_mul_f32 v139, v139, v91
    v_cvt_pk_bf16_f32 v71, v138, v139
    v_sub_f32 v140, v140, v90
    v_sub_f32 v141, v141, v90
    v_cvt_pk_bf16_f32 v72, v140, v141
    v_lshlrev_b32 v140, 16, v72
    v_and_b32 v141, 0xffff0000, v72
    v_mul_f32 v140, v140, v91
    v_mul_f32 v141, v141, v91
    v_cvt_pk_bf16_f32 v72, v140, v141
    v_sub_f32 v142, v142, v90
    v_sub_f32 v143, v143, v90
    v_cvt_pk_bf16_f32 v73, v142, v143
    v_lshlrev_b32 v142, 16, v73
    v_and_b32 v143, 0xffff0000, v73
    v_mul_f32 v142, v142, v91
    v_mul_f32 v143, v143, v91
    v_cvt_pk_bf16_f32 v73, v142, v143
    v_sub_f32 v144, v144, v90
    v_sub_f32 v145, v145, v90
    v_cvt_pk_bf16_f32 v74, v144, v145
    v_lshlrev_b32 v144, 16, v74
    v_and_b32 v145, 0xffff0000, v74
    v_mul_f32 v144, v144, v91
    v_mul_f32 v145, v145, v91
    v_cvt_pk_bf16_f32 v74, v144, v145
    v_sub_f32 v146, v146, v90
    v_sub_f32 v147, v147, v90
    v_cvt_pk_bf16_f32 v75, v146, v147
    v_lshlrev_b32 v146, 16, v75
    v_and_b32 v147, 0xffff0000, v75
    v_mul_f32 v146, v146, v91
    v_mul_f32 v147, v147, v91
    v_cvt_pk_bf16_f32 v75, v146, v147
    v_sub_f32 v148, v148, v90
    v_sub_f32 v149, v149, v90
    v_cvt_pk_bf16_f32 v76, v148, v149
    v_lshlrev_b32 v148, 16, v76
    v_and_b32 v149, 0xffff0000, v76
    v_mul_f32 v148, v148, v91
    v_mul_f32 v149, v149, v91
    v_cvt_pk_bf16_f32 v76, v148, v149
    v_sub_f32 v150, v150, v90
    v_sub_f32 v151, v151, v90
    v_cvt_pk_bf16_f32 v77, v150, v151
    v_lshlrev_b32 v150, 16, v77
    v_and_b32 v151, 0xffff0000, v77
    v_mul_f32 v150, v150, v91
    v_mul_f32 v151, v151, v91
    v_cvt_pk_bf16_f32 v77, v150, v151
    v_sub_f32 v152, v152, v90
    v_sub_f32 v153, v153, v90
    v_cvt_pk_bf16_f32 v78, v152, v153
    v_lshlrev_b32 v152, 16, v78
    v_and_b32 v153, 0xffff0000, v78
    v_mul_f32 v152, v152, v91
    v_mul_f32 v153, v153, v91
    v_cvt_pk_bf16_f32 v78, v152, v153
    v_sub_f32 v154, v154, v90
    v_sub_f32 v155, v155, v90
    v_cvt_pk_bf16_f32 v79, v154, v155
    v_lshlrev_b32 v154, 16, v79
    v_and_b32 v155, 0xffff0000, v79
    v_mul_f32 v154, v154, v91
    v_mul_f32 v155, v155, v91
    v_cvt_pk_bf16_f32 v79, v154, v155
    v_sub_f32 v156, v156, v90
    v_sub_f32 v157, v157, v90
    v_cvt_pk_bf16_f32 v80, v156, v157
    v_lshlrev_b32 v156, 16, v80
    v_and_b32 v157, 0xffff0000, v80
    v_mul_f32 v156, v156, v91
    v_mul_f32 v157, v157, v91
    v_cvt_pk_bf16_f32 v80, v156, v157
    v_sub_f32 v158, v158, v90
    v_sub_f32 v159, v159, v90
    v_cvt_pk_bf16_f32 v81, v158, v159
    v_lshlrev_b32 v158, 16, v81
    v_and_b32 v159, 0xffff0000, v81
    v_mul_f32 v158, v158, v91
    v_mul_f32 v159, v159, v91
    v_cvt_pk_bf16_f32 v81, v158, v159
    v_sub_f32 v160, v160, v90
    v_sub_f32 v161, v161, v90
    v_cvt_pk_bf16_f32 v82, v160, v161
    v_lshlrev_b32 v160, 16, v82
    v_and_b32 v161, 0xffff0000, v82
    v_mul_f32 v160, v160, v91
    v_mul_f32 v161, v161, v91
    v_cvt_pk_bf16_f32 v82, v160, v161
    v_sub_f32 v162, v162, v90
    v_sub_f32 v163, v163, v90
    v_cvt_pk_bf16_f32 v83, v162, v163
    v_lshlrev_b32 v162, 16, v83
    v_and_b32 v163, 0xffff0000, v83
    v_mul_f32 v162, v162, v91
    v_mul_f32 v163, v163, v91
    v_cvt_pk_bf16_f32 v83, v162, v163
    v_sub_f32 v164, v164, v90
    v_sub_f32 v165, v165, v90
    v_cvt_pk_bf16_f32 v84, v164, v165
    v_lshlrev_b32 v164, 16, v84
    v_and_b32 v165, 0xffff0000, v84
    v_mul_f32 v164, v164, v91
    v_mul_f32 v165, v165, v91
    v_cvt_pk_bf16_f32 v84, v164, v165
    v_sub_f32 v166, v166, v90
    v_sub_f32 v167, v167, v90
    v_cvt_pk_bf16_f32 v85, v166, v167
    v_lshlrev_b32 v166, 16, v85
    v_and_b32 v167, 0xffff0000, v85
    v_mul_f32 v166, v166, v91
    v_mul_f32 v167, v167, v91
    v_cvt_pk_bf16_f32 v85, v166, v167
    v_sub_f32 v168, v168, v90
    v_sub_f32 v169, v169, v90
    v_cvt_pk_bf16_f32 v86, v168, v169
    v_lshlrev_b32 v168, 16, v86
    v_and_b32 v169, 0xffff0000, v86
    v_mul_f32 v168, v168, v91
    v_mul_f32 v169, v169, v91
    v_cvt_pk_bf16_f32 v86, v168, v169
    v_sub_f32 v170, v170, v90
    v_sub_f32 v171, v171, v90
    v_cvt_pk_bf16_f32 v87, v170, v171
    v_lshlrev_b32 v170, 16, v87
    v_and_b32 v171, 0xffff0000, v87
    v_mul_f32 v170, v170, v91
    v_mul_f32 v171, v171, v91
    v_cvt_pk_bf16_f32 v87, v170, v171
    s_lshl_b32 s22, s3, 4
    s_add_u32 s22, s22, 8
    s_lshr_b32 s23, s22, 5
    s_mul_i32 s23, s23, 36864
    s_and_b32 s22, s22, 31
    v_lshrrev_b32 v7, 3, v1
    v_add_u32 v7, s22, v7
    v_lshlrev_b32 v7, 4, v7
    v_add_u32 v7, s23, v7
    v_and_b32 v6, 7, v1
    v_lshrrev_b32 v8, 1, v6
    v_lshl_add_u32 v7, v8, 10, v7
    v_and_b32 v8, 1, v6
    v_lshl_add_u32 v7, v8, 9, v7
    ds_write_b128 v7, v[52:55] offset:0
    ds_write_b128 v7, v[56:59] offset:4096
    ds_write_b128 v7, v[60:63] offset:8192
    ds_write_b128 v7, v[64:67] offset:12288
    ds_write_b128 v7, v[68:71] offset:16384
    ds_write_b128 v7, v[72:75] offset:20480
    ds_write_b128 v7, v[76:79] offset:24576
    ds_write_b128 v7, v[80:83] offset:28672
    ds_write_b128 v7, v[84:87] offset:32768
    s_waitcnt lgkmcnt(0)
    s_barrier
    v_mov_b32 v100, 0
    v_mov_b32 v101, 0
    v_mov_b32 v102, 0
    v_mov_b32 v103, 0
    v_mov_b32 v104, 0
    v_mov_b32 v105, 0
    v_mov_b32 v106, 0
    v_mov_b32 v107, 0
    v_mov_b32 v108, 0
    v_mov_b32 v109, 0
    v_mov_b32 v110, 0
    v_mov_b32 v111, 0
    v_mov_b32 v112, 0
    v_mov_b32 v113, 0
    v_mov_b32 v114, 0
    v_mov_b32 v115, 0
    v_mov_b32 v116, 0
    v_mov_b32 v117, 0
    v_mov_b32 v118, 0
    v_mov_b32 v119, 0
    v_mov_b32 v120, 0
    v_mov_b32 v121, 0
    v_mov_b32 v122, 0
    v_mov_b32 v123, 0
    v_mov_b32 v124, 0
    v_mov_b32 v125, 0
    v_mov_b32 v126, 0
    v_mov_b32 v127, 0
    v_mov_b32 v128, 0
    v_mov_b32 v129, 0
    v_mov_b32 v130, 0
    v_mov_b32 v131, 0
    v_mov_b32 v132, 0
    v_mov_b32 v133, 0
    v_mov_b32 v134, 0
    v_mov_b32 v135, 0
    v_mov_b32 v136, 0
    v_mov_b32 v137, 0
    v_mov_b32 v138, 0
    v_mov_b32 v139, 0
    v_mov_b32 v140, 0
    v_mov_b32 v141, 0
    v_mov_b32 v142, 0
    v_mov_b32 v143, 0
    v_mov_b32 v144, 0
    v_mov_b32 v145, 0
    v_mov_b32 v146, 0
    v_mov_b32 v147, 0
    v_mov_b32 v148, 0
    v_mov_b32 v149, 0
    v_mov_b32 v150, 0
    v_mov_b32 v151, 0
    v_mov_b32 v152, 0
    v_mov_b32 v153, 0
    v_mov_b32 v154, 0
    v_mov_b32 v155, 0
    v_mov_b32 v156, 0
    v_mov_b32 v157, 0
    v_mov_b32 v158, 0
    v_mov_b32 v159, 0
    v_mov_b32 v160, 0
    v_mov_b32 v161, 0
    v_mov_b32 v162, 0
    v_mov_b32 v163, 0
    v_mov_b32 v164, 0
    v_mov_b32 v165, 0
    v_mov_b32 v166, 0
    v_mov_b32 v167, 0
    v_mov_b32 v168, 0
    v_mov_b32 v169, 0
    v_mov_b32 v170, 0
    v_mov_b32 v171, 0
    v_mov_b32 v172, 0
    v_mov_b32 v173, 0
    v_mov_b32 v174, 0
    v_mov_b32 v175, 0
    v_mov_b32 v176, 0
    v_mov_b32 v177, 0
    v_mov_b32 v178, 0
    v_mov_b32 v179, 0
    v_mov_b32 v180, 0
    v_mov_b32 v181, 0
    v_mov_b32 v182, 0
    v_mov_b32 v183, 0
    v_mov_b32 v184, 0
    v_mov_b32 v185, 0
    v_mov_b32 v186, 0
    v_mov_b32 v187, 0
    v_mov_b32 v188, 0
    v_mov_b32 v189, 0
    v_mov_b32 v190, 0
    v_mov_b32 v191, 0
    v_mov_b32 v192, 0
    v_mov_b32 v193, 0
    v_mov_b32 v194, 0
    v_mov_b32 v195, 0
    v_add_u32 v5, 36864, v4
    buffer_load_dwordx4 v[16:19], v4, s[12:15], s19 offen
    buffer_load_dwordx4 v[20:23], v4, s[12:15], s20 offen
    buffer_load_dwordx4 v[24:27], v4, s[12:15], s21 offen
    s_add_u32 s19, s19, 1024
    s_add_u32 s20, s20, 1024
    s_add_u32 s21, s21, 1024
    buffer_load_dwordx4 v[28:31], v4, s[12:15], s19 offen
    buffer_load_dwordx4 v[32:35], v4, s[12:15], s20 offen
    buffer_load_dwordx4 v[36:39], v4, s[12:15], s21 offen
    s_add_u32 s19, s19, 1024
    s_add_u32 s20, s20, 1024
    s_add_u32 s21, s21, 1024
    buffer_load_dwordx4 v[40:43], v4, s[12:15], s19 offen
    buffer_load_dwordx4 v[44:47], v4, s[12:15], s20 offen
    buffer_load_dwordx4 v[48:51], v4, s[12:15], s21 offen
    s_add_u32 s19, s19, 1024
    s_add_u32 s20, s20, 1024
    s_add_u32 s21, s21, 1024
    ds_read_b128 v[64:67], v4 offset:0
    ds_read_b128 v[68:71], v5 offset:0
    buffer_load_dwordx4 v[52:55], v4, s[12:15], s19 offen
    buffer_load_dwordx4 v[56:59], v4, s[12:15], s20 offen
    buffer_load_dwordx4 v[60:63], v4, s[12:15], s21 offen
    s_add_u32 s19, s19, 1024
    s_add_u32 s20, s20, 1024
    s_add_u32 s21, s21, 1024
    ds_read_b128 v[72:75], v4 offset:1024
    ds_read_b128 v[76:79], v5 offset:1024
    s_waitcnt vmcnt(9) lgkmcnt(2)
    v_mfma_f32_32x32x16_bf16 v[100:115], v[16:19], v[64:67], v[100:115]
    v_mfma_f32_32x32x16_bf16 v[132:147], v[20:23], v[64:67], v[132:147]
    v_mfma_f32_32x32x16_bf16 v[164:179], v[64:67], v[24:27], v[164:179]
    v_mfma_f32_32x32x16_bf16 v[116:131], v[16:19], v[68:71], v[116:131]
    v_mfma_f32_32x32x16_bf16 v[148:163], v[20:23], v[68:71], v[148:163]
    v_mfma_f32_32x32x16_bf16 v[180:195], v[68:71], v[24:27], v[180:195]
    buffer_load_dwordx4 v[16:19], v4, s[12:15], s19 offen
    buffer_load_dwordx4 v[20:23], v4, s[12:15], s20 offen
    buffer_load_dwordx4 v[24:27], v4, s[12:15], s21 offen
    s_add_u32 s19, s19, 1024
    s_add_u32 s20, s20, 1024
    s_add_u32 s21, s21, 1024
    ds_read_b128 v[80:83], v4 offset:2048
    ds_read_b128 v[84:87], v5 offset:2048
    s_waitcnt vmcnt(9) lgkmcnt(2)
    v_mfma_f32_32x32x16_bf16 v[100:115], v[28:31], v[72:75], v[100:115]
    v_mfma_f32_32x32x16_bf16 v[132:147], v[32:35], v[72:75], v[132:147]
    v_mfma_f32_32x32x16_bf16 v[164:179], v[72:75], v[36:39], v[164:179]
    v_mfma_f32_32x32x16_bf16 v[116:131], v[28:31], v[76:79], v[116:131]
    v_mfma_f32_32x32x16_bf16 v[148:163], v[32:35], v[76:79], v[148:163]
    v_mfma_f32_32x32x16_bf16 v[180:195], v[76:79], v[36:39], v[180:195]
    buffer_load_dwordx4 v[28:31], v4, s[12:15], s19 offen
    buffer_load_dwordx4 v[32:35], v4, s[12:15], s20 offen
    buffer_load_dwordx4 v[36:39], v4, s[12:15], s21 offen
    s_add_u32 s19, s19, 1024
    s_add_u32 s20, s20, 1024
    s_add_u32 s21, s21, 1024
    ds_read_b128 v[64:67], v4 offset:3072
    ds_read_b128 v[68:71], v5 offset:3072
    s_waitcnt vmcnt(9) lgkmcnt(2)
    v_mfma_f32_32x32x16_bf16 v[100:115], v[40:43], v[80:83], v[100:115]
    v_mfma_f32_32x32x16_bf16 v[132:147], v[44:47], v[80:83], v[132:147]
    v_mfma_f32_32x32x16_bf16 v[164:179], v[80:83], v[48:51], v[164:179]
    v_mfma_f32_32x32x16_bf16 v[116:131], v[40:43], v[84:87], v[116:131]
    v_mfma_f32_32x32x16_bf16 v[148:163], v[44:47], v[84:87], v[148:163]
    v_mfma_f32_32x32x16_bf16 v[180:195], v[84:87], v[48:51], v[180:195]
    buffer_load_dwordx4 v[40:43], v4, s[12:15], s19 offen
    buffer_load_dwordx4 v[44:47], v4, s[12:15], s20 offen
    buffer_load_dwordx4 v[48:51], v4, s[12:15], s21 offen
    s_add_u32 s19, s19, 1024
    s_add_u32 s20, s20, 1024
    s_add_u32 s21, s21, 1024
    ds_read_b128 v[72:75], v4 offset:4096
    ds_read_b128 v[76:79], v5 offset:4096
    s_waitcnt vmcnt(9) lgkmcnt(2)
    v_mfma_f32_32x32x16_bf16 v[100:115], v[52:55], v[64:67], v[100:115]
    v_mfma_f32_32x32x16_bf16 v[132:147], v[56:59], v[64:67], v[132:147]
    v_mfma_f32_32x32x16_bf16 v[164:179], v[64:67], v[60:63], v[164:179]
    v_mfma_f32_32x32x16_bf16 v[116:131], v[52:55], v[68:71], v[116:131]
    v_mfma_f32_32x32x16_bf16 v[148:163], v[56:59], v[68:71], v[148:163]
    v_mfma_f32_32x32x16_bf16 v[180:195], v[68:71], v[60:63], v[180:195]
    buffer_load_dwordx4 v[52:55], v4, s[12:15], s19 offen
    buffer_load_dwordx4 v[56:59], v4, s[12:15], s20 offen
    buffer_load_dwordx4 v[60:63], v4, s[12:15], s21 offen
    s_add_u32 s19, s19, 1024
    s_add_u32 s20, s20, 1024
    s_add_u32 s21, s21, 1024
    ds_read_b128 v[80:83], v4 offset:5120
    ds_read_b128 v[84:87], v5 offset:5120
    s_waitcnt vmcnt(9) lgkmcnt(2)
    v_mfma_f32_32x32x16_bf16 v[100:115], v[16:19], v[72:75], v[100:115]
    v_mfma_f32_32x32x16_bf16 v[132:147], v[20:23], v[72:75], v[132:147]
    v_mfma_f32_32x32x16_bf16 v[164:179], v[72:75], v[24:27], v[164:179]
    v_mfma_f32_32x32x16_bf16 v[116:131], v[16:19], v[76:79], v[116:131]
    v_mfma_f32_32x32x16_bf16 v[148:163], v[20:23], v[76:79], v[148:163]
    v_mfma_f32_32x32x16_bf16 v[180:195], v[76:79], v[24:27], v[180:195]
    buffer_load_dwordx4 v[16:19], v4, s[12:15], s19 offen
    buffer_load_dwordx4 v[20:23], v4, s[12:15], s20 offen
    buffer_load_dwordx4 v[24:27], v4, s[12:15], s21 offen
    s_add_u32 s19, s19, 1024
    s_add_u32 s20, s20, 1024
    s_add_u32 s21, s21, 1024
    ds_read_b128 v[64:67], v4 offset:6144
    ds_read_b128 v[68:71], v5 offset:6144
    s_waitcnt vmcnt(9) lgkmcnt(2)
    v_mfma_f32_32x32x16_bf16 v[100:115], v[28:31], v[80:83], v[100:115]
    v_mfma_f32_32x32x16_bf16 v[132:147], v[32:35], v[80:83], v[132:147]
    v_mfma_f32_32x32x16_bf16 v[164:179], v[80:83], v[36:39], v[164:179]
    v_mfma_f32_32x32x16_bf16 v[116:131], v[28:31], v[84:87], v[116:131]
    v_mfma_f32_32x32x16_bf16 v[148:163], v[32:35], v[84:87], v[148:163]
    v_mfma_f32_32x32x16_bf16 v[180:195], v[84:87], v[36:39], v[180:195]
    buffer_load_dwordx4 v[28:31], v4, s[12:15], s19 offen
    buffer_load_dwordx4 v[32:35], v4, s[12:15], s20 offen
    buffer_load_dwordx4 v[36:39], v4, s[12:15], s21 offen
    s_add_u32 s19, s19, 1024
    s_add_u32 s20, s20, 1024
    s_add_u32 s21, s21, 1024
    ds_read_b128 v[72:75], v4 offset:7168
    ds_read_b128 v[76:79], v5 offset:7168
    s_waitcnt vmcnt(9) lgkmcnt(2)
    v_mfma_f32_32x32x16_bf16 v[100:115], v[40:43], v[64:67], v[100:115]
    v_mfma_f32_32x32x16_bf16 v[132:147], v[44:47], v[64:67], v[132:147]
    v_mfma_f32_32x32x16_bf16 v[164:179], v[64:67], v[48:51], v[164:179]
    v_mfma_f32_32x32x16_bf16 v[116:131], v[40:43], v[68:71], v[116:131]
    v_mfma_f32_32x32x16_bf16 v[148:163], v[44:47], v[68:71], v[148:163]
    v_mfma_f32_32x32x16_bf16 v[180:195], v[68:71], v[48:51], v[180:195]
    buffer_load_dwordx4 v[40:43], v4, s[12:15], s19 offen
    buffer_load_dwordx4 v[44:47], v4, s[12:15], s20 offen
    buffer_load_dwordx4 v[48:51], v4, s[12:15], s21 offen
    s_add_u32 s19, s19, 1024
    s_add_u32 s20, s20, 1024
    s_add_u32 s21, s21, 1024
    ds_read_b128 v[80:83], v4 offset:8192
    ds_read_b128 v[84:87], v5 offset:8192
    s_waitcnt vmcnt(9) lgkmcnt(2)
    v_mfma_f32_32x32x16_bf16 v[100:115], v[52:55], v[72:75], v[100:115]
    v_mfma_f32_32x32x16_bf16 v[132:147], v[56:59], v[72:75], v[132:147]
    v_mfma_f32_32x32x16_bf16 v[164:179], v[72:75], v[60:63], v[164:179]
    v_mfma_f32_32x32x16_bf16 v[116:131], v[52:55], v[76:79], v[116:131]
    v_mfma_f32_32x32x16_bf16 v[148:163], v[56:59], v[76:79], v[148:163]
    v_mfma_f32_32x32x16_bf16 v[180:195], v[76:79], v[60:63], v[180:195]
    buffer_load_dwordx4 v[52:55], v4, s[12:15], s19 offen
    buffer_load_dwordx4 v[56:59], v4, s[12:15], s20 offen
    buffer_load_dwordx4 v[60:63], v4, s[12:15], s21 offen
    s_add_u32 s19, s19, 1024
    s_add_u32 s20, s20, 1024
    s_add_u32 s21, s21, 1024
    ds_read_b128 v[64:67], v4 offset:9216
    ds_read_b128 v[68:71], v5 offset:9216
    s_waitcnt vmcnt(9) lgkmcnt(2)
    v_mfma_f32_32x32x16_bf16 v[100:115], v[16:19], v[80:83], v[100:115]
    v_mfma_f32_32x32x16_bf16 v[132:147], v[20:23], v[80:83], v[132:147]
    v_mfma_f32_32x32x16_bf16 v[164:179], v[80:83], v[24:27], v[164:179]
    v_mfma_f32_32x32x16_bf16 v[116:131], v[16:19], v[84:87], v[116:131]
    v_mfma_f32_32x32x16_bf16 v[148:163], v[20:23], v[84:87], v[148:163]
    v_mfma_f32_32x32x16_bf16 v[180:195], v[84:87], v[24:27], v[180:195]
    buffer_load_dwordx4 v[16:19], v4, s[12:15], s19 offen
    buffer_load_dwordx4 v[20:23], v4, s[12:15], s20 offen
    buffer_load_dwordx4 v[24:27], v4, s[12:15], s21 offen
    s_add_u32 s19, s19, 1024
    s_add_u32 s20, s20, 1024
    s_add_u32 s21, s21, 1024
    ds_read_b128 v[72:75], v4 offset:10240
    ds_read_b128 v[76:79], v5 offset:10240
    s_waitcnt vmcnt(9) lgkmcnt(2)
    v_mfma_f32_32x32x16_bf16 v[100:115], v[28:31], v[64:67], v[100:115]
    v_mfma_f32_32x32x16_bf16 v[132:147], v[32:35], v[64:67], v[132:147]
    v_mfma_f32_32x32x16_bf16 v[164:179], v[64:67], v[36:39], v[164:179]
    v_mfma_f32_32x32x16_bf16 v[116:131], v[28:31], v[68:71], v[116:131]
    v_mfma_f32_32x32x16_bf16 v[148:163], v[32:35], v[68:71], v[148:163]
    v_mfma_f32_32x32x16_bf16 v[180:195], v[68:71], v[36:39], v[180:195]
    buffer_load_dwordx4 v[28:31], v4, s[12:15], s19 offen
    buffer_load_dwordx4 v[32:35], v4, s[12:15], s20 offen
    buffer_load_dwordx4 v[36:39], v4, s[12:15], s21 offen
    s_add_u32 s19, s19, 1024
    s_add_u32 s20, s20, 1024
    s_add_u32 s21, s21, 1024
    ds_read_b128 v[80:83], v4 offset:11264
    ds_read_b128 v[84:87], v5 offset:11264
    s_waitcnt vmcnt(9) lgkmcnt(2)
    v_mfma_f32_32x32x16_bf16 v[100:115], v[40:43], v[72:75], v[100:115]
    v_mfma_f32_32x32x16_bf16 v[132:147], v[44:47], v[72:75], v[132:147]
    v_mfma_f32_32x32x16_bf16 v[164:179], v[72:75], v[48:51], v[164:179]
    v_mfma_f32_32x32x16_bf16 v[116:131], v[40:43], v[76:79], v[116:131]
    v_mfma_f32_32x32x16_bf16 v[148:163], v[44:47], v[76:79], v[148:163]
    v_mfma_f32_32x32x16_bf16 v[180:195], v[76:79], v[48:51], v[180:195]
    buffer_load_dwordx4 v[40:43], v4, s[12:15], s19 offen
    buffer_load_dwordx4 v[44:47], v4, s[12:15], s20 offen
    buffer_load_dwordx4 v[48:51], v4, s[12:15], s21 offen
    s_add_u32 s19, s19, 1024
    s_add_u32 s20, s20, 1024
    s_add_u32 s21, s21, 1024
    ds_read_b128 v[64:67], v4 offset:12288
    ds_read_b128 v[68:71], v5 offset:12288
    s_waitcnt vmcnt(9) lgkmcnt(2)
    v_mfma_f32_32x32x16_bf16 v[100:115], v[52:55], v[80:83], v[100:115]
    v_mfma_f32_32x32x16_bf16 v[132:147], v[56:59], v[80:83], v[132:147]
    v_mfma_f32_32x32x16_bf16 v[164:179], v[80:83], v[60:63], v[164:179]
    v_mfma_f32_32x32x16_bf16 v[116:131], v[52:55], v[84:87], v[116:131]
    v_mfma_f32_32x32x16_bf16 v[148:163], v[56:59], v[84:87], v[148:163]
    v_mfma_f32_32x32x16_bf16 v[180:195], v[84:87], v[60:63], v[180:195]
    buffer_load_dwordx4 v[52:55], v4, s[12:15], s19 offen
    buffer_load_dwordx4 v[56:59], v4, s[12:15], s20 offen
    buffer_load_dwordx4 v[60:63], v4, s[12:15], s21 offen
    s_add_u32 s19, s19, 1024
    s_add_u32 s20, s20, 1024
    s_add_u32 s21, s21, 1024
    ds_read_b128 v[72:75], v4 offset:13312
    ds_read_b128 v[76:79], v5 offset:13312
    s_waitcnt vmcnt(9) lgkmcnt(2)
    v_mfma_f32_32x32x16_bf16 v[100:115], v[16:19], v[64:67], v[100:115]
    v_mfma_f32_32x32x16_bf16 v[132:147], v[20:23], v[64:67], v[132:147]
    v_mfma_f32_32x32x16_bf16 v[164:179], v[64:67], v[24:27], v[164:179]
    v_mfma_f32_32x32x16_bf16 v[116:131], v[16:19], v[68:71], v[116:131]
    v_mfma_f32_32x32x16_bf16 v[148:163], v[20:23], v[68:71], v[148:163]
    v_mfma_f32_32x32x16_bf16 v[180:195], v[68:71], v[24:27], v[180:195]
    buffer_load_dwordx4 v[16:19], v4, s[12:15], s19 offen
    buffer_load_dwordx4 v[20:23], v4, s[12:15], s20 offen
    buffer_load_dwordx4 v[24:27], v4, s[12:15], s21 offen
    s_add_u32 s19, s19, 1024
    s_add_u32 s20, s20, 1024
    s_add_u32 s21, s21, 1024
    ds_read_b128 v[80:83], v4 offset:14336
    ds_read_b128 v[84:87], v5 offset:14336
    s_waitcnt vmcnt(9) lgkmcnt(2)
    v_mfma_f32_32x32x16_bf16 v[100:115], v[28:31], v[72:75], v[100:115]
    v_mfma_f32_32x32x16_bf16 v[132:147], v[32:35], v[72:75], v[132:147]
    v_mfma_f32_32x32x16_bf16 v[164:179], v[72:75], v[36:39], v[164:179]
    v_mfma_f32_32x32x16_bf16 v[116:131], v[28:31], v[76:79], v[116:131]
    v_mfma_f32_32x32x16_bf16 v[148:163], v[32:35], v[76:79], v[148:163]
    v_mfma_f32_32x32x16_bf16 v[180:195], v[76:79], v[36:39], v[180:195]
    buffer_load_dwordx4 v[28:31], v4, s[12:15], s19 offen
    buffer_load_dwordx4 v[32:35], v4, s[12:15], s20 offen
    buffer_load_dwordx4 v[36:39], v4, s[12:15], s21 offen
    s_add_u32 s19, s19, 1024
    s_add_u32 s20, s20, 1024
    s_add_u32 s21, s21, 1024
    ds_read_b128 v[64:67], v4 offset:15360
    ds_read_b128 v[68:71], v5 offset:15360
    s_waitcnt vmcnt(9) lgkmcnt(2)
    v_mfma_f32_32x32x16_bf16 v[100:115], v[40:43], v[80:83], v[100:115]
    v_mfma_f32_32x32x16_bf16 v[132:147], v[44:47], v[80:83], v[132:147]
    v_mfma_f32_32x32x16_bf16 v[164:179], v[80:83], v[48:51], v[164:179]
    v_mfma_f32_32x32x16_bf16 v[116:131], v[40:43], v[84:87], v[116:131]
    v_mfma_f32_32x32x16_bf16 v[148:163], v[44:47], v[84:87], v[148:163]
    v_mfma_f32_32x32x16_bf16 v[180:195], v[84:87], v[48:51], v[180:195]
    buffer_load_dwordx4 v[40:43], v4, s[12:15], s19 offen
    buffer_load_dwordx4 v[44:47], v4, s[12:15], s20 offen
    buffer_load_dwordx4 v[48:51], v4, s[12:15], s21 offen
    s_add_u32 s19, s19, 1024
    s_add_u32 s20, s20, 1024
    s_add_u32 s21, s21, 1024
    ds_read_b128 v[72:75], v4 offset:16384
    ds_read_b128 v[76:79], v5 offset:16384
    s_waitcnt vmcnt(9) lgkmcnt(2)
    v_mfma_f32_32x32x16_bf16 v[100:115], v[52:55], v[64:67], v[100:115]
    v_mfma_f32_32x32x16_bf16 v[132:147], v[56:59], v[64:67], v[132:147]
    v_mfma_f32_32x32x16_bf16 v[164:179], v[64:67], v[60:63], v[164:179]
    v_mfma_f32_32x32x16_bf16 v[116:131], v[52:55], v[68:71], v[116:131]
    v_mfma_f32_32x32x16_bf16 v[148:163], v[56:59], v[68:71], v[148:163]
    v_mfma_f32_32x32x16_bf16 v[180:195], v[68:71], v[60:63], v[180:195]
    buffer_load_dwordx4 v[52:55], v4, s[12:15], s19 offen
    buffer_load_dwordx4 v[56:59], v4, s[12:15], s20 offen
    buffer_load_dwordx4 v[60:63], v4, s[12:15], s21 offen
    s_add_u32 s19, s19, 1024
    s_add_u32 s20, s20, 1024
    s_add_u32 s21, s21, 1024
    ds_read_b128 v[80:83], v4 offset:17408
    ds_read_b128 v[84:87], v5 offset:17408
    s_waitcnt vmcnt(9) lgkmcnt(2)
    v_mfma_f32_32x32x16_bf16 v[100:115], v[16:19], v[72:75], v[100:115]
    v_mfma_f32_32x32x16_bf16 v[132:147], v[20:23], v[72:75], v[132:147]
    v_mfma_f32_32x32x16_bf16 v[164:179], v[72:75], v[24:27], v[164:179]
    v_mfma_f32_32x32x16_bf16 v[116:131], v[16:19], v[76:79], v[116:131]
    v_mfma_f32_32x32x16_bf16 v[148:163], v[20:23], v[76:79], v[148:163]
    v_mfma_f32_32x32x16_bf16 v[180:195], v[76:79], v[24:27], v[180:195]
    buffer_load_dwordx4 v[16:19], v4, s[12:15], s19 offen
    buffer_load_dwordx4 v[20:23], v4, s[12:15], s20 offen
    buffer_load_dwordx4 v[24:27], v4, s[12:15], s21 offen
    s_add_u32 s19, s19, 1024
    s_add_u32 s20, s20, 1024
    s_add_u32 s21, s21, 1024
    ds_read_b128 v[64:67], v4 offset:18432
    ds_read_b128 v[68:71], v5 offset:18432
    s_waitcnt vmcnt(9) lgkmcnt(2)
    v_mfma_f32_32x32x16_bf16 v[100:115], v[28:31], v[80:83], v[100:115]
    v_mfma_f32_32x32x16_bf16 v[132:147], v[32:35], v[80:83], v[132:147]
    v_mfma_f32_32x32x16_bf16 v[164:179], v[80:83], v[36:39], v[164:179]
    v_mfma_f32_32x32x16_bf16 v[116:131], v[28:31], v[84:87], v[116:131]
    v_mfma_f32_32x32x16_bf16 v[148:163], v[32:35], v[84:87], v[148:163]
    v_mfma_f32_32x32x16_bf16 v[180:195], v[84:87], v[36:39], v[180:195]
    buffer_load_dwordx4 v[28:31], v4, s[12:15], s19 offen
    buffer_load_dwordx4 v[32:35], v4, s[12:15], s20 offen
    buffer_load_dwordx4 v[36:39], v4, s[12:15], s21 offen
    s_add_u32 s19, s19, 1024
    s_add_u32 s20, s20, 1024
    s_add_u32 s21, s21, 1024
    ds_read_b128 v[72:75], v4 offset:19456
    ds_read_b128 v[76:79], v5 offset:19456
    s_waitcnt vmcnt(9) lgkmcnt(2)
    v_mfma_f32_32x32x16_bf16 v[100:115], v[40:43], v[64:67], v[100:115]
    v_mfma_f32_32x32x16_bf16 v[132:147], v[44:47], v[64:67], v[132:147]
    v_mfma_f32_32x32x16_bf16 v[164:179], v[64:67], v[48:51], v[164:179]
    v_mfma_f32_32x32x16_bf16 v[116:131], v[40:43], v[68:71], v[116:131]
    v_mfma_f32_32x32x16_bf16 v[148:163], v[44:47], v[68:71], v[148:163]
    v_mfma_f32_32x32x16_bf16 v[180:195], v[68:71], v[48:51], v[180:195]
    buffer_load_dwordx4 v[40:43], v4, s[12:15], s19 offen
    buffer_load_dwordx4 v[44:47], v4, s[12:15], s20 offen
    buffer_load_dwordx4 v[48:51], v4, s[12:15], s21 offen
    s_add_u32 s19, s19, 1024
    s_add_u32 s20, s20, 1024
    s_add_u32 s21, s21, 1024
    ds_read_b128 v[80:83], v4 offset:20480
    ds_read_b128 v[84:87], v5 offset:20480
    s_waitcnt vmcnt(9) lgkmcnt(2)
    v_mfma_f32_32x32x16_bf16 v[100:115], v[52:55], v[72:75], v[100:115]
    v_mfma_f32_32x32x16_bf16 v[132:147], v[56:59], v[72:75], v[132:147]
    v_mfma_f32_32x32x16_bf16 v[164:179], v[72:75], v[60:63], v[164:179]
    v_mfma_f32_32x32x16_bf16 v[116:131], v[52:55], v[76:79], v[116:131]
    v_mfma_f32_32x32x16_bf16 v[148:163], v[56:59], v[76:79], v[148:163]
    v_mfma_f32_32x32x16_bf16 v[180:195], v[76:79], v[60:63], v[180:195]
    buffer_load_dwordx4 v[52:55], v4, s[12:15], s19 offen
    buffer_load_dwordx4 v[56:59], v4, s[12:15], s20 offen
    buffer_load_dwordx4 v[60:63], v4, s[12:15], s21 offen
    s_add_u32 s19, s19, 1024
    s_add_u32 s20, s20, 1024
    s_add_u32 s21, s21, 1024
    ds_read_b128 v[64:67], v4 offset:21504
    ds_read_b128 v[68:71], v5 offset:21504
    s_waitcnt vmcnt(9) lgkmcnt(2)
    v_mfma_f32_32x32x16_bf16 v[100:115], v[16:19], v[80:83], v[100:115]
    v_mfma_f32_32x32x16_bf16 v[132:147], v[20:23], v[80:83], v[132:147]
    v_mfma_f32_32x32x16_bf16 v[164:179], v[80:83], v[24:27], v[164:179]
    v_mfma_f32_32x32x16_bf16 v[116:131], v[16:19], v[84:87], v[116:131]
    v_mfma_f32_32x32x16_bf16 v[148:163], v[20:23], v[84:87], v[148:163]
    v_mfma_f32_32x32x16_bf16 v[180:195], v[84:87], v[24:27], v[180:195]
    buffer_load_dwordx4 v[16:19], v4, s[12:15], s19 offen
    buffer_load_dwordx4 v[20:23], v4, s[12:15], s20 offen
    buffer_load_dwordx4 v[24:27], v4, s[12:15], s21 offen
    s_add_u32 s19, s19, 1024
    s_add_u32 s20, s20, 1024
    s_add_u32 s21, s21, 1024
    ds_read_b128 v[72:75], v4 offset:22528
    ds_read_b128 v[76:79], v5 offset:22528
    s_waitcnt vmcnt(9) lgkmcnt(2)
    v_mfma_f32_32x32x16_bf16 v[100:115], v[28:31], v[64:67], v[100:115]
    v_mfma_f32_32x32x16_bf16 v[132:147], v[32:35], v[64:67], v[132:147]
    v_mfma_f32_32x32x16_bf16 v[164:179], v[64:67], v[36:39], v[164:179]
    v_mfma_f32_32x32x16_bf16 v[116:131], v[28:31], v[68:71], v[116:131]
    v_mfma_f32_32x32x16_bf16 v[148:163], v[32:35], v[68:71], v[148:163]
    v_mfma_f32_32x32x16_bf16 v[180:195], v[68:71], v[36:39], v[180:195]
    buffer_load_dwordx4 v[28:31], v4, s[12:15], s19 offen
    buffer_load_dwordx4 v[32:35], v4, s[12:15], s20 offen
    buffer_load_dwordx4 v[36:39], v4, s[12:15], s21 offen
    s_add_u32 s19, s19, 1024
    s_add_u32 s20, s20, 1024
    s_add_u32 s21, s21, 1024
    ds_read_b128 v[80:83], v4 offset:23552
    ds_read_b128 v[84:87], v5 offset:23552
    s_waitcnt vmcnt(9) lgkmcnt(2)
    v_mfma_f32_32x32x16_bf16 v[100:115], v[40:43], v[72:75], v[100:115]
    v_mfma_f32_32x32x16_bf16 v[132:147], v[44:47], v[72:75], v[132:147]
    v_mfma_f32_32x32x16_bf16 v[164:179], v[72:75], v[48:51], v[164:179]
    v_mfma_f32_32x32x16_bf16 v[116:131], v[40:43], v[76:79], v[116:131]
    v_mfma_f32_32x32x16_bf16 v[148:163], v[44:47], v[76:79], v[148:163]
    v_mfma_f32_32x32x16_bf16 v[180:195], v[76:79], v[48:51], v[180:195]
    buffer_load_dwordx4 v[40:43], v4, s[12:15], s19 offen
    buffer_load_dwordx4 v[44:47], v4, s[12:15], s20 offen
    buffer_load_dwordx4 v[48:51], v4, s[12:15], s21 offen
    s_add_u32 s19, s19, 1024
    s_add_u32 s20, s20, 1024
    s_add_u32 s21, s21, 1024
    ds_read_b128 v[64:67], v4 offset:24576
    ds_read_b128 v[68:71], v5 offset:24576
    s_waitcnt vmcnt(9) lgkmcnt(2)
    v_mfma_f32_32x32x16_bf16 v[100:115], v[52:55], v[80:83], v[100:115]
    v_mfma_f32_32x32x16_bf16 v[132:147], v[56:59], v[80:83], v[132:147]
    v_mfma_f32_32x32x16_bf16 v[164:179], v[80:83], v[60:63], v[164:179]
    v_mfma_f32_32x32x16_bf16 v[116:131], v[52:55], v[84:87], v[116:131]
    v_mfma_f32_32x32x16_bf16 v[148:163], v[56:59], v[84:87], v[148:163]
    v_mfma_f32_32x32x16_bf16 v[180:195], v[84:87], v[60:63], v[180:195]
    buffer_load_dwordx4 v[52:55], v4, s[12:15], s19 offen
    buffer_load_dwordx4 v[56:59], v4, s[12:15], s20 offen
    buffer_load_dwordx4 v[60:63], v4, s[12:15], s21 offen
    s_add_u32 s19, s19, 1024
    s_add_u32 s20, s20, 1024
    s_add_u32 s21, s21, 1024
    ds_read_b128 v[72:75], v4 offset:25600
    ds_read_b128 v[76:79], v5 offset:25600
    s_waitcnt vmcnt(9) lgkmcnt(2)
    v_mfma_f32_32x32x16_bf16 v[100:115], v[16:19], v[64:67], v[100:115]
    v_mfma_f32_32x32x16_bf16 v[132:147], v[20:23], v[64:67], v[132:147]
    v_mfma_f32_32x32x16_bf16 v[164:179], v[64:67], v[24:27], v[164:179]
    v_mfma_f32_32x32x16_bf16 v[116:131], v[16:19], v[68:71], v[116:131]
    v_mfma_f32_32x32x16_bf16 v[148:163], v[20:23], v[68:71], v[148:163]
    v_mfma_f32_32x32x16_bf16 v[180:195], v[68:71], v[24:27], v[180:195]
    buffer_load_dwordx4 v[16:19], v4, s[12:15], s19 offen
    buffer_load_dwordx4 v[20:23], v4, s[12:15], s20 offen
    buffer_load_dwordx4 v[24:27], v4, s[12:15], s21 offen
    s_add_u32 s19, s19, 1024
    s_add_u32 s20, s20, 1024
    s_add_u32 s21, s21, 1024
    ds_read_b128 v[80:83], v4 offset:26624
    ds_read_b128 v[84:87], v5 offset:26624
    s_waitcnt vmcnt(9) lgkmcnt(2)
    v_mfma_f32_32x32x16_bf16 v[100:115], v[28:31], v[72:75], v[100:115]
    v_mfma_f32_32x32x16_bf16 v[132:147], v[32:35], v[72:75], v[132:147]
    v_mfma_f32_32x32x16_bf16 v[164:179], v[72:75], v[36:39], v[164:179]
    v_mfma_f32_32x32x16_bf16 v[116:131], v[28:31], v[76:79], v[116:131]
    v_mfma_f32_32x32x16_bf16 v[148:163], v[32:35], v[76:79], v[148:163]
    v_mfma_f32_32x32x16_bf16 v[180:195], v[76:79], v[36:39], v[180:195]
    buffer_load_dwordx4 v[28:31], v4, s[12:15], s19 offen
    buffer_load_dwordx4 v[32:35], v4, s[12:15], s20 offen
    buffer_load_dwordx4 v[36:39], v4, s[12:15], s21 offen
    s_add_u32 s19, s19, 1024
    s_add_u32 s20, s20, 1024
    s_add_u32 s21, s21, 1024
    ds_read_b128 v[64:67], v4 offset:27648
    ds_read_b128 v[68:71], v5 offset:27648
    s_waitcnt vmcnt(9) lgkmcnt(2)
    v_mfma_f32_32x32x16_bf16 v[100:115], v[40:43], v[80:83], v[100:115]
    v_mfma_f32_32x32x16_bf16 v[132:147], v[44:47], v[80:83], v[132:147]
    v_mfma_f32_32x32x16_bf16 v[164:179], v[80:83], v[48:51], v[164:179]
    v_mfma_f32_32x32x16_bf16 v[116:131], v[40:43], v[84:87], v[116:131]
    v_mfma_f32_32x32x16_bf16 v[148:163], v[44:47], v[84:87], v[148:163]
    v_mfma_f32_32x32x16_bf16 v[180:195], v[84:87], v[48:51], v[180:195]
    buffer_load_dwordx4 v[40:43], v4, s[12:15], s19 offen
    buffer_load_dwordx4 v[44:47], v4, s[12:15], s20 offen
    buffer_load_dwordx4 v[48:51], v4, s[12:15], s21 offen
    s_add_u32 s19, s19, 1024
    s_add_u32 s20, s20, 1024
    s_add_u32 s21, s21, 1024
    ds_read_b128 v[72:75], v4 offset:28672
    ds_read_b128 v[76:79], v5 offset:28672
    s_waitcnt vmcnt(9) lgkmcnt(2)
    v_mfma_f32_32x32x16_bf16 v[100:115], v[52:55], v[64:67], v[100:115]
    v_mfma_f32_32x32x16_bf16 v[132:147], v[56:59], v[64:67], v[132:147]
    v_mfma_f32_32x32x16_bf16 v[164:179], v[64:67], v[60:63], v[164:179]
    v_mfma_f32_32x32x16_bf16 v[116:131], v[52:55], v[68:71], v[116:131]
    v_mfma_f32_32x32x16_bf16 v[148:163], v[56:59], v[68:71], v[148:163]
    v_mfma_f32_32x32x16_bf16 v[180:195], v[68:71], v[60:63], v[180:195]
    buffer_load_dwordx4 v[52:55], v4, s[12:15], s19 offen
    buffer_load_dwordx4 v[56:59], v4, s[12:15], s20 offen
    buffer_load_dwordx4 v[60:63], v4, s[12:15], s21 offen
    s_add_u32 s19, s19, 1024
    s_add_u32 s20, s20, 1024
    s_add_u32 s21, s21, 1024
    ds_read_b128 v[80:83], v4 offset:29696
    ds_read_b128 v[84:87], v5 offset:29696
    s_waitcnt vmcnt(9) lgkmcnt(2)
    v_mfma_f32_32x32x16_bf16 v[100:115], v[16:19], v[72:75], v[100:115]
    v_mfma_f32_32x32x16_bf16 v[132:147], v[20:23], v[72:75], v[132:147]
    v_mfma_f32_32x32x16_bf16 v[164:179], v[72:75], v[24:27], v[164:179]
    v_mfma_f32_32x32x16_bf16 v[116:131], v[16:19], v[76:79], v[116:131]
    v_mfma_f32_32x32x16_bf16 v[148:163], v[20:23], v[76:79], v[148:163]
    v_mfma_f32_32x32x16_bf16 v[180:195], v[76:79], v[24:27], v[180:195]
    buffer_load_dwordx4 v[16:19], v4, s[12:15], s19 offen
    buffer_load_dwordx4 v[20:23], v4, s[12:15], s20 offen
    buffer_load_dwordx4 v[24:27], v4, s[12:15], s21 offen
    s_add_u32 s19, s19, 1024
    s_add_u32 s20, s20, 1024
    s_add_u32 s21, s21, 1024
    ds_read_b128 v[64:67], v4 offset:30720
    ds_read_b128 v[68:71], v5 offset:30720
    s_waitcnt vmcnt(9) lgkmcnt(2)
    v_mfma_f32_32x32x16_bf16 v[100:115], v[28:31], v[80:83], v[100:115]
    v_mfma_f32_32x32x16_bf16 v[132:147], v[32:35], v[80:83], v[132:147]
    v_mfma_f32_32x32x16_bf16 v[164:179], v[80:83], v[36:39], v[164:179]
    v_mfma_f32_32x32x16_bf16 v[116:131], v[28:31], v[84:87], v[116:131]
    v_mfma_f32_32x32x16_bf16 v[148:163], v[32:35], v[84:87], v[148:163]
    v_mfma_f32_32x32x16_bf16 v[180:195], v[84:87], v[36:39], v[180:195]
    buffer_load_dwordx4 v[28:31], v4, s[12:15], s19 offen
    buffer_load_dwordx4 v[32:35], v4, s[12:15], s20 offen
    buffer_load_dwordx4 v[36:39], v4, s[12:15], s21 offen
    s_add_u32 s19, s19, 1024
    s_add_u32 s20, s20, 1024
    s_add_u32 s21, s21, 1024
    ds_read_b128 v[72:75], v4 offset:31744
    ds_read_b128 v[76:79], v5 offset:31744
    s_waitcnt vmcnt(9) lgkmcnt(2)
    v_mfma_f32_32x32x16_bf16 v[100:115], v[40:43], v[64:67], v[100:115]
    v_mfma_f32_32x32x16_bf16 v[132:147], v[44:47], v[64:67], v[132:147]
    v_mfma_f32_32x32x16_bf16 v[164:179], v[64:67], v[48:51], v[164:179]
    v_mfma_f32_32x32x16_bf16 v[116:131], v[40:43], v[68:71], v[116:131]
    v_mfma_f32_32x32x16_bf16 v[148:163], v[44:47], v[68:71], v[148:163]
    v_mfma_f32_32x32x16_bf16 v[180:195], v[68:71], v[48:51], v[180:195]
    buffer_load_dwordx4 v[40:43], v4, s[12:15], s19 offen
    buffer_load_dwordx4 v[44:47], v4, s[12:15], s20 offen
    buffer_load_dwordx4 v[48:51], v4, s[12:15], s21 offen
    s_add_u32 s19, s19, 1024
    s_add_u32 s20, s20, 1024
    s_add_u32 s21, s21, 1024
    ds_read_b128 v[80:83], v4 offset:32768
    ds_read_b128 v[84:87], v5 offset:32768
    s_waitcnt vmcnt(9) lgkmcnt(2)
    v_mfma_f32_32x32x16_bf16 v[100:115], v[52:55], v[72:75], v[100:115]
    v_mfma_f32_32x32x16_bf16 v[132:147], v[56:59], v[72:75], v[132:147]
    v_mfma_f32_32x32x16_bf16 v[164:179], v[72:75], v[60:63], v[164:179]
    v_mfma_f32_32x32x16_bf16 v[116:131], v[52:55], v[76:79], v[116:131]
    v_mfma_f32_32x32x16_bf16 v[148:163], v[56:59], v[76:79], v[148:163]
    v_mfma_f32_32x32x16_bf16 v[180:195], v[76:79], v[60:63], v[180:195]
    buffer_load_dwordx4 v[52:55], v4, s[12:15], s19 offen
    buffer_load_dwordx4 v[56:59], v4, s[12:15], s20 offen
    buffer_load_dwordx4 v[60:63], v4, s[12:15], s21 offen
    s_add_u32 s19, s19, 1024
    s_add_u32 s20, s20, 1024
    s_add_u32 s21, s21, 1024
    ds_read_b128 v[64:67], v4 offset:33792
    ds_read_b128 v[68:71], v5 offset:33792
    s_waitcnt vmcnt(9) lgkmcnt(2)
    v_mfma_f32_32x32x16_bf16 v[100:115], v[16:19], v[80:83], v[100:115]
    v_mfma_f32_32x32x16_bf16 v[132:147], v[20:23], v[80:83], v[132:147]
    v_mfma_f32_32x32x16_bf16 v[164:179], v[80:83], v[24:27], v[164:179]
    v_mfma_f32_32x32x16_bf16 v[116:131], v[16:19], v[84:87], v[116:131]
    v_mfma_f32_32x32x16_bf16 v[148:163], v[20:23], v[84:87], v[148:163]
    v_mfma_f32_32x32x16_bf16 v[180:195], v[84:87], v[24:27], v[180:195]
    ds_read_b128 v[72:75], v4 offset:34816
    ds_read_b128 v[76:79], v5 offset:34816
    s_waitcnt vmcnt(6) lgkmcnt(2)
    v_mfma_f32_32x32x16_bf16 v[100:115], v[28:31], v[64:67], v[100:115]
    v_mfma_f32_32x32x16_bf16 v[132:147], v[32:35], v[64:67], v[132:147]
    v_mfma_f32_32x32x16_bf16 v[164:179], v[64:67], v[36:39], v[164:179]
    v_mfma_f32_32x32x16_bf16 v[116:131], v[28:31], v[68:71], v[116:131]
    v_mfma_f32_32x32x16_bf16 v[148:163], v[32:35], v[68:71], v[148:163]
    v_mfma_f32_32x32x16_bf16 v[180:195], v[68:71], v[36:39], v[180:195]
    ds_read_b128 v[80:83], v4 offset:35840
    ds_read_b128 v[84:87], v5 offset:35840
    s_waitcnt vmcnt(3) lgkmcnt(2)
    v_mfma_f32_32x32x16_bf16 v[100:115], v[40:43], v[72:75], v[100:115]
    v_mfma_f32_32x32x16_bf16 v[132:147], v[44:47], v[72:75], v[132:147]
    v_mfma_f32_32x32x16_bf16 v[164:179], v[72:75], v[48:51], v[164:179]
    v_mfma_f32_32x32x16_bf16 v[116:131], v[40:43], v[76:79], v[116:131]
    v_mfma_f32_32x32x16_bf16 v[148:163], v[44:47], v[76:79], v[148:163]
    v_mfma_f32_32x32x16_bf16 v[180:195], v[76:79], v[48:51], v[180:195]
    s_waitcnt vmcnt(0) lgkmcnt(0)
    v_mfma_f32_32x32x16_bf16 v[100:115], v[52:55], v[80:83], v[100:115]
    v_mfma_f32_32x32x16_bf16 v[132:147], v[56:59], v[80:83], v[132:147]
    v_mfma_f32_32x32x16_bf16 v[164:179], v[80:83], v[60:63], v[164:179]
    v_mfma_f32_32x32x16_bf16 v[116:131], v[52:55], v[84:87], v[116:131]
    v_mfma_f32_32x32x16_bf16 v[148:163], v[56:59], v[84:87], v[148:163]
    v_mfma_f32_32x32x16_bf16 v[180:195], v[84:87], v[60:63], v[180:195]
    s_nop 15
    v_cmp_eq_u32 s[34:35], 18, v2
    v_mov_b32 v6, 1.0
    s_nop 1
    v_cndmask_b32 v164, v164, v6, s[34:35]
    v_cndmask_b32 v165, v165, v6, s[34:35]
    v_cndmask_b32 v166, v166, v6, s[34:35]
    v_cndmask_b32 v167, v167, v6, s[34:35]
    v_cndmask_b32 v168, v168, v6, s[34:35]
    v_cndmask_b32 v169, v169, v6, s[34:35]
    v_cndmask_b32 v170, v170, v6, s[34:35]
    v_cndmask_b32 v171, v171, v6, s[34:35]
    v_cndmask_b32 v172, v172, v6, s[34:35]
    v_cndmask_b32 v173, v173, v6, s[34:35]
    v_cndmask_b32 v174, v174, v6, s[34:35]
    v_cndmask_b32 v175, v175, v6, s[34:35]
    v_cndmask_b32 v176, v176, v6, s[34:35]
    v_cndmask_b32 v177, v177, v6, s[34:35]
    v_cndmask_b32 v178, v178, v6, s[34:35]
    v_cndmask_b32 v179, v179, v6, s[34:35]
    v_cndmask_b32 v180, v180, v6, s[34:35]
    v_cndmask_b32 v181, v181, v6, s[34:35]
    v_cndmask_b32 v182, v182, v6, s[34:35]
    v_cndmask_b32 v183, v183, v6, s[34:35]
    v_cndmask_b32 v184, v184, v6, s[34:35]
    v_cndmask_b32 v185, v185, v6, s[34:35]
    v_cndmask_b32 v186, v186, v6, s[34:35]
    v_cndmask_b32 v187, v187, v6, s[34:35]
    v_cndmask_b32 v188, v188, v6, s[34:35]
    v_cndmask_b32 v189, v189, v6, s[34:35]
    v_cndmask_b32 v190, v190, v6, s[34:35]
    v_cndmask_b32 v191, v191, v6, s[34:35]
    v_cndmask_b32 v192, v192, v6, s[34:35]
    v_cndmask_b32 v193, v193, v6, s[34:35]
    v_cndmask_b32 v194, v194, v6, s[34:35]
    v_cndmask_b32 v195, v195, v6, s[34:35]
    s_lshl_b32 s22, s18, 11
    s_add_u32 s22, s22, 8404992
    buffer_load_dwordx4 v[200:203], v4, s[12:15], s22 offen
    buffer_load_dwordx4 v[204:207], v4, s[12:15], s22 offen offset:1024
    v_mov_b32 v208, 0
    v_mov_b32 v224, 0
    v_mov_b32 v209, 0
    v_mov_b32 v225, 0
    v_mov_b32 v210, 0
    v_mov_b32 v226, 0
    v_mov_b32 v211, 0
    v_mov_b32 v227, 0
    v_mov_b32 v212, 0
    v_mov_b32 v228, 0
    v_mov_b32 v213, 0
    v_mov_b32 v229, 0
    v_mov_b32 v214, 0
    v_mov_b32 v230, 0
    v_mov_b32 v215, 0
    v_mov_b32 v231, 0
    v_mov_b32 v216, 0
    v_mov_b32 v232, 0
    v_mov_b32 v217, 0
    v_mov_b32 v233, 0
    v_mov_b32 v218, 0
    v_mov_b32 v234, 0
    v_mov_b32 v219, 0
    v_mov_b32 v235, 0
    v_mov_b32 v220, 0
    v_mov_b32 v236, 0
    v_mov_b32 v221, 0
    v_mov_b32 v237, 0
    v_mov_b32 v222, 0
    v_mov_b32 v238, 0
    v_mov_b32 v223, 0
    v_mov_b32 v239, 0
    v_and_b32 v8, 3, v2
    v_lshrrev_b32 v9, 2, v2
    v_and_b32 v9, 1, v9
    v_lshl_or_b32 v8, v9, 3, v8
    v_lshrrev_b32 v9, 3, v2
    v_and_b32 v9, 1, v9
    v_lshl_or_b32 v8, v9, 2, v8
    v_and_b32 v9, 16, v2
    v_or_b32 v8, v8, v9
    s_mul_i32 s22, s3, 5120
    s_add_u32 s22, s22, 73728
    v_mul_u32_u24 v9, 320, v3
    v_lshl_add_u32 v8, v8, 1, v9
    v_add_u32 v8, s22, v8
    v_mul_u32_u24 v9, 80, v2
    v_lshl_add_u32 v9, v3, 4, v9
    v_add_u32 v9, s22, v9
    s_waitcnt vmcnt(0)
    s_lshl_b32 s22, s18, 6
    s_lshl_b32 s23, s16, 1
    s_add_u32 s22, s22, s23
    s_add_u32 s22, s22, 0
    s_lshl_b32 s23, s22, 12
    s_add_u32 s23, s23, 17907712
    v_cvt_pk_bf16_f32 v16, v100, v101
    v_cvt_pk_bf16_f32 v17, v102, v103
    v_cvt_pk_bf16_f32 v18, v104, v105
    v_cvt_pk_bf16_f32 v19, v106, v107
    v_cvt_pk_bf16_f32 v20, v108, v109
    v_cvt_pk_bf16_f32 v21, v110, v111
    v_cvt_pk_bf16_f32 v22, v112, v113
    v_cvt_pk_bf16_f32 v23, v114, v115
    s_nop 1
    v_mfma_f32_32x32x16_bf16 v[24:39], v[200:203], v[16:19], 0
    v_mfma_f32_32x32x16_bf16 v[24:39], v[204:207], v[20:23], v[24:39]
    s_nop 15
    v_cvt_pk_bf16_f32 v72, v24, v25
    v_lshlrev_b32 v40, 16, v72
    v_and_b32 v41, 0xffff0000, v72
    v_cvt_pk_bf16_f32 v72, v26, v27
    v_lshlrev_b32 v42, 16, v72
    v_and_b32 v43, 0xffff0000, v72
    v_cvt_pk_bf16_f32 v72, v28, v29
    v_lshlrev_b32 v44, 16, v72
    v_and_b32 v45, 0xffff0000, v72
    v_cvt_pk_bf16_f32 v72, v30, v31
    v_lshlrev_b32 v46, 16, v72
    v_and_b32 v47, 0xffff0000, v72
    v_cvt_pk_bf16_f32 v72, v32, v33
    v_lshlrev_b32 v48, 16, v72
    v_and_b32 v49, 0xffff0000, v72
    v_max3_f32 v72, v40, v41, v42
    v_max3_f32 v72, v72, v43, v44
    v_max3_f32 v72, v72, v45, v46
    v_max_f32 v72, v72, v47
    v_min3_f32 v73, v40, v41, v42
    v_min3_f32 v73, v73, v43, v44
    v_min3_f32 v73, v73, v45, v46
    v_min_f32 v73, v73, v47
    v_max_f32 v74, v48, v49
    v_min_f32 v75, v48, v49
    v_mov_b32 v76, 4286578688
    v_mov_b32 v77, 2139095040
    v_cndmask_b32 v74, v76, v74, s[30:31]
    v_cndmask_b32 v75, v77, v75, s[30:31]
    v_max_f32 v72, v72, v74
    v_min_f32 v73, v73, v75
    v_mov_b32 v76, v72
    s_nop 1
    v_permlane32_swap_b32 v72, v76
    v_max_f32 v72, v72, v76
    v_mov_b32 v76, v73
    s_nop 1
    v_permlane32_swap_b32 v73, v76
    v_min_f32 v73, v73, v76
    s_mov_b32 s32, 1069066811
    v_sub_f32 v24, v40, v72
    v_sub_f32 v40, v73, v40
    v_sub_f32 v25, v41, v72
    v_sub_f32 v41, v73, v41
    v_sub_f32 v26, v42, v72
    v_sub_f32 v42, v73, v42
    v_sub_f32 v27, v43, v72
    v_sub_f32 v43, v73, v43
    v_sub_f32 v28, v44, v72
    v_sub_f32 v44, v73, v44
    v_sub_f32 v29, v45, v72
    v_sub_f32 v45, v73, v45
    v_sub_f32 v30, v46, v72
    v_sub_f32 v46, v73, v46
    v_sub_f32 v31, v47, v72
    v_sub_f32 v47, v73, v47
    v_sub_f32 v32, v48, v72
    v_sub_f32 v48, v73, v48
    v_sub_f32 v33, v49, v72
    v_sub_f32 v49, v73, v49
    v_mul_f32 v24, s32, v24
    v_mul_f32 v40, s32, v40
    v_mul_f32 v25, s32, v25
    v_mul_f32 v41, s32, v41
    v_mul_f32 v26, s32, v26
    v_mul_f32 v42, s32, v42
    v_mul_f32 v27, s32, v27
    v_mul_f32 v43, s32, v43
    v_mul_f32 v28, s32, v28
    v_mul_f32 v44, s32, v44
    v_mul_f32 v29, s32, v29
    v_mul_f32 v45, s32, v45
    v_mul_f32 v30, s32, v30
    v_mul_f32 v46, s32, v46
    v_mul_f32 v31, s32, v31
    v_mul_f32 v47, s32, v47
    v_mul_f32 v32, s32, v32
    v_mul_f32 v48, s32, v48
    v_mul_f32 v33, s32, v33
    v_mul_f32 v49, s32, v49
    v_exp_f32 v24, v24
    v_exp_f32 v40, v40
    v_exp_f32 v25, v25
    v_exp_f32 v41, v41
    v_exp_f32 v26, v26
    v_exp_f32 v42, v42
    v_exp_f32 v27, v27
    v_exp_f32 v43, v43
    v_exp_f32 v28, v28
    v_exp_f32 v44, v44
    v_exp_f32 v29, v29
    v_exp_f32 v45, v45
    v_exp_f32 v30, v30
    v_exp_f32 v46, v46
    v_exp_f32 v31, v31
    v_exp_f32 v47, v47
    v_exp_f32 v32, v32
    v_exp_f32 v48, v48
    v_exp_f32 v33, v33
    v_exp_f32 v49, v49
    s_nop 0
    v_cndmask_b32 v32, 0, v32, s[30:31]
    v_cndmask_b32 v48, 0, v48, s[30:31]
    v_cndmask_b32 v33, 0, v33, s[30:31]
    v_cndmask_b32 v49, 0, v49, s[30:31]
    v_add_f32 v72, v24, v25
    v_add_f32 v73, v40, v41
    v_add_f32 v72, v72, v26
    v_add_f32 v73, v73, v42
    v_add_f32 v72, v72, v27
    v_add_f32 v73, v73, v43
    v_add_f32 v72, v72, v28
    v_add_f32 v73, v73, v44
    v_add_f32 v72, v72, v29
    v_add_f32 v73, v73, v45
    v_add_f32 v72, v72, v30
    v_add_f32 v73, v73, v46
    v_add_f32 v72, v72, v31
    v_add_f32 v73, v73, v47
    v_add_f32 v72, v72, v32
    v_add_f32 v73, v73, v48
    v_add_f32 v72, v72, v33
    v_add_f32 v73, v73, v49
    v_mov_b32 v76, v72
    s_nop 1
    v_permlane32_swap_b32 v72, v76
    v_add_f32 v72, v72, v76
    v_mov_b32 v76, v73
    s_nop 1
    v_permlane32_swap_b32 v73, v76
    v_add_f32 v73, v73, v76
    v_rcp_f32 v72, v72
    v_rcp_f32 v73, v73
    s_nop 0
    v_mul_f32 v24, v24, v72
    v_mul_f32 v40, v40, v73
    v_mul_f32 v25, v25, v72
    v_mul_f32 v41, v41, v73
    v_mul_f32 v26, v26, v72
    v_mul_f32 v42, v42, v73
    v_mul_f32 v27, v27, v72
    v_mul_f32 v43, v43, v73
    v_mul_f32 v28, v28, v72
    v_mul_f32 v44, v44, v73
    v_mul_f32 v29, v29, v72
    v_mul_f32 v45, v45, v73
    v_mul_f32 v30, v30, v72
    v_mul_f32 v46, v46, v73
    v_mul_f32 v31, v31, v72
    v_mul_f32 v47, v47, v73
    v_mul_f32 v32, v32, v72
    v_mul_f32 v48, v48, v73
    v_mul_f32 v33, v33, v72
    v_mul_f32 v49, v49, v73
    v_cvt_pk_bf16_f32 v56, v24, v25
    v_cvt_pk_bf16_f32 v64, v40, v41
    v_cvt_pk_bf16_f32 v57, v26, v27
    v_cvt_pk_bf16_f32 v65, v42, v43
    v_cvt_pk_bf16_f32 v58, v28, v29
    v_cvt_pk_bf16_f32 v66, v44, v45
    v_cvt_pk_bf16_f32 v59, v30, v31
    v_cvt_pk_bf16_f32 v67, v46, v47
    v_cvt_pk_bf16_f32 v60, v32, v33
    v_cvt_pk_bf16_f32 v68, v48, v49
    v_mov_b32 v61, 0
    v_mov_b32 v69, 0
    v_mov_b32 v62, 0
    v_mov_b32 v70, 0
    v_mov_b32 v63, 0
    v_mov_b32 v71, 0
    buffer_store_dwordx4 v[56:59], v4, s[12:15], s23 offen offset:0
    buffer_store_dwordx4 v[60:63], v4, s[12:15], s23 offen offset:1024
    buffer_store_dwordx4 v[64:67], v4, s[12:15], s23 offen offset:2048
    buffer_store_dwordx4 v[68:71], v4, s[12:15], s23 offen offset:3072
    s_nop 2
    v_cvt_pk_bf16_f32 v16, v132, v133
    v_cvt_pk_bf16_f32 v17, v134, v135
    v_cvt_pk_bf16_f32 v18, v136, v137
    v_cvt_pk_bf16_f32 v19, v138, v139
    v_cvt_pk_bf16_f32 v20, v140, v141
    v_cvt_pk_bf16_f32 v21, v142, v143
    v_cvt_pk_bf16_f32 v22, v144, v145
    v_cvt_pk_bf16_f32 v23, v146, v147
    s_nop 1
    v_mfma_f32_32x32x16_bf16 v[24:39], v[200:203], v[16:19], 0
    v_mfma_f32_32x32x16_bf16 v[24:39], v[204:207], v[20:23], v[24:39]
    s_nop 15
    v_cvt_pk_bf16_f32 v72, v24, v25
    v_lshlrev_b32 v40, 16, v72
    v_and_b32 v41, 0xffff0000, v72
    v_cvt_pk_bf16_f32 v72, v26, v27
    v_lshlrev_b32 v42, 16, v72
    v_and_b32 v43, 0xffff0000, v72
    v_cvt_pk_bf16_f32 v72, v28, v29
    v_lshlrev_b32 v44, 16, v72
    v_and_b32 v45, 0xffff0000, v72
    v_cvt_pk_bf16_f32 v72, v30, v31
    v_lshlrev_b32 v46, 16, v72
    v_and_b32 v47, 0xffff0000, v72
    v_cvt_pk_bf16_f32 v72, v32, v33
    v_lshlrev_b32 v48, 16, v72
    v_and_b32 v49, 0xffff0000, v72
    v_max3_f32 v72, v40, v41, v42
    v_max3_f32 v72, v72, v43, v44
    v_max3_f32 v72, v72, v45, v46
    v_max_f32 v72, v72, v47
    v_min3_f32 v73, v40, v41, v42
    v_min3_f32 v73, v73, v43, v44
    v_min3_f32 v73, v73, v45, v46
    v_min_f32 v73, v73, v47
    v_max_f32 v74, v48, v49
    v_min_f32 v75, v48, v49
    v_mov_b32 v76, 4286578688
    v_mov_b32 v77, 2139095040
    v_cndmask_b32 v74, v76, v74, s[30:31]
    v_cndmask_b32 v75, v77, v75, s[30:31]
    v_max_f32 v72, v72, v74
    v_min_f32 v73, v73, v75
    v_mov_b32 v76, v72
    s_nop 1
    v_permlane32_swap_b32 v72, v76
    v_max_f32 v72, v72, v76
    v_mov_b32 v76, v73
    s_nop 1
    v_permlane32_swap_b32 v73, v76
    v_min_f32 v73, v73, v76
    s_mov_b32 s32, 1069066811
    v_sub_f32 v24, v40, v72
    v_sub_f32 v40, v73, v40
    v_sub_f32 v25, v41, v72
    v_sub_f32 v41, v73, v41
    v_sub_f32 v26, v42, v72
    v_sub_f32 v42, v73, v42
    v_sub_f32 v27, v43, v72
    v_sub_f32 v43, v73, v43
    v_sub_f32 v28, v44, v72
    v_sub_f32 v44, v73, v44
    v_sub_f32 v29, v45, v72
    v_sub_f32 v45, v73, v45
    v_sub_f32 v30, v46, v72
    v_sub_f32 v46, v73, v46
    v_sub_f32 v31, v47, v72
    v_sub_f32 v47, v73, v47
    v_sub_f32 v32, v48, v72
    v_sub_f32 v48, v73, v48
    v_sub_f32 v33, v49, v72
    v_sub_f32 v49, v73, v49
    v_mul_f32 v24, s32, v24
    v_mul_f32 v40, s32, v40
    v_mul_f32 v25, s32, v25
    v_mul_f32 v41, s32, v41
    v_mul_f32 v26, s32, v26
    v_mul_f32 v42, s32, v42
    v_mul_f32 v27, s32, v27
    v_mul_f32 v43, s32, v43
    v_mul_f32 v28, s32, v28
    v_mul_f32 v44, s32, v44
    v_mul_f32 v29, s32, v29
    v_mul_f32 v45, s32, v45
    v_mul_f32 v30, s32, v30
    v_mul_f32 v46, s32, v46
    v_mul_f32 v31, s32, v31
    v_mul_f32 v47, s32, v47
    v_mul_f32 v32, s32, v32
    v_mul_f32 v48, s32, v48
    v_mul_f32 v33, s32, v33
    v_mul_f32 v49, s32, v49
    v_exp_f32 v24, v24
    v_exp_f32 v40, v40
    v_exp_f32 v25, v25
    v_exp_f32 v41, v41
    v_exp_f32 v26, v26
    v_exp_f32 v42, v42
    v_exp_f32 v27, v27
    v_exp_f32 v43, v43
    v_exp_f32 v28, v28
    v_exp_f32 v44, v44
    v_exp_f32 v29, v29
    v_exp_f32 v45, v45
    v_exp_f32 v30, v30
    v_exp_f32 v46, v46
    v_exp_f32 v31, v31
    v_exp_f32 v47, v47
    v_exp_f32 v32, v32
    v_exp_f32 v48, v48
    v_exp_f32 v33, v33
    v_exp_f32 v49, v49
    s_nop 0
    v_cndmask_b32 v32, 0, v32, s[30:31]
    v_cndmask_b32 v48, 0, v48, s[30:31]
    v_cndmask_b32 v33, 0, v33, s[30:31]
    v_cndmask_b32 v49, 0, v49, s[30:31]
    v_add_f32 v72, v24, v25
    v_add_f32 v73, v40, v41
    v_add_f32 v72, v72, v26
    v_add_f32 v73, v73, v42
    v_add_f32 v72, v72, v27
    v_add_f32 v73, v73, v43
    v_add_f32 v72, v72, v28
    v_add_f32 v73, v73, v44
    v_add_f32 v72, v72, v29
    v_add_f32 v73, v73, v45
    v_add_f32 v72, v72, v30
    v_add_f32 v73, v73, v46
    v_add_f32 v72, v72, v31
    v_add_f32 v73, v73, v47
    v_add_f32 v72, v72, v32
    v_add_f32 v73, v73, v48
    v_add_f32 v72, v72, v33
    v_add_f32 v73, v73, v49
    v_mov_b32 v76, v72
    s_nop 1
    v_permlane32_swap_b32 v72, v76
    v_add_f32 v72, v72, v76
    v_mov_b32 v76, v73
    s_nop 1
    v_permlane32_swap_b32 v73, v76
    v_add_f32 v73, v73, v76
    v_rcp_f32 v72, v72
    v_rcp_f32 v73, v73
    s_nop 0
    v_mul_f32 v24, v24, v72
    v_mul_f32 v40, v40, v73
    v_mul_f32 v25, v25, v72
    v_mul_f32 v41, v41, v73
    v_mul_f32 v26, v26, v72
    v_mul_f32 v42, v42, v73
    v_mul_f32 v27, v27, v72
    v_mul_f32 v43, v43, v73
    v_mul_f32 v28, v28, v72
    v_mul_f32 v44, v44, v73
    v_mul_f32 v29, v29, v72
    v_mul_f32 v45, v45, v73
    v_mul_f32 v30, v30, v72
    v_mul_f32 v46, v46, v73
    v_mul_f32 v31, v31, v72
    v_mul_f32 v47, v47, v73
    v_mul_f32 v32, v32, v72
    v_mul_f32 v48, v48, v73
    v_mul_f32 v33, v33, v72
    v_mul_f32 v49, v49, v73
    v_cvt_pk_bf16_f32 v56, v24, v25
    v_cvt_pk_bf16_f32 v64, v40, v41
    v_cvt_pk_bf16_f32 v57, v26, v27
    v_cvt_pk_bf16_f32 v65, v42, v43
    v_cvt_pk_bf16_f32 v58, v28, v29
    v_cvt_pk_bf16_f32 v66, v44, v45
    v_cvt_pk_bf16_f32 v59, v30, v31
    v_cvt_pk_bf16_f32 v67, v46, v47
    v_cvt_pk_bf16_f32 v60, v32, v33
    v_cvt_pk_bf16_f32 v68, v48, v49
    v_mov_b32 v61, 0
    v_mov_b32 v69, 0
    v_mov_b32 v62, 0
    v_mov_b32 v70, 0
    v_mov_b32 v63, 0
    v_mov_b32 v71, 0
    ds_write_b16 v8, v56 offset:0
    ds_write_b16_d16_hi v8, v56 offset:80
    ds_write_b16 v8, v57 offset:160
    ds_write_b16_d16_hi v8, v57 offset:240
    ds_write_b16 v8, v58 offset:640
    ds_write_b16_d16_hi v8, v58 offset:720
    ds_write_b16 v8, v59 offset:800
    ds_write_b16_d16_hi v8, v59 offset:880
    ds_write_b16 v8, v60 offset:1280
    ds_write_b16_d16_hi v8, v60 offset:1360
    ds_write_b16 v8, v64 offset:2560
    ds_write_b16_d16_hi v8, v64 offset:2640
    ds_write_b16 v8, v65 offset:2720
    ds_write_b16_d16_hi v8, v65 offset:2800
    ds_write_b16 v8, v66 offset:3200
    ds_write_b16_d16_hi v8, v66 offset:3280
    ds_write_b16 v8, v67 offset:3360
    ds_write_b16_d16_hi v8, v67 offset:3440
    ds_write_b16 v8, v68 offset:3840
    ds_write_b16_d16_hi v8, v68 offset:3920
    s_waitcnt lgkmcnt(0)
    ds_read_b128 v[40:43], v9 offset:0
    ds_read_b128 v[44:47], v9 offset:32
    ds_read_b128 v[48:51], v9 offset:2560
    ds_read_b128 v[52:55], v9 offset:2592
    v_cvt_pk_bf16_f32 v16, v164, v165
    v_cvt_pk_bf16_f32 v17, v166, v167
    v_cvt_pk_bf16_f32 v18, v168, v169
    v_cvt_pk_bf16_f32 v19, v170, v171
    v_cvt_pk_bf16_f32 v20, v172, v173
    v_cvt_pk_bf16_f32 v21, v174, v175
    v_cvt_pk_bf16_f32 v22, v176, v177
    v_cvt_pk_bf16_f32 v23, v178, v179
    s_waitcnt lgkmcnt(0)
    s_nop 1
    v_mfma_f32_32x32x16_bf16 v[208:223], v[40:43], v[16:19], v[208:223]
    v_mfma_f32_32x32x16_bf16 v[224:239], v[48:51], v[16:19], v[224:239]
    v_mfma_f32_32x32x16_bf16 v[208:223], v[44:47], v[20:23], v[208:223]
    v_mfma_f32_32x32x16_bf16 v[224:239], v[52:55], v[20:23], v[224:239]
    s_lshl_b32 s22, s18, 6
    s_lshl_b32 s23, s16, 1
    s_add_u32 s22, s22, s23
    s_add_u32 s22, s22, 1
    s_lshl_b32 s23, s22, 12
    s_add_u32 s23, s23, 17907712
    v_cvt_pk_bf16_f32 v16, v116, v117
    v_cvt_pk_bf16_f32 v17, v118, v119
    v_cvt_pk_bf16_f32 v18, v120, v121
    v_cvt_pk_bf16_f32 v19, v122, v123
    v_cvt_pk_bf16_f32 v20, v124, v125
    v_cvt_pk_bf16_f32 v21, v126, v127
    v_cvt_pk_bf16_f32 v22, v128, v129
    v_cvt_pk_bf16_f32 v23, v130, v131
    s_nop 1
    v_mfma_f32_32x32x16_bf16 v[24:39], v[200:203], v[16:19], 0
    v_mfma_f32_32x32x16_bf16 v[24:39], v[204:207], v[20:23], v[24:39]
    s_nop 15
    v_cvt_pk_bf16_f32 v72, v24, v25
    v_lshlrev_b32 v40, 16, v72
    v_and_b32 v41, 0xffff0000, v72
    v_cvt_pk_bf16_f32 v72, v26, v27
    v_lshlrev_b32 v42, 16, v72
    v_and_b32 v43, 0xffff0000, v72
    v_cvt_pk_bf16_f32 v72, v28, v29
    v_lshlrev_b32 v44, 16, v72
    v_and_b32 v45, 0xffff0000, v72
    v_cvt_pk_bf16_f32 v72, v30, v31
    v_lshlrev_b32 v46, 16, v72
    v_and_b32 v47, 0xffff0000, v72
    v_cvt_pk_bf16_f32 v72, v32, v33
    v_lshlrev_b32 v48, 16, v72
    v_and_b32 v49, 0xffff0000, v72
    v_max3_f32 v72, v40, v41, v42
    v_max3_f32 v72, v72, v43, v44
    v_max3_f32 v72, v72, v45, v46
    v_max_f32 v72, v72, v47
    v_min3_f32 v73, v40, v41, v42
    v_min3_f32 v73, v73, v43, v44
    v_min3_f32 v73, v73, v45, v46
    v_min_f32 v73, v73, v47
    v_max_f32 v74, v48, v49
    v_min_f32 v75, v48, v49
    v_mov_b32 v76, 4286578688
    v_mov_b32 v77, 2139095040
    v_cndmask_b32 v74, v76, v74, s[30:31]
    v_cndmask_b32 v75, v77, v75, s[30:31]
    v_max_f32 v72, v72, v74
    v_min_f32 v73, v73, v75
    v_mov_b32 v76, v72
    s_nop 1
    v_permlane32_swap_b32 v72, v76
    v_max_f32 v72, v72, v76
    v_mov_b32 v76, v73
    s_nop 1
    v_permlane32_swap_b32 v73, v76
    v_min_f32 v73, v73, v76
    s_mov_b32 s32, 1069066811
    v_sub_f32 v24, v40, v72
    v_sub_f32 v40, v73, v40
    v_sub_f32 v25, v41, v72
    v_sub_f32 v41, v73, v41
    v_sub_f32 v26, v42, v72
    v_sub_f32 v42, v73, v42
    v_sub_f32 v27, v43, v72
    v_sub_f32 v43, v73, v43
    v_sub_f32 v28, v44, v72
    v_sub_f32 v44, v73, v44
    v_sub_f32 v29, v45, v72
    v_sub_f32 v45, v73, v45
    v_sub_f32 v30, v46, v72
    v_sub_f32 v46, v73, v46
    v_sub_f32 v31, v47, v72
    v_sub_f32 v47, v73, v47
    v_sub_f32 v32, v48, v72
    v_sub_f32 v48, v73, v48
    v_sub_f32 v33, v49, v72
    v_sub_f32 v49, v73, v49
    v_mul_f32 v24, s32, v24
    v_mul_f32 v40, s32, v40
    v_mul_f32 v25, s32, v25
    v_mul_f32 v41, s32, v41
    v_mul_f32 v26, s32, v26
    v_mul_f32 v42, s32, v42
    v_mul_f32 v27, s32, v27
    v_mul_f32 v43, s32, v43
    v_mul_f32 v28, s32, v28
    v_mul_f32 v44, s32, v44
    v_mul_f32 v29, s32, v29
    v_mul_f32 v45, s32, v45
    v_mul_f32 v30, s32, v30
    v_mul_f32 v46, s32, v46
    v_mul_f32 v31, s32, v31
    v_mul_f32 v47, s32, v47
    v_mul_f32 v32, s32, v32
    v_mul_f32 v48, s32, v48
    v_mul_f32 v33, s32, v33
    v_mul_f32 v49, s32, v49
    v_exp_f32 v24, v24
    v_exp_f32 v40, v40
    v_exp_f32 v25, v25
    v_exp_f32 v41, v41
    v_exp_f32 v26, v26
    v_exp_f32 v42, v42
    v_exp_f32 v27, v27
    v_exp_f32 v43, v43
    v_exp_f32 v28, v28
    v_exp_f32 v44, v44
    v_exp_f32 v29, v29
    v_exp_f32 v45, v45
    v_exp_f32 v30, v30
    v_exp_f32 v46, v46
    v_exp_f32 v31, v31
    v_exp_f32 v47, v47
    v_exp_f32 v32, v32
    v_exp_f32 v48, v48
    v_exp_f32 v33, v33
    v_exp_f32 v49, v49
    s_nop 0
    v_cndmask_b32 v32, 0, v32, s[30:31]
    v_cndmask_b32 v48, 0, v48, s[30:31]
    v_cndmask_b32 v33, 0, v33, s[30:31]
    v_cndmask_b32 v49, 0, v49, s[30:31]
    v_add_f32 v72, v24, v25
    v_add_f32 v73, v40, v41
    v_add_f32 v72, v72, v26
    v_add_f32 v73, v73, v42
    v_add_f32 v72, v72, v27
    v_add_f32 v73, v73, v43
    v_add_f32 v72, v72, v28
    v_add_f32 v73, v73, v44
    v_add_f32 v72, v72, v29
    v_add_f32 v73, v73, v45
    v_add_f32 v72, v72, v30
    v_add_f32 v73, v73, v46
    v_add_f32 v72, v72, v31
    v_add_f32 v73, v73, v47
    v_add_f32 v72, v72, v32
    v_add_f32 v73, v73, v48
    v_add_f32 v72, v72, v33
    v_add_f32 v73, v73, v49
    v_mov_b32 v76, v72
    s_nop 1
    v_permlane32_swap_b32 v72, v76
    v_add_f32 v72, v72, v76
    v_mov_b32 v76, v73
    s_nop 1
    v_permlane32_swap_b32 v73, v76
    v_add_f32 v73, v73, v76
    v_rcp_f32 v72, v72
    v_rcp_f32 v73, v73
    s_nop 0
    v_mul_f32 v24, v24, v72
    v_mul_f32 v40, v40, v73
    v_mul_f32 v25, v25, v72
    v_mul_f32 v41, v41, v73
    v_mul_f32 v26, v26, v72
    v_mul_f32 v42, v42, v73
    v_mul_f32 v27, v27, v72
    v_mul_f32 v43, v43, v73
    v_mul_f32 v28, v28, v72
    v_mul_f32 v44, v44, v73
    v_mul_f32 v29, v29, v72
    v_mul_f32 v45, v45, v73
    v_mul_f32 v30, v30, v72
    v_mul_f32 v46, v46, v73
    v_mul_f32 v31, v31, v72
    v_mul_f32 v47, v47, v73
    v_mul_f32 v32, v32, v72
    v_mul_f32 v48, v48, v73
    v_mul_f32 v33, v33, v72
    v_mul_f32 v49, v49, v73
    v_cvt_pk_bf16_f32 v56, v24, v25
    v_cvt_pk_bf16_f32 v64, v40, v41
    v_cvt_pk_bf16_f32 v57, v26, v27
    v_cvt_pk_bf16_f32 v65, v42, v43
    v_cvt_pk_bf16_f32 v58, v28, v29
    v_cvt_pk_bf16_f32 v66, v44, v45
    v_cvt_pk_bf16_f32 v59, v30, v31
    v_cvt_pk_bf16_f32 v67, v46, v47
    v_cvt_pk_bf16_f32 v60, v32, v33
    v_cvt_pk_bf16_f32 v68, v48, v49
    v_mov_b32 v61, 0
    v_mov_b32 v69, 0
    v_mov_b32 v62, 0
    v_mov_b32 v70, 0
    v_mov_b32 v63, 0
    v_mov_b32 v71, 0
    buffer_store_dwordx4 v[56:59], v4, s[12:15], s23 offen offset:0
    buffer_store_dwordx4 v[60:63], v4, s[12:15], s23 offen offset:1024
    buffer_store_dwordx4 v[64:67], v4, s[12:15], s23 offen offset:2048
    buffer_store_dwordx4 v[68:71], v4, s[12:15], s23 offen offset:3072
    s_nop 2
    v_cvt_pk_bf16_f32 v16, v148, v149
    v_cvt_pk_bf16_f32 v17, v150, v151
    v_cvt_pk_bf16_f32 v18, v152, v153
    v_cvt_pk_bf16_f32 v19, v154, v155
    v_cvt_pk_bf16_f32 v20, v156, v157
    v_cvt_pk_bf16_f32 v21, v158, v159
    v_cvt_pk_bf16_f32 v22, v160, v161
    v_cvt_pk_bf16_f32 v23, v162, v163
    s_nop 1
    v_mfma_f32_32x32x16_bf16 v[24:39], v[200:203], v[16:19], 0
    v_mfma_f32_32x32x16_bf16 v[24:39], v[204:207], v[20:23], v[24:39]
    s_nop 15
    v_cvt_pk_bf16_f32 v72, v24, v25
    v_lshlrev_b32 v40, 16, v72
    v_and_b32 v41, 0xffff0000, v72
    v_cvt_pk_bf16_f32 v72, v26, v27
    v_lshlrev_b32 v42, 16, v72
    v_and_b32 v43, 0xffff0000, v72
    v_cvt_pk_bf16_f32 v72, v28, v29
    v_lshlrev_b32 v44, 16, v72
    v_and_b32 v45, 0xffff0000, v72
    v_cvt_pk_bf16_f32 v72, v30, v31
    v_lshlrev_b32 v46, 16, v72
    v_and_b32 v47, 0xffff0000, v72
    v_cvt_pk_bf16_f32 v72, v32, v33
    v_lshlrev_b32 v48, 16, v72
    v_and_b32 v49, 0xffff0000, v72
    v_max3_f32 v72, v40, v41, v42
    v_max3_f32 v72, v72, v43, v44
    v_max3_f32 v72, v72, v45, v46
    v_max_f32 v72, v72, v47
    v_min3_f32 v73, v40, v41, v42
    v_min3_f32 v73, v73, v43, v44
    v_min3_f32 v73, v73, v45, v46
    v_min_f32 v73, v73, v47
    v_max_f32 v74, v48, v49
    v_min_f32 v75, v48, v49
    v_mov_b32 v76, 4286578688
    v_mov_b32 v77, 2139095040
    v_cndmask_b32 v74, v76, v74, s[30:31]
    v_cndmask_b32 v75, v77, v75, s[30:31]
    v_max_f32 v72, v72, v74
    v_min_f32 v73, v73, v75
    v_mov_b32 v76, v72
    s_nop 1
    v_permlane32_swap_b32 v72, v76
    v_max_f32 v72, v72, v76
    v_mov_b32 v76, v73
    s_nop 1
    v_permlane32_swap_b32 v73, v76
    v_min_f32 v73, v73, v76
    s_mov_b32 s32, 1069066811
    v_sub_f32 v24, v40, v72
    v_sub_f32 v40, v73, v40
    v_sub_f32 v25, v41, v72
    v_sub_f32 v41, v73, v41
    v_sub_f32 v26, v42, v72
    v_sub_f32 v42, v73, v42
    v_sub_f32 v27, v43, v72
    v_sub_f32 v43, v73, v43
    v_sub_f32 v28, v44, v72
    v_sub_f32 v44, v73, v44
    v_sub_f32 v29, v45, v72
    v_sub_f32 v45, v73, v45
    v_sub_f32 v30, v46, v72
    v_sub_f32 v46, v73, v46
    v_sub_f32 v31, v47, v72
    v_sub_f32 v47, v73, v47
    v_sub_f32 v32, v48, v72
    v_sub_f32 v48, v73, v48
    v_sub_f32 v33, v49, v72
    v_sub_f32 v49, v73, v49
    v_mul_f32 v24, s32, v24
    v_mul_f32 v40, s32, v40
    v_mul_f32 v25, s32, v25
    v_mul_f32 v41, s32, v41
    v_mul_f32 v26, s32, v26
    v_mul_f32 v42, s32, v42
    v_mul_f32 v27, s32, v27
    v_mul_f32 v43, s32, v43
    v_mul_f32 v28, s32, v28
    v_mul_f32 v44, s32, v44
    v_mul_f32 v29, s32, v29
    v_mul_f32 v45, s32, v45
    v_mul_f32 v30, s32, v30
    v_mul_f32 v46, s32, v46
    v_mul_f32 v31, s32, v31
    v_mul_f32 v47, s32, v47
    v_mul_f32 v32, s32, v32
    v_mul_f32 v48, s32, v48
    v_mul_f32 v33, s32, v33
    v_mul_f32 v49, s32, v49
    v_exp_f32 v24, v24
    v_exp_f32 v40, v40
    v_exp_f32 v25, v25
    v_exp_f32 v41, v41
    v_exp_f32 v26, v26
    v_exp_f32 v42, v42
    v_exp_f32 v27, v27
    v_exp_f32 v43, v43
    v_exp_f32 v28, v28
    v_exp_f32 v44, v44
    v_exp_f32 v29, v29
    v_exp_f32 v45, v45
    v_exp_f32 v30, v30
    v_exp_f32 v46, v46
    v_exp_f32 v31, v31
    v_exp_f32 v47, v47
    v_exp_f32 v32, v32
    v_exp_f32 v48, v48
    v_exp_f32 v33, v33
    v_exp_f32 v49, v49
    s_nop 0
    v_cndmask_b32 v32, 0, v32, s[30:31]
    v_cndmask_b32 v48, 0, v48, s[30:31]
    v_cndmask_b32 v33, 0, v33, s[30:31]
    v_cndmask_b32 v49, 0, v49, s[30:31]
    v_add_f32 v72, v24, v25
    v_add_f32 v73, v40, v41
    v_add_f32 v72, v72, v26
    v_add_f32 v73, v73, v42
    v_add_f32 v72, v72, v27
    v_add_f32 v73, v73, v43
    v_add_f32 v72, v72, v28
    v_add_f32 v73, v73, v44
    v_add_f32 v72, v72, v29
    v_add_f32 v73, v73, v45
    v_add_f32 v72, v72, v30
    v_add_f32 v73, v73, v46
    v_add_f32 v72, v72, v31
    v_add_f32 v73, v73, v47
    v_add_f32 v72, v72, v32
    v_add_f32 v73, v73, v48
    v_add_f32 v72, v72, v33
    v_add_f32 v73, v73, v49
    v_mov_b32 v76, v72
    s_nop 1
    v_permlane32_swap_b32 v72, v76
    v_add_f32 v72, v72, v76
    v_mov_b32 v76, v73
    s_nop 1
    v_permlane32_swap_b32 v73, v76
    v_add_f32 v73, v73, v76
    v_rcp_f32 v72, v72
    v_rcp_f32 v73, v73
    s_nop 0
    v_mul_f32 v24, v24, v72
    v_mul_f32 v40, v40, v73
    v_mul_f32 v25, v25, v72
    v_mul_f32 v41, v41, v73
    v_mul_f32 v26, v26, v72
    v_mul_f32 v42, v42, v73
    v_mul_f32 v27, v27, v72
    v_mul_f32 v43, v43, v73
    v_mul_f32 v28, v28, v72
    v_mul_f32 v44, v44, v73
    v_mul_f32 v29, v29, v72
    v_mul_f32 v45, v45, v73
    v_mul_f32 v30, v30, v72
    v_mul_f32 v46, v46, v73
    v_mul_f32 v31, v31, v72
    v_mul_f32 v47, v47, v73
    v_mul_f32 v32, v32, v72
    v_mul_f32 v48, v48, v73
    v_mul_f32 v33, v33, v72
    v_mul_f32 v49, v49, v73
    v_cvt_pk_bf16_f32 v56, v24, v25
    v_cvt_pk_bf16_f32 v64, v40, v41
    v_cvt_pk_bf16_f32 v57, v26, v27
    v_cvt_pk_bf16_f32 v65, v42, v43
    v_cvt_pk_bf16_f32 v58, v28, v29
    v_cvt_pk_bf16_f32 v66, v44, v45
    v_cvt_pk_bf16_f32 v59, v30, v31
    v_cvt_pk_bf16_f32 v67, v46, v47
    v_cvt_pk_bf16_f32 v60, v32, v33
    v_cvt_pk_bf16_f32 v68, v48, v49
    v_mov_b32 v61, 0
    v_mov_b32 v69, 0
    v_mov_b32 v62, 0
    v_mov_b32 v70, 0
    v_mov_b32 v63, 0
    v_mov_b32 v71, 0
    ds_write_b16 v8, v56 offset:0
    ds_write_b16_d16_hi v8, v56 offset:80
    ds_write_b16 v8, v57 offset:160
    ds_write_b16_d16_hi v8, v57 offset:240
    ds_write_b16 v8, v58 offset:640
    ds_write_b16_d16_hi v8, v58 offset:720
    ds_write_b16 v8, v59 offset:800
    ds_write_b16_d16_hi v8, v59 offset:880
    ds_write_b16 v8, v60 offset:1280
    ds_write_b16_d16_hi v8, v60 offset:1360
    ds_write_b16 v8, v64 offset:2560
    ds_write_b16_d16_hi v8, v64 offset:2640
    ds_write_b16 v8, v65 offset:2720
    ds_write_b16_d16_hi v8, v65 offset:2800
    ds_write_b16 v8, v66 offset:3200
    ds_write_b16_d16_hi v8, v66 offset:3280
    ds_write_b16 v8, v67 offset:3360
    ds_write_b16_d16_hi v8, v67 offset:3440
    ds_write_b16 v8, v68 offset:3840
    ds_write_b16_d16_hi v8, v68 offset:3920
    s_waitcnt lgkmcnt(0)
    ds_read_b128 v[40:43], v9 offset:0
    ds_read_b128 v[44:47], v9 offset:32
    ds_read_b128 v[48:51], v9 offset:2560
    ds_read_b128 v[52:55], v9 offset:2592
    v_cvt_pk_bf16_f32 v16, v180, v181
    v_cvt_pk_bf16_f32 v17, v182, v183
    v_cvt_pk_bf16_f32 v18, v184, v185
    v_cvt_pk_bf16_f32 v19, v186, v187
    v_cvt_pk_bf16_f32 v20, v188, v189
    v_cvt_pk_bf16_f32 v21, v190, v191
    v_cvt_pk_bf16_f32 v22, v192, v193
    v_cvt_pk_bf16_f32 v23, v194, v195
    s_waitcnt lgkmcnt(0)
    s_nop 1
    v_mfma_f32_32x32x16_bf16 v[208:223], v[40:43], v[16:19], v[208:223]
    v_mfma_f32_32x32x16_bf16 v[224:239], v[48:51], v[16:19], v[224:239]
    v_mfma_f32_32x32x16_bf16 v[208:223], v[44:47], v[20:23], v[208:223]
    v_mfma_f32_32x32x16_bf16 v[224:239], v[52:55], v[20:23], v[224:239]
    s_nop 15
    s_lshl_b32 s22, s18, 5
    s_add_u32 s22, s22, s16
    s_lshl_b32 s22, s22, 13
    s_add_u32 s22, s22, 26296320
    buffer_store_dwordx4 v[208:211], v4, s[12:15], s22 offen offset:0
    buffer_store_dwordx4 v[212:215], v4, s[12:15], s22 offen offset:1024
    buffer_store_dwordx4 v[216:219], v4, s[12:15], s22 offen offset:2048
    buffer_store_dwordx4 v[220:223], v4, s[12:15], s22 offen offset:3072
    s_add_u32 s22, s22, 4096
    buffer_store_dwordx4 v[224:227], v4, s[12:15], s22 offen offset:0
    buffer_store_dwordx4 v[228:231], v4, s[12:15], s22 offen offset:1024
    buffer_store_dwordx4 v[232:235], v4, s[12:15], s22 offen offset:2048
    buffer_store_dwordx4 v[236:239], v4, s[12:15], s22 offen offset:3072
    s_add_u32 s22, s22, 4096
L_a1_l0_kernel_end:
    s_endpgm
.globl a2_l0_kernel
.p2align 8
.type a2_l0_kernel,@function
a2_l0_kernel:
    s_cmp_ge_u32 s2, 256
    s_cbranch_scc1 L_a2_l0_kernel_end
    s_load_dwordx2 s[4:5], s[0:1], 72
    s_load_dwordx2 s[6:7], s[0:1], 0
    s_load_dwordx2 s[36:37], s[0:1], 56
    v_lshrrev_b32 v1, 6, v0
    s_nop 0
    v_readfirstlane_b32 s3, v1
    v_and_b32 v1, 63, v0
    v_and_b32 v2, 31, v1
    v_lshrrev_b32 v3, 5, v1
    v_lshlrev_b32 v4, 4, v1
    s_mov_b32 s30, -1
    s_mov_b32 s31, 0
    s_waitcnt lgkmcnt(0)
    s_mov_b32 s12, s4
    s_mov_b32 s13, s5
    s_mov_b32 s14, 268435456
    s_mov_b32 s15, 0x00020000
    s_mov_b32 s25, 15548416
    s_lshr_b32 s18, s2, 3
    s_and_b32 s16, s2, 7
    s_lshl_b32 s22, s18, 5
    s_lshl_b32 s23, s3, 3
    s_add_u32 s22, s22, s23
    s_lshl_b32 s22, s22, 13
    s_add_u32 s22, s22, 26296320
    buffer_load_dwordx4 v[64:67], v4, s[12:15], s22 offen offset:0
    buffer_load_dwordx4 v[68:71], v4, s[12:15], s22 offen offset:1024
    buffer_load_dwordx4 v[72:75], v4, s[12:15], s22 offen offset:2048
    buffer_load_dwordx4 v[76:79], v4, s[12:15], s22 offen offset:3072
    s_add_u32 s22, s22, 4096
    buffer_load_dwordx4 v[80:83], v4, s[12:15], s22 offen offset:0
    buffer_load_dwordx4 v[84:87], v4, s[12:15], s22 offen offset:1024
    buffer_load_dwordx4 v[88:91], v4, s[12:15], s22 offen offset:2048
    buffer_load_dwordx4 v[92:95], v4, s[12:15], s22 offen offset:3072
    s_add_u32 s22, s22, 4096
    buffer_load_dwordx4 v[96:99], v4, s[12:15], s22 offen offset:0
    buffer_load_dwordx4 v[100:103], v4, s[12:15], s22 offen offset:1024
    buffer_load_dwordx4 v[104:107], v4, s[12:15], s22 offen offset:2048
    buffer_load_dwordx4 v[108:111], v4, s[12:15], s22 offen offset:3072
    s_add_u32 s22, s22, 4096
    buffer_load_dwordx4 v[112:115], v4, s[12:15], s22 offen offset:0
    buffer_load_dwordx4 v[116:119], v4, s[12:15], s22 offen offset:1024
    buffer_load_dwordx4 v[120:123], v4, s[12:15], s22 offen offset:2048
    buffer_load_dwordx4 v[124:127], v4, s[12:15], s22 offen offset:3072
    s_add_u32 s22, s22, 4096
    buffer_load_dwordx4 v[128:131], v4, s[12:15], s22 offen offset:0
    buffer_load_dwordx4 v[132:135], v4, s[12:15], s22 offen offset:1024
    buffer_load_dwordx4 v[136:139], v4, s[12:15], s22 offen offset:2048
    buffer_load_dwordx4 v[140:143], v4, s[12:15], s22 offen offset:3072
    s_add_u32 s22, s22, 4096
    buffer_load_dwordx4 v[144:147], v4, s[12:15], s22 offen offset:0
    buffer_load_dwordx4 v[148:151], v4, s[12:15], s22 offen offset:1024
    buffer_load_dwordx4 v[152:155], v4, s[12:15], s22 offen offset:2048
    buffer_load_dwordx4 v[156:159], v4, s[12:15], s22 offen offset:3072
    s_add_u32 s22, s22, 4096
    buffer_load_dwordx4 v[160:163], v4, s[12:15], s22 offen offset:0
    buffer_load_dwordx4 v[164:167], v4, s[12:15], s22 offen offset:1024
    buffer_load_dwordx4 v[168:171], v4, s[12:15], s22 offen offset:2048
    buffer_load_dwordx4 v[172:175], v4, s[12:15], s22 offen offset:3072
    s_add_u32 s22, s22, 4096
    buffer_load_dwordx4 v[176:179], v4, s[12:15], s22 offen offset:0
    buffer_load_dwordx4 v[180:183], v4, s[12:15], s22 offen offset:1024
    buffer_load_dwordx4 v[184:187], v4, s[12:15], s22 offen offset:2048
    buffer_load_dwordx4 v[188:191], v4, s[12:15], s22 offen offset:3072
    s_add_u32 s22, s22, 4096
    s_waitcnt vmcnt(0)
    v_mov_b32 v16, v64
    v_mov_b32 v17, v65
    v_mov_b32 v18, v66
    v_mov_b32 v19, v67
    v_mov_b32 v20, v68
    v_mov_b32 v21, v69
    v_mov_b32 v22, v70
    v_mov_b32 v23, v71
    v_mov_b32 v24, v72
    v_mov_b32 v25, v73
    v_mov_b32 v26, v74
    v_mov_b32 v27, v75
    v_mov_b32 v28, v76
    v_mov_b32 v29, v77
    v_mov_b32 v30, v78
    v_mov_b32 v31, v79
    v_mov_b32 v32, v80
    v_mov_b32 v33, v81
    v_mov_b32 v34, v82
    v_mov_b32 v35, v83
    v_mov_b32 v36, v84
    v_mov_b32 v37, v85
    v_mov_b32 v38, v86
    v_mov_b32 v39, v87
    v_mov_b32 v40, v88
    v_mov_b32 v41, v89
    v_mov_b32 v42, v90
    v_mov_b32 v43, v91
    v_mov_b32 v44, v92
    v_mov_b32 v45, v93
    v_mov_b32 v46, v94
    v_mov_b32 v47, v95
    v_add_f32 v16, v16, v96
    v_add_f32 v17, v17, v97
    v_add_f32 v18, v18, v98
    v_add_f32 v19, v19, v99
    v_add_f32 v20, v20, v100
    v_add_f32 v21, v21, v101
    v_add_f32 v22, v22, v102
    v_add_f32 v23, v23, v103
    v_add_f32 v24, v24, v104
    v_add_f32 v25, v25, v105
    v_add_f32 v26, v26, v106
    v_add_f32 v27, v27, v107
    v_add_f32 v28, v28, v108
    v_add_f32 v29, v29, v109
    v_add_f32 v30, v30, v110
    v_add_f32 v31, v31, v111
    v_add_f32 v32, v32, v112
    v_add_f32 v33, v33, v113
    v_add_f32 v34, v34, v114
    v_add_f32 v35, v35, v115
    v_add_f32 v36, v36, v116
    v_add_f32 v37, v37, v117
    v_add_f32 v38, v38, v118
    v_add_f32 v39, v39, v119
    v_add_f32 v40, v40, v120
    v_add_f32 v41, v41, v121
    v_add_f32 v42, v42, v122
    v_add_f32 v43, v43, v123
    v_add_f32 v44, v44, v124
    v_add_f32 v45, v45, v125
    v_add_f32 v46, v46, v126
    v_add_f32 v47, v47, v127
    v_add_f32 v16, v16, v128
    v_add_f32 v17, v17, v129
    v_add_f32 v18, v18, v130
    v_add_f32 v19, v19, v131
    v_add_f32 v20, v20, v132
    v_add_f32 v21, v21, v133
    v_add_f32 v22, v22, v134
    v_add_f32 v23, v23, v135
    v_add_f32 v24, v24, v136
    v_add_f32 v25, v25, v137
    v_add_f32 v26, v26, v138
    v_add_f32 v27, v27, v139
    v_add_f32 v28, v28, v140
    v_add_f32 v29, v29, v141
    v_add_f32 v30, v30, v142
    v_add_f32 v31, v31, v143
    v_add_f32 v32, v32, v144
    v_add_f32 v33, v33, v145
    v_add_f32 v34, v34, v146
    v_add_f32 v35, v35, v147
    v_add_f32 v36, v36, v148
    v_add_f32 v37, v37, v149
    v_add_f32 v38, v38, v150
    v_add_f32 v39, v39, v151
    v_add_f32 v40, v40, v152
    v_add_f32 v41, v41, v153
    v_add_f32 v42, v42, v154
    v_add_f32 v43, v43, v155
    v_add_f32 v44, v44, v156
    v_add_f32 v45, v45, v157
    v_add_f32 v46, v46, v158
    v_add_f32 v47, v47, v159
    v_add_f32 v16, v16, v160
    v_add_f32 v17, v17, v161
    v_add_f32 v18, v18, v162
    v_add_f32 v19, v19, v163
    v_add_f32 v20, v20, v164
    v_add_f32 v21, v21, v165
    v_add_f32 v22, v22, v166
    v_add_f32 v23, v23, v167
    v_add_f32 v24, v24, v168
    v_add_f32 v25, v25, v169
    v_add_f32 v26, v26, v170
    v_add_f32 v27, v27, v171
    v_add_f32 v28, v28, v172
    v_add_f32 v29, v29, v173
    v_add_f32 v30, v30, v174
    v_add_f32 v31, v31, v175
    v_add_f32 v32, v32, v176
    v_add_f32 v33, v33, v177
    v_add_f32 v34, v34, v178
    v_add_f32 v35, v35, v179
    v_add_f32 v36, v36, v180
    v_add_f32 v37, v37, v181
    v_add_f32 v38, v38, v182
    v_add_f32 v39, v39, v183
    v_add_f32 v40, v40, v184
    v_add_f32 v41, v41, v185
    v_add_f32 v42, v42, v186
    v_add_f32 v43, v43, v187
    v_add_f32 v44, v44, v188
    v_add_f32 v45, v45, v189
    v_add_f32 v46, v46, v190
    v_add_f32 v47, v47, v191
    buffer_load_dwordx4 v[64:67], v4, s[12:15], s22 offen offset:0
    buffer_load_dwordx4 v[68:71], v4, s[12:15], s22 offen offset:1024
    buffer_load_dwordx4 v[72:75], v4, s[12:15], s22 offen offset:2048
    buffer_load_dwordx4 v[76:79], v4, s[12:15], s22 offen offset:3072
    s_add_u32 s22, s22, 4096
    buffer_load_dwordx4 v[80:83], v4, s[12:15], s22 offen offset:0
    buffer_load_dwordx4 v[84:87], v4, s[12:15], s22 offen offset:1024
    buffer_load_dwordx4 v[88:91], v4, s[12:15], s22 offen offset:2048
    buffer_load_dwordx4 v[92:95], v4, s[12:15], s22 offen offset:3072
    s_add_u32 s22, s22, 4096
    buffer_load_dwordx4 v[96:99], v4, s[12:15], s22 offen offset:0
    buffer_load_dwordx4 v[100:103], v4, s[12:15], s22 offen offset:1024
    buffer_load_dwordx4 v[104:107], v4, s[12:15], s22 offen offset:2048
    buffer_load_dwordx4 v[108:111], v4, s[12:15], s22 offen offset:3072
    s_add_u32 s22, s22, 4096
    buffer_load_dwordx4 v[112:115], v4, s[12:15], s22 offen offset:0
    buffer_load_dwordx4 v[116:119], v4, s[12:15], s22 offen offset:1024
    buffer_load_dwordx4 v[120:123], v4, s[12:15], s22 offen offset:2048
    buffer_load_dwordx4 v[124:127], v4, s[12:15], s22 offen offset:3072
    s_add_u32 s22, s22, 4096
    buffer_load_dwordx4 v[128:131], v4, s[12:15], s22 offen offset:0
    buffer_load_dwordx4 v[132:135], v4, s[12:15], s22 offen offset:1024
    buffer_load_dwordx4 v[136:139], v4, s[12:15], s22 offen offset:2048
    buffer_load_dwordx4 v[140:143], v4, s[12:15], s22 offen offset:3072
    s_add_u32 s22, s22, 4096
    buffer_load_dwordx4 v[144:147], v4, s[12:15], s22 offen offset:0
    buffer_load_dwordx4 v[148:151], v4, s[12:15], s22 offen offset:1024
    buffer_load_dwordx4 v[152:155], v4, s[12:15], s22 offen offset:2048
    buffer_load_dwordx4 v[156:159], v4, s[12:15], s22 offen offset:3072
    s_add_u32 s22, s22, 4096
    buffer_load_dwordx4 v[160:163], v4, s[12:15], s22 offen offset:0
    buffer_load_dwordx4 v[164:167], v4, s[12:15], s22 offen offset:1024
    buffer_load_dwordx4 v[168:171], v4, s[12:15], s22 offen offset:2048
    buffer_load_dwordx4 v[172:175], v4, s[12:15], s22 offen offset:3072
    s_add_u32 s22, s22, 4096
    buffer_load_dwordx4 v[176:179], v4, s[12:15], s22 offen offset:0
    buffer_load_dwordx4 v[180:183], v4, s[12:15], s22 offen offset:1024
    buffer_load_dwordx4 v[184:187], v4, s[12:15], s22 offen offset:2048
    buffer_load_dwordx4 v[188:191], v4, s[12:15], s22 offen offset:3072
    s_add_u32 s22, s22, 4096
    s_waitcnt vmcnt(0)
    v_add_f32 v16, v16, v64
    v_add_f32 v17, v17, v65
    v_add_f32 v18, v18, v66
    v_add_f32 v19, v19, v67
    v_add_f32 v20, v20, v68
    v_add_f32 v21, v21, v69
    v_add_f32 v22, v22, v70
    v_add_f32 v23, v23, v71
    v_add_f32 v24, v24, v72
    v_add_f32 v25, v25, v73
    v_add_f32 v26, v26, v74
    v_add_f32 v27, v27, v75
    v_add_f32 v28, v28, v76
    v_add_f32 v29, v29, v77
    v_add_f32 v30, v30, v78
    v_add_f32 v31, v31, v79
    v_add_f32 v32, v32, v80
    v_add_f32 v33, v33, v81
    v_add_f32 v34, v34, v82
    v_add_f32 v35, v35, v83
    v_add_f32 v36, v36, v84
    v_add_f32 v37, v37, v85
    v_add_f32 v38, v38, v86
    v_add_f32 v39, v39, v87
    v_add_f32 v40, v40, v88
    v_add_f32 v41, v41, v89
    v_add_f32 v42, v42, v90
    v_add_f32 v43, v43, v91
    v_add_f32 v44, v44, v92
    v_add_f32 v45, v45, v93
    v_add_f32 v46, v46, v94
    v_add_f32 v47, v47, v95
    v_add_f32 v16, v16, v96
    v_add_f32 v17, v17, v97
    v_add_f32 v18, v18, v98
    v_add_f32 v19, v19, v99
    v_add_f32 v20, v20, v100
    v_add_f32 v21, v21, v101
    v_add_f32 v22, v22, v102
    v_add_f32 v23, v23, v103
    v_add_f32 v24, v24, v104
    v_add_f32 v25, v25, v105
    v_add_f32 v26, v26, v106
    v_add_f32 v27, v27, v107
    v_add_f32 v28, v28, v108
    v_add_f32 v29, v29, v109
    v_add_f32 v30, v30, v110
    v_add_f32 v31, v31, v111
    v_add_f32 v32, v32, v112
    v_add_f32 v33, v33, v113
    v_add_f32 v34, v34, v114
    v_add_f32 v35, v35, v115
    v_add_f32 v36, v36, v116
    v_add_f32 v37, v37, v117
    v_add_f32 v38, v38, v118
    v_add_f32 v39, v39, v119
    v_add_f32 v40, v40, v120
    v_add_f32 v41, v41, v121
    v_add_f32 v42, v42, v122
    v_add_f32 v43, v43, v123
    v_add_f32 v44, v44, v124
    v_add_f32 v45, v45, v125
    v_add_f32 v46, v46, v126
    v_add_f32 v47, v47, v127
    v_add_f32 v16, v16, v128
    v_add_f32 v17, v17, v129
    v_add_f32 v18, v18, v130
    v_add_f32 v19, v19, v131
    v_add_f32 v20, v20, v132
    v_add_f32 v21, v21, v133
    v_add_f32 v22, v22, v134
    v_add_f32 v23, v23, v135
    v_add_f32 v24, v24, v136
    v_add_f32 v25, v25, v137
    v_add_f32 v26, v26, v138
    v_add_f32 v27, v27, v139
    v_add_f32 v28, v28, v140
    v_add_f32 v29, v29, v141
    v_add_f32 v30, v30, v142
    v_add_f32 v31, v31, v143
    v_add_f32 v32, v32, v144
    v_add_f32 v33, v33, v145
    v_add_f32 v34, v34, v146
    v_add_f32 v35, v35, v147
    v_add_f32 v36, v36, v148
    v_add_f32 v37, v37, v149
    v_add_f32 v38, v38, v150
    v_add_f32 v39, v39, v151
    v_add_f32 v40, v40, v152
    v_add_f32 v41, v41, v153
    v_add_f32 v42, v42, v154
    v_add_f32 v43, v43, v155
    v_add_f32 v44, v44, v156
    v_add_f32 v45, v45, v157
    v_add_f32 v46, v46, v158
    v_add_f32 v47, v47, v159
    v_add_f32 v16, v16, v160
    v_add_f32 v17, v17, v161
    v_add_f32 v18, v18, v162
    v_add_f32 v19, v19, v163
    v_add_f32 v20, v20, v164
    v_add_f32 v21, v21, v165
    v_add_f32 v22, v22, v166
    v_add_f32 v23, v23, v167
    v_add_f32 v24, v24, v168
    v_add_f32 v25, v25, v169
    v_add_f32 v26, v26, v170
    v_add_f32 v27, v27, v171
    v_add_f32 v28, v28, v172
    v_add_f32 v29, v29, v173
    v_add_f32 v30, v30, v174
    v_add_f32 v31, v31, v175
    v_add_f32 v32, v32, v176
    v_add_f32 v33, v33, v177
    v_add_f32 v34, v34, v178
    v_add_f32 v35, v35, v179
    v_add_f32 v36, v36, v180
    v_add_f32 v37, v37, v181
    v_add_f32 v38, v38, v182
    v_add_f32 v39, v39, v183
    v_add_f32 v40, v40, v184
    v_add_f32 v41, v41, v185
    v_add_f32 v42, v42, v186
    v_add_f32 v43, v43, v187
    v_add_f32 v44, v44, v188
    v_add_f32 v45, v45, v189
    v_add_f32 v46, v46, v190
    v_add_f32 v47, v47, v191
    s_lshl_b32 s22, s3, 13
    v_add_u32 v5, s22, v4
    ds_write_b128 v5, v[16:19] offset:0
    ds_write_b128 v5, v[20:23] offset:1024
    ds_write_b128 v5, v[24:27] offset:2048
    ds_write_b128 v5, v[28:31] offset:3072
    ds_write_b128 v5, v[32:35] offset:4096
    ds_write_b128 v5, v[36:39] offset:5120
    ds_write_b128 v5, v[40:43] offset:6144
    ds_write_b128 v5, v[44:47] offset:7168
    s_waitcnt lgkmcnt(0)
    s_barrier
    ds_read_b128 v[64:67], v4 offset:0
    ds_read_b128 v[68:71], v4 offset:1024
    ds_read_b128 v[72:75], v4 offset:2048
    ds_read_b128 v[76:79], v4 offset:3072
    ds_read_b128 v[80:83], v4 offset:4096
    ds_read_b128 v[84:87], v4 offset:5120
    ds_read_b128 v[88:91], v4 offset:6144
    ds_read_b128 v[92:95], v4 offset:7168
    ds_read_b128 v[96:99], v4 offset:8192
    ds_read_b128 v[100:103], v4 offset:9216
    ds_read_b128 v[104:107], v4 offset:10240
    ds_read_b128 v[108:111], v4 offset:11264
    ds_read_b128 v[112:115], v4 offset:12288
    ds_read_b128 v[116:119], v4 offset:13312
    ds_read_b128 v[120:123], v4 offset:14336
    ds_read_b128 v[124:127], v4 offset:15360
    ds_read_b128 v[128:131], v4 offset:16384
    ds_read_b128 v[132:135], v4 offset:17408
    ds_read_b128 v[136:139], v4 offset:18432
    ds_read_b128 v[140:143], v4 offset:19456
    ds_read_b128 v[144:147], v4 offset:20480
    ds_read_b128 v[148:151], v4 offset:21504
    ds_read_b128 v[152:155], v4 offset:22528
    ds_read_b128 v[156:159], v4 offset:23552
    ds_read_b128 v[160:163], v4 offset:24576
    ds_read_b128 v[164:167], v4 offset:25600
    ds_read_b128 v[168:171], v4 offset:26624
    ds_read_b128 v[172:175], v4 offset:27648
    ds_read_b128 v[176:179], v4 offset:28672
    ds_read_b128 v[180:183], v4 offset:29696
    ds_read_b128 v[184:187], v4 offset:30720
    ds_read_b128 v[188:191], v4 offset:31744
    s_waitcnt lgkmcnt(0)
    v_add_f32 v16, v64, v96
    v_add_f32 v128, v128, v160
    v_add_f32 v16, v16, v128
    v_add_f32 v17, v65, v97
    v_add_f32 v129, v129, v161
    v_add_f32 v17, v17, v129
    v_add_f32 v18, v66, v98
    v_add_f32 v130, v130, v162
    v_add_f32 v18, v18, v130
    v_add_f32 v19, v67, v99
    v_add_f32 v131, v131, v163
    v_add_f32 v19, v19, v131
    v_add_f32 v20, v68, v100
    v_add_f32 v132, v132, v164
    v_add_f32 v20, v20, v132
    v_add_f32 v21, v69, v101
    v_add_f32 v133, v133, v165
    v_add_f32 v21, v21, v133
    v_add_f32 v22, v70, v102
    v_add_f32 v134, v134, v166
    v_add_f32 v22, v22, v134
    v_add_f32 v23, v71, v103
    v_add_f32 v135, v135, v167
    v_add_f32 v23, v23, v135
    v_add_f32 v24, v72, v104
    v_add_f32 v136, v136, v168
    v_add_f32 v24, v24, v136
    v_add_f32 v25, v73, v105
    v_add_f32 v137, v137, v169
    v_add_f32 v25, v25, v137
    v_add_f32 v26, v74, v106
    v_add_f32 v138, v138, v170
    v_add_f32 v26, v26, v138
    v_add_f32 v27, v75, v107
    v_add_f32 v139, v139, v171
    v_add_f32 v27, v27, v139
    v_add_f32 v28, v76, v108
    v_add_f32 v140, v140, v172
    v_add_f32 v28, v28, v140
    v_add_f32 v29, v77, v109
    v_add_f32 v141, v141, v173
    v_add_f32 v29, v29, v141
    v_add_f32 v30, v78, v110
    v_add_f32 v142, v142, v174
    v_add_f32 v30, v30, v142
    v_add_f32 v31, v79, v111
    v_add_f32 v143, v143, v175
    v_add_f32 v31, v31, v143
    v_add_f32 v32, v80, v112
    v_add_f32 v144, v144, v176
    v_add_f32 v32, v32, v144
    v_add_f32 v33, v81, v113
    v_add_f32 v145, v145, v177
    v_add_f32 v33, v33, v145
    v_add_f32 v34, v82, v114
    v_add_f32 v146, v146, v178
    v_add_f32 v34, v34, v146
    v_add_f32 v35, v83, v115
    v_add_f32 v147, v147, v179
    v_add_f32 v35, v35, v147
    v_add_f32 v36, v84, v116
    v_add_f32 v148, v148, v180
    v_add_f32 v36, v36, v148
    v_add_f32 v37, v85, v117
    v_add_f32 v149, v149, v181
    v_add_f32 v37, v37, v149
    v_add_f32 v38, v86, v118
    v_add_f32 v150, v150, v182
    v_add_f32 v38, v38, v150
    v_add_f32 v39, v87, v119
    v_add_f32 v151, v151, v183
    v_add_f32 v39, v39, v151
    v_add_f32 v40, v88, v120
    v_add_f32 v152, v152, v184
    v_add_f32 v40, v40, v152
    v_add_f32 v41, v89, v121
    v_add_f32 v153, v153, v185
    v_add_f32 v41, v41, v153
    v_add_f32 v42, v90, v122
    v_add_f32 v154, v154, v186
    v_add_f32 v42, v42, v154
    v_add_f32 v43, v91, v123
    v_add_f32 v155, v155, v187
    v_add_f32 v43, v43, v155
    v_add_f32 v44, v92, v124
    v_add_f32 v156, v156, v188
    v_add_f32 v44, v44, v156
    v_add_f32 v45, v93, v125
    v_add_f32 v157, v157, v189
    v_add_f32 v45, v45, v157
    v_add_f32 v46, v94, v126
    v_add_f32 v158, v158, v190
    v_add_f32 v46, v46, v158
    v_add_f32 v47, v95, v127
    v_add_f32 v159, v159, v191
    v_add_f32 v47, v47, v159
    v_cvt_pk_bf16_f32 v48, v16, v17
    v_cvt_pk_bf16_f32 v49, v18, v19
    v_cvt_pk_bf16_f32 v50, v20, v21
    v_cvt_pk_bf16_f32 v51, v22, v23
    v_cvt_pk_bf16_f32 v52, v24, v25
    v_cndmask_b32 v52, 0, v52, s[30:31]
    v_mov_b32 v53, 0
    v_mov_b32 v54, 0
    v_mov_b32 v55, 0
    v_cvt_pk_bf16_f32 v56, v32, v33
    v_cvt_pk_bf16_f32 v57, v34, v35
    v_cvt_pk_bf16_f32 v58, v36, v37
    v_cvt_pk_bf16_f32 v59, v38, v39
    v_cvt_pk_bf16_f32 v60, v40, v41
    v_cndmask_b32 v60, 0, v60, s[30:31]
    v_mov_b32 v61, 0
    v_mov_b32 v62, 0
    v_mov_b32 v63, 0
    s_lshl_b32 s22, s16, 3
    s_lshl_b32 s23, s3, 1
    s_add_u32 s22, s22, s23
    s_add_u32 s22, s22, 0
    s_lshl_b32 s23, s18, 6
    s_add_u32 s23, s23, s22
    s_lshl_b32 s23, s23, 12
    s_add_u32 s23, s23, 17907712
    buffer_load_dwordx4 v[64:67], v4, s[12:15], s23 offen offset:0
    buffer_load_dwordx4 v[68:71], v4, s[12:15], s23 offen offset:1024
    buffer_load_dwordx4 v[72:75], v4, s[12:15], s23 offen offset:2048
    buffer_load_dwordx4 v[76:79], v4, s[12:15], s23 offen offset:3072
    s_lshl_b32 s22, s22, 5
    v_add_u32 v6, s22, v2
    v_mul_u32_u24 v6, 1152, v6
    s_mul_i32 s23, s18, 36
    v_lshl_add_u32 v6, v3, 3, v6
    v_add_u32 v6, s23, v6
    s_waitcnt vmcnt(0)
    v_mfma_f32_32x32x16_bf16 v[80:95], v[48:51], v[64:67], 0
    v_mfma_f32_32x32x16_bf16 v[80:95], v[52:55], v[68:71], v[80:95]
    v_mfma_f32_32x32x16_bf16 v[80:95], v[56:59], v[72:75], v[80:95]
    v_mfma_f32_32x32x16_bf16 v[80:95], v[60:63], v[76:79], v[80:95]
    s_nop 15
    v_mov_b32 v8, v90
    v_mov_b32 v9, v90
    s_nop 1
    v_permlane32_swap_b32 v8, v9
    v_cvt_pk_bf16_f32 v8, v8, v8
    v_lshlrev_b32 v8, 16, v8
    v_add_f32 v8, 0x358637bd, v8
    v_cvt_pk_bf16_f32 v8, v8, v8
    v_lshlrev_b32 v8, 16, v8
    v_rcp_f32 v8, v8
    s_nop 0
    v_cvt_pk_bf16_f32 v9, v80, v81
    v_lshlrev_b32 v80, 16, v9
    v_and_b32 v81, 0xffff0000, v9
    v_mul_f32 v80, v80, v8
    v_mul_f32 v81, v81, v8
    v_cvt_pk_bf16_f32 v100, v80, v81
    v_cvt_pk_bf16_f32 v9, v82, v83
    v_lshlrev_b32 v82, 16, v9
    v_and_b32 v83, 0xffff0000, v9
    v_mul_f32 v82, v82, v8
    v_mul_f32 v83, v83, v8
    v_cvt_pk_bf16_f32 v101, v82, v83
    v_cvt_pk_bf16_f32 v9, v84, v85
    v_lshlrev_b32 v84, 16, v9
    v_and_b32 v85, 0xffff0000, v9
    v_mul_f32 v84, v84, v8
    v_mul_f32 v85, v85, v8
    v_cvt_pk_bf16_f32 v102, v84, v85
    v_cvt_pk_bf16_f32 v9, v86, v87
    v_lshlrev_b32 v86, 16, v9
    v_and_b32 v87, 0xffff0000, v9
    v_mul_f32 v86, v86, v8
    v_mul_f32 v87, v87, v8
    v_cvt_pk_bf16_f32 v103, v86, v87
    v_cvt_pk_bf16_f32 v9, v88, v89
    v_lshlrev_b32 v88, 16, v9
    v_and_b32 v89, 0xffff0000, v9
    v_mul_f32 v88, v88, v8
    v_mul_f32 v89, v89, v8
    v_cvt_pk_bf16_f32 v104, v88, v89
    s_lshr_b32 s22, s22, 5
    s_mul_i32 s26, s22, 36864
    s_add_u32 s26, s26, 15548416
    s_mul_i32 s27, s18, 18
    v_lshlrev_b32 v112, 2, v3
    v_add_u32 v112, s27, v112
    v_add_u32 v110, 0, v112
    v_lshrrev_b32 v111, 4, v110
    v_lshlrev_b32 v111, 10, v111
    v_lshl_add_u32 v111, v2, 4, v111
    v_bfe_u32 v113, v110, 3, 1
    v_lshl_add_u32 v111, v113, 9, v111
    v_and_b32 v113, 7, v110
    v_lshl_add_u32 v111, v113, 1, v111
    buffer_store_dword v100, v111, s[12:15], s26 offen
    v_add_u32 v110, 2, v112
    v_lshrrev_b32 v111, 4, v110
    v_lshlrev_b32 v111, 10, v111
    v_lshl_add_u32 v111, v2, 4, v111
    v_bfe_u32 v113, v110, 3, 1
    v_lshl_add_u32 v111, v113, 9, v111
    v_and_b32 v113, 7, v110
    v_lshl_add_u32 v111, v113, 1, v111
    buffer_store_dword v101, v111, s[12:15], s26 offen
    v_add_u32 v110, 8, v112
    v_lshrrev_b32 v111, 4, v110
    v_lshlrev_b32 v111, 10, v111
    v_lshl_add_u32 v111, v2, 4, v111
    v_bfe_u32 v113, v110, 3, 1
    v_lshl_add_u32 v111, v113, 9, v111
    v_and_b32 v113, 7, v110
    v_lshl_add_u32 v111, v113, 1, v111
    buffer_store_dword v102, v111, s[12:15], s26 offen
    v_add_u32 v110, 10, v112
    v_lshrrev_b32 v111, 4, v110
    v_lshlrev_b32 v111, 10, v111
    v_lshl_add_u32 v111, v2, 4, v111
    v_bfe_u32 v113, v110, 3, 1
    v_lshl_add_u32 v111, v113, 9, v111
    v_and_b32 v113, 7, v110
    v_lshl_add_u32 v111, v113, 1, v111
    buffer_store_dword v103, v111, s[12:15], s26 offen
    v_add_u32 v110, 16, v112
    v_lshrrev_b32 v111, 4, v110
    v_lshlrev_b32 v111, 10, v111
    v_lshl_add_u32 v111, v2, 4, v111
    v_bfe_u32 v113, v110, 3, 1
    v_lshl_add_u32 v111, v113, 9, v111
    v_and_b32 v113, 7, v110
    v_lshl_add_u32 v111, v113, 1, v111
    s_mov_b64 exec, s[30:31]
    buffer_store_dword v104, v111, s[12:15], s26 offen
    s_mov_b64 exec, -1
    s_lshl_b32 s22, s16, 3
    s_lshl_b32 s23, s3, 1
    s_add_u32 s22, s22, s23
    s_add_u32 s22, s22, 1
    s_lshl_b32 s23, s18, 6
    s_add_u32 s23, s23, s22
    s_lshl_b32 s23, s23, 12
    s_add_u32 s23, s23, 17907712
    buffer_load_dwordx4 v[64:67], v4, s[12:15], s23 offen offset:0
    buffer_load_dwordx4 v[68:71], v4, s[12:15], s23 offen offset:1024
    buffer_load_dwordx4 v[72:75], v4, s[12:15], s23 offen offset:2048
    buffer_load_dwordx4 v[76:79], v4, s[12:15], s23 offen offset:3072
    s_lshl_b32 s22, s22, 5
    v_add_u32 v6, s22, v2
    v_mul_u32_u24 v6, 1152, v6
    s_mul_i32 s23, s18, 36
    v_lshl_add_u32 v6, v3, 3, v6
    v_add_u32 v6, s23, v6
    s_waitcnt vmcnt(0)
    v_mfma_f32_32x32x16_bf16 v[80:95], v[48:51], v[64:67], 0
    v_mfma_f32_32x32x16_bf16 v[80:95], v[52:55], v[68:71], v[80:95]
    v_mfma_f32_32x32x16_bf16 v[80:95], v[56:59], v[72:75], v[80:95]
    v_mfma_f32_32x32x16_bf16 v[80:95], v[60:63], v[76:79], v[80:95]
    s_nop 15
    v_mov_b32 v8, v90
    v_mov_b32 v9, v90
    s_nop 1
    v_permlane32_swap_b32 v8, v9
    v_cvt_pk_bf16_f32 v8, v8, v8
    v_lshlrev_b32 v8, 16, v8
    v_add_f32 v8, 0x358637bd, v8
    v_cvt_pk_bf16_f32 v8, v8, v8
    v_lshlrev_b32 v8, 16, v8
    v_rcp_f32 v8, v8
    s_nop 0
    v_cvt_pk_bf16_f32 v9, v80, v81
    v_lshlrev_b32 v80, 16, v9
    v_and_b32 v81, 0xffff0000, v9
    v_mul_f32 v80, v80, v8
    v_mul_f32 v81, v81, v8
    v_cvt_pk_bf16_f32 v100, v80, v81
    v_cvt_pk_bf16_f32 v9, v82, v83
    v_lshlrev_b32 v82, 16, v9
    v_and_b32 v83, 0xffff0000, v9
    v_mul_f32 v82, v82, v8
    v_mul_f32 v83, v83, v8
    v_cvt_pk_bf16_f32 v101, v82, v83
    v_cvt_pk_bf16_f32 v9, v84, v85
    v_lshlrev_b32 v84, 16, v9
    v_and_b32 v85, 0xffff0000, v9
    v_mul_f32 v84, v84, v8
    v_mul_f32 v85, v85, v8
    v_cvt_pk_bf16_f32 v102, v84, v85
    v_cvt_pk_bf16_f32 v9, v86, v87
    v_lshlrev_b32 v86, 16, v9
    v_and_b32 v87, 0xffff0000, v9
    v_mul_f32 v86, v86, v8
    v_mul_f32 v87, v87, v8
    v_cvt_pk_bf16_f32 v103, v86, v87
    v_cvt_pk_bf16_f32 v9, v88, v89
    v_lshlrev_b32 v88, 16, v9
    v_and_b32 v89, 0xffff0000, v9
    v_mul_f32 v88, v88, v8
    v_mul_f32 v89, v89, v8
    v_cvt_pk_bf16_f32 v104, v88, v89
    s_lshr_b32 s22, s22, 5
    s_mul_i32 s26, s22, 36864
    s_add_u32 s26, s26, 15548416
    s_mul_i32 s27, s18, 18
    v_lshlrev_b32 v112, 2, v3
    v_add_u32 v112, s27, v112
    v_add_u32 v110, 0, v112
    v_lshrrev_b32 v111, 4, v110
    v_lshlrev_b32 v111, 10, v111
    v_lshl_add_u32 v111, v2, 4, v111
    v_bfe_u32 v113, v110, 3, 1
    v_lshl_add_u32 v111, v113, 9, v111
    v_and_b32 v113, 7, v110
    v_lshl_add_u32 v111, v113, 1, v111
    buffer_store_dword v100, v111, s[12:15], s26 offen
    v_add_u32 v110, 2, v112
    v_lshrrev_b32 v111, 4, v110
    v_lshlrev_b32 v111, 10, v111
    v_lshl_add_u32 v111, v2, 4, v111
    v_bfe_u32 v113, v110, 3, 1
    v_lshl_add_u32 v111, v113, 9, v111
    v_and_b32 v113, 7, v110
    v_lshl_add_u32 v111, v113, 1, v111
    buffer_store_dword v101, v111, s[12:15], s26 offen
    v_add_u32 v110, 8, v112
    v_lshrrev_b32 v111, 4, v110
    v_lshlrev_b32 v111, 10, v111
    v_lshl_add_u32 v111, v2, 4, v111
    v_bfe_u32 v113, v110, 3, 1
    v_lshl_add_u32 v111, v113, 9, v111
    v_and_b32 v113, 7, v110
    v_lshl_add_u32 v111, v113, 1, v111
    buffer_store_dword v102, v111, s[12:15], s26 offen
    v_add_u32 v110, 10, v112
    v_lshrrev_b32 v111, 4, v110
    v_lshlrev_b32 v111, 10, v111
    v_lshl_add_u32 v111, v2, 4, v111
    v_bfe_u32 v113, v110, 3, 1
    v_lshl_add_u32 v111, v113, 9, v111
    v_and_b32 v113, 7, v110
    v_lshl_add_u32 v111, v113, 1, v111
    buffer_store_dword v103, v111, s[12:15], s26 offen
    v_add_u32 v110, 16, v112
    v_lshrrev_b32 v111, 4, v110
    v_lshlrev_b32 v111, 10, v111
    v_lshl_add_u32 v111, v2, 4, v111
    v_bfe_u32 v113, v110, 3, 1
    v_lshl_add_u32 v111, v113, 9, v111
    v_and_b32 v113, 7, v110
    v_lshl_add_u32 v111, v113, 1, v111
    s_mov_b64 exec, s[30:31]
    buffer_store_dword v104, v111, s[12:15], s26 offen
    s_mov_b64 exec, -1
L_a2_l0_kernel_end:
    s_endpgm
.globl outa_l0_kernel
.p2align 8
.type outa_l0_kernel,@function
outa_l0_kernel:
    s_cmp_ge_u32 s2, 288
    s_cbranch_scc1 L_outa_l0_kernel_end
    s_load_dwordx2 s[4:5], s[0:1], 72
    s_load_dwordx2 s[6:7], s[0:1], 0
    s_load_dwordx2 s[36:37], s[0:1], 56
    v_lshrrev_b32 v1, 6, v0
    s_nop 0
    v_readfirstlane_b32 s3, v1
    v_and_b32 v1, 63, v0
    v_and_b32 v2, 31, v1
    v_lshrrev_b32 v3, 5, v1
    v_lshlrev_b32 v4, 4, v1
    s_mov_b32 s30, -1
    s_mov_b32 s31, 0
    s_waitcnt lgkmcnt(0)
    s_mov_b32 s12, s4
    s_mov_b32 s13, s5
    s_mov_b32 s14, 268435456
    s_mov_b32 s15, 0x00020000
    s_mov_b32 s8, s6
    s_mov_b32 s9, s7
    s_mov_b32 s10, 2359296
    s_mov_b32 s11, 0x00020000
    s_add_u32 s40, s4, 8470528
    s_addc_u32 s41, s5, 0
    s_mov_b32 s42, 2359296
    s_mov_b32 s43, 0x00020000
    s_mul_i32 s16, s2, 7282
    s_lshr_b32 s16, s16, 16
    s_mul_i32 s17, s16, 9
    s_sub_u32 s17, s2, s17
    s_lshl_b32 s16, s16, 1
    s_and_b32 s18, s3, 1
    s_add_u32 s16, s16, s18
    s_lshl_b32 s17, s17, 1
    s_lshr_b32 s18, s3, 1
    s_add_u32 s17, s17, s18
    s_mul_i32 s19, s17, 36864
    s_add_u32 s19, s19, 7077888
    s_lshl_b32 s20, s16, 5
    v_add_u32 v5, s20, v2
    v_mul_u32_u24 v5, 1152, v5
    v_lshl_add_u32 v6, v3, 4, v5
    s_mul_i32 s21, s16, 36864
    s_add_u32 s21, s21, 15548416
    buffer_load_dwordx4 v[40:43], v4, s[12:15], s19 offen
    buffer_load_dwordx4 v[44:47], v4, s[12:15], s21 offen
    s_add_u32 s19, s19, 1024
    s_add_u32 s21, s21, 1024
    buffer_load_dwordx4 v[48:51], v4, s[12:15], s19 offen
    buffer_load_dwordx4 v[52:55], v4, s[12:15], s21 offen
    s_add_u32 s19, s19, 1024
    s_add_u32 s21, s21, 1024
    buffer_load_dwordx4 v[56:59], v4, s[12:15], s19 offen
    buffer_load_dwordx4 v[60:63], v4, s[12:15], s21 offen
    s_add_u32 s19, s19, 1024
    s_add_u32 s21, s21, 1024
    buffer_load_dwordx4 v[64:67], v4, s[12:15], s19 offen
    buffer_load_dwordx4 v[68:71], v4, s[12:15], s21 offen
    s_add_u32 s19, s19, 1024
    s_add_u32 s21, s21, 1024
    buffer_load_dwordx4 v[72:75], v4, s[12:15], s19 offen
    buffer_load_dwordx4 v[76:79], v4, s[12:15], s21 offen
    s_add_u32 s19, s19, 1024
    s_add_u32 s21, s21, 1024
    buffer_load_dwordx4 v[80:83], v4, s[12:15], s19 offen
    buffer_load_dwordx4 v[84:87], v4, s[12:15], s21 offen
    s_add_u32 s19, s19, 1024
    s_add_u32 s21, s21, 1024
    buffer_load_dwordx4 v[88:91], v4, s[12:15], s19 offen
    buffer_load_dwordx4 v[92:95], v4, s[12:15], s21 offen
    s_add_u32 s19, s19, 1024
    s_add_u32 s21, s21, 1024
    buffer_load_dwordx4 v[96:99], v4, s[12:15], s19 offen
    buffer_load_dwordx4 v[100:103], v4, s[12:15], s21 offen
    s_add_u32 s19, s19, 1024
    s_add_u32 s21, s21, 1024
    buffer_load_dwordx4 v[104:107], v4, s[12:15], s19 offen
    buffer_load_dwordx4 v[108:111], v4, s[12:15], s21 offen
    s_add_u32 s19, s19, 1024
    s_add_u32 s21, s21, 1024
    buffer_load_dwordx4 v[112:115], v4, s[12:15], s19 offen
    buffer_load_dwordx4 v[116:119], v4, s[12:15], s21 offen
    s_add_u32 s19, s19, 1024
    s_add_u32 s21, s21, 1024
    buffer_load_dwordx4 v[120:123], v4, s[12:15], s19 offen
    buffer_load_dwordx4 v[124:127], v4, s[12:15], s21 offen
    s_add_u32 s19, s19, 1024
    s_add_u32 s21, s21, 1024
    buffer_load_dwordx4 v[128:131], v4, s[12:15], s19 offen
    buffer_load_dwordx4 v[132:135], v4, s[12:15], s21 offen
    s_add_u32 s19, s19, 1024
    s_add_u32 s21, s21, 1024
    buffer_load_dwordx4 v[136:139], v4, s[12:15], s19 offen
    buffer_load_dwordx4 v[140:143], v4, s[12:15], s21 offen
    s_add_u32 s19, s19, 1024
    s_add_u32 s21, s21, 1024
    buffer_load_dwordx4 v[144:147], v4, s[12:15], s19 offen
    buffer_load_dwordx4 v[148:151], v4, s[12:15], s21 offen
    s_add_u32 s19, s19, 1024
    s_add_u32 s21, s21, 1024
    buffer_load_dwordx4 v[152:155], v4, s[12:15], s19 offen
    buffer_load_dwordx4 v[156:159], v4, s[12:15], s21 offen
    s_add_u32 s19, s19, 1024
    s_add_u32 s21, s21, 1024
    s_waitcnt vmcnt(28)
    v_mfma_f32_32x32x16_bf16 v[16:31], v[40:43], v[44:47], 0
    buffer_load_dwordx4 v[40:43], v4, s[12:15], s19 offen
    buffer_load_dwordx4 v[44:47], v4, s[12:15], s21 offen
    s_add_u32 s19, s19, 1024
    s_add_u32 s21, s21, 1024
    s_waitcnt vmcnt(28)
    v_mfma_f32_32x32x16_bf16 v[16:31], v[48:51], v[52:55], v[16:31]
    buffer_load_dwordx4 v[48:51], v4, s[12:15], s19 offen
    buffer_load_dwordx4 v[52:55], v4, s[12:15], s21 offen
    s_add_u32 s19, s19, 1024
    s_add_u32 s21, s21, 1024
    s_waitcnt vmcnt(28)
    v_mfma_f32_32x32x16_bf16 v[16:31], v[56:59], v[60:63], v[16:31]
    buffer_load_dwordx4 v[56:59], v4, s[12:15], s19 offen
    buffer_load_dwordx4 v[60:63], v4, s[12:15], s21 offen
    s_add_u32 s19, s19, 1024
    s_add_u32 s21, s21, 1024
    s_waitcnt vmcnt(28)
    v_mfma_f32_32x32x16_bf16 v[16:31], v[64:67], v[68:71], v[16:31]
    buffer_load_dwordx4 v[64:67], v4, s[12:15], s19 offen
    buffer_load_dwordx4 v[68:71], v4, s[12:15], s21 offen
    s_add_u32 s19, s19, 1024
    s_add_u32 s21, s21, 1024
    s_waitcnt vmcnt(28)
    v_mfma_f32_32x32x16_bf16 v[16:31], v[72:75], v[76:79], v[16:31]
    buffer_load_dwordx4 v[72:75], v4, s[12:15], s19 offen
    buffer_load_dwordx4 v[76:79], v4, s[12:15], s21 offen
    s_add_u32 s19, s19, 1024
    s_add_u32 s21, s21, 1024
    s_waitcnt vmcnt(28)
    v_mfma_f32_32x32x16_bf16 v[16:31], v[80:83], v[84:87], v[16:31]
    buffer_load_dwordx4 v[80:83], v4, s[12:15], s19 offen
    buffer_load_dwordx4 v[84:87], v4, s[12:15], s21 offen
    s_add_u32 s19, s19, 1024
    s_add_u32 s21, s21, 1024
    s_waitcnt vmcnt(28)
    v_mfma_f32_32x32x16_bf16 v[16:31], v[88:91], v[92:95], v[16:31]
    buffer_load_dwordx4 v[88:91], v4, s[12:15], s19 offen
    buffer_load_dwordx4 v[92:95], v4, s[12:15], s21 offen
    s_add_u32 s19, s19, 1024
    s_add_u32 s21, s21, 1024
    s_waitcnt vmcnt(28)
    v_mfma_f32_32x32x16_bf16 v[16:31], v[96:99], v[100:103], v[16:31]
    buffer_load_dwordx4 v[96:99], v4, s[12:15], s19 offen
    buffer_load_dwordx4 v[100:103], v4, s[12:15], s21 offen
    s_add_u32 s19, s19, 1024
    s_add_u32 s21, s21, 1024
    s_waitcnt vmcnt(28)
    v_mfma_f32_32x32x16_bf16 v[16:31], v[104:107], v[108:111], v[16:31]
    buffer_load_dwordx4 v[104:107], v4, s[12:15], s19 offen
    buffer_load_dwordx4 v[108:111], v4, s[12:15], s21 offen
    s_add_u32 s19, s19, 1024
    s_add_u32 s21, s21, 1024
    s_waitcnt vmcnt(28)
    v_mfma_f32_32x32x16_bf16 v[16:31], v[112:115], v[116:119], v[16:31]
    buffer_load_dwordx4 v[112:115], v4, s[12:15], s19 offen
    buffer_load_dwordx4 v[116:119], v4, s[12:15], s21 offen
    s_add_u32 s19, s19, 1024
    s_add_u32 s21, s21, 1024
    s_waitcnt vmcnt(28)
    v_mfma_f32_32x32x16_bf16 v[16:31], v[120:123], v[124:127], v[16:31]
    buffer_load_dwordx4 v[120:123], v4, s[12:15], s19 offen
    buffer_load_dwordx4 v[124:127], v4, s[12:15], s21 offen
    s_add_u32 s19, s19, 1024
    s_add_u32 s21, s21, 1024
    s_waitcnt vmcnt(28)
    v_mfma_f32_32x32x16_bf16 v[16:31], v[128:131], v[132:135], v[16:31]
    buffer_load_dwordx4 v[128:131], v4, s[12:15], s19 offen
    buffer_load_dwordx4 v[132:135], v4, s[12:15], s21 offen
    s_add_u32 s19, s19, 1024
    s_add_u32 s21, s21, 1024
    s_waitcnt vmcnt(28)
    v_mfma_f32_32x32x16_bf16 v[16:31], v[136:139], v[140:143], v[16:31]
    buffer_load_dwordx4 v[136:139], v4, s[12:15], s19 offen
    buffer_load_dwordx4 v[140:143], v4, s[12:15], s21 offen
    s_add_u32 s19, s19, 1024
    s_add_u32 s21, s21, 1024
    s_waitcnt vmcnt(28)
    v_mfma_f32_32x32x16_bf16 v[16:31], v[144:147], v[148:151], v[16:31]
    buffer_load_dwordx4 v[144:147], v4, s[12:15], s19 offen
    buffer_load_dwordx4 v[148:151], v4, s[12:15], s21 offen
    s_add_u32 s19, s19, 1024
    s_add_u32 s21, s21, 1024
    s_waitcnt vmcnt(28)
    v_mfma_f32_32x32x16_bf16 v[16:31], v[152:155], v[156:159], v[16:31]
    buffer_load_dwordx4 v[152:155], v4, s[12:15], s19 offen
    buffer_load_dwordx4 v[156:159], v4, s[12:15], s21 offen
    s_add_u32 s19, s19, 1024
    s_add_u32 s21, s21, 1024
    s_waitcnt vmcnt(28)
    v_mfma_f32_32x32x16_bf16 v[16:31], v[40:43], v[44:47], v[16:31]
    buffer_load_dwordx4 v[40:43], v4, s[12:15], s19 offen
    buffer_load_dwordx4 v[44:47], v4, s[12:15], s21 offen
    s_add_u32 s19, s19, 1024
    s_add_u32 s21, s21, 1024
    s_waitcnt vmcnt(28)
    v_mfma_f32_32x32x16_bf16 v[16:31], v[48:51], v[52:55], v[16:31]
    buffer_load_dwordx4 v[48:51], v4, s[12:15], s19 offen
    buffer_load_dwordx4 v[52:55], v4, s[12:15], s21 offen
    s_add_u32 s19, s19, 1024
    s_add_u32 s21, s21, 1024
    s_waitcnt vmcnt(28)
    v_mfma_f32_32x32x16_bf16 v[16:31], v[56:59], v[60:63], v[16:31]
    buffer_load_dwordx4 v[56:59], v4, s[12:15], s19 offen
    buffer_load_dwordx4 v[60:63], v4, s[12:15], s21 offen
    s_add_u32 s19, s19, 1024
    s_add_u32 s21, s21, 1024
    s_waitcnt vmcnt(28)
    v_mfma_f32_32x32x16_bf16 v[16:31], v[64:67], v[68:71], v[16:31]
    buffer_load_dwordx4 v[64:67], v4, s[12:15], s19 offen
    buffer_load_dwordx4 v[68:71], v4, s[12:15], s21 offen
    s_add_u32 s19, s19, 1024
    s_add_u32 s21, s21, 1024
    s_waitcnt vmcnt(28)
    v_mfma_f32_32x32x16_bf16 v[16:31], v[72:75], v[76:79], v[16:31]
    buffer_load_dwordx4 v[72:75], v4, s[12:15], s19 offen
    buffer_load_dwordx4 v[76:79], v4, s[12:15], s21 offen
    s_add_u32 s19, s19, 1024
    s_add_u32 s21, s21, 1024
    s_waitcnt vmcnt(28)
    v_mfma_f32_32x32x16_bf16 v[16:31], v[80:83], v[84:87], v[16:31]
    buffer_load_dwordx4 v[80:83], v4, s[12:15], s19 offen
    buffer_load_dwordx4 v[84:87], v4, s[12:15], s21 offen
    s_add_u32 s19, s19, 1024
    s_add_u32 s21, s21, 1024
    s_waitcnt vmcnt(28)
    v_mfma_f32_32x32x16_bf16 v[16:31], v[88:91], v[92:95], v[16:31]
    s_waitcnt vmcnt(26)
    v_mfma_f32_32x32x16_bf16 v[16:31], v[96:99], v[100:103], v[16:31]
    s_waitcnt vmcnt(24)
    v_mfma_f32_32x32x16_bf16 v[16:31], v[104:107], v[108:111], v[16:31]
    s_waitcnt vmcnt(22)
    v_mfma_f32_32x32x16_bf16 v[16:31], v[112:115], v[116:119], v[16:31]
    s_waitcnt vmcnt(20)
    v_mfma_f32_32x32x16_bf16 v[16:31], v[120:123], v[124:127], v[16:31]
    s_waitcnt vmcnt(18)
    v_mfma_f32_32x32x16_bf16 v[16:31], v[128:131], v[132:135], v[16:31]
    s_waitcnt vmcnt(16)
    v_mfma_f32_32x32x16_bf16 v[16:31], v[136:139], v[140:143], v[16:31]
    s_waitcnt vmcnt(14)
    v_mfma_f32_32x32x16_bf16 v[16:31], v[144:147], v[148:151], v[16:31]
    s_waitcnt vmcnt(12)
    v_mfma_f32_32x32x16_bf16 v[16:31], v[152:155], v[156:159], v[16:31]
    s_waitcnt vmcnt(10)
    v_mfma_f32_32x32x16_bf16 v[16:31], v[40:43], v[44:47], v[16:31]
    s_waitcnt vmcnt(8)
    v_mfma_f32_32x32x16_bf16 v[16:31], v[48:51], v[52:55], v[16:31]
    s_waitcnt vmcnt(6)
    v_mfma_f32_32x32x16_bf16 v[16:31], v[56:59], v[60:63], v[16:31]
    s_waitcnt vmcnt(4)
    v_mfma_f32_32x32x16_bf16 v[16:31], v[64:67], v[68:71], v[16:31]
    s_waitcnt vmcnt(2)
    v_mfma_f32_32x32x16_bf16 v[16:31], v[72:75], v[76:79], v[16:31]
    s_waitcnt vmcnt(0)
    v_mfma_f32_32x32x16_bf16 v[16:31], v[80:83], v[84:87], v[16:31]
    s_lshl_b32 s20, s17, 6
    v_lshl_add_u32 v7, v3, 3, v5
    v_add_u32 v7, s20, v7
    buffer_load_dwordx2 v[8:9], v7, s[8:11], 0 offen offset:0
    buffer_load_dwordx2 v[10:11], v7, s[8:11], 0 offen offset:16
    buffer_load_dwordx2 v[12:13], v7, s[8:11], 0 offen offset:32
    buffer_load_dwordx2 v[14:15], v7, s[8:11], 0 offen offset:48
    s_nop 15
    v_cvt_pk_bf16_f32 v90, v16, v17
    v_cvt_pk_bf16_f32 v91, v18, v19
    v_cvt_pk_bf16_f32 v92, v20, v21
    v_cvt_pk_bf16_f32 v93, v22, v23
    v_cvt_pk_bf16_f32 v94, v24, v25
    v_cvt_pk_bf16_f32 v95, v26, v27
    v_cvt_pk_bf16_f32 v96, v28, v29
    v_cvt_pk_bf16_f32 v97, v30, v31
    s_waitcnt vmcnt(0)
    v_lshlrev_b32 v100, 16, v90
    v_and_b32 v101, 0xffff0000, v90
    v_lshlrev_b32 v102, 16, v8
    v_and_b32 v103, 0xffff0000, v8
    v_add_f32 v100, v100, v102
    v_add_f32 v101, v101, v103
    v_cvt_pk_bf16_f32 v90, v100, v101
    v_lshlrev_b32 v100, 16, v91
    v_and_b32 v101, 0xffff0000, v91
    v_lshlrev_b32 v102, 16, v9
    v_and_b32 v103, 0xffff0000, v9
    v_add_f32 v100, v100, v102
    v_add_f32 v101, v101, v103
    v_cvt_pk_bf16_f32 v91, v100, v101
    v_lshlrev_b32 v100, 16, v92
    v_and_b32 v101, 0xffff0000, v92
    v_lshlrev_b32 v102, 16, v10
    v_and_b32 v103, 0xffff0000, v10
    v_add_f32 v100, v100, v102
    v_add_f32 v101, v101, v103
    v_cvt_pk_bf16_f32 v92, v100, v101
    v_lshlrev_b32 v100, 16, v93
    v_and_b32 v101, 0xffff0000, v93
    v_lshlrev_b32 v102, 16, v11
    v_and_b32 v103, 0xffff0000, v11
    v_add_f32 v100, v100, v102
    v_add_f32 v101, v101, v103
    v_cvt_pk_bf16_f32 v93, v100, v101
    v_lshlrev_b32 v100, 16, v94
    v_and_b32 v101, 0xffff0000, v94
    v_lshlrev_b32 v102, 16, v12
    v_and_b32 v103, 0xffff0000, v12
    v_add_f32 v100, v100, v102
    v_add_f32 v101, v101, v103
    v_cvt_pk_bf16_f32 v94, v100, v101
    v_lshlrev_b32 v100, 16, v95
    v_and_b32 v101, 0xffff0000, v95
    v_lshlrev_b32 v102, 16, v13
    v_and_b32 v103, 0xffff0000, v13
    v_add_f32 v100, v100, v102
    v_add_f32 v101, v101, v103
    v_cvt_pk_bf16_f32 v95, v100, v101
    v_lshlrev_b32 v100, 16, v96
    v_and_b32 v101, 0xffff0000, v96
    v_lshlrev_b32 v102, 16, v14
    v_and_b32 v103, 0xffff0000, v14
    v_add_f32 v100, v100, v102
    v_add_f32 v101, v101, v103
    v_cvt_pk_bf16_f32 v96, v100, v101
    v_lshlrev_b32 v100, 16, v97
    v_and_b32 v101, 0xffff0000, v97
    v_lshlrev_b32 v102, 16, v15
    v_and_b32 v103, 0xffff0000, v15
    v_add_f32 v100, v100, v102
    v_add_f32 v101, v101, v103
    v_cvt_pk_bf16_f32 v97, v100, v101
    buffer_store_dwordx2 v[90:91], v7, s[40:43], 0 offen offset:0
    buffer_store_dwordx2 v[92:93], v7, s[40:43], 0 offen offset:16
    buffer_store_dwordx2 v[94:95], v7, s[40:43], 0 offen offset:32
    buffer_store_dwordx2 v[96:97], v7, s[40:43], 0 offen offset:48
L_outa_l0_kernel_end:
    s_endpgm
.globl b1_l0_kernel
.p2align 8
.type b1_l0_kernel,@function
b1_l0_kernel:
    s_cmp_ge_u32 s2, 256
    s_cbranch_scc1 L_b1_l0_kernel_end
    s_load_dwordx2 s[4:5], s[0:1], 72
    s_load_dwordx2 s[6:7], s[0:1], 0
    v_lshrrev_b32 v1, 6, v0
    s_nop 0
    v_readfirstlane_b32 s3, v1
    v_and_b32 v1, 63, v0
    v_and_b32 v2, 31, v1
    v_lshrrev_b32 v3, 5, v1
    v_lshlrev_b32 v4, 4, v1
    s_lshr_b32 s16, s2, 3
    s_and_b32 s17, s2, 7
    s_lshl_b32 s17, s17, 2
    s_add_u32 s18, s17, s3
    s_mov_b32 s30, -1
    s_mov_b32 s31, 0
    s_waitcnt lgkmcnt(0)
    s_mov_b32 s12, s4
    s_mov_b32 s13, s5
    s_mov_b32 s14, 268435456
    s_mov_b32 s15, 0x00020000
    s_add_u32 s8, s4, 8470528
    s_addc_u32 s9, s5, 0
    s_mov_b32 s10, 2359296
    s_mov_b32 s11, 0x00020000
    s_lshl_b32 s19, s16, 6
    s_lshl_b32 s20, s3, 4
    s_add_u32 s19, s19, s20
    v_lshrrev_b32 v5, 3, v1
    v_add_u32 v5, s19, v5
    v_mul_u32_u24 v5, 1152, v5
    v_and_b32 v6, 7, v1
    v_lshl_add_u32 v5, v6, 4, v5
    buffer_load_dwordx4 v[16:19], v5, s[8:11], 0 offen offset:0
    buffer_load_dwordx4 v[20:23], v5, s[8:11], 0 offen offset:128
    buffer_load_dwordx4 v[24:27], v5, s[8:11], 0 offen offset:256
    buffer_load_dwordx4 v[28:31], v5, s[8:11], 0 offen offset:384
    buffer_load_dwordx4 v[32:35], v5, s[8:11], 0 offen offset:512
    buffer_load_dwordx4 v[36:39], v5, s[8:11], 0 offen offset:640
    buffer_load_dwordx4 v[40:43], v5, s[8:11], 0 offen offset:768
    buffer_load_dwordx4 v[44:47], v5, s[8:11], 0 offen offset:896
    buffer_load_dwordx4 v[48:51], v5, s[8:11], 0 offen offset:1024
    v_add_u32 v5, 9216, v5
    buffer_load_dwordx4 v[52:55], v5, s[8:11], 0 offen offset:0
    buffer_load_dwordx4 v[56:59], v5, s[8:11], 0 offen offset:128
    buffer_load_dwordx4 v[60:63], v5, s[8:11], 0 offen offset:256
    buffer_load_dwordx4 v[64:67], v5, s[8:11], 0 offen offset:384
    buffer_load_dwordx4 v[68:71], v5, s[8:11], 0 offen offset:512
    buffer_load_dwordx4 v[72:75], v5, s[8:11], 0 offen offset:640
    buffer_load_dwordx4 v[76:79], v5, s[8:11], 0 offen offset:768
    buffer_load_dwordx4 v[80:83], v5, s[8:11], 0 offen offset:896
    buffer_load_dwordx4 v[84:87], v5, s[8:11], 0 offen offset:1024
    s_mul_i32 s19, s18, 36864
    s_add_u32 s19, s19, 3538944
    s_add_u32 s20, s19, 1179648
    s_add_u32 s21, s19, 2359296
    s_waitcnt vmcnt(9)
    v_lshlrev_b32 v100, 16, v16
    v_and_b32 v101, 0xffff0000, v16
    v_lshlrev_b32 v102, 16, v17
    v_and_b32 v103, 0xffff0000, v17
    v_lshlrev_b32 v104, 16, v18
    v_and_b32 v105, 0xffff0000, v18
    v_lshlrev_b32 v106, 16, v19
    v_and_b32 v107, 0xffff0000, v19
    v_lshlrev_b32 v108, 16, v20
    v_and_b32 v109, 0xffff0000, v20
    v_lshlrev_b32 v110, 16, v21
    v_and_b32 v111, 0xffff0000, v21
    v_lshlrev_b32 v112, 16, v22
    v_and_b32 v113, 0xffff0000, v22
    v_lshlrev_b32 v114, 16, v23
    v_and_b32 v115, 0xffff0000, v23
    v_lshlrev_b32 v116, 16, v24
    v_and_b32 v117, 0xffff0000, v24
    v_lshlrev_b32 v118, 16, v25
    v_and_b32 v119, 0xffff0000, v25
    v_lshlrev_b32 v120, 16, v26
    v_and_b32 v121, 0xffff0000, v26
    v_lshlrev_b32 v122, 16, v27
    v_and_b32 v123, 0xffff0000, v27
    v_lshlrev_b32 v124, 16, v28
    v_and_b32 v125, 0xffff0000, v28
    v_lshlrev_b32 v126, 16, v29
    v_and_b32 v127, 0xffff0000, v29
    v_lshlrev_b32 v128, 16, v30
    v_and_b32 v129, 0xffff0000, v30
    v_lshlrev_b32 v130, 16, v31
    v_and_b32 v131, 0xffff0000, v31
    v_lshlrev_b32 v132, 16, v32
    v_and_b32 v133, 0xffff0000, v32
    v_lshlrev_b32 v134, 16, v33
    v_and_b32 v135, 0xffff0000, v33
    v_lshlrev_b32 v136, 16, v34
    v_and_b32 v137, 0xffff0000, v34
    v_lshlrev_b32 v138, 16, v35
    v_and_b32 v139, 0xffff0000, v35
    v_lshlrev_b32 v140, 16, v36
    v_and_b32 v141, 0xffff0000, v36
    v_lshlrev_b32 v142, 16, v37
    v_and_b32 v143, 0xffff0000, v37
    v_lshlrev_b32 v144, 16, v38
    v_and_b32 v145, 0xffff0000, v38
    v_lshlrev_b32 v146, 16, v39
    v_and_b32 v147, 0xffff0000, v39
    v_lshlrev_b32 v148, 16, v40
    v_and_b32 v149, 0xffff0000, v40
    v_lshlrev_b32 v150, 16, v41
    v_and_b32 v151, 0xffff0000, v41
    v_lshlrev_b32 v152, 16, v42
    v_and_b32 v153, 0xffff0000, v42
    v_lshlrev_b32 v154, 16, v43
    v_and_b32 v155, 0xffff0000, v43
    v_lshlrev_b32 v156, 16, v44
    v_and_b32 v157, 0xffff0000, v44
    v_lshlrev_b32 v158, 16, v45
    v_and_b32 v159, 0xffff0000, v45
    v_lshlrev_b32 v160, 16, v46
    v_and_b32 v161, 0xffff0000, v46
    v_lshlrev_b32 v162, 16, v47
    v_and_b32 v163, 0xffff0000, v47
    v_lshlrev_b32 v164, 16, v48
    v_and_b32 v165, 0xffff0000, v48
    v_lshlrev_b32 v166, 16, v49
    v_and_b32 v167, 0xffff0000, v49
    v_lshlrev_b32 v168, 16, v50
    v_and_b32 v169, 0xffff0000, v50
    v_lshlrev_b32 v170, 16, v51
    v_and_b32 v171, 0xffff0000, v51
    v_add_f32 v90, v100, v101
    v_add_f32 v91, v102, v103
    v_add_f32 v90, v90, v104
    v_add_f32 v91, v91, v105
    v_add_f32 v90, v90, v106
    v_add_f32 v91, v91, v107
    v_add_f32 v90, v90, v108
    v_add_f32 v91, v91, v109
    v_add_f32 v90, v90, v110
    v_add_f32 v91, v91, v111
    v_add_f32 v90, v90, v112
    v_add_f32 v91, v91, v113
    v_add_f32 v90, v90, v114
    v_add_f32 v91, v91, v115
    v_add_f32 v90, v90, v116
    v_add_f32 v91, v91, v117
    v_add_f32 v90, v90, v118
    v_add_f32 v91, v91, v119
    v_add_f32 v90, v90, v120
    v_add_f32 v91, v91, v121
    v_add_f32 v90, v90, v122
    v_add_f32 v91, v91, v123
    v_add_f32 v90, v90, v124
    v_add_f32 v91, v91, v125
    v_add_f32 v90, v90, v126
    v_add_f32 v91, v91, v127
    v_add_f32 v90, v90, v128
    v_add_f32 v91, v91, v129
    v_add_f32 v90, v90, v130
    v_add_f32 v91, v91, v131
    v_add_f32 v90, v90, v132
    v_add_f32 v91, v91, v133
    v_add_f32 v90, v90, v134
    v_add_f32 v91, v91, v135
    v_add_f32 v90, v90, v136
    v_add_f32 v91, v91, v137
    v_add_f32 v90, v90, v138
    v_add_f32 v91, v91, v139
    v_add_f32 v90, v90, v140
    v_add_f32 v91, v91, v141
    v_add_f32 v90, v90, v142
    v_add_f32 v91, v91, v143
    v_add_f32 v90, v90, v144
    v_add_f32 v91, v91, v145
    v_add_f32 v90, v90, v146
    v_add_f32 v91, v91, v147
    v_add_f32 v90, v90, v148
    v_add_f32 v91, v91, v149
    v_add_f32 v90, v90, v150
    v_add_f32 v91, v91, v151
    v_add_f32 v90, v90, v152
    v_add_f32 v91, v91, v153
    v_add_f32 v90, v90, v154
    v_add_f32 v91, v91, v155
    v_add_f32 v90, v90, v156
    v_add_f32 v91, v91, v157
    v_add_f32 v90, v90, v158
    v_add_f32 v91, v91, v159
    v_add_f32 v90, v90, v160
    v_add_f32 v91, v91, v161
    v_add_f32 v90, v90, v162
    v_add_f32 v91, v91, v163
    v_add_f32 v90, v90, v164
    v_add_f32 v91, v91, v165
    v_add_f32 v90, v90, v166
    v_add_f32 v91, v91, v167
    v_add_f32 v90, v90, v168
    v_add_f32 v91, v91, v169
    v_add_f32 v90, v90, v170
    v_add_f32 v91, v91, v171
    v_add_f32 v90, v90, v91
    s_nop 1
    v_add_f32_dpp v90, v90, v90 quad_perm:[1,0,3,2] row_mask:0xf bank_mask:0xf
    s_nop 1
    v_add_f32_dpp v90, v90, v90 quad_perm:[2,3,0,1] row_mask:0xf bank_mask:0xf
    s_nop 1
    v_add_f32_dpp v90, v90, v90 row_half_mirror row_mask:0xf bank_mask:0xf
    v_mul_f32 v90, 0x3ae38e39, v90
    v_sub_f32 v92, v100, v90
    v_mul_f32 v91, v92, v92
    v_sub_f32 v92, v101, v90
    v_fmac_f32 v91, v92, v92
    v_sub_f32 v92, v102, v90
    v_fmac_f32 v91, v92, v92
    v_sub_f32 v92, v103, v90
    v_fmac_f32 v91, v92, v92
    v_sub_f32 v92, v104, v90
    v_fmac_f32 v91, v92, v92
    v_sub_f32 v92, v105, v90
    v_fmac_f32 v91, v92, v92
    v_sub_f32 v92, v106, v90
    v_fmac_f32 v91, v92, v92
    v_sub_f32 v92, v107, v90
    v_fmac_f32 v91, v92, v92
    v_sub_f32 v92, v108, v90
    v_fmac_f32 v91, v92, v92
    v_sub_f32 v92, v109, v90
    v_fmac_f32 v91, v92, v92
    v_sub_f32 v92, v110, v90
    v_fmac_f32 v91, v92, v92
    v_sub_f32 v92, v111, v90
    v_fmac_f32 v91, v92, v92
    v_sub_f32 v92, v112, v90
    v_fmac_f32 v91, v92, v92
    v_sub_f32 v92, v113, v90
    v_fmac_f32 v91, v92, v92
    v_sub_f32 v92, v114, v90
    v_fmac_f32 v91, v92, v92
    v_sub_f32 v92, v115, v90
    v_fmac_f32 v91, v92, v92
    v_sub_f32 v92, v116, v90
    v_fmac_f32 v91, v92, v92
    v_sub_f32 v92, v117, v90
    v_fmac_f32 v91, v92, v92
    v_sub_f32 v92, v118, v90
    v_fmac_f32 v91, v92, v92
    v_sub_f32 v92, v119, v90
    v_fmac_f32 v91, v92, v92
    v_sub_f32 v92, v120, v90
    v_fmac_f32 v91, v92, v92
    v_sub_f32 v92, v121, v90
    v_fmac_f32 v91, v92, v92
    v_sub_f32 v92, v122, v90
    v_fmac_f32 v91, v92, v92
    v_sub_f32 v92, v123, v90
    v_fmac_f32 v91, v92, v92
    v_sub_f32 v92, v124, v90
    v_fmac_f32 v91, v92, v92
    v_sub_f32 v92, v125, v90
    v_fmac_f32 v91, v92, v92
    v_sub_f32 v92, v126, v90
    v_fmac_f32 v91, v92, v92
    v_sub_f32 v92, v127, v90
    v_fmac_f32 v91, v92, v92
    v_sub_f32 v92, v128, v90
    v_fmac_f32 v91, v92, v92
    v_sub_f32 v92, v129, v90
    v_fmac_f32 v91, v92, v92
    v_sub_f32 v92, v130, v90
    v_fmac_f32 v91, v92, v92
    v_sub_f32 v92, v131, v90
    v_fmac_f32 v91, v92, v92
    v_sub_f32 v92, v132, v90
    v_fmac_f32 v91, v92, v92
    v_sub_f32 v92, v133, v90
    v_fmac_f32 v91, v92, v92
    v_sub_f32 v92, v134, v90
    v_fmac_f32 v91, v92, v92
    v_sub_f32 v92, v135, v90
    v_fmac_f32 v91, v92, v92
    v_sub_f32 v92, v136, v90
    v_fmac_f32 v91, v92, v92
    v_sub_f32 v92, v137, v90
    v_fmac_f32 v91, v92, v92
    v_sub_f32 v92, v138, v90
    v_fmac_f32 v91, v92, v92
    v_sub_f32 v92, v139, v90
    v_fmac_f32 v91, v92, v92
    v_sub_f32 v92, v140, v90
    v_fmac_f32 v91, v92, v92
    v_sub_f32 v92, v141, v90
    v_fmac_f32 v91, v92, v92
    v_sub_f32 v92, v142, v90
    v_fmac_f32 v91, v92, v92
    v_sub_f32 v92, v143, v90
    v_fmac_f32 v91, v92, v92
    v_sub_f32 v92, v144, v90
    v_fmac_f32 v91, v92, v92
    v_sub_f32 v92, v145, v90
    v_fmac_f32 v91, v92, v92
    v_sub_f32 v92, v146, v90
    v_fmac_f32 v91, v92, v92
    v_sub_f32 v92, v147, v90
    v_fmac_f32 v91, v92, v92
    v_sub_f32 v92, v148, v90
    v_fmac_f32 v91, v92, v92
    v_sub_f32 v92, v149, v90
    v_fmac_f32 v91, v92, v92
    v_sub_f32 v92, v150, v90
    v_fmac_f32 v91, v92, v92
    v_sub_f32 v92, v151, v90
    v_fmac_f32 v91, v92, v92
    v_sub_f32 v92, v152, v90
    v_fmac_f32 v91, v92, v92
    v_sub_f32 v92, v153, v90
    v_fmac_f32 v91, v92, v92
    v_sub_f32 v92, v154, v90
    v_fmac_f32 v91, v92, v92
    v_sub_f32 v92, v155, v90
    v_fmac_f32 v91, v92, v92
    v_sub_f32 v92, v156, v90
    v_fmac_f32 v91, v92, v92
    v_sub_f32 v92, v157, v90
    v_fmac_f32 v91, v92, v92
    v_sub_f32 v92, v158, v90
    v_fmac_f32 v91, v92, v92
    v_sub_f32 v92, v159, v90
    v_fmac_f32 v91, v92, v92
    v_sub_f32 v92, v160, v90
    v_fmac_f32 v91, v92, v92
    v_sub_f32 v92, v161, v90
    v_fmac_f32 v91, v92, v92
    v_sub_f32 v92, v162, v90
    v_fmac_f32 v91, v92, v92
    v_sub_f32 v92, v163, v90
    v_fmac_f32 v91, v92, v92
    v_sub_f32 v92, v164, v90
    v_fmac_f32 v91, v92, v92
    v_sub_f32 v92, v165, v90
    v_fmac_f32 v91, v92, v92
    v_sub_f32 v92, v166, v90
    v_fmac_f32 v91, v92, v92
    v_sub_f32 v92, v167, v90
    v_fmac_f32 v91, v92, v92
    v_sub_f32 v92, v168, v90
    v_fmac_f32 v91, v92, v92
    v_sub_f32 v92, v169, v90
    v_fmac_f32 v91, v92, v92
    v_sub_f32 v92, v170, v90
    v_fmac_f32 v91, v92, v92
    v_sub_f32 v92, v171, v90
    v_fmac_f32 v91, v92, v92
    s_nop 1
    v_add_f32_dpp v91, v91, v91 quad_perm:[1,0,3,2] row_mask:0xf bank_mask:0xf
    s_nop 1
    v_add_f32_dpp v91, v91, v91 quad_perm:[2,3,0,1] row_mask:0xf bank_mask:0xf
    s_nop 1
    v_add_f32_dpp v91, v91, v91 row_half_mirror row_mask:0xf bank_mask:0xf
    v_mul_f32 v91, 0x3ae38e39, v91
    v_cvt_pk_bf16_f32 v92, v90, v91
    v_lshlrev_b32 v90, 16, v92
    v_and_b32 v91, 0xffff0000, v92
    v_add_f32 v91, 0x3727c5ac, v91
    v_cvt_pk_bf16_f32 v91, v91, v91
    v_lshlrev_b32 v91, 16, v91
    v_sqrt_f32 v91, v91
    s_nop 0
    v_cvt_pk_bf16_f32 v91, v91, v91
    v_lshlrev_b32 v91, 16, v91
    v_rcp_f32 v91, v91
    s_nop 0
    v_sub_f32 v100, v100, v90
    v_sub_f32 v101, v101, v90
    v_cvt_pk_bf16_f32 v16, v100, v101
    v_lshlrev_b32 v100, 16, v16
    v_and_b32 v101, 0xffff0000, v16
    v_mul_f32 v100, v100, v91
    v_mul_f32 v101, v101, v91
    v_cvt_pk_bf16_f32 v16, v100, v101
    v_sub_f32 v102, v102, v90
    v_sub_f32 v103, v103, v90
    v_cvt_pk_bf16_f32 v17, v102, v103
    v_lshlrev_b32 v102, 16, v17
    v_and_b32 v103, 0xffff0000, v17
    v_mul_f32 v102, v102, v91
    v_mul_f32 v103, v103, v91
    v_cvt_pk_bf16_f32 v17, v102, v103
    v_sub_f32 v104, v104, v90
    v_sub_f32 v105, v105, v90
    v_cvt_pk_bf16_f32 v18, v104, v105
    v_lshlrev_b32 v104, 16, v18
    v_and_b32 v105, 0xffff0000, v18
    v_mul_f32 v104, v104, v91
    v_mul_f32 v105, v105, v91
    v_cvt_pk_bf16_f32 v18, v104, v105
    v_sub_f32 v106, v106, v90
    v_sub_f32 v107, v107, v90
    v_cvt_pk_bf16_f32 v19, v106, v107
    v_lshlrev_b32 v106, 16, v19
    v_and_b32 v107, 0xffff0000, v19
    v_mul_f32 v106, v106, v91
    v_mul_f32 v107, v107, v91
    v_cvt_pk_bf16_f32 v19, v106, v107
    v_sub_f32 v108, v108, v90
    v_sub_f32 v109, v109, v90
    v_cvt_pk_bf16_f32 v20, v108, v109
    v_lshlrev_b32 v108, 16, v20
    v_and_b32 v109, 0xffff0000, v20
    v_mul_f32 v108, v108, v91
    v_mul_f32 v109, v109, v91
    v_cvt_pk_bf16_f32 v20, v108, v109
    v_sub_f32 v110, v110, v90
    v_sub_f32 v111, v111, v90
    v_cvt_pk_bf16_f32 v21, v110, v111
    v_lshlrev_b32 v110, 16, v21
    v_and_b32 v111, 0xffff0000, v21
    v_mul_f32 v110, v110, v91
    v_mul_f32 v111, v111, v91
    v_cvt_pk_bf16_f32 v21, v110, v111
    v_sub_f32 v112, v112, v90
    v_sub_f32 v113, v113, v90
    v_cvt_pk_bf16_f32 v22, v112, v113
    v_lshlrev_b32 v112, 16, v22
    v_and_b32 v113, 0xffff0000, v22
    v_mul_f32 v112, v112, v91
    v_mul_f32 v113, v113, v91
    v_cvt_pk_bf16_f32 v22, v112, v113
    v_sub_f32 v114, v114, v90
    v_sub_f32 v115, v115, v90
    v_cvt_pk_bf16_f32 v23, v114, v115
    v_lshlrev_b32 v114, 16, v23
    v_and_b32 v115, 0xffff0000, v23
    v_mul_f32 v114, v114, v91
    v_mul_f32 v115, v115, v91
    v_cvt_pk_bf16_f32 v23, v114, v115
    v_sub_f32 v116, v116, v90
    v_sub_f32 v117, v117, v90
    v_cvt_pk_bf16_f32 v24, v116, v117
    v_lshlrev_b32 v116, 16, v24
    v_and_b32 v117, 0xffff0000, v24
    v_mul_f32 v116, v116, v91
    v_mul_f32 v117, v117, v91
    v_cvt_pk_bf16_f32 v24, v116, v117
    v_sub_f32 v118, v118, v90
    v_sub_f32 v119, v119, v90
    v_cvt_pk_bf16_f32 v25, v118, v119
    v_lshlrev_b32 v118, 16, v25
    v_and_b32 v119, 0xffff0000, v25
    v_mul_f32 v118, v118, v91
    v_mul_f32 v119, v119, v91
    v_cvt_pk_bf16_f32 v25, v118, v119
    v_sub_f32 v120, v120, v90
    v_sub_f32 v121, v121, v90
    v_cvt_pk_bf16_f32 v26, v120, v121
    v_lshlrev_b32 v120, 16, v26
    v_and_b32 v121, 0xffff0000, v26
    v_mul_f32 v120, v120, v91
    v_mul_f32 v121, v121, v91
    v_cvt_pk_bf16_f32 v26, v120, v121
    v_sub_f32 v122, v122, v90
    v_sub_f32 v123, v123, v90
    v_cvt_pk_bf16_f32 v27, v122, v123
    v_lshlrev_b32 v122, 16, v27
    v_and_b32 v123, 0xffff0000, v27
    v_mul_f32 v122, v122, v91
    v_mul_f32 v123, v123, v91
    v_cvt_pk_bf16_f32 v27, v122, v123
    v_sub_f32 v124, v124, v90
    v_sub_f32 v125, v125, v90
    v_cvt_pk_bf16_f32 v28, v124, v125
    v_lshlrev_b32 v124, 16, v28
    v_and_b32 v125, 0xffff0000, v28
    v_mul_f32 v124, v124, v91
    v_mul_f32 v125, v125, v91
    v_cvt_pk_bf16_f32 v28, v124, v125
    v_sub_f32 v126, v126, v90
    v_sub_f32 v127, v127, v90
    v_cvt_pk_bf16_f32 v29, v126, v127
    v_lshlrev_b32 v126, 16, v29
    v_and_b32 v127, 0xffff0000, v29
    v_mul_f32 v126, v126, v91
    v_mul_f32 v127, v127, v91
    v_cvt_pk_bf16_f32 v29, v126, v127
    v_sub_f32 v128, v128, v90
    v_sub_f32 v129, v129, v90
    v_cvt_pk_bf16_f32 v30, v128, v129
    v_lshlrev_b32 v128, 16, v30
    v_and_b32 v129, 0xffff0000, v30
    v_mul_f32 v128, v128, v91
    v_mul_f32 v129, v129, v91
    v_cvt_pk_bf16_f32 v30, v128, v129
    v_sub_f32 v130, v130, v90
    v_sub_f32 v131, v131, v90
    v_cvt_pk_bf16_f32 v31, v130, v131
    v_lshlrev_b32 v130, 16, v31
    v_and_b32 v131, 0xffff0000, v31
    v_mul_f32 v130, v130, v91
    v_mul_f32 v131, v131, v91
    v_cvt_pk_bf16_f32 v31, v130, v131
    v_sub_f32 v132, v132, v90
    v_sub_f32 v133, v133, v90
    v_cvt_pk_bf16_f32 v32, v132, v133
    v_lshlrev_b32 v132, 16, v32
    v_and_b32 v133, 0xffff0000, v32
    v_mul_f32 v132, v132, v91
    v_mul_f32 v133, v133, v91
    v_cvt_pk_bf16_f32 v32, v132, v133
    v_sub_f32 v134, v134, v90
    v_sub_f32 v135, v135, v90
    v_cvt_pk_bf16_f32 v33, v134, v135
    v_lshlrev_b32 v134, 16, v33
    v_and_b32 v135, 0xffff0000, v33
    v_mul_f32 v134, v134, v91
    v_mul_f32 v135, v135, v91
    v_cvt_pk_bf16_f32 v33, v134, v135
    v_sub_f32 v136, v136, v90
    v_sub_f32 v137, v137, v90
    v_cvt_pk_bf16_f32 v34, v136, v137
    v_lshlrev_b32 v136, 16, v34
    v_and_b32 v137, 0xffff0000, v34
    v_mul_f32 v136, v136, v91
    v_mul_f32 v137, v137, v91
    v_cvt_pk_bf16_f32 v34, v136, v137
    v_sub_f32 v138, v138, v90
    v_sub_f32 v139, v139, v90
    v_cvt_pk_bf16_f32 v35, v138, v139
    v_lshlrev_b32 v138, 16, v35
    v_and_b32 v139, 0xffff0000, v35
    v_mul_f32 v138, v138, v91
    v_mul_f32 v139, v139, v91
    v_cvt_pk_bf16_f32 v35, v138, v139
    v_sub_f32 v140, v140, v90
    v_sub_f32 v141, v141, v90
    v_cvt_pk_bf16_f32 v36, v140, v141
    v_lshlrev_b32 v140, 16, v36
    v_and_b32 v141, 0xffff0000, v36
    v_mul_f32 v140, v140, v91
    v_mul_f32 v141, v141, v91
    v_cvt_pk_bf16_f32 v36, v140, v141
    v_sub_f32 v142, v142, v90
    v_sub_f32 v143, v143, v90
    v_cvt_pk_bf16_f32 v37, v142, v143
    v_lshlrev_b32 v142, 16, v37
    v_and_b32 v143, 0xffff0000, v37
    v_mul_f32 v142, v142, v91
    v_mul_f32 v143, v143, v91
    v_cvt_pk_bf16_f32 v37, v142, v143
    v_sub_f32 v144, v144, v90
    v_sub_f32 v145, v145, v90
    v_cvt_pk_bf16_f32 v38, v144, v145
    v_lshlrev_b32 v144, 16, v38
    v_and_b32 v145, 0xffff0000, v38
    v_mul_f32 v144, v144, v91
    v_mul_f32 v145, v145, v91
    v_cvt_pk_bf16_f32 v38, v144, v145
    v_sub_f32 v146, v146, v90
    v_sub_f32 v147, v147, v90
    v_cvt_pk_bf16_f32 v39, v146, v147
    v_lshlrev_b32 v146, 16, v39
    v_and_b32 v147, 0xffff0000, v39
    v_mul_f32 v146, v146, v91
    v_mul_f32 v147, v147, v91
    v_cvt_pk_bf16_f32 v39, v146, v147
    v_sub_f32 v148, v148, v90
    v_sub_f32 v149, v149, v90
    v_cvt_pk_bf16_f32 v40, v148, v149
    v_lshlrev_b32 v148, 16, v40
    v_and_b32 v149, 0xffff0000, v40
    v_mul_f32 v148, v148, v91
    v_mul_f32 v149, v149, v91
    v_cvt_pk_bf16_f32 v40, v148, v149
    v_sub_f32 v150, v150, v90
    v_sub_f32 v151, v151, v90
    v_cvt_pk_bf16_f32 v41, v150, v151
    v_lshlrev_b32 v150, 16, v41
    v_and_b32 v151, 0xffff0000, v41
    v_mul_f32 v150, v150, v91
    v_mul_f32 v151, v151, v91
    v_cvt_pk_bf16_f32 v41, v150, v151
    v_sub_f32 v152, v152, v90
    v_sub_f32 v153, v153, v90
    v_cvt_pk_bf16_f32 v42, v152, v153
    v_lshlrev_b32 v152, 16, v42
    v_and_b32 v153, 0xffff0000, v42
    v_mul_f32 v152, v152, v91
    v_mul_f32 v153, v153, v91
    v_cvt_pk_bf16_f32 v42, v152, v153
    v_sub_f32 v154, v154, v90
    v_sub_f32 v155, v155, v90
    v_cvt_pk_bf16_f32 v43, v154, v155
    v_lshlrev_b32 v154, 16, v43
    v_and_b32 v155, 0xffff0000, v43
    v_mul_f32 v154, v154, v91
    v_mul_f32 v155, v155, v91
    v_cvt_pk_bf16_f32 v43, v154, v155
    v_sub_f32 v156, v156, v90
    v_sub_f32 v157, v157, v90
    v_cvt_pk_bf16_f32 v44, v156, v157
    v_lshlrev_b32 v156, 16, v44
    v_and_b32 v157, 0xffff0000, v44
    v_mul_f32 v156, v156, v91
    v_mul_f32 v157, v157, v91
    v_cvt_pk_bf16_f32 v44, v156, v157
    v_sub_f32 v158, v158, v90
    v_sub_f32 v159, v159, v90
    v_cvt_pk_bf16_f32 v45, v158, v159
    v_lshlrev_b32 v158, 16, v45
    v_and_b32 v159, 0xffff0000, v45
    v_mul_f32 v158, v158, v91
    v_mul_f32 v159, v159, v91
    v_cvt_pk_bf16_f32 v45, v158, v159
    v_sub_f32 v160, v160, v90
    v_sub_f32 v161, v161, v90
    v_cvt_pk_bf16_f32 v46, v160, v161
    v_lshlrev_b32 v160, 16, v46
    v_and_b32 v161, 0xffff0000, v46
    v_mul_f32 v160, v160, v91
    v_mul_f32 v161, v161, v91
    v_cvt_pk_bf16_f32 v46, v160, v161
    v_sub_f32 v162, v162, v90
    v_sub_f32 v163, v163, v90
    v_cvt_pk_bf16_f32 v47, v162, v163
    v_lshlrev_b32 v162, 16, v47
    v_and_b32 v163, 0xffff0000, v47
    v_mul_f32 v162, v162, v91
    v_mul_f32 v163, v163, v91
    v_cvt_pk_bf16_f32 v47, v162, v163
    v_sub_f32 v164, v164, v90
    v_sub_f32 v165, v165, v90
    v_cvt_pk_bf16_f32 v48, v164, v165
    v_lshlrev_b32 v164, 16, v48
    v_and_b32 v165, 0xffff0000, v48
    v_mul_f32 v164, v164, v91
    v_mul_f32 v165, v165, v91
    v_cvt_pk_bf16_f32 v48, v164, v165
    v_sub_f32 v166, v166, v90
    v_sub_f32 v167, v167, v90
    v_cvt_pk_bf16_f32 v49, v166, v167
    v_lshlrev_b32 v166, 16, v49
    v_and_b32 v167, 0xffff0000, v49
    v_mul_f32 v166, v166, v91
    v_mul_f32 v167, v167, v91
    v_cvt_pk_bf16_f32 v49, v166, v167
    v_sub_f32 v168, v168, v90
    v_sub_f32 v169, v169, v90
    v_cvt_pk_bf16_f32 v50, v168, v169
    v_lshlrev_b32 v168, 16, v50
    v_and_b32 v169, 0xffff0000, v50
    v_mul_f32 v168, v168, v91
    v_mul_f32 v169, v169, v91
    v_cvt_pk_bf16_f32 v50, v168, v169
    v_sub_f32 v170, v170, v90
    v_sub_f32 v171, v171, v90
    v_cvt_pk_bf16_f32 v51, v170, v171
    v_lshlrev_b32 v170, 16, v51
    v_and_b32 v171, 0xffff0000, v51
    v_mul_f32 v170, v170, v91
    v_mul_f32 v171, v171, v91
    v_cvt_pk_bf16_f32 v51, v170, v171
    s_lshl_b32 s22, s3, 4
    s_add_u32 s22, s22, 0
    s_lshr_b32 s23, s22, 5
    s_mul_i32 s23, s23, 36864
    s_and_b32 s22, s22, 31
    v_lshrrev_b32 v7, 3, v1
    v_add_u32 v7, s22, v7
    v_lshlrev_b32 v7, 4, v7
    v_add_u32 v7, s23, v7
    v_and_b32 v6, 7, v1
    v_lshrrev_b32 v8, 1, v6
    v_lshl_add_u32 v7, v8, 10, v7
    v_and_b32 v8, 1, v6
    v_lshl_add_u32 v7, v8, 9, v7
    ds_write_b128 v7, v[16:19] offset:0
    ds_write_b128 v7, v[20:23] offset:4096
    ds_write_b128 v7, v[24:27] offset:8192
    ds_write_b128 v7, v[28:31] offset:12288
    ds_write_b128 v7, v[32:35] offset:16384
    ds_write_b128 v7, v[36:39] offset:20480
    ds_write_b128 v7, v[40:43] offset:24576
    ds_write_b128 v7, v[44:47] offset:28672
    ds_write_b128 v7, v[48:51] offset:32768
    s_waitcnt vmcnt(0)
    v_lshlrev_b32 v100, 16, v52
    v_and_b32 v101, 0xffff0000, v52
    v_lshlrev_b32 v102, 16, v53
    v_and_b32 v103, 0xffff0000, v53
    v_lshlrev_b32 v104, 16, v54
    v_and_b32 v105, 0xffff0000, v54
    v_lshlrev_b32 v106, 16, v55
    v_and_b32 v107, 0xffff0000, v55
    v_lshlrev_b32 v108, 16, v56
    v_and_b32 v109, 0xffff0000, v56
    v_lshlrev_b32 v110, 16, v57
    v_and_b32 v111, 0xffff0000, v57
    v_lshlrev_b32 v112, 16, v58
    v_and_b32 v113, 0xffff0000, v58
    v_lshlrev_b32 v114, 16, v59
    v_and_b32 v115, 0xffff0000, v59
    v_lshlrev_b32 v116, 16, v60
    v_and_b32 v117, 0xffff0000, v60
    v_lshlrev_b32 v118, 16, v61
    v_and_b32 v119, 0xffff0000, v61
    v_lshlrev_b32 v120, 16, v62
    v_and_b32 v121, 0xffff0000, v62
    v_lshlrev_b32 v122, 16, v63
    v_and_b32 v123, 0xffff0000, v63
    v_lshlrev_b32 v124, 16, v64
    v_and_b32 v125, 0xffff0000, v64
    v_lshlrev_b32 v126, 16, v65
    v_and_b32 v127, 0xffff0000, v65
    v_lshlrev_b32 v128, 16, v66
    v_and_b32 v129, 0xffff0000, v66
    v_lshlrev_b32 v130, 16, v67
    v_and_b32 v131, 0xffff0000, v67
    v_lshlrev_b32 v132, 16, v68
    v_and_b32 v133, 0xffff0000, v68
    v_lshlrev_b32 v134, 16, v69
    v_and_b32 v135, 0xffff0000, v69
    v_lshlrev_b32 v136, 16, v70
    v_and_b32 v137, 0xffff0000, v70
    v_lshlrev_b32 v138, 16, v71
    v_and_b32 v139, 0xffff0000, v71
    v_lshlrev_b32 v140, 16, v72
    v_and_b32 v141, 0xffff0000, v72
    v_lshlrev_b32 v142, 16, v73
    v_and_b32 v143, 0xffff0000, v73
    v_lshlrev_b32 v144, 16, v74
    v_and_b32 v145, 0xffff0000, v74
    v_lshlrev_b32 v146, 16, v75
    v_and_b32 v147, 0xffff0000, v75
    v_lshlrev_b32 v148, 16, v76
    v_and_b32 v149, 0xffff0000, v76
    v_lshlrev_b32 v150, 16, v77
    v_and_b32 v151, 0xffff0000, v77
    v_lshlrev_b32 v152, 16, v78
    v_and_b32 v153, 0xffff0000, v78
    v_lshlrev_b32 v154, 16, v79
    v_and_b32 v155, 0xffff0000, v79
    v_lshlrev_b32 v156, 16, v80
    v_and_b32 v157, 0xffff0000, v80
    v_lshlrev_b32 v158, 16, v81
    v_and_b32 v159, 0xffff0000, v81
    v_lshlrev_b32 v160, 16, v82
    v_and_b32 v161, 0xffff0000, v82
    v_lshlrev_b32 v162, 16, v83
    v_and_b32 v163, 0xffff0000, v83
    v_lshlrev_b32 v164, 16, v84
    v_and_b32 v165, 0xffff0000, v84
    v_lshlrev_b32 v166, 16, v85
    v_and_b32 v167, 0xffff0000, v85
    v_lshlrev_b32 v168, 16, v86
    v_and_b32 v169, 0xffff0000, v86
    v_lshlrev_b32 v170, 16, v87
    v_and_b32 v171, 0xffff0000, v87
    v_add_f32 v90, v100, v101
    v_add_f32 v91, v102, v103
    v_add_f32 v90, v90, v104
    v_add_f32 v91, v91, v105
    v_add_f32 v90, v90, v106
    v_add_f32 v91, v91, v107
    v_add_f32 v90, v90, v108
    v_add_f32 v91, v91, v109
    v_add_f32 v90, v90, v110
    v_add_f32 v91, v91, v111
    v_add_f32 v90, v90, v112
    v_add_f32 v91, v91, v113
    v_add_f32 v90, v90, v114
    v_add_f32 v91, v91, v115
    v_add_f32 v90, v90, v116
    v_add_f32 v91, v91, v117
    v_add_f32 v90, v90, v118
    v_add_f32 v91, v91, v119
    v_add_f32 v90, v90, v120
    v_add_f32 v91, v91, v121
    v_add_f32 v90, v90, v122
    v_add_f32 v91, v91, v123
    v_add_f32 v90, v90, v124
    v_add_f32 v91, v91, v125
    v_add_f32 v90, v90, v126
    v_add_f32 v91, v91, v127
    v_add_f32 v90, v90, v128
    v_add_f32 v91, v91, v129
    v_add_f32 v90, v90, v130
    v_add_f32 v91, v91, v131
    v_add_f32 v90, v90, v132
    v_add_f32 v91, v91, v133
    v_add_f32 v90, v90, v134
    v_add_f32 v91, v91, v135
    v_add_f32 v90, v90, v136
    v_add_f32 v91, v91, v137
    v_add_f32 v90, v90, v138
    v_add_f32 v91, v91, v139
    v_add_f32 v90, v90, v140
    v_add_f32 v91, v91, v141
    v_add_f32 v90, v90, v142
    v_add_f32 v91, v91, v143
    v_add_f32 v90, v90, v144
    v_add_f32 v91, v91, v145
    v_add_f32 v90, v90, v146
    v_add_f32 v91, v91, v147
    v_add_f32 v90, v90, v148
    v_add_f32 v91, v91, v149
    v_add_f32 v90, v90, v150
    v_add_f32 v91, v91, v151
    v_add_f32 v90, v90, v152
    v_add_f32 v91, v91, v153
    v_add_f32 v90, v90, v154
    v_add_f32 v91, v91, v155
    v_add_f32 v90, v90, v156
    v_add_f32 v91, v91, v157
    v_add_f32 v90, v90, v158
    v_add_f32 v91, v91, v159
    v_add_f32 v90, v90, v160
    v_add_f32 v91, v91, v161
    v_add_f32 v90, v90, v162
    v_add_f32 v91, v91, v163
    v_add_f32 v90, v90, v164
    v_add_f32 v91, v91, v165
    v_add_f32 v90, v90, v166
    v_add_f32 v91, v91, v167
    v_add_f32 v90, v90, v168
    v_add_f32 v91, v91, v169
    v_add_f32 v90, v90, v170
    v_add_f32 v91, v91, v171
    v_add_f32 v90, v90, v91
    s_nop 1
    v_add_f32_dpp v90, v90, v90 quad_perm:[1,0,3,2] row_mask:0xf bank_mask:0xf
    s_nop 1
    v_add_f32_dpp v90, v90, v90 quad_perm:[2,3,0,1] row_mask:0xf bank_mask:0xf
    s_nop 1
    v_add_f32_dpp v90, v90, v90 row_half_mirror row_mask:0xf bank_mask:0xf
    v_mul_f32 v90, 0x3ae38e39, v90
    v_sub_f32 v92, v100, v90
    v_mul_f32 v91, v92, v92
    v_sub_f32 v92, v101, v90
    v_fmac_f32 v91, v92, v92
    v_sub_f32 v92, v102, v90
    v_fmac_f32 v91, v92, v92
    v_sub_f32 v92, v103, v90
    v_fmac_f32 v91, v92, v92
    v_sub_f32 v92, v104, v90
    v_fmac_f32 v91, v92, v92
    v_sub_f32 v92, v105, v90
    v_fmac_f32 v91, v92, v92
    v_sub_f32 v92, v106, v90
    v_fmac_f32 v91, v92, v92
    v_sub_f32 v92, v107, v90
    v_fmac_f32 v91, v92, v92
    v_sub_f32 v92, v108, v90
    v_fmac_f32 v91, v92, v92
    v_sub_f32 v92, v109, v90
    v_fmac_f32 v91, v92, v92
    v_sub_f32 v92, v110, v90
    v_fmac_f32 v91, v92, v92
    v_sub_f32 v92, v111, v90
    v_fmac_f32 v91, v92, v92
    v_sub_f32 v92, v112, v90
    v_fmac_f32 v91, v92, v92
    v_sub_f32 v92, v113, v90
    v_fmac_f32 v91, v92, v92
    v_sub_f32 v92, v114, v90
    v_fmac_f32 v91, v92, v92
    v_sub_f32 v92, v115, v90
    v_fmac_f32 v91, v92, v92
    v_sub_f32 v92, v116, v90
    v_fmac_f32 v91, v92, v92
    v_sub_f32 v92, v117, v90
    v_fmac_f32 v91, v92, v92
    v_sub_f32 v92, v118, v90
    v_fmac_f32 v91, v92, v92
    v_sub_f32 v92, v119, v90
    v_fmac_f32 v91, v92, v92
    v_sub_f32 v92, v120, v90
    v_fmac_f32 v91, v92, v92
    v_sub_f32 v92, v121, v90
    v_fmac_f32 v91, v92, v92
    v_sub_f32 v92, v122, v90
    v_fmac_f32 v91, v92, v92
    v_sub_f32 v92, v123, v90
    v_fmac_f32 v91, v92, v92
    v_sub_f32 v92, v124, v90
    v_fmac_f32 v91, v92, v92
    v_sub_f32 v92, v125, v90
    v_fmac_f32 v91, v92, v92
    v_sub_f32 v92, v126, v90
    v_fmac_f32 v91, v92, v92
    v_sub_f32 v92, v127, v90
    v_fmac_f32 v91, v92, v92
    v_sub_f32 v92, v128, v90
    v_fmac_f32 v91, v92, v92
    v_sub_f32 v92, v129, v90
    v_fmac_f32 v91, v92, v92
    v_sub_f32 v92, v130, v90
    v_fmac_f32 v91, v92, v92
    v_sub_f32 v92, v131, v90
    v_fmac_f32 v91, v92, v92
    v_sub_f32 v92, v132, v90
    v_fmac_f32 v91, v92, v92
    v_sub_f32 v92, v133, v90
    v_fmac_f32 v91, v92, v92
    v_sub_f32 v92, v134, v90
    v_fmac_f32 v91, v92, v92
    v_sub_f32 v92, v135, v90
    v_fmac_f32 v91, v92, v92
    v_sub_f32 v92, v136, v90
    v_fmac_f32 v91, v92, v92
    v_sub_f32 v92, v137, v90
    v_fmac_f32 v91, v92, v92
    v_sub_f32 v92, v138, v90
    v_fmac_f32 v91, v92, v92
    v_sub_f32 v92, v139, v90
    v_fmac_f32 v91, v92, v92
    v_sub_f32 v92, v140, v90
    v_fmac_f32 v91, v92, v92
    v_sub_f32 v92, v141, v90
    v_fmac_f32 v91, v92, v92
    v_sub_f32 v92, v142, v90
    v_fmac_f32 v91, v92, v92
    v_sub_f32 v92, v143, v90
    v_fmac_f32 v91, v92, v92
    v_sub_f32 v92, v144, v90
    v_fmac_f32 v91, v92, v92
    v_sub_f32 v92, v145, v90
    v_fmac_f32 v91, v92, v92
    v_sub_f32 v92, v146, v90
    v_fmac_f32 v91, v92, v92
    v_sub_f32 v92, v147, v90
    v_fmac_f32 v91, v92, v92
    v_sub_f32 v92, v148, v90
    v_fmac_f32 v91, v92, v92
    v_sub_f32 v92, v149, v90
    v_fmac_f32 v91, v92, v92
    v_sub_f32 v92, v150, v90
    v_fmac_f32 v91, v92, v92
    v_sub_f32 v92, v151, v90
    v_fmac_f32 v91, v92, v92
    v_sub_f32 v92, v152, v90
    v_fmac_f32 v91, v92, v92
    v_sub_f32 v92, v153, v90
    v_fmac_f32 v91, v92, v92
    v_sub_f32 v92, v154, v90
    v_fmac_f32 v91, v92, v92
    v_sub_f32 v92, v155, v90
    v_fmac_f32 v91, v92, v92
    v_sub_f32 v92, v156, v90
    v_fmac_f32 v91, v92, v92
    v_sub_f32 v92, v157, v90
    v_fmac_f32 v91, v92, v92
    v_sub_f32 v92, v158, v90
    v_fmac_f32 v91, v92, v92
    v_sub_f32 v92, v159, v90
    v_fmac_f32 v91, v92, v92
    v_sub_f32 v92, v160, v90
    v_fmac_f32 v91, v92, v92
    v_sub_f32 v92, v161, v90
    v_fmac_f32 v91, v92, v92
    v_sub_f32 v92, v162, v90
    v_fmac_f32 v91, v92, v92
    v_sub_f32 v92, v163, v90
    v_fmac_f32 v91, v92, v92
    v_sub_f32 v92, v164, v90
    v_fmac_f32 v91, v92, v92
    v_sub_f32 v92, v165, v90
    v_fmac_f32 v91, v92, v92
    v_sub_f32 v92, v166, v90
    v_fmac_f32 v91, v92, v92
    v_sub_f32 v92, v167, v90
    v_fmac_f32 v91, v92, v92
    v_sub_f32 v92, v168, v90
    v_fmac_f32 v91, v92, v92
    v_sub_f32 v92, v169, v90
    v_fmac_f32 v91, v92, v92
    v_sub_f32 v92, v170, v90
    v_fmac_f32 v91, v92, v92
    v_sub_f32 v92, v171, v90
    v_fmac_f32 v91, v92, v92
    s_nop 1
    v_add_f32_dpp v91, v91, v91 quad_perm:[1,0,3,2] row_mask:0xf bank_mask:0xf
    s_nop 1
    v_add_f32_dpp v91, v91, v91 quad_perm:[2,3,0,1] row_mask:0xf bank_mask:0xf
    s_nop 1
    v_add_f32_dpp v91, v91, v91 row_half_mirror row_mask:0xf bank_mask:0xf
    v_mul_f32 v91, 0x3ae38e39, v91
    v_cvt_pk_bf16_f32 v92, v90, v91
    v_lshlrev_b32 v90, 16, v92
    v_and_b32 v91, 0xffff0000, v92
    v_add_f32 v91, 0x3727c5ac, v91
    v_cvt_pk_bf16_f32 v91, v91, v91
    v_lshlrev_b32 v91, 16, v91
    v_sqrt_f32 v91, v91
    s_nop 0
    v_cvt_pk_bf16_f32 v91, v91, v91
    v_lshlrev_b32 v91, 16, v91
    v_rcp_f32 v91, v91
    s_nop 0
    v_sub_f32 v100, v100, v90
    v_sub_f32 v101, v101, v90
    v_cvt_pk_bf16_f32 v52, v100, v101
    v_lshlrev_b32 v100, 16, v52
    v_and_b32 v101, 0xffff0000, v52
    v_mul_f32 v100, v100, v91
    v_mul_f32 v101, v101, v91
    v_cvt_pk_bf16_f32 v52, v100, v101
    v_sub_f32 v102, v102, v90
    v_sub_f32 v103, v103, v90
    v_cvt_pk_bf16_f32 v53, v102, v103
    v_lshlrev_b32 v102, 16, v53
    v_and_b32 v103, 0xffff0000, v53
    v_mul_f32 v102, v102, v91
    v_mul_f32 v103, v103, v91
    v_cvt_pk_bf16_f32 v53, v102, v103
    v_sub_f32 v104, v104, v90
    v_sub_f32 v105, v105, v90
    v_cvt_pk_bf16_f32 v54, v104, v105
    v_lshlrev_b32 v104, 16, v54
    v_and_b32 v105, 0xffff0000, v54
    v_mul_f32 v104, v104, v91
    v_mul_f32 v105, v105, v91
    v_cvt_pk_bf16_f32 v54, v104, v105
    v_sub_f32 v106, v106, v90
    v_sub_f32 v107, v107, v90
    v_cvt_pk_bf16_f32 v55, v106, v107
    v_lshlrev_b32 v106, 16, v55
    v_and_b32 v107, 0xffff0000, v55
    v_mul_f32 v106, v106, v91
    v_mul_f32 v107, v107, v91
    v_cvt_pk_bf16_f32 v55, v106, v107
    v_sub_f32 v108, v108, v90
    v_sub_f32 v109, v109, v90
    v_cvt_pk_bf16_f32 v56, v108, v109
    v_lshlrev_b32 v108, 16, v56
    v_and_b32 v109, 0xffff0000, v56
    v_mul_f32 v108, v108, v91
    v_mul_f32 v109, v109, v91
    v_cvt_pk_bf16_f32 v56, v108, v109
    v_sub_f32 v110, v110, v90
    v_sub_f32 v111, v111, v90
    v_cvt_pk_bf16_f32 v57, v110, v111
    v_lshlrev_b32 v110, 16, v57
    v_and_b32 v111, 0xffff0000, v57
    v_mul_f32 v110, v110, v91
    v_mul_f32 v111, v111, v91
    v_cvt_pk_bf16_f32 v57, v110, v111
    v_sub_f32 v112, v112, v90
    v_sub_f32 v113, v113, v90
    v_cvt_pk_bf16_f32 v58, v112, v113
    v_lshlrev_b32 v112, 16, v58
    v_and_b32 v113, 0xffff0000, v58
    v_mul_f32 v112, v112, v91
    v_mul_f32 v113, v113, v91
    v_cvt_pk_bf16_f32 v58, v112, v113
    v_sub_f32 v114, v114, v90
    v_sub_f32 v115, v115, v90
    v_cvt_pk_bf16_f32 v59, v114, v115
    v_lshlrev_b32 v114, 16, v59
    v_and_b32 v115, 0xffff0000, v59
    v_mul_f32 v114, v114, v91
    v_mul_f32 v115, v115, v91
    v_cvt_pk_bf16_f32 v59, v114, v115
    v_sub_f32 v116, v116, v90
    v_sub_f32 v117, v117, v90
    v_cvt_pk_bf16_f32 v60, v116, v117
    v_lshlrev_b32 v116, 16, v60
    v_and_b32 v117, 0xffff0000, v60
    v_mul_f32 v116, v116, v91
    v_mul_f32 v117, v117, v91
    v_cvt_pk_bf16_f32 v60, v116, v117
    v_sub_f32 v118, v118, v90
    v_sub_f32 v119, v119, v90
    v_cvt_pk_bf16_f32 v61, v118, v119
    v_lshlrev_b32 v118, 16, v61
    v_and_b32 v119, 0xffff0000, v61
    v_mul_f32 v118, v118, v91
    v_mul_f32 v119, v119, v91
    v_cvt_pk_bf16_f32 v61, v118, v119
    v_sub_f32 v120, v120, v90
    v_sub_f32 v121, v121, v90
    v_cvt_pk_bf16_f32 v62, v120, v121
    v_lshlrev_b32 v120, 16, v62
    v_and_b32 v121, 0xffff0000, v62
    v_mul_f32 v120, v120, v91
    v_mul_f32 v121, v121, v91
    v_cvt_pk_bf16_f32 v62, v120, v121
    v_sub_f32 v122, v122, v90
    v_sub_f32 v123, v123, v90
    v_cvt_pk_bf16_f32 v63, v122, v123
    v_lshlrev_b32 v122, 16, v63
    v_and_b32 v123, 0xffff0000, v63
    v_mul_f32 v122, v122, v91
    v_mul_f32 v123, v123, v91
    v_cvt_pk_bf16_f32 v63, v122, v123
    v_sub_f32 v124, v124, v90
    v_sub_f32 v125, v125, v90
    v_cvt_pk_bf16_f32 v64, v124, v125
    v_lshlrev_b32 v124, 16, v64
    v_and_b32 v125, 0xffff0000, v64
    v_mul_f32 v124, v124, v91
    v_mul_f32 v125, v125, v91
    v_cvt_pk_bf16_f32 v64, v124, v125
    v_sub_f32 v126, v126, v90
    v_sub_f32 v127, v127, v90
    v_cvt_pk_bf16_f32 v65, v126, v127
    v_lshlrev_b32 v126, 16, v65
    v_and_b32 v127, 0xffff0000, v65
    v_mul_f32 v126, v126, v91
    v_mul_f32 v127, v127, v91
    v_cvt_pk_bf16_f32 v65, v126, v127
    v_sub_f32 v128, v128, v90
    v_sub_f32 v129, v129, v90
    v_cvt_pk_bf16_f32 v66, v128, v129
    v_lshlrev_b32 v128, 16, v66
    v_and_b32 v129, 0xffff0000, v66
    v_mul_f32 v128, v128, v91
    v_mul_f32 v129, v129, v91
    v_cvt_pk_bf16_f32 v66, v128, v129
    v_sub_f32 v130, v130, v90
    v_sub_f32 v131, v131, v90
    v_cvt_pk_bf16_f32 v67, v130, v131
    v_lshlrev_b32 v130, 16, v67
    v_and_b32 v131, 0xffff0000, v67
    v_mul_f32 v130, v130, v91
    v_mul_f32 v131, v131, v91
    v_cvt_pk_bf16_f32 v67, v130, v131
    v_sub_f32 v132, v132, v90
    v_sub_f32 v133, v133, v90
    v_cvt_pk_bf16_f32 v68, v132, v133
    v_lshlrev_b32 v132, 16, v68
    v_and_b32 v133, 0xffff0000, v68
    v_mul_f32 v132, v132, v91
    v_mul_f32 v133, v133, v91
    v_cvt_pk_bf16_f32 v68, v132, v133
    v_sub_f32 v134, v134, v90
    v_sub_f32 v135, v135, v90
    v_cvt_pk_bf16_f32 v69, v134, v135
    v_lshlrev_b32 v134, 16, v69
    v_and_b32 v135, 0xffff0000, v69
    v_mul_f32 v134, v134, v91
    v_mul_f32 v135, v135, v91
    v_cvt_pk_bf16_f32 v69, v134, v135
    v_sub_f32 v136, v136, v90
    v_sub_f32 v137, v137, v90
    v_cvt_pk_bf16_f32 v70, v136, v137
    v_lshlrev_b32 v136, 16, v70
    v_and_b32 v137, 0xffff0000, v70
    v_mul_f32 v136, v136, v91
    v_mul_f32 v137, v137, v91
    v_cvt_pk_bf16_f32 v70, v136, v137
    v_sub_f32 v138, v138, v90
    v_sub_f32 v139, v139, v90
    v_cvt_pk_bf16_f32 v71, v138, v139
    v_lshlrev_b32 v138, 16, v71
    v_and_b32 v139, 0xffff0000, v71
    v_mul_f32 v138, v138, v91
    v_mul_f32 v139, v139, v91
    v_cvt_pk_bf16_f32 v71, v138, v139
    v_sub_f32 v140, v140, v90
    v_sub_f32 v141, v141, v90
    v_cvt_pk_bf16_f32 v72, v140, v141
    v_lshlrev_b32 v140, 16, v72
    v_and_b32 v141, 0xffff0000, v72
    v_mul_f32 v140, v140, v91
    v_mul_f32 v141, v141, v91
    v_cvt_pk_bf16_f32 v72, v140, v141
    v_sub_f32 v142, v142, v90
    v_sub_f32 v143, v143, v90
    v_cvt_pk_bf16_f32 v73, v142, v143
    v_lshlrev_b32 v142, 16, v73
    v_and_b32 v143, 0xffff0000, v73
    v_mul_f32 v142, v142, v91
    v_mul_f32 v143, v143, v91
    v_cvt_pk_bf16_f32 v73, v142, v143
    v_sub_f32 v144, v144, v90
    v_sub_f32 v145, v145, v90
    v_cvt_pk_bf16_f32 v74, v144, v145
    v_lshlrev_b32 v144, 16, v74
    v_and_b32 v145, 0xffff0000, v74
    v_mul_f32 v144, v144, v91
    v_mul_f32 v145, v145, v91
    v_cvt_pk_bf16_f32 v74, v144, v145
    v_sub_f32 v146, v146, v90
    v_sub_f32 v147, v147, v90
    v_cvt_pk_bf16_f32 v75, v146, v147
    v_lshlrev_b32 v146, 16, v75
    v_and_b32 v147, 0xffff0000, v75
    v_mul_f32 v146, v146, v91
    v_mul_f32 v147, v147, v91
    v_cvt_pk_bf16_f32 v75, v146, v147
    v_sub_f32 v148, v148, v90
    v_sub_f32 v149, v149, v90
    v_cvt_pk_bf16_f32 v76, v148, v149
    v_lshlrev_b32 v148, 16, v76
    v_and_b32 v149, 0xffff0000, v76
    v_mul_f32 v148, v148, v91
    v_mul_f32 v149, v149, v91
    v_cvt_pk_bf16_f32 v76, v148, v149
    v_sub_f32 v150, v150, v90
    v_sub_f32 v151, v151, v90
    v_cvt_pk_bf16_f32 v77, v150, v151
    v_lshlrev_b32 v150, 16, v77
    v_and_b32 v151, 0xffff0000, v77
    v_mul_f32 v150, v150, v91
    v_mul_f32 v151, v151, v91
    v_cvt_pk_bf16_f32 v77, v150, v151
    v_sub_f32 v152, v152, v90
    v_sub_f32 v153, v153, v90
    v_cvt_pk_bf16_f32 v78, v152, v153
    v_lshlrev_b32 v152, 16, v78
    v_and_b32 v153, 0xffff0000, v78
    v_mul_f32 v152, v152, v91
    v_mul_f32 v153, v153, v91
    v_cvt_pk_bf16_f32 v78, v152, v153
    v_sub_f32 v154, v154, v90
    v_sub_f32 v155, v155, v90
    v_cvt_pk_bf16_f32 v79, v154, v155
    v_lshlrev_b32 v154, 16, v79
    v_and_b32 v155, 0xffff0000, v79
    v_mul_f32 v154, v154, v91
    v_mul_f32 v155, v155, v91
    v_cvt_pk_bf16_f32 v79, v154, v155
    v_sub_f32 v156, v156, v90
    v_sub_f32 v157, v157, v90
    v_cvt_pk_bf16_f32 v80, v156, v157
    v_lshlrev_b32 v156, 16, v80
    v_and_b32 v157, 0xffff0000, v80
    v_mul_f32 v156, v156, v91
    v_mul_f32 v157, v157, v91
    v_cvt_pk_bf16_f32 v80, v156, v157
    v_sub_f32 v158, v158, v90
    v_sub_f32 v159, v159, v90
    v_cvt_pk_bf16_f32 v81, v158, v159
    v_lshlrev_b32 v158, 16, v81
    v_and_b32 v159, 0xffff0000, v81
    v_mul_f32 v158, v158, v91
    v_mul_f32 v159, v159, v91
    v_cvt_pk_bf16_f32 v81, v158, v159
    v_sub_f32 v160, v160, v90
    v_sub_f32 v161, v161, v90
    v_cvt_pk_bf16_f32 v82, v160, v161
    v_lshlrev_b32 v160, 16, v82
    v_and_b32 v161, 0xffff0000, v82
    v_mul_f32 v160, v160, v91
    v_mul_f32 v161, v161, v91
    v_cvt_pk_bf16_f32 v82, v160, v161
    v_sub_f32 v162, v162, v90
    v_sub_f32 v163, v163, v90
    v_cvt_pk_bf16_f32 v83, v162, v163
    v_lshlrev_b32 v162, 16, v83
    v_and_b32 v163, 0xffff0000, v83
    v_mul_f32 v162, v162, v91
    v_mul_f32 v163, v163, v91
    v_cvt_pk_bf16_f32 v83, v162, v163
    v_sub_f32 v164, v164, v90
    v_sub_f32 v165, v165, v90
    v_cvt_pk_bf16_f32 v84, v164, v165
    v_lshlrev_b32 v164, 16, v84
    v_and_b32 v165, 0xffff0000, v84
    v_mul_f32 v164, v164, v91
    v_mul_f32 v165, v165, v91
    v_cvt_pk_bf16_f32 v84, v164, v165
    v_sub_f32 v166, v166, v90
    v_sub_f32 v167, v167, v90
    v_cvt_pk_bf16_f32 v85, v166, v167
    v_lshlrev_b32 v166, 16, v85
    v_and_b32 v167, 0xffff0000, v85
    v_mul_f32 v166, v166, v91
    v_mul_f32 v167, v167, v91
    v_cvt_pk_bf16_f32 v85, v166, v167
    v_sub_f32 v168, v168, v90
    v_sub_f32 v169, v169, v90
    v_cvt_pk_bf16_f32 v86, v168, v169
    v_lshlrev_b32 v168, 16, v86
    v_and_b32 v169, 0xffff0000, v86
    v_mul_f32 v168, v168, v91
    v_mul_f32 v169, v169, v91
    v_cvt_pk_bf16_f32 v86, v168, v169
    v_sub_f32 v170, v170, v90
    v_sub_f32 v171, v171, v90
    v_cvt_pk_bf16_f32 v87, v170, v171
    v_lshlrev_b32 v170, 16, v87
    v_and_b32 v171, 0xffff0000, v87
    v_mul_f32 v170, v170, v91
    v_mul_f32 v171, v171, v91
    v_cvt_pk_bf16_f32 v87, v170, v171
    s_lshl_b32 s22, s3, 4
    s_add_u32 s22, s22, 8
    s_lshr_b32 s23, s22, 5
    s_mul_i32 s23, s23, 36864
    s_and_b32 s22, s22, 31
    v_lshrrev_b32 v7, 3, v1
    v_add_u32 v7, s22, v7
    v_lshlrev_b32 v7, 4, v7
    v_add_u32 v7, s23, v7
    v_and_b32 v6, 7, v1
    v_lshrrev_b32 v8, 1, v6
    v_lshl_add_u32 v7, v8, 10, v7
    v_and_b32 v8, 1, v6
    v_lshl_add_u32 v7, v8, 9, v7
    ds_write_b128 v7, v[52:55] offset:0
    ds_write_b128 v7, v[56:59] offset:4096
    ds_write_b128 v7, v[60:63] offset:8192
    ds_write_b128 v7, v[64:67] offset:12288
    ds_write_b128 v7, v[68:71] offset:16384
    ds_write_b128 v7, v[72:75] offset:20480
    ds_write_b128 v7, v[76:79] offset:24576
    ds_write_b128 v7, v[80:83] offset:28672
    ds_write_b128 v7, v[84:87] offset:32768
    s_waitcnt lgkmcnt(0)
    s_barrier
    v_mov_b32 v100, 0
    v_mov_b32 v101, 0
    v_mov_b32 v102, 0
    v_mov_b32 v103, 0
    v_mov_b32 v104, 0
    v_mov_b32 v105, 0
    v_mov_b32 v106, 0
    v_mov_b32 v107, 0
    v_mov_b32 v108, 0
    v_mov_b32 v109, 0
    v_mov_b32 v110, 0
    v_mov_b32 v111, 0
    v_mov_b32 v112, 0
    v_mov_b32 v113, 0
    v_mov_b32 v114, 0
    v_mov_b32 v115, 0
    v_mov_b32 v116, 0
    v_mov_b32 v117, 0
    v_mov_b32 v118, 0
    v_mov_b32 v119, 0
    v_mov_b32 v120, 0
    v_mov_b32 v121, 0
    v_mov_b32 v122, 0
    v_mov_b32 v123, 0
    v_mov_b32 v124, 0
    v_mov_b32 v125, 0
    v_mov_b32 v126, 0
    v_mov_b32 v127, 0
    v_mov_b32 v128, 0
    v_mov_b32 v129, 0
    v_mov_b32 v130, 0
    v_mov_b32 v131, 0
    v_mov_b32 v132, 0
    v_mov_b32 v133, 0
    v_mov_b32 v134, 0
    v_mov_b32 v135, 0
    v_mov_b32 v136, 0
    v_mov_b32 v137, 0
    v_mov_b32 v138, 0
    v_mov_b32 v139, 0
    v_mov_b32 v140, 0
    v_mov_b32 v141, 0
    v_mov_b32 v142, 0
    v_mov_b32 v143, 0
    v_mov_b32 v144, 0
    v_mov_b32 v145, 0
    v_mov_b32 v146, 0
    v_mov_b32 v147, 0
    v_mov_b32 v148, 0
    v_mov_b32 v149, 0
    v_mov_b32 v150, 0
    v_mov_b32 v151, 0
    v_mov_b32 v152, 0
    v_mov_b32 v153, 0
    v_mov_b32 v154, 0
    v_mov_b32 v155, 0
    v_mov_b32 v156, 0
    v_mov_b32 v157, 0
    v_mov_b32 v158, 0
    v_mov_b32 v159, 0
    v_mov_b32 v160, 0
    v_mov_b32 v161, 0
    v_mov_b32 v162, 0
    v_mov_b32 v163, 0
    v_mov_b32 v164, 0
    v_mov_b32 v165, 0
    v_mov_b32 v166, 0
    v_mov_b32 v167, 0
    v_mov_b32 v168, 0
    v_mov_b32 v169, 0
    v_mov_b32 v170, 0
    v_mov_b32 v171, 0
    v_mov_b32 v172, 0
    v_mov_b32 v173, 0
    v_mov_b32 v174, 0
    v_mov_b32 v175, 0
    v_mov_b32 v176, 0
    v_mov_b32 v177, 0
    v_mov_b32 v178, 0
    v_mov_b32 v179, 0
    v_mov_b32 v180, 0
    v_mov_b32 v181, 0
    v_mov_b32 v182, 0
    v_mov_b32 v183, 0
    v_mov_b32 v184, 0
    v_mov_b32 v185, 0
    v_mov_b32 v186, 0
    v_mov_b32 v187, 0
    v_mov_b32 v188, 0
    v_mov_b32 v189, 0
    v_mov_b32 v190, 0
    v_mov_b32 v191, 0
    v_mov_b32 v192, 0
    v_mov_b32 v193, 0
    v_mov_b32 v194, 0
    v_mov_b32 v195, 0
    v_add_u32 v5, 36864, v4
    buffer_load_dwordx4 v[16:19], v4, s[12:15], s19 offen
    buffer_load_dwordx4 v[20:23], v4, s[12:15], s20 offen
    buffer_load_dwordx4 v[24:27], v4, s[12:15], s21 offen
    s_add_u32 s19, s19, 1024
    s_add_u32 s20, s20, 1024
    s_add_u32 s21, s21, 1024
    buffer_load_dwordx4 v[28:31], v4, s[12:15], s19 offen
    buffer_load_dwordx4 v[32:35], v4, s[12:15], s20 offen
    buffer_load_dwordx4 v[36:39], v4, s[12:15], s21 offen
    s_add_u32 s19, s19, 1024
    s_add_u32 s20, s20, 1024
    s_add_u32 s21, s21, 1024
    buffer_load_dwordx4 v[40:43], v4, s[12:15], s19 offen
    buffer_load_dwordx4 v[44:47], v4, s[12:15], s20 offen
    buffer_load_dwordx4 v[48:51], v4, s[12:15], s21 offen
    s_add_u32 s19, s19, 1024
    s_add_u32 s20, s20, 1024
    s_add_u32 s21, s21, 1024
    ds_read_b128 v[64:67], v4 offset:0
    ds_read_b128 v[68:71], v5 offset:0
    buffer_load_dwordx4 v[52:55], v4, s[12:15], s19 offen
    buffer_load_dwordx4 v[56:59], v4, s[12:15], s20 offen
    buffer_load_dwordx4 v[60:63], v4, s[12:15], s21 offen
    s_add_u32 s19, s19, 1024
    s_add_u32 s20, s20, 1024
    s_add_u32 s21, s21, 1024
    ds_read_b128 v[72:75], v4 offset:1024
    ds_read_b128 v[76:79], v5 offset:1024
    s_waitcnt vmcnt(9) lgkmcnt(2)
    v_mfma_f32_32x32x16_bf16 v[100:115], v[16:19], v[64:67], v[100:115]
    v_mfma_f32_32x32x16_bf16 v[132:147], v[20:23], v[64:67], v[132:147]
    v_mfma_f32_32x32x16_bf16 v[164:179], v[64:67], v[24:27], v[164:179]
    v_mfma_f32_32x32x16_bf16 v[116:131], v[16:19], v[68:71], v[116:131]
    v_mfma_f32_32x32x16_bf16 v[148:163], v[20:23], v[68:71], v[148:163]
    v_mfma_f32_32x32x16_bf16 v[180:195], v[68:71], v[24:27], v[180:195]
    buffer_load_dwordx4 v[16:19], v4, s[12:15], s19 offen
    buffer_load_dwordx4 v[20:23], v4, s[12:15], s20 offen
    buffer_load_dwordx4 v[24:27], v4, s[12:15], s21 offen
    s_add_u32 s19, s19, 1024
    s_add_u32 s20, s20, 1024
    s_add_u32 s21, s21, 1024
    ds_read_b128 v[80:83], v4 offset:2048
    ds_read_b128 v[84:87], v5 offset:2048
    s_waitcnt vmcnt(9) lgkmcnt(2)
    v_mfma_f32_32x32x16_bf16 v[100:115], v[28:31], v[72:75], v[100:115]
    v_mfma_f32_32x32x16_bf16 v[132:147], v[32:35], v[72:75], v[132:147]
    v_mfma_f32_32x32x16_bf16 v[164:179], v[72:75], v[36:39], v[164:179]
    v_mfma_f32_32x32x16_bf16 v[116:131], v[28:31], v[76:79], v[116:131]
    v_mfma_f32_32x32x16_bf16 v[148:163], v[32:35], v[76:79], v[148:163]
    v_mfma_f32_32x32x16_bf16 v[180:195], v[76:79], v[36:39], v[180:195]
    buffer_load_dwordx4 v[28:31], v4, s[12:15], s19 offen
    buffer_load_dwordx4 v[32:35], v4, s[12:15], s20 offen
    buffer_load_dwordx4 v[36:39], v4, s[12:15], s21 offen
    s_add_u32 s19, s19, 1024
    s_add_u32 s20, s20, 1024
    s_add_u32 s21, s21, 1024
    ds_read_b128 v[64:67], v4 offset:3072
    ds_read_b128 v[68:71], v5 offset:3072
    s_waitcnt vmcnt(9) lgkmcnt(2)
    v_mfma_f32_32x32x16_bf16 v[100:115], v[40:43], v[80:83], v[100:115]
    v_mfma_f32_32x32x16_bf16 v[132:147], v[44:47], v[80:83], v[132:147]
    v_mfma_f32_32x32x16_bf16 v[164:179], v[80:83], v[48:51], v[164:179]
    v_mfma_f32_32x32x16_bf16 v[116:131], v[40:43], v[84:87], v[116:131]
    v_mfma_f32_32x32x16_bf16 v[148:163], v[44:47], v[84:87], v[148:163]
    v_mfma_f32_32x32x16_bf16 v[180:195], v[84:87], v[48:51], v[180:195]
    buffer_load_dwordx4 v[40:43], v4, s[12:15], s19 offen
    buffer_load_dwordx4 v[44:47], v4, s[12:15], s20 offen
    buffer_load_dwordx4 v[48:51], v4, s[12:15], s21 offen
    s_add_u32 s19, s19, 1024
    s_add_u32 s20, s20, 1024
    s_add_u32 s21, s21, 1024
    ds_read_b128 v[72:75], v4 offset:4096
    ds_read_b128 v[76:79], v5 offset:4096
    s_waitcnt vmcnt(9) lgkmcnt(2)
    v_mfma_f32_32x32x16_bf16 v[100:115], v[52:55], v[64:67], v[100:115]
    v_mfma_f32_32x32x16_bf16 v[132:147], v[56:59], v[64:67], v[132:147]
    v_mfma_f32_32x32x16_bf16 v[164:179], v[64:67], v[60:63], v[164:179]
    v_mfma_f32_32x32x16_bf16 v[116:131], v[52:55], v[68:71], v[116:131]
    v_mfma_f32_32x32x16_bf16 v[148:163], v[56:59], v[68:71], v[148:163]
    v_mfma_f32_32x32x16_bf16 v[180:195], v[68:71], v[60:63], v[180:195]
    buffer_load_dwordx4 v[52:55], v4, s[12:15], s19 offen
    buffer_load_dwordx4 v[56:59], v4, s[12:15], s20 offen
    buffer_load_dwordx4 v[60:63], v4, s[12:15], s21 offen
    s_add_u32 s19, s19, 1024
    s_add_u32 s20, s20, 1024
    s_add_u32 s21, s21, 1024
    ds_read_b128 v[80:83], v4 offset:5120
    ds_read_b128 v[84:87], v5 offset:5120
    s_waitcnt vmcnt(9) lgkmcnt(2)
    v_mfma_f32_32x32x16_bf16 v[100:115], v[16:19], v[72:75], v[100:115]
    v_mfma_f32_32x32x16_bf16 v[132:147], v[20:23], v[72:75], v[132:147]
    v_mfma_f32_32x32x16_bf16 v[164:179], v[72:75], v[24:27], v[164:179]
    v_mfma_f32_32x32x16_bf16 v[116:131], v[16:19], v[76:79], v[116:131]
    v_mfma_f32_32x32x16_bf16 v[148:163], v[20:23], v[76:79], v[148:163]
    v_mfma_f32_32x32x16_bf16 v[180:195], v[76:79], v[24:27], v[180:195]
    buffer_load_dwordx4 v[16:19], v4, s[12:15], s19 offen
    buffer_load_dwordx4 v[20:23], v4, s[12:15], s20 offen
    buffer_load_dwordx4 v[24:27], v4, s[12:15], s21 offen
    s_add_u32 s19, s19, 1024
    s_add_u32 s20, s20, 1024
    s_add_u32 s21, s21, 1024
    ds_read_b128 v[64:67], v4 offset:6144
    ds_read_b128 v[68:71], v5 offset:6144
    s_waitcnt vmcnt(9) lgkmcnt(2)
    v_mfma_f32_32x32x16_bf16 v[100:115], v[28:31], v[80:83], v[100:115]
    v_mfma_f32_32x32x16_bf16 v[132:147], v[32:35], v[80:83], v[132:147]
    v_mfma_f32_32x32x16_bf16 v[164:179], v[80:83], v[36:39], v[164:179]
    v_mfma_f32_32x32x16_bf16 v[116:131], v[28:31], v[84:87], v[116:131]
    v_mfma_f32_32x32x16_bf16 v[148:163], v[32:35], v[84:87], v[148:163]
    v_mfma_f32_32x32x16_bf16 v[180:195], v[84:87], v[36:39], v[180:195]
    buffer_load_dwordx4 v[28:31], v4, s[12:15], s19 offen
    buffer_load_dwordx4 v[32:35], v4, s[12:15], s20 offen
    buffer_load_dwordx4 v[36:39], v4, s[12:15], s21 offen
    s_add_u32 s19, s19, 1024
    s_add_u32 s20, s20, 1024
    s_add_u32 s21, s21, 1024
    ds_read_b128 v[72:75], v4 offset:7168
    ds_read_b128 v[76:79], v5 offset:7168
    s_waitcnt vmcnt(9) lgkmcnt(2)
    v_mfma_f32_32x32x16_bf16 v[100:115], v[40:43], v[64:67], v[100:115]
    v_mfma_f32_32x32x16_bf16 v[132:147], v[44:47], v[64:67], v[132:147]
    v_mfma_f32_32x32x16_bf16 v[164:179], v[64:67], v[48:51], v[164:179]
    v_mfma_f32_32x32x16_bf16 v[116:131], v[40:43], v[68:71], v[116:131]
    v_mfma_f32_32x32x16_bf16 v[148:163], v[44:47], v[68:71], v[148:163]
    v_mfma_f32_32x32x16_bf16 v[180:195], v[68:71], v[48:51], v[180:195]
    buffer_load_dwordx4 v[40:43], v4, s[12:15], s19 offen
    buffer_load_dwordx4 v[44:47], v4, s[12:15], s20 offen
    buffer_load_dwordx4 v[48:51], v4, s[12:15], s21 offen
    s_add_u32 s19, s19, 1024
    s_add_u32 s20, s20, 1024
    s_add_u32 s21, s21, 1024
    ds_read_b128 v[80:83], v4 offset:8192
    ds_read_b128 v[84:87], v5 offset:8192
    s_waitcnt vmcnt(9) lgkmcnt(2)
    v_mfma_f32_32x32x16_bf16 v[100:115], v[52:55], v[72:75], v[100:115]
    v_mfma_f32_32x32x16_bf16 v[132:147], v[56:59], v[72:75], v[132:147]
    v_mfma_f32_32x32x16_bf16 v[164:179], v[72:75], v[60:63], v[164:179]
    v_mfma_f32_32x32x16_bf16 v[116:131], v[52:55], v[76:79], v[116:131]
    v_mfma_f32_32x32x16_bf16 v[148:163], v[56:59], v[76:79], v[148:163]
    v_mfma_f32_32x32x16_bf16 v[180:195], v[76:79], v[60:63], v[180:195]
    buffer_load_dwordx4 v[52:55], v4, s[12:15], s19 offen
    buffer_load_dwordx4 v[56:59], v4, s[12:15], s20 offen
    buffer_load_dwordx4 v[60:63], v4, s[12:15], s21 offen
    s_add_u32 s19, s19, 1024
    s_add_u32 s20, s20, 1024
    s_add_u32 s21, s21, 1024
    ds_read_b128 v[64:67], v4 offset:9216
    ds_read_b128 v[68:71], v5 offset:9216
    s_waitcnt vmcnt(9) lgkmcnt(2)
    v_mfma_f32_32x32x16_bf16 v[100:115], v[16:19], v[80:83], v[100:115]
    v_mfma_f32_32x32x16_bf16 v[132:147], v[20:23], v[80:83], v[132:147]
    v_mfma_f32_32x32x16_bf16 v[164:179], v[80:83], v[24:27], v[164:179]
    v_mfma_f32_32x32x16_bf16 v[116:131], v[16:19], v[84:87], v[116:131]
    v_mfma_f32_32x32x16_bf16 v[148:163], v[20:23], v[84:87], v[148:163]
    v_mfma_f32_32x32x16_bf16 v[180:195], v[84:87], v[24:27], v[180:195]
    buffer_load_dwordx4 v[16:19], v4, s[12:15], s19 offen
    buffer_load_dwordx4 v[20:23], v4, s[12:15], s20 offen
    buffer_load_dwordx4 v[24:27], v4, s[12:15], s21 offen
    s_add_u32 s19, s19, 1024
    s_add_u32 s20, s20, 1024
    s_add_u32 s21, s21, 1024
    ds_read_b128 v[72:75], v4 offset:10240
    ds_read_b128 v[76:79], v5 offset:10240
    s_waitcnt vmcnt(9) lgkmcnt(2)
    v_mfma_f32_32x32x16_bf16 v[100:115], v[28:31], v[64:67], v[100:115]
    v_mfma_f32_32x32x16_bf16 v[132:147], v[32:35], v[64:67], v[132:147]
    v_mfma_f32_32x32x16_bf16 v[164:179], v[64:67], v[36:39], v[164:179]
    v_mfma_f32_32x32x16_bf16 v[116:131], v[28:31], v[68:71], v[116:131]
    v_mfma_f32_32x32x16_bf16 v[148:163], v[32:35], v[68:71], v[148:163]
    v_mfma_f32_32x32x16_bf16 v[180:195], v[68:71], v[36:39], v[180:195]
    buffer_load_dwordx4 v[28:31], v4, s[12:15], s19 offen
    buffer_load_dwordx4 v[32:35], v4, s[12:15], s20 offen
    buffer_load_dwordx4 v[36:39], v4, s[12:15], s21 offen
    s_add_u32 s19, s19, 1024
    s_add_u32 s20, s20, 1024
    s_add_u32 s21, s21, 1024
    ds_read_b128 v[80:83], v4 offset:11264
    ds_read_b128 v[84:87], v5 offset:11264
    s_waitcnt vmcnt(9) lgkmcnt(2)
    v_mfma_f32_32x32x16_bf16 v[100:115], v[40:43], v[72:75], v[100:115]
    v_mfma_f32_32x32x16_bf16 v[132:147], v[44:47], v[72:75], v[132:147]
    v_mfma_f32_32x32x16_bf16 v[164:179], v[72:75], v[48:51], v[164:179]
    v_mfma_f32_32x32x16_bf16 v[116:131], v[40:43], v[76:79], v[116:131]
    v_mfma_f32_32x32x16_bf16 v[148:163], v[44:47], v[76:79], v[148:163]
    v_mfma_f32_32x32x16_bf16 v[180:195], v[76:79], v[48:51], v[180:195]
    buffer_load_dwordx4 v[40:43], v4, s[12:15], s19 offen
    buffer_load_dwordx4 v[44:47], v4, s[12:15], s20 offen
    buffer_load_dwordx4 v[48:51], v4, s[12:15], s21 offen
    s_add_u32 s19, s19, 1024
    s_add_u32 s20, s20, 1024
    s_add_u32 s21, s21, 1024
    ds_read_b128 v[64:67], v4 offset:12288
    ds_read_b128 v[68:71], v5 offset:12288
    s_waitcnt vmcnt(9) lgkmcnt(2)
    v_mfma_f32_32x32x16_bf16 v[100:115], v[52:55], v[80:83], v[100:115]
    v_mfma_f32_32x32x16_bf16 v[132:147], v[56:59], v[80:83], v[132:147]
    v_mfma_f32_32x32x16_bf16 v[164:179], v[80:83], v[60:63], v[164:179]
    v_mfma_f32_32x32x16_bf16 v[116:131], v[52:55], v[84:87], v[116:131]
    v_mfma_f32_32x32x16_bf16 v[148:163], v[56:59], v[84:87], v[148:163]
    v_mfma_f32_32x32x16_bf16 v[180:195], v[84:87], v[60:63], v[180:195]
    buffer_load_dwordx4 v[52:55], v4, s[12:15], s19 offen
    buffer_load_dwordx4 v[56:59], v4, s[12:15], s20 offen
    buffer_load_dwordx4 v[60:63], v4, s[12:15], s21 offen
    s_add_u32 s19, s19, 1024
    s_add_u32 s20, s20, 1024
    s_add_u32 s21, s21, 1024
    ds_read_b128 v[72:75], v4 offset:13312
    ds_read_b128 v[76:79], v5 offset:13312
    s_waitcnt vmcnt(9) lgkmcnt(2)
    v_mfma_f32_32x32x16_bf16 v[100:115], v[16:19], v[64:67], v[100:115]
    v_mfma_f32_32x32x16_bf16 v[132:147], v[20:23], v[64:67], v[132:147]
    v_mfma_f32_32x32x16_bf16 v[164:179], v[64:67], v[24:27], v[164:179]
    v_mfma_f32_32x32x16_bf16 v[116:131], v[16:19], v[68:71], v[116:131]
    v_mfma_f32_32x32x16_bf16 v[148:163], v[20:23], v[68:71], v[148:163]
    v_mfma_f32_32x32x16_bf16 v[180:195], v[68:71], v[24:27], v[180:195]
    buffer_load_dwordx4 v[16:19], v4, s[12:15], s19 offen
    buffer_load_dwordx4 v[20:23], v4, s[12:15], s20 offen
    buffer_load_dwordx4 v[24:27], v4, s[12:15], s21 offen
    s_add_u32 s19, s19, 1024
    s_add_u32 s20, s20, 1024
    s_add_u32 s21, s21, 1024
    ds_read_b128 v[80:83], v4 offset:14336
    ds_read_b128 v[84:87], v5 offset:14336
    s_waitcnt vmcnt(9) lgkmcnt(2)
    v_mfma_f32_32x32x16_bf16 v[100:115], v[28:31], v[72:75], v[100:115]
    v_mfma_f32_32x32x16_bf16 v[132:147], v[32:35], v[72:75], v[132:147]
    v_mfma_f32_32x32x16_bf16 v[164:179], v[72:75], v[36:39], v[164:179]
    v_mfma_f32_32x32x16_bf16 v[116:131], v[28:31], v[76:79], v[116:131]
    v_mfma_f32_32x32x16_bf16 v[148:163], v[32:35], v[76:79], v[148:163]
    v_mfma_f32_32x32x16_bf16 v[180:195], v[76:79], v[36:39], v[180:195]
    buffer_load_dwordx4 v[28:31], v4, s[12:15], s19 offen
    buffer_load_dwordx4 v[32:35], v4, s[12:15], s20 offen
    buffer_load_dwordx4 v[36:39], v4, s[12:15], s21 offen
    s_add_u32 s19, s19, 1024
    s_add_u32 s20, s20, 1024
    s_add_u32 s21, s21, 1024
    ds_read_b128 v[64:67], v4 offset:15360
    ds_read_b128 v[68:71], v5 offset:15360
    s_waitcnt vmcnt(9) lgkmcnt(2)
    v_mfma_f32_32x32x16_bf16 v[100:115], v[40:43], v[80:83], v[100:115]
    v_mfma_f32_32x32x16_bf16 v[132:147], v[44:47], v[80:83], v[132:147]
    v_mfma_f32_32x32x16_bf16 v[164:179], v[80:83], v[48:51], v[164:179]
    v_mfma_f32_32x32x16_bf16 v[116:131], v[40:43], v[84:87], v[116:131]
    v_mfma_f32_32x32x16_bf16 v[148:163], v[44:47], v[84:87], v[148:163]
    v_mfma_f32_32x32x16_bf16 v[180:195], v[84:87], v[48:51], v[180:195]
    buffer_load_dwordx4 v[40:43], v4, s[12:15], s19 offen
    buffer_load_dwordx4 v[44:47], v4, s[12:15], s20 offen
    buffer_load_dwordx4 v[48:51], v4, s[12:15], s21 offen
    s_add_u32 s19, s19, 1024
    s_add_u32 s20, s20, 1024
    s_add_u32 s21, s21, 1024
    ds_read_b128 v[72:75], v4 offset:16384
    ds_read_b128 v[76:79], v5 offset:16384
    s_waitcnt vmcnt(9) lgkmcnt(2)
    v_mfma_f32_32x32x16_bf16 v[100:115], v[52:55], v[64:67], v[100:115]
    v_mfma_f32_32x32x16_bf16 v[132:147], v[56:59], v[64:67], v[132:147]
    v_mfma_f32_32x32x16_bf16 v[164:179], v[64:67], v[60:63], v[164:179]
    v_mfma_f32_32x32x16_bf16 v[116:131], v[52:55], v[68:71], v[116:131]
    v_mfma_f32_32x32x16_bf16 v[148:163], v[56:59], v[68:71], v[148:163]
    v_mfma_f32_32x32x16_bf16 v[180:195], v[68:71], v[60:63], v[180:195]
    buffer_load_dwordx4 v[52:55], v4, s[12:15], s19 offen
    buffer_load_dwordx4 v[56:59], v4, s[12:15], s20 offen
    buffer_load_dwordx4 v[60:63], v4, s[12:15], s21 offen
    s_add_u32 s19, s19, 1024
    s_add_u32 s20, s20, 1024
    s_add_u32 s21, s21, 1024
    ds_read_b128 v[80:83], v4 offset:17408
    ds_read_b128 v[84:87], v5 offset:17408
    s_waitcnt vmcnt(9) lgkmcnt(2)
    v_mfma_f32_32x32x16_bf16 v[100:115], v[16:19], v[72:75], v[100:115]
    v_mfma_f32_32x32x16_bf16 v[132:147], v[20:23], v[72:75], v[132:147]
    v_mfma_f32_32x32x16_bf16 v[164:179], v[72:75], v[24:27], v[164:179]
    v_mfma_f32_32x32x16_bf16 v[116:131], v[16:19], v[76:79], v[116:131]
    v_mfma_f32_32x32x16_bf16 v[148:163], v[20:23], v[76:79], v[148:163]
    v_mfma_f32_32x32x16_bf16 v[180:195], v[76:79], v[24:27], v[180:195]
    buffer_load_dwordx4 v[16:19], v4, s[12:15], s19 offen
    buffer_load_dwordx4 v[20:23], v4, s[12:15], s20 offen
    buffer_load_dwordx4 v[24:27], v4, s[12:15], s21 offen
    s_add_u32 s19, s19, 1024
    s_add_u32 s20, s20, 1024
    s_add_u32 s21, s21, 1024
    ds_read_b128 v[64:67], v4 offset:18432
    ds_read_b128 v[68:71], v5 offset:18432
    s_waitcnt vmcnt(9) lgkmcnt(2)
    v_mfma_f32_32x32x16_bf16 v[100:115], v[28:31], v[80:83], v[100:115]
    v_mfma_f32_32x32x16_bf16 v[132:147], v[32:35], v[80:83], v[132:147]
    v_mfma_f32_32x32x16_bf16 v[164:179], v[80:83], v[36:39], v[164:179]
    v_mfma_f32_32x32x16_bf16 v[116:131], v[28:31], v[84:87], v[116:131]
    v_mfma_f32_32x32x16_bf16 v[148:163], v[32:35], v[84:87], v[148:163]
    v_mfma_f32_32x32x16_bf16 v[180:195], v[84:87], v[36:39], v[180:195]
    buffer_load_dwordx4 v[28:31], v4, s[12:15], s19 offen
    buffer_load_dwordx4 v[32:35], v4, s[12:15], s20 offen
    buffer_load_dwordx4 v[36:39], v4, s[12:15], s21 offen
    s_add_u32 s19, s19, 1024
    s_add_u32 s20, s20, 1024
    s_add_u32 s21, s21, 1024
    ds_read_b128 v[72:75], v4 offset:19456
    ds_read_b128 v[76:79], v5 offset:19456
    s_waitcnt vmcnt(9) lgkmcnt(2)
    v_mfma_f32_32x32x16_bf16 v[100:115], v[40:43], v[64:67], v[100:115]
    v_mfma_f32_32x32x16_bf16 v[132:147], v[44:47], v[64:67], v[132:147]
    v_mfma_f32_32x32x16_bf16 v[164:179], v[64:67], v[48:51], v[164:179]
    v_mfma_f32_32x32x16_bf16 v[116:131], v[40:43], v[68:71], v[116:131]
    v_mfma_f32_32x32x16_bf16 v[148:163], v[44:47], v[68:71], v[148:163]
    v_mfma_f32_32x32x16_bf16 v[180:195], v[68:71], v[48:51], v[180:195]
    buffer_load_dwordx4 v[40:43], v4, s[12:15], s19 offen
    buffer_load_dwordx4 v[44:47], v4, s[12:15], s20 offen
    buffer_load_dwordx4 v[48:51], v4, s[12:15], s21 offen
    s_add_u32 s19, s19, 1024
    s_add_u32 s20, s20, 1024
    s_add_u32 s21, s21, 1024
    ds_read_b128 v[80:83], v4 offset:20480
    ds_read_b128 v[84:87], v5 offset:20480
    s_waitcnt vmcnt(9) lgkmcnt(2)
    v_mfma_f32_32x32x16_bf16 v[100:115], v[52:55], v[72:75], v[100:115]
    v_mfma_f32_32x32x16_bf16 v[132:147], v[56:59], v[72:75], v[132:147]
    v_mfma_f32_32x32x16_bf16 v[164:179], v[72:75], v[60:63], v[164:179]
    v_mfma_f32_32x32x16_bf16 v[116:131], v[52:55], v[76:79], v[116:131]
    v_mfma_f32_32x32x16_bf16 v[148:163], v[56:59], v[76:79], v[148:163]
    v_mfma_f32_32x32x16_bf16 v[180:195], v[76:79], v[60:63], v[180:195]
    buffer_load_dwordx4 v[52:55], v4, s[12:15], s19 offen
    buffer_load_dwordx4 v[56:59], v4, s[12:15], s20 offen
    buffer_load_dwordx4 v[60:63], v4, s[12:15], s21 offen
    s_add_u32 s19, s19, 1024
    s_add_u32 s20, s20, 1024
    s_add_u32 s21, s21, 1024
    ds_read_b128 v[64:67], v4 offset:21504
    ds_read_b128 v[68:71], v5 offset:21504
    s_waitcnt vmcnt(9) lgkmcnt(2)
    v_mfma_f32_32x32x16_bf16 v[100:115], v[16:19], v[80:83], v[100:115]
    v_mfma_f32_32x32x16_bf16 v[132:147], v[20:23], v[80:83], v[132:147]
    v_mfma_f32_32x32x16_bf16 v[164:179], v[80:83], v[24:27], v[164:179]
    v_mfma_f32_32x32x16_bf16 v[116:131], v[16:19], v[84:87], v[116:131]
    v_mfma_f32_32x32x16_bf16 v[148:163], v[20:23], v[84:87], v[148:163]
    v_mfma_f32_32x32x16_bf16 v[180:195], v[84:87], v[24:27], v[180:195]
    buffer_load_dwordx4 v[16:19], v4, s[12:15], s19 offen
    buffer_load_dwordx4 v[20:23], v4, s[12:15], s20 offen
    buffer_load_dwordx4 v[24:27], v4, s[12:15], s21 offen
    s_add_u32 s19, s19, 1024
    s_add_u32 s20, s20, 1024
    s_add_u32 s21, s21, 1024
    ds_read_b128 v[72:75], v4 offset:22528
    ds_read_b128 v[76:79], v5 offset:22528
    s_waitcnt vmcnt(9) lgkmcnt(2)
    v_mfma_f32_32x32x16_bf16 v[100:115], v[28:31], v[64:67], v[100:115]
    v_mfma_f32_32x32x16_bf16 v[132:147], v[32:35], v[64:67], v[132:147]
    v_mfma_f32_32x32x16_bf16 v[164:179], v[64:67], v[36:39], v[164:179]
    v_mfma_f32_32x32x16_bf16 v[116:131], v[28:31], v[68:71], v[116:131]
    v_mfma_f32_32x32x16_bf16 v[148:163], v[32:35], v[68:71], v[148:163]
    v_mfma_f32_32x32x16_bf16 v[180:195], v[68:71], v[36:39], v[180:195]
    buffer_load_dwordx4 v[28:31], v4, s[12:15], s19 offen
    buffer_load_dwordx4 v[32:35], v4, s[12:15], s20 offen
    buffer_load_dwordx4 v[36:39], v4, s[12:15], s21 offen
    s_add_u32 s19, s19, 1024
    s_add_u32 s20, s20, 1024
    s_add_u32 s21, s21, 1024
    ds_read_b128 v[80:83], v4 offset:23552
    ds_read_b128 v[84:87], v5 offset:23552
    s_waitcnt vmcnt(9) lgkmcnt(2)
    v_mfma_f32_32x32x16_bf16 v[100:115], v[40:43], v[72:75], v[100:115]
    v_mfma_f32_32x32x16_bf16 v[132:147], v[44:47], v[72:75], v[132:147]
    v_mfma_f32_32x32x16_bf16 v[164:179], v[72:75], v[48:51], v[164:179]
    v_mfma_f32_32x32x16_bf16 v[116:131], v[40:43], v[76:79], v[116:131]
    v_mfma_f32_32x32x16_bf16 v[148:163], v[44:47], v[76:79], v[148:163]
    v_mfma_f32_32x32x16_bf16 v[180:195], v[76:79], v[48:51], v[180:195]
    buffer_load_dwordx4 v[40:43], v4, s[12:15], s19 offen
    buffer_load_dwordx4 v[44:47], v4, s[12:15], s20 offen
    buffer_load_dwordx4 v[48:51], v4, s[12:15], s21 offen
    s_add_u32 s19, s19, 1024
    s_add_u32 s20, s20, 1024
    s_add_u32 s21, s21, 1024
    ds_read_b128 v[64:67], v4 offset:24576
    ds_read_b128 v[68:71], v5 offset:24576
    s_waitcnt vmcnt(9) lgkmcnt(2)
    v_mfma_f32_32x32x16_bf16 v[100:115], v[52:55], v[80:83], v[100:115]
    v_mfma_f32_32x32x16_bf16 v[132:147], v[56:59], v[80:83], v[132:147]
    v_mfma_f32_32x32x16_bf16 v[164:179], v[80:83], v[60:63], v[164:179]
    v_mfma_f32_32x32x16_bf16 v[116:131], v[52:55], v[84:87], v[116:131]
    v_mfma_f32_32x32x16_bf16 v[148:163], v[56:59], v[84:87], v[148:163]
    v_mfma_f32_32x32x16_bf16 v[180:195], v[84:87], v[60:63], v[180:195]
    buffer_load_dwordx4 v[52:55], v4, s[12:15], s19 offen
    buffer_load_dwordx4 v[56:59], v4, s[12:15], s20 offen
    buffer_load_dwordx4 v[60:63], v4, s[12:15], s21 offen
    s_add_u32 s19, s19, 1024
    s_add_u32 s20, s20, 1024
    s_add_u32 s21, s21, 1024
    ds_read_b128 v[72:75], v4 offset:25600
    ds_read_b128 v[76:79], v5 offset:25600
    s_waitcnt vmcnt(9) lgkmcnt(2)
    v_mfma_f32_32x32x16_bf16 v[100:115], v[16:19], v[64:67], v[100:115]
    v_mfma_f32_32x32x16_bf16 v[132:147], v[20:23], v[64:67], v[132:147]
    v_mfma_f32_32x32x16_bf16 v[164:179], v[64:67], v[24:27], v[164:179]
    v_mfma_f32_32x32x16_bf16 v[116:131], v[16:19], v[68:71], v[116:131]
    v_mfma_f32_32x32x16_bf16 v[148:163], v[20:23], v[68:71], v[148:163]
    v_mfma_f32_32x32x16_bf16 v[180:195], v[68:71], v[24:27], v[180:195]
    buffer_load_dwordx4 v[16:19], v4, s[12:15], s19 offen
    buffer_load_dwordx4 v[20:23], v4, s[12:15], s20 offen
    buffer_load_dwordx4 v[24:27], v4, s[12:15], s21 offen
    s_add_u32 s19, s19, 1024
    s_add_u32 s20, s20, 1024
    s_add_u32 s21, s21, 1024
    ds_read_b128 v[80:83], v4 offset:26624
    ds_read_b128 v[84:87], v5 offset:26624
    s_waitcnt vmcnt(9) lgkmcnt(2)
    v_mfma_f32_32x32x16_bf16 v[100:115], v[28:31], v[72:75], v[100:115]
    v_mfma_f32_32x32x16_bf16 v[132:147], v[32:35], v[72:75], v[132:147]
    v_mfma_f32_32x32x16_bf16 v[164:179], v[72:75], v[36:39], v[164:179]
    v_mfma_f32_32x32x16_bf16 v[116:131], v[28:31], v[76:79], v[116:131]
    v_mfma_f32_32x32x16_bf16 v[148:163], v[32:35], v[76:79], v[148:163]
    v_mfma_f32_32x32x16_bf16 v[180:195], v[76:79], v[36:39], v[180:195]
    buffer_load_dwordx4 v[28:31], v4, s[12:15], s19 offen
    buffer_load_dwordx4 v[32:35], v4, s[12:15], s20 offen
    buffer_load_dwordx4 v[36:39], v4, s[12:15], s21 offen
    s_add_u32 s19, s19, 1024
    s_add_u32 s20, s20, 1024
    s_add_u32 s21, s21, 1024
    ds_read_b128 v[64:67], v4 offset:27648
    ds_read_b128 v[68:71], v5 offset:27648
    s_waitcnt vmcnt(9) lgkmcnt(2)
    v_mfma_f32_32x32x16_bf16 v[100:115], v[40:43], v[80:83], v[100:115]
    v_mfma_f32_32x32x16_bf16 v[132:147], v[44:47], v[80:83], v[132:147]
    v_mfma_f32_32x32x16_bf16 v[164:179], v[80:83], v[48:51], v[164:179]
    v_mfma_f32_32x32x16_bf16 v[116:131], v[40:43], v[84:87], v[116:131]
    v_mfma_f32_32x32x16_bf16 v[148:163], v[44:47], v[84:87], v[148:163]
    v_mfma_f32_32x32x16_bf16 v[180:195], v[84:87], v[48:51], v[180:195]
    buffer_load_dwordx4 v[40:43], v4, s[12:15], s19 offen
    buffer_load_dwordx4 v[44:47], v4, s[12:15], s20 offen
    buffer_load_dwordx4 v[48:51], v4, s[12:15], s21 offen
    s_add_u32 s19, s19, 1024
    s_add_u32 s20, s20, 1024
    s_add_u32 s21, s21, 1024
    ds_read_b128 v[72:75], v4 offset:28672
    ds_read_b128 v[76:79], v5 offset:28672
    s_waitcnt vmcnt(9) lgkmcnt(2)
    v_mfma_f32_32x32x16_bf16 v[100:115], v[52:55], v[64:67], v[100:115]
    v_mfma_f32_32x32x16_bf16 v[132:147], v[56:59], v[64:67], v[132:147]
    v_mfma_f32_32x32x16_bf16 v[164:179], v[64:67], v[60:63], v[164:179]
    v_mfma_f32_32x32x16_bf16 v[116:131], v[52:55], v[68:71], v[116:131]
    v_mfma_f32_32x32x16_bf16 v[148:163], v[56:59], v[68:71], v[148:163]
    v_mfma_f32_32x32x16_bf16 v[180:195], v[68:71], v[60:63], v[180:195]
    buffer_load_dwordx4 v[52:55], v4, s[12:15], s19 offen
    buffer_load_dwordx4 v[56:59], v4, s[12:15], s20 offen
    buffer_load_dwordx4 v[60:63], v4, s[12:15], s21 offen
    s_add_u32 s19, s19, 1024
    s_add_u32 s20, s20, 1024
    s_add_u32 s21, s21, 1024
    ds_read_b128 v[80:83], v4 offset:29696
    ds_read_b128 v[84:87], v5 offset:29696
    s_waitcnt vmcnt(9) lgkmcnt(2)
    v_mfma_f32_32x32x16_bf16 v[100:115], v[16:19], v[72:75], v[100:115]
    v_mfma_f32_32x32x16_bf16 v[132:147], v[20:23], v[72:75], v[132:147]
    v_mfma_f32_32x32x16_bf16 v[164:179], v[72:75], v[24:27], v[164:179]
    v_mfma_f32_32x32x16_bf16 v[116:131], v[16:19], v[76:79], v[116:131]
    v_mfma_f32_32x32x16_bf16 v[148:163], v[20:23], v[76:79], v[148:163]
    v_mfma_f32_32x32x16_bf16 v[180:195], v[76:79], v[24:27], v[180:195]
    buffer_load_dwordx4 v[16:19], v4, s[12:15], s19 offen
    buffer_load_dwordx4 v[20:23], v4, s[12:15], s20 offen
    buffer_load_dwordx4 v[24:27], v4, s[12:15], s21 offen
    s_add_u32 s19, s19, 1024
    s_add_u32 s20, s20, 1024
    s_add_u32 s21, s21, 1024
    ds_read_b128 v[64:67], v4 offset:30720
    ds_read_b128 v[68:71], v5 offset:30720
    s_waitcnt vmcnt(9) lgkmcnt(2)
    v_mfma_f32_32x32x16_bf16 v[100:115], v[28:31], v[80:83], v[100:115]
    v_mfma_f32_32x32x16_bf16 v[132:147], v[32:35], v[80:83], v[132:147]
    v_mfma_f32_32x32x16_bf16 v[164:179], v[80:83], v[36:39], v[164:179]
    v_mfma_f32_32x32x16_bf16 v[116:131], v[28:31], v[84:87], v[116:131]
    v_mfma_f32_32x32x16_bf16 v[148:163], v[32:35], v[84:87], v[148:163]
    v_mfma_f32_32x32x16_bf16 v[180:195], v[84:87], v[36:39], v[180:195]
    buffer_load_dwordx4 v[28:31], v4, s[12:15], s19 offen
    buffer_load_dwordx4 v[32:35], v4, s[12:15], s20 offen
    buffer_load_dwordx4 v[36:39], v4, s[12:15], s21 offen
    s_add_u32 s19, s19, 1024
    s_add_u32 s20, s20, 1024
    s_add_u32 s21, s21, 1024
    ds_read_b128 v[72:75], v4 offset:31744
    ds_read_b128 v[76:79], v5 offset:31744
    s_waitcnt vmcnt(9) lgkmcnt(2)
    v_mfma_f32_32x32x16_bf16 v[100:115], v[40:43], v[64:67], v[100:115]
    v_mfma_f32_32x32x16_bf16 v[132:147], v[44:47], v[64:67], v[132:147]
    v_mfma_f32_32x32x16_bf16 v[164:179], v[64:67], v[48:51], v[164:179]
    v_mfma_f32_32x32x16_bf16 v[116:131], v[40:43], v[68:71], v[116:131]
    v_mfma_f32_32x32x16_bf16 v[148:163], v[44:47], v[68:71], v[148:163]
    v_mfma_f32_32x32x16_bf16 v[180:195], v[68:71], v[48:51], v[180:195]
    buffer_load_dwordx4 v[40:43], v4, s[12:15], s19 offen
    buffer_load_dwordx4 v[44:47], v4, s[12:15], s20 offen
    buffer_load_dwordx4 v[48:51], v4, s[12:15], s21 offen
    s_add_u32 s19, s19, 1024
    s_add_u32 s20, s20, 1024
    s_add_u32 s21, s21, 1024
    ds_read_b128 v[80:83], v4 offset:32768
    ds_read_b128 v[84:87], v5 offset:32768
    s_waitcnt vmcnt(9) lgkmcnt(2)
    v_mfma_f32_32x32x16_bf16 v[100:115], v[52:55], v[72:75], v[100:115]
    v_mfma_f32_32x32x16_bf16 v[132:147], v[56:59], v[72:75], v[132:147]
    v_mfma_f32_32x32x16_bf16 v[164:179], v[72:75], v[60:63], v[164:179]
    v_mfma_f32_32x32x16_bf16 v[116:131], v[52:55], v[76:79], v[116:131]
    v_mfma_f32_32x32x16_bf16 v[148:163], v[56:59], v[76:79], v[148:163]
    v_mfma_f32_32x32x16_bf16 v[180:195], v[76:79], v[60:63], v[180:195]
    buffer_load_dwordx4 v[52:55], v4, s[12:15], s19 offen
    buffer_load_dwordx4 v[56:59], v4, s[12:15], s20 offen
    buffer_load_dwordx4 v[60:63], v4, s[12:15], s21 offen
    s_add_u32 s19, s19, 1024
    s_add_u32 s20, s20, 1024
    s_add_u32 s21, s21, 1024
    ds_read_b128 v[64:67], v4 offset:33792
    ds_read_b128 v[68:71], v5 offset:33792
    s_waitcnt vmcnt(9) lgkmcnt(2)
    v_mfma_f32_32x32x16_bf16 v[100:115], v[16:19], v[80:83], v[100:115]
    v_mfma_f32_32x32x16_bf16 v[132:147], v[20:23], v[80:83], v[132:147]
    v_mfma_f32_32x32x16_bf16 v[164:179], v[80:83], v[24:27], v[164:179]
    v_mfma_f32_32x32x16_bf16 v[116:131], v[16:19], v[84:87], v[116:131]
    v_mfma_f32_32x32x16_bf16 v[148:163], v[20:23], v[84:87], v[148:163]
    v_mfma_f32_32x32x16_bf16 v[180:195], v[84:87], v[24:27], v[180:195]
    ds_read_b128 v[72:75], v4 offset:34816
    ds_read_b128 v[76:79], v5 offset:34816
    s_waitcnt vmcnt(6) lgkmcnt(2)
    v_mfma_f32_32x32x16_bf16 v[100:115], v[28:31], v[64:67], v[100:115]
    v_mfma_f32_32x32x16_bf16 v[132:147], v[32:35], v[64:67], v[132:147]
    v_mfma_f32_32x32x16_bf16 v[164:179], v[64:67], v[36:39], v[164:179]
    v_mfma_f32_32x32x16_bf16 v[116:131], v[28:31], v[68:71], v[116:131]
    v_mfma_f32_32x32x16_bf16 v[148:163], v[32:35], v[68:71], v[148:163]
    v_mfma_f32_32x32x16_bf16 v[180:195], v[68:71], v[36:39], v[180:195]
    ds_read_b128 v[80:83], v4 offset:35840
    ds_read_b128 v[84:87], v5 offset:35840
    s_waitcnt vmcnt(3) lgkmcnt(2)
    v_mfma_f32_32x32x16_bf16 v[100:115], v[40:43], v[72:75], v[100:115]
    v_mfma_f32_32x32x16_bf16 v[132:147], v[44:47], v[72:75], v[132:147]
    v_mfma_f32_32x32x16_bf16 v[164:179], v[72:75], v[48:51], v[164:179]
    v_mfma_f32_32x32x16_bf16 v[116:131], v[40:43], v[76:79], v[116:131]
    v_mfma_f32_32x32x16_bf16 v[148:163], v[44:47], v[76:79], v[148:163]
    v_mfma_f32_32x32x16_bf16 v[180:195], v[76:79], v[48:51], v[180:195]
    s_waitcnt vmcnt(0) lgkmcnt(0)
    v_mfma_f32_32x32x16_bf16 v[100:115], v[52:55], v[80:83], v[100:115]
    v_mfma_f32_32x32x16_bf16 v[132:147], v[56:59], v[80:83], v[132:147]
    v_mfma_f32_32x32x16_bf16 v[164:179], v[80:83], v[60:63], v[164:179]
    v_mfma_f32_32x32x16_bf16 v[116:131], v[52:55], v[84:87], v[116:131]
    v_mfma_f32_32x32x16_bf16 v[148:163], v[56:59], v[84:87], v[148:163]
    v_mfma_f32_32x32x16_bf16 v[180:195], v[84:87], v[60:63], v[180:195]
    s_nop 15
    v_cmp_eq_u32 s[34:35], 18, v2
    v_mov_b32 v6, 1.0
    s_nop 1
    v_cndmask_b32 v164, v164, v6, s[34:35]
    v_cndmask_b32 v165, v165, v6, s[34:35]
    v_cndmask_b32 v166, v166, v6, s[34:35]
    v_cndmask_b32 v167, v167, v6, s[34:35]
    v_cndmask_b32 v168, v168, v6, s[34:35]
    v_cndmask_b32 v169, v169, v6, s[34:35]
    v_cndmask_b32 v170, v170, v6, s[34:35]
    v_cndmask_b32 v171, v171, v6, s[34:35]
    v_cndmask_b32 v172, v172, v6, s[34:35]
    v_cndmask_b32 v173, v173, v6, s[34:35]
    v_cndmask_b32 v174, v174, v6, s[34:35]
    v_cndmask_b32 v175, v175, v6, s[34:35]
    v_cndmask_b32 v176, v176, v6, s[34:35]
    v_cndmask_b32 v177, v177, v6, s[34:35]
    v_cndmask_b32 v178, v178, v6, s[34:35]
    v_cndmask_b32 v179, v179, v6, s[34:35]
    v_cndmask_b32 v180, v180, v6, s[34:35]
    v_cndmask_b32 v181, v181, v6, s[34:35]
    v_cndmask_b32 v182, v182, v6, s[34:35]
    v_cndmask_b32 v183, v183, v6, s[34:35]
    v_cndmask_b32 v184, v184, v6, s[34:35]
    v_cndmask_b32 v185, v185, v6, s[34:35]
    v_cndmask_b32 v186, v186, v6, s[34:35]
    v_cndmask_b32 v187, v187, v6, s[34:35]
    v_cndmask_b32 v188, v188, v6, s[34:35]
    v_cndmask_b32 v189, v189, v6, s[34:35]
    v_cndmask_b32 v190, v190, v6, s[34:35]
    v_cndmask_b32 v191, v191, v6, s[34:35]
    v_cndmask_b32 v192, v192, v6, s[34:35]
    v_cndmask_b32 v193, v193, v6, s[34:35]
    v_cndmask_b32 v194, v194, v6, s[34:35]
    v_cndmask_b32 v195, v195, v6, s[34:35]
    v_lshlrev_b32 v7, 4, v2
    v_lshl_add_u32 v7, v3, 3, v7
    s_lshl_b32 s22, s18, 6
    s_lshl_b32 s23, s16, 1
    s_add_u32 s22, s22, s23
    s_add_u32 s22, s22, 0
    s_lshl_b32 s23, s22, 11
    s_add_u32 s23, s23, 34684928
    s_lshl_b32 s24, s22, 12
    s_add_u32 s24, s24, 38879232
    v_cvt_pk_bf16_f32 v16, v100, v101
    v_cvt_pk_bf16_f32 v17, v102, v103
    v_cvt_pk_bf16_f32 v18, v104, v105
    v_cvt_pk_bf16_f32 v19, v106, v107
    v_cvt_pk_bf16_f32 v20, v108, v109
    v_cvt_pk_bf16_f32 v21, v110, v111
    v_cvt_pk_bf16_f32 v22, v112, v113
    v_cvt_pk_bf16_f32 v23, v114, v115
    buffer_store_dwordx2 v[16:17], v7, s[12:15], s23 offen offset:0
    buffer_store_dwordx2 v[18:19], v7, s[12:15], s23 offen offset:512
    buffer_store_dwordx2 v[20:21], v7, s[12:15], s23 offen offset:1024
    buffer_store_dwordx2 v[22:23], v7, s[12:15], s23 offen offset:1536
    v_cvt_pk_bf16_f32 v32, v132, v133
    v_cvt_pk_bf16_f32 v33, v134, v135
    v_cvt_pk_bf16_f32 v34, v136, v137
    v_cvt_pk_bf16_f32 v35, v138, v139
    v_cvt_pk_bf16_f32 v36, v140, v141
    v_cvt_pk_bf16_f32 v37, v142, v143
    v_cvt_pk_bf16_f32 v38, v144, v145
    v_cvt_pk_bf16_f32 v39, v146, v147
    buffer_store_dwordx2 v[32:33], v7, s[12:15], s24 offen offset:0
    buffer_store_dwordx2 v[34:35], v7, s[12:15], s24 offen offset:512
    buffer_store_dwordx2 v[36:37], v7, s[12:15], s24 offen offset:1024
    buffer_store_dwordx2 v[38:39], v7, s[12:15], s24 offen offset:1536
    v_cvt_pk_bf16_f32 v48, v164, v165
    v_cvt_pk_bf16_f32 v49, v166, v167
    v_cvt_pk_bf16_f32 v50, v168, v169
    v_cvt_pk_bf16_f32 v51, v170, v171
    v_cvt_pk_bf16_f32 v52, v172, v173
    v_cvt_pk_bf16_f32 v53, v174, v175
    v_cvt_pk_bf16_f32 v54, v176, v177
    v_cvt_pk_bf16_f32 v55, v178, v179
    buffer_store_dwordx4 v[48:51], v4, s[12:15], s24 offen offset:2048
    buffer_store_dwordx4 v[52:55], v4, s[12:15], s24 offen offset:3072
    s_nop 4
    s_lshl_b32 s22, s18, 6
    s_lshl_b32 s23, s16, 1
    s_add_u32 s22, s22, s23
    s_add_u32 s22, s22, 1
    s_lshl_b32 s23, s22, 11
    s_add_u32 s23, s23, 34684928
    s_lshl_b32 s24, s22, 12
    s_add_u32 s24, s24, 38879232
    v_cvt_pk_bf16_f32 v16, v116, v117
    v_cvt_pk_bf16_f32 v17, v118, v119
    v_cvt_pk_bf16_f32 v18, v120, v121
    v_cvt_pk_bf16_f32 v19, v122, v123
    v_cvt_pk_bf16_f32 v20, v124, v125
    v_cvt_pk_bf16_f32 v21, v126, v127
    v_cvt_pk_bf16_f32 v22, v128, v129
    v_cvt_pk_bf16_f32 v23, v130, v131
    buffer_store_dwordx2 v[16:17], v7, s[12:15], s23 offen offset:0
    buffer_store_dwordx2 v[18:19], v7, s[12:15], s23 offen offset:512
    buffer_store_dwordx2 v[20:21], v7, s[12:15], s23 offen offset:1024
    buffer_store_dwordx2 v[22:23], v7, s[12:15], s23 offen offset:1536
    v_cvt_pk_bf16_f32 v32, v148, v149
    v_cvt_pk_bf16_f32 v33, v150, v151
    v_cvt_pk_bf16_f32 v34, v152, v153
    v_cvt_pk_bf16_f32 v35, v154, v155
    v_cvt_pk_bf16_f32 v36, v156, v157
    v_cvt_pk_bf16_f32 v37, v158, v159
    v_cvt_pk_bf16_f32 v38, v160, v161
    v_cvt_pk_bf16_f32 v39, v162, v163
    buffer_store_dwordx2 v[32:33], v7, s[12:15], s24 offen offset:0
    buffer_store_dwordx2 v[34:35], v7, s[12:15], s24 offen offset:512
    buffer_store_dwordx2 v[36:37], v7, s[12:15], s24 offen offset:1024
    buffer_store_dwordx2 v[38:39], v7, s[12:15], s24 offen offset:1536
    v_cvt_pk_bf16_f32 v48, v180, v181
    v_cvt_pk_bf16_f32 v49, v182, v183
    v_cvt_pk_bf16_f32 v50, v184, v185
    v_cvt_pk_bf16_f32 v51, v186, v187
    v_cvt_pk_bf16_f32 v52, v188, v189
    v_cvt_pk_bf16_f32 v53, v190, v191
    v_cvt_pk_bf16_f32 v54, v192, v193
    v_cvt_pk_bf16_f32 v55, v194, v195
    buffer_store_dwordx4 v[48:51], v4, s[12:15], s24 offen offset:2048
    buffer_store_dwordx4 v[52:55], v4, s[12:15], s24 offen offset:3072
    s_nop 4
L_b1_l0_kernel_end:
    s_endpgm
.globl b2_l0_kernel
.p2align 8
.type b2_l0_kernel,@function
b2_l0_kernel:
    s_cmp_ge_u32 s2, 256
    s_cbranch_scc1 L_b2_l0_kernel_end
    s_load_dwordx2 s[4:5], s[0:1], 72
    s_load_dwordx2 s[6:7], s[0:1], 0
    s_load_dwordx2 s[36:37], s[0:1], 56
    v_lshrrev_b32 v1, 6, v0
    s_nop 0
    v_readfirstlane_b32 s3, v1
    v_and_b32 v1, 63, v0
    v_and_b32 v2, 31, v1
    v_lshrrev_b32 v3, 5, v1
    v_lshlrev_b32 v4, 4, v1
    s_mov_b32 s30, -1
    s_mov_b32 s31, 0
    s_waitcnt lgkmcnt(0)
    s_mov_b32 s12, s4
    s_mov_b32 s13, s5
    s_mov_b32 s14, 268435456
    s_mov_b32 s15, 0x00020000
    s_lshr_b32 s18, s2, 3
    s_and_b32 s16, s2, 7
    s_mov_b32 s25, 15548416
    s_mov_b32 s33, 1051597459
    s_lshl_b32 s22, s16, 3
    s_add_u32 s22, s22, s3
    s_lshl_b32 s23, s18, 6
    s_add_u32 s23, s23, s22
    s_lshl_b32 s23, s23, 11
    s_add_u32 s23, s23, 34684928
    buffer_load_dwordx4 v[8:11], v4, s[12:15], s23 offen
    buffer_load_dwordx4 v[12:15], v4, s[12:15], s23 offen offset:1024
    s_lshl_b32 s19, s18, 18
    s_add_u32 s19, s19, 38879232
    v_lshlrev_b32 v5, 4, v0
    buffer_load_dwordx4 v[96:99], v5, s[12:15], s19 offen
    s_add_u32 s19, s19, 8192
    buffer_load_dwordx4 v[100:103], v5, s[12:15], s19 offen
    s_add_u32 s19, s19, 8192
    buffer_load_dwordx4 v[104:107], v5, s[12:15], s19 offen
    s_add_u32 s19, s19, 8192
    buffer_load_dwordx4 v[108:111], v5, s[12:15], s19 offen
    s_add_u32 s19, s19, 8192
    v_mov_b32 v48, 0
    v_mov_b32 v49, 0
    v_mov_b32 v50, 0
    v_mov_b32 v51, 0
    v_mov_b32 v52, 0
    v_mov_b32 v53, 0
    v_mov_b32 v54, 0
    v_mov_b32 v55, 0
    v_mov_b32 v56, 0
    v_mov_b32 v57, 0
    v_mov_b32 v58, 0
    v_mov_b32 v59, 0
    v_mov_b32 v60, 0
    v_mov_b32 v61, 0
    v_mov_b32 v62, 0
    v_mov_b32 v63, 0
    v_mov_b32 v16, 0xff800000
    v_mov_b32 v6, v5
    v_mov_b32 v7, v4
    s_waitcnt vmcnt(0)
    ds_write_b128 v6, v[96:99] offset:0
    ds_write_b128 v6, v[100:103] offset:8192
    ds_write_b128 v6, v[104:107] offset:16384
    ds_write_b128 v6, v[108:111] offset:24576
    s_waitcnt lgkmcnt(0)
    s_barrier
    v_xor_b32 v6, 0x8000, v6
    s_mov_b32 s20, 0
L_b2_l0_kernel_loop:
    s_cmp_eq_u32 s20, 7
    s_cbranch_scc1 L_b2_l0_kernel_nog
    buffer_load_dwordx4 v[96:99], v5, s[12:15], s19 offen
    s_add_u32 s19, s19, 8192
    buffer_load_dwordx4 v[100:103], v5, s[12:15], s19 offen
    s_add_u32 s19, s19, 8192
    buffer_load_dwordx4 v[104:107], v5, s[12:15], s19 offen
    s_add_u32 s19, s19, 8192
    buffer_load_dwordx4 v[108:111], v5, s[12:15], s19 offen
    s_add_u32 s19, s19, 8192
L_b2_l0_kernel_nog:
    ds_read_b128 v[72:75], v7 offset:0
    ds_read_b128 v[76:79], v7 offset:1024
    ds_read_b128 v[80:83], v7 offset:4096
    ds_read_b128 v[84:87], v7 offset:5120
    s_waitcnt lgkmcnt(2)
    v_mfma_f32_32x32x16_bf16 v[32:47], v[72:75], v[8:11], 0
    v_mfma_f32_32x32x16_bf16 v[32:47], v[76:79], v[12:15], v[32:47]
    s_nop 7
    ds_read_b128 v[88:91], v7 offset:2048
    ds_read_b128 v[92:95], v7 offset:3072
    s_waitcnt lgkmcnt(2)
    v_mfma_f32_32x32x16_bf16 v[112:127], v[80:83], v[8:11], 0
    v_mfma_f32_32x32x16_bf16 v[112:127], v[84:87], v[12:15], v[112:127]
    ds_read_b128 v[72:75], v7 offset:8192
    ds_read_b128 v[76:79], v7 offset:9216
    v_max3_f32 v17, v32, v33, v34
    v_max3_f32 v17, v17, v35, v36
    v_max3_f32 v17, v17, v37, v38
    v_max3_f32 v17, v17, v39, v40
    v_max3_f32 v17, v17, v41, v42
    v_max3_f32 v17, v17, v43, v44
    v_max3_f32 v17, v17, v45, v46
    v_max_f32 v17, v17, v47
    v_mov_b32 v18, v17
    s_nop 1
    v_permlane32_swap_b32 v17, v18
    v_max_f32 v17, v17, v18
    v_mul_f32 v17, s33, v17
    v_max_f32 v17, v16, v17
    v_sub_f32 v18, v16, v17
    v_mov_b32 v16, v17
    v_exp_f32 v18, v18
    v_fma_f32 v32, v32, s33, -v16
    v_fma_f32 v33, v33, s33, -v16
    v_fma_f32 v34, v34, s33, -v16
    v_fma_f32 v35, v35, s33, -v16
    v_fma_f32 v36, v36, s33, -v16
    v_fma_f32 v37, v37, s33, -v16
    v_fma_f32 v38, v38, s33, -v16
    v_fma_f32 v39, v39, s33, -v16
    v_fma_f32 v40, v40, s33, -v16
    v_fma_f32 v41, v41, s33, -v16
    v_fma_f32 v42, v42, s33, -v16
    v_fma_f32 v43, v43, s33, -v16
    v_fma_f32 v44, v44, s33, -v16
    v_fma_f32 v45, v45, s33, -v16
    v_fma_f32 v46, v46, s33, -v16
    v_fma_f32 v47, v47, s33, -v16
    v_exp_f32 v32, v32
    v_exp_f32 v33, v33
    v_exp_f32 v34, v34
    v_exp_f32 v35, v35
    v_exp_f32 v36, v36
    v_exp_f32 v37, v37
    v_exp_f32 v38, v38
    v_exp_f32 v39, v39
    v_exp_f32 v40, v40
    v_exp_f32 v41, v41
    v_exp_f32 v42, v42
    v_exp_f32 v43, v43
    v_exp_f32 v44, v44
    v_exp_f32 v45, v45
    v_exp_f32 v46, v46
    v_exp_f32 v47, v47
    v_mul_f32 v48, v48, v18
    v_mul_f32 v49, v49, v18
    v_mul_f32 v50, v50, v18
    v_mul_f32 v51, v51, v18
    v_mul_f32 v52, v52, v18
    v_mul_f32 v53, v53, v18
    v_mul_f32 v54, v54, v18
    v_mul_f32 v55, v55, v18
    v_mul_f32 v56, v56, v18
    v_mul_f32 v57, v57, v18
    v_mul_f32 v58, v58, v18
    v_mul_f32 v59, v59, v18
    v_cvt_pk_bf16_f32 v64, v32, v33
    v_cvt_pk_bf16_f32 v65, v34, v35
    v_cvt_pk_bf16_f32 v66, v36, v37
    v_cvt_pk_bf16_f32 v67, v38, v39
    v_cvt_pk_bf16_f32 v68, v40, v41
    v_cvt_pk_bf16_f32 v69, v42, v43
    v_cvt_pk_bf16_f32 v70, v44, v45
    v_cvt_pk_bf16_f32 v71, v46, v47
    s_waitcnt lgkmcnt(2)
    s_nop 1
    v_mfma_f32_32x32x16_bf16 v[48:63], v[88:91], v[64:67], v[48:63]
    v_mfma_f32_32x32x16_bf16 v[48:63], v[92:95], v[68:71], v[48:63]
    ds_read_b128 v[88:91], v7 offset:6144
    ds_read_b128 v[92:95], v7 offset:7168
    s_waitcnt lgkmcnt(2)
    v_mfma_f32_32x32x16_bf16 v[32:47], v[72:75], v[8:11], 0
    v_mfma_f32_32x32x16_bf16 v[32:47], v[76:79], v[12:15], v[32:47]
    ds_read_b128 v[80:83], v7 offset:12288
    ds_read_b128 v[84:87], v7 offset:13312
    v_max3_f32 v17, v112, v113, v114
    v_max3_f32 v17, v17, v115, v116
    v_max3_f32 v17, v17, v117, v118
    v_max3_f32 v17, v17, v119, v120
    v_max3_f32 v17, v17, v121, v122
    v_max3_f32 v17, v17, v123, v124
    v_max3_f32 v17, v17, v125, v126
    v_max_f32 v17, v17, v127
    v_mov_b32 v18, v17
    s_nop 1
    v_permlane32_swap_b32 v17, v18
    v_max_f32 v17, v17, v18
    v_mul_f32 v17, s33, v17
    v_max_f32 v17, v16, v17
    v_sub_f32 v18, v16, v17
    v_mov_b32 v16, v17
    v_exp_f32 v18, v18
    v_fma_f32 v112, v112, s33, -v16
    v_fma_f32 v113, v113, s33, -v16
    v_fma_f32 v114, v114, s33, -v16
    v_fma_f32 v115, v115, s33, -v16
    v_fma_f32 v116, v116, s33, -v16
    v_fma_f32 v117, v117, s33, -v16
    v_fma_f32 v118, v118, s33, -v16
    v_fma_f32 v119, v119, s33, -v16
    v_fma_f32 v120, v120, s33, -v16
    v_fma_f32 v121, v121, s33, -v16
    v_fma_f32 v122, v122, s33, -v16
    v_fma_f32 v123, v123, s33, -v16
    v_fma_f32 v124, v124, s33, -v16
    v_fma_f32 v125, v125, s33, -v16
    v_fma_f32 v126, v126, s33, -v16
    v_fma_f32 v127, v127, s33, -v16
    v_exp_f32 v112, v112
    v_exp_f32 v113, v113
    v_exp_f32 v114, v114
    v_exp_f32 v115, v115
    v_exp_f32 v116, v116
    v_exp_f32 v117, v117
    v_exp_f32 v118, v118
    v_exp_f32 v119, v119
    v_exp_f32 v120, v120
    v_exp_f32 v121, v121
    v_exp_f32 v122, v122
    v_exp_f32 v123, v123
    v_exp_f32 v124, v124
    v_exp_f32 v125, v125
    v_exp_f32 v126, v126
    v_exp_f32 v127, v127
    v_mul_f32 v48, v48, v18
    v_mul_f32 v49, v49, v18
    v_mul_f32 v50, v50, v18
    v_mul_f32 v51, v51, v18
    v_mul_f32 v52, v52, v18
    v_mul_f32 v53, v53, v18
    v_mul_f32 v54, v54, v18
    v_mul_f32 v55, v55, v18
    v_mul_f32 v56, v56, v18
    v_mul_f32 v57, v57, v18
    v_mul_f32 v58, v58, v18
    v_mul_f32 v59, v59, v18
    v_cvt_pk_bf16_f32 v64, v112, v113
    v_cvt_pk_bf16_f32 v65, v114, v115
    v_cvt_pk_bf16_f32 v66, v116, v117
    v_cvt_pk_bf16_f32 v67, v118, v119
    v_cvt_pk_bf16_f32 v68, v120, v121
    v_cvt_pk_bf16_f32 v69, v122, v123
    v_cvt_pk_bf16_f32 v70, v124, v125
    v_cvt_pk_bf16_f32 v71, v126, v127
    s_waitcnt lgkmcnt(2)
    s_nop 1
    v_mfma_f32_32x32x16_bf16 v[48:63], v[88:91], v[64:67], v[48:63]
    v_mfma_f32_32x32x16_bf16 v[48:63], v[92:95], v[68:71], v[48:63]
    ds_read_b128 v[88:91], v7 offset:10240
    ds_read_b128 v[92:95], v7 offset:11264
    s_waitcnt lgkmcnt(2)
    v_mfma_f32_32x32x16_bf16 v[112:127], v[80:83], v[8:11], 0
    v_mfma_f32_32x32x16_bf16 v[112:127], v[84:87], v[12:15], v[112:127]
    ds_read_b128 v[72:75], v7 offset:16384
    ds_read_b128 v[76:79], v7 offset:17408
    v_max3_f32 v17, v32, v33, v34
    v_max3_f32 v17, v17, v35, v36
    v_max3_f32 v17, v17, v37, v38
    v_max3_f32 v17, v17, v39, v40
    v_max3_f32 v17, v17, v41, v42
    v_max3_f32 v17, v17, v43, v44
    v_max3_f32 v17, v17, v45, v46
    v_max_f32 v17, v17, v47
    v_mov_b32 v18, v17
    s_nop 1
    v_permlane32_swap_b32 v17, v18
    v_max_f32 v17, v17, v18
    v_mul_f32 v17, s33, v17
    v_max_f32 v17, v16, v17
    v_sub_f32 v18, v16, v17
    v_mov_b32 v16, v17
    v_exp_f32 v18, v18
    v_fma_f32 v32, v32, s33, -v16
    v_fma_f32 v33, v33, s33, -v16
    v_fma_f32 v34, v34, s33, -v16
    v_fma_f32 v35, v35, s33, -v16
    v_fma_f32 v36, v36, s33, -v16
    v_fma_f32 v37, v37, s33, -v16
    v_fma_f32 v38, v38, s33, -v16
    v_fma_f32 v39, v39, s33, -v16
    v_fma_f32 v40, v40, s33, -v16
    v_fma_f32 v41, v41, s33, -v16
    v_fma_f32 v42, v42, s33, -v16
    v_fma_f32 v43, v43, s33, -v16
    v_fma_f32 v44, v44, s33, -v16
    v_fma_f32 v45, v45, s33, -v16
    v_fma_f32 v46, v46, s33, -v16
    v_fma_f32 v47, v47, s33, -v16
    v_exp_f32 v32, v32
    v_exp_f32 v33, v33
    v_exp_f32 v34, v34
    v_exp_f32 v35, v35
    v_exp_f32 v36, v36
    v_exp_f32 v37, v37
    v_exp_f32 v38, v38
    v_exp_f32 v39, v39
    v_exp_f32 v40, v40
    v_exp_f32 v41, v41
    v_exp_f32 v42, v42
    v_exp_f32 v43, v43
    v_exp_f32 v44, v44
    v_exp_f32 v45, v45
    v_exp_f32 v46, v46
    v_exp_f32 v47, v47
    v_mul_f32 v48, v48, v18
    v_mul_f32 v49, v49, v18
    v_mul_f32 v50, v50, v18
    v_mul_f32 v51, v51, v18
    v_mul_f32 v52, v52, v18
    v_mul_f32 v53, v53, v18
    v_mul_f32 v54, v54, v18
    v_mul_f32 v55, v55, v18
    v_mul_f32 v56, v56, v18
    v_mul_f32 v57, v57, v18
    v_mul_f32 v58, v58, v18
    v_mul_f32 v59, v59, v18
    v_cvt_pk_bf16_f32 v64, v32, v33
    v_cvt_pk_bf16_f32 v65, v34, v35
    v_cvt_pk_bf16_f32 v66, v36, v37
    v_cvt_pk_bf16_f32 v67, v38, v39
    v_cvt_pk_bf16_f32 v68, v40, v41
    v_cvt_pk_bf16_f32 v69, v42, v43
    v_cvt_pk_bf16_f32 v70, v44, v45
    v_cvt_pk_bf16_f32 v71, v46, v47
    s_waitcnt lgkmcnt(2)
    s_nop 1
    v_mfma_f32_32x32x16_bf16 v[48:63], v[88:91], v[64:67], v[48:63]
    v_mfma_f32_32x32x16_bf16 v[48:63], v[92:95], v[68:71], v[48:63]
    ds_read_b128 v[88:91], v7 offset:14336
    ds_read_b128 v[92:95], v7 offset:15360
    s_waitcnt lgkmcnt(2)
    v_mfma_f32_32x32x16_bf16 v[32:47], v[72:75], v[8:11], 0
    v_mfma_f32_32x32x16_bf16 v[32:47], v[76:79], v[12:15], v[32:47]
    ds_read_b128 v[80:83], v7 offset:20480
    ds_read_b128 v[84:87], v7 offset:21504
    v_max3_f32 v17, v112, v113, v114
    v_max3_f32 v17, v17, v115, v116
    v_max3_f32 v17, v17, v117, v118
    v_max3_f32 v17, v17, v119, v120
    v_max3_f32 v17, v17, v121, v122
    v_max3_f32 v17, v17, v123, v124
    v_max3_f32 v17, v17, v125, v126
    v_max_f32 v17, v17, v127
    v_mov_b32 v18, v17
    s_nop 1
    v_permlane32_swap_b32 v17, v18
    v_max_f32 v17, v17, v18
    v_mul_f32 v17, s33, v17
    v_max_f32 v17, v16, v17
    v_sub_f32 v18, v16, v17
    v_mov_b32 v16, v17
    v_exp_f32 v18, v18
    v_fma_f32 v112, v112, s33, -v16
    v_fma_f32 v113, v113, s33, -v16
    v_fma_f32 v114, v114, s33, -v16
    v_fma_f32 v115, v115, s33, -v16
    v_fma_f32 v116, v116, s33, -v16
    v_fma_f32 v117, v117, s33, -v16
    v_fma_f32 v118, v118, s33, -v16
    v_fma_f32 v119, v119, s33, -v16
    v_fma_f32 v120, v120, s33, -v16
    v_fma_f32 v121, v121, s33, -v16
    v_fma_f32 v122, v122, s33, -v16
    v_fma_f32 v123, v123, s33, -v16
    v_fma_f32 v124, v124, s33, -v16
    v_fma_f32 v125, v125, s33, -v16
    v_fma_f32 v126, v126, s33, -v16
    v_fma_f32 v127, v127, s33, -v16
    v_exp_f32 v112, v112
    v_exp_f32 v113, v113
    v_exp_f32 v114, v114
    v_exp_f32 v115, v115
    v_exp_f32 v116, v116
    v_exp_f32 v117, v117
    v_exp_f32 v118, v118
    v_exp_f32 v119, v119
    v_exp_f32 v120, v120
    v_exp_f32 v121, v121
    v_exp_f32 v122, v122
    v_exp_f32 v123, v123
    v_exp_f32 v124, v124
    v_exp_f32 v125, v125
    v_exp_f32 v126, v126
    v_exp_f32 v127, v127
    v_mul_f32 v48, v48, v18
    v_mul_f32 v49, v49, v18
    v_mul_f32 v50, v50, v18
    v_mul_f32 v51, v51, v18
    v_mul_f32 v52, v52, v18
    v_mul_f32 v53, v53, v18
    v_mul_f32 v54, v54, v18
    v_mul_f32 v55, v55, v18
    v_mul_f32 v56, v56, v18
    v_mul_f32 v57, v57, v18
    v_mul_f32 v58, v58, v18
    v_mul_f32 v59, v59, v18
    v_cvt_pk_bf16_f32 v64, v112, v113
    v_cvt_pk_bf16_f32 v65, v114, v115
    v_cvt_pk_bf16_f32 v66, v116, v117
    v_cvt_pk_bf16_f32 v67, v118, v119
    v_cvt_pk_bf16_f32 v68, v120, v121
    v_cvt_pk_bf16_f32 v69, v122, v123
    v_cvt_pk_bf16_f32 v70, v124, v125
    v_cvt_pk_bf16_f32 v71, v126, v127
    s_waitcnt lgkmcnt(2)
    s_nop 1
    v_mfma_f32_32x32x16_bf16 v[48:63], v[88:91], v[64:67], v[48:63]
    v_mfma_f32_32x32x16_bf16 v[48:63], v[92:95], v[68:71], v[48:63]
    ds_read_b128 v[88:91], v7 offset:18432
    ds_read_b128 v[92:95], v7 offset:19456
    s_waitcnt lgkmcnt(2)
    v_mfma_f32_32x32x16_bf16 v[112:127], v[80:83], v[8:11], 0
    v_mfma_f32_32x32x16_bf16 v[112:127], v[84:87], v[12:15], v[112:127]
    ds_read_b128 v[72:75], v7 offset:24576
    ds_read_b128 v[76:79], v7 offset:25600
    v_max3_f32 v17, v32, v33, v34
    v_max3_f32 v17, v17, v35, v36
    v_max3_f32 v17, v17, v37, v38
    v_max3_f32 v17, v17, v39, v40
    v_max3_f32 v17, v17, v41, v42
    v_max3_f32 v17, v17, v43, v44
    v_max3_f32 v17, v17, v45, v46
    v_max_f32 v17, v17, v47
    v_mov_b32 v18, v17
    s_nop 1
    v_permlane32_swap_b32 v17, v18
    v_max_f32 v17, v17, v18
    v_mul_f32 v17, s33, v17
    v_max_f32 v17, v16, v17
    v_sub_f32 v18, v16, v17
    v_mov_b32 v16, v17
    v_exp_f32 v18, v18
    v_fma_f32 v32, v32, s33, -v16
    v_fma_f32 v33, v33, s33, -v16
    v_fma_f32 v34, v34, s33, -v16
    v_fma_f32 v35, v35, s33, -v16
    v_fma_f32 v36, v36, s33, -v16
    v_fma_f32 v37, v37, s33, -v16
    v_fma_f32 v38, v38, s33, -v16
    v_fma_f32 v39, v39, s33, -v16
    v_fma_f32 v40, v40, s33, -v16
    v_fma_f32 v41, v41, s33, -v16
    v_fma_f32 v42, v42, s33, -v16
    v_fma_f32 v43, v43, s33, -v16
    v_fma_f32 v44, v44, s33, -v16
    v_fma_f32 v45, v45, s33, -v16
    v_fma_f32 v46, v46, s33, -v16
    v_fma_f32 v47, v47, s33, -v16
    v_exp_f32 v32, v32
    v_exp_f32 v33, v33
    v_exp_f32 v34, v34
    v_exp_f32 v35, v35
    v_exp_f32 v36, v36
    v_exp_f32 v37, v37
    v_exp_f32 v38, v38
    v_exp_f32 v39, v39
    v_exp_f32 v40, v40
    v_exp_f32 v41, v41
    v_exp_f32 v42, v42
    v_exp_f32 v43, v43
    v_exp_f32 v44, v44
    v_exp_f32 v45, v45
    v_exp_f32 v46, v46
    v_exp_f32 v47, v47
    v_mul_f32 v48, v48, v18
    v_mul_f32 v49, v49, v18
    v_mul_f32 v50, v50, v18
    v_mul_f32 v51, v51, v18
    v_mul_f32 v52, v52, v18
    v_mul_f32 v53, v53, v18
    v_mul_f32 v54, v54, v18
    v_mul_f32 v55, v55, v18
    v_mul_f32 v56, v56, v18
    v_mul_f32 v57, v57, v18
    v_mul_f32 v58, v58, v18
    v_mul_f32 v59, v59, v18
    v_cvt_pk_bf16_f32 v64, v32, v33
    v_cvt_pk_bf16_f32 v65, v34, v35
    v_cvt_pk_bf16_f32 v66, v36, v37
    v_cvt_pk_bf16_f32 v67, v38, v39
    v_cvt_pk_bf16_f32 v68, v40, v41
    v_cvt_pk_bf16_f32 v69, v42, v43
    v_cvt_pk_bf16_f32 v70, v44, v45
    v_cvt_pk_bf16_f32 v71, v46, v47
    s_waitcnt lgkmcnt(2)
    s_nop 1
    v_mfma_f32_32x32x16_bf16 v[48:63], v[88:91], v[64:67], v[48:63]
    v_mfma_f32_32x32x16_bf16 v[48:63], v[92:95], v[68:71], v[48:63]
    ds_read_b128 v[88:91], v7 offset:22528
    ds_read_b128 v[92:95], v7 offset:23552
    s_waitcnt lgkmcnt(2)
    v_mfma_f32_32x32x16_bf16 v[32:47], v[72:75], v[8:11], 0
    v_mfma_f32_32x32x16_bf16 v[32:47], v[76:79], v[12:15], v[32:47]
    ds_read_b128 v[80:83], v7 offset:28672
    ds_read_b128 v[84:87], v7 offset:29696
    v_max3_f32 v17, v112, v113, v114
    v_max3_f32 v17, v17, v115, v116
    v_max3_f32 v17, v17, v117, v118
    v_max3_f32 v17, v17, v119, v120
    v_max3_f32 v17, v17, v121, v122
    v_max3_f32 v17, v17, v123, v124
    v_max3_f32 v17, v17, v125, v126
    v_max_f32 v17, v17, v127
    v_mov_b32 v18, v17
    s_nop 1
    v_permlane32_swap_b32 v17, v18
    v_max_f32 v17, v17, v18
    v_mul_f32 v17, s33, v17
    v_max_f32 v17, v16, v17
    v_sub_f32 v18, v16, v17
    v_mov_b32 v16, v17
    v_exp_f32 v18, v18
    v_fma_f32 v112, v112, s33, -v16
    v_fma_f32 v113, v113, s33, -v16
    v_fma_f32 v114, v114, s33, -v16
    v_fma_f32 v115, v115, s33, -v16
    v_fma_f32 v116, v116, s33, -v16
    v_fma_f32 v117, v117, s33, -v16
    v_fma_f32 v118, v118, s33, -v16
    v_fma_f32 v119, v119, s33, -v16
    v_fma_f32 v120, v120, s33, -v16
    v_fma_f32 v121, v121, s33, -v16
    v_fma_f32 v122, v122, s33, -v16
    v_fma_f32 v123, v123, s33, -v16
    v_fma_f32 v124, v124, s33, -v16
    v_fma_f32 v125, v125, s33, -v16
    v_fma_f32 v126, v126, s33, -v16
    v_fma_f32 v127, v127, s33, -v16
    v_exp_f32 v112, v112
    v_exp_f32 v113, v113
    v_exp_f32 v114, v114
    v_exp_f32 v115, v115
    v_exp_f32 v116, v116
    v_exp_f32 v117, v117
    v_exp_f32 v118, v118
    v_exp_f32 v119, v119
    v_exp_f32 v120, v120
    v_exp_f32 v121, v121
    v_exp_f32 v122, v122
    v_exp_f32 v123, v123
    v_exp_f32 v124, v124
    v_exp_f32 v125, v125
    v_exp_f32 v126, v126
    v_exp_f32 v127, v127
    v_mul_f32 v48, v48, v18
    v_mul_f32 v49, v49, v18
    v_mul_f32 v50, v50, v18
    v_mul_f32 v51, v51, v18
    v_mul_f32 v52, v52, v18
    v_mul_f32 v53, v53, v18
    v_mul_f32 v54, v54, v18
    v_mul_f32 v55, v55, v18
    v_mul_f32 v56, v56, v18
    v_mul_f32 v57, v57, v18
    v_mul_f32 v58, v58, v18
    v_mul_f32 v59, v59, v18
    v_cvt_pk_bf16_f32 v64, v112, v113
    v_cvt_pk_bf16_f32 v65, v114, v115
    v_cvt_pk_bf16_f32 v66, v116, v117
    v_cvt_pk_bf16_f32 v67, v118, v119
    v_cvt_pk_bf16_f32 v68, v120, v121
    v_cvt_pk_bf16_f32 v69, v122, v123
    v_cvt_pk_bf16_f32 v70, v124, v125
    v_cvt_pk_bf16_f32 v71, v126, v127
    s_waitcnt lgkmcnt(2)
    s_nop 1
    v_mfma_f32_32x32x16_bf16 v[48:63], v[88:91], v[64:67], v[48:63]
    v_mfma_f32_32x32x16_bf16 v[48:63], v[92:95], v[68:71], v[48:63]
    ds_read_b128 v[88:91], v7 offset:26624
    ds_read_b128 v[92:95], v7 offset:27648
    s_waitcnt lgkmcnt(2)
    v_mfma_f32_32x32x16_bf16 v[112:127], v[80:83], v[8:11], 0
    v_mfma_f32_32x32x16_bf16 v[112:127], v[84:87], v[12:15], v[112:127]
    v_max3_f32 v17, v32, v33, v34
    v_max3_f32 v17, v17, v35, v36
    v_max3_f32 v17, v17, v37, v38
    v_max3_f32 v17, v17, v39, v40
    v_max3_f32 v17, v17, v41, v42
    v_max3_f32 v17, v17, v43, v44
    v_max3_f32 v17, v17, v45, v46
    v_max_f32 v17, v17, v47
    v_mov_b32 v18, v17
    s_nop 1
    v_permlane32_swap_b32 v17, v18
    v_max_f32 v17, v17, v18
    v_mul_f32 v17, s33, v17
    v_max_f32 v17, v16, v17
    v_sub_f32 v18, v16, v17
    v_mov_b32 v16, v17
    v_exp_f32 v18, v18
    v_fma_f32 v32, v32, s33, -v16
    v_fma_f32 v33, v33, s33, -v16
    v_fma_f32 v34, v34, s33, -v16
    v_fma_f32 v35, v35, s33, -v16
    v_fma_f32 v36, v36, s33, -v16
    v_fma_f32 v37, v37, s33, -v16
    v_fma_f32 v38, v38, s33, -v16
    v_fma_f32 v39, v39, s33, -v16
    v_fma_f32 v40, v40, s33, -v16
    v_fma_f32 v41, v41, s33, -v16
    v_fma_f32 v42, v42, s33, -v16
    v_fma_f32 v43, v43, s33, -v16
    v_fma_f32 v44, v44, s33, -v16
    v_fma_f32 v45, v45, s33, -v16
    v_fma_f32 v46, v46, s33, -v16
    v_fma_f32 v47, v47, s33, -v16
    v_exp_f32 v32, v32
    v_exp_f32 v33, v33
    v_exp_f32 v34, v34
    v_exp_f32 v35, v35
    v_exp_f32 v36, v36
    v_exp_f32 v37, v37
    v_exp_f32 v38, v38
    v_exp_f32 v39, v39
    v_exp_f32 v40, v40
    v_exp_f32 v41, v41
    v_exp_f32 v42, v42
    v_exp_f32 v43, v43
    v_exp_f32 v44, v44
    v_exp_f32 v45, v45
    v_exp_f32 v46, v46
    v_exp_f32 v47, v47
    v_mul_f32 v48, v48, v18
    v_mul_f32 v49, v49, v18
    v_mul_f32 v50, v50, v18
    v_mul_f32 v51, v51, v18
    v_mul_f32 v52, v52, v18
    v_mul_f32 v53, v53, v18
    v_mul_f32 v54, v54, v18
    v_mul_f32 v55, v55, v18
    v_mul_f32 v56, v56, v18
    v_mul_f32 v57, v57, v18
    v_mul_f32 v58, v58, v18
    v_mul_f32 v59, v59, v18
    v_cvt_pk_bf16_f32 v64, v32, v33
    v_cvt_pk_bf16_f32 v65, v34, v35
    v_cvt_pk_bf16_f32 v66, v36, v37
    v_cvt_pk_bf16_f32 v67, v38, v39
    v_cvt_pk_bf16_f32 v68, v40, v41
    v_cvt_pk_bf16_f32 v69, v42, v43
    v_cvt_pk_bf16_f32 v70, v44, v45
    v_cvt_pk_bf16_f32 v71, v46, v47
    s_waitcnt lgkmcnt(0)
    s_nop 1
    v_mfma_f32_32x32x16_bf16 v[48:63], v[88:91], v[64:67], v[48:63]
    v_mfma_f32_32x32x16_bf16 v[48:63], v[92:95], v[68:71], v[48:63]
    ds_read_b128 v[88:91], v7 offset:30720
    ds_read_b128 v[92:95], v7 offset:31744
    s_nop 7
    v_max3_f32 v17, v112, v113, v114
    v_max3_f32 v17, v17, v115, v116
    v_max3_f32 v17, v17, v117, v118
    v_max3_f32 v17, v17, v119, v120
    v_max3_f32 v17, v17, v121, v122
    v_max3_f32 v17, v17, v123, v124
    v_max3_f32 v17, v17, v125, v126
    v_max_f32 v17, v17, v127
    v_mov_b32 v18, v17
    s_nop 1
    v_permlane32_swap_b32 v17, v18
    v_max_f32 v17, v17, v18
    v_mul_f32 v17, s33, v17
    v_max_f32 v17, v16, v17
    v_sub_f32 v18, v16, v17
    v_mov_b32 v16, v17
    v_exp_f32 v18, v18
    v_fma_f32 v112, v112, s33, -v16
    v_fma_f32 v113, v113, s33, -v16
    v_fma_f32 v114, v114, s33, -v16
    v_fma_f32 v115, v115, s33, -v16
    v_fma_f32 v116, v116, s33, -v16
    v_fma_f32 v117, v117, s33, -v16
    v_fma_f32 v118, v118, s33, -v16
    v_fma_f32 v119, v119, s33, -v16
    v_fma_f32 v120, v120, s33, -v16
    v_fma_f32 v121, v121, s33, -v16
    v_fma_f32 v122, v122, s33, -v16
    v_fma_f32 v123, v123, s33, -v16
    v_fma_f32 v124, v124, s33, -v16
    v_fma_f32 v125, v125, s33, -v16
    v_fma_f32 v126, v126, s33, -v16
    v_fma_f32 v127, v127, s33, -v16
    v_exp_f32 v112, v112
    v_exp_f32 v113, v113
    v_exp_f32 v114, v114
    v_exp_f32 v115, v115
    v_exp_f32 v116, v116
    v_exp_f32 v117, v117
    v_exp_f32 v118, v118
    v_exp_f32 v119, v119
    v_exp_f32 v120, v120
    v_exp_f32 v121, v121
    v_exp_f32 v122, v122
    v_exp_f32 v123, v123
    v_exp_f32 v124, v124
    v_exp_f32 v125, v125
    v_exp_f32 v126, v126
    v_exp_f32 v127, v127
    v_mul_f32 v48, v48, v18
    v_mul_f32 v49, v49, v18
    v_mul_f32 v50, v50, v18
    v_mul_f32 v51, v51, v18
    v_mul_f32 v52, v52, v18
    v_mul_f32 v53, v53, v18
    v_mul_f32 v54, v54, v18
    v_mul_f32 v55, v55, v18
    v_mul_f32 v56, v56, v18
    v_mul_f32 v57, v57, v18
    v_mul_f32 v58, v58, v18
    v_mul_f32 v59, v59, v18
    v_cvt_pk_bf16_f32 v64, v112, v113
    v_cvt_pk_bf16_f32 v65, v114, v115
    v_cvt_pk_bf16_f32 v66, v116, v117
    v_cvt_pk_bf16_f32 v67, v118, v119
    v_cvt_pk_bf16_f32 v68, v120, v121
    v_cvt_pk_bf16_f32 v69, v122, v123
    v_cvt_pk_bf16_f32 v70, v124, v125
    v_cvt_pk_bf16_f32 v71, v126, v127
    s_waitcnt lgkmcnt(0)
    s_nop 1
    v_mfma_f32_32x32x16_bf16 v[48:63], v[88:91], v[64:67], v[48:63]
    v_mfma_f32_32x32x16_bf16 v[48:63], v[92:95], v[68:71], v[48:63]
    s_cmp_eq_u32 s20, 7
    s_cbranch_scc1 L_b2_l0_kernel_fin
    s_waitcnt vmcnt(0)
    ds_write_b128 v6, v[96:99] offset:0
    ds_write_b128 v6, v[100:103] offset:8192
    ds_write_b128 v6, v[104:107] offset:16384
    ds_write_b128 v6, v[108:111] offset:24576
    s_waitcnt lgkmcnt(0)
    s_barrier
    v_xor_b32 v6, 0x8000, v6
    v_xor_b32 v7, 0x8000, v7
    s_add_u32 s20, s20, 1
    s_branch L_b2_l0_kernel_loop
L_b2_l0_kernel_fin:
    s_nop 15
    v_mov_b32 v17, v58
    v_mov_b32 v18, v58
    s_nop 1
    v_permlane32_swap_b32 v17, v18
    v_rcp_f32 v17, v17
    s_nop 0
    v_mul_f32 v48, v48, v17
    v_mul_f32 v49, v49, v17
    v_cvt_pk_bf16_f32 v64, v48, v49
    v_mul_f32 v50, v50, v17
    v_mul_f32 v51, v51, v17
    v_cvt_pk_bf16_f32 v65, v50, v51
    v_mul_f32 v52, v52, v17
    v_mul_f32 v53, v53, v17
    v_cvt_pk_bf16_f32 v66, v52, v53
    v_mul_f32 v54, v54, v17
    v_mul_f32 v55, v55, v17
    v_cvt_pk_bf16_f32 v67, v54, v55
    v_mul_f32 v56, v56, v17
    v_mul_f32 v57, v57, v17
    v_cvt_pk_bf16_f32 v68, v56, v57
    s_mul_i32 s26, s22, 36864
    s_add_u32 s26, s26, 15548416
    s_mul_i32 s27, s18, 18
    v_lshlrev_b32 v22, 2, v3
    v_add_u32 v22, s27, v22
    v_add_u32 v20, 0, v22
    v_lshrrev_b32 v21, 4, v20
    v_lshlrev_b32 v21, 10, v21
    v_lshl_add_u32 v21, v2, 4, v21
    v_bfe_u32 v23, v20, 3, 1
    v_lshl_add_u32 v21, v23, 9, v21
    v_and_b32 v23, 7, v20
    v_lshl_add_u32 v21, v23, 1, v21
    buffer_store_dword v64, v21, s[12:15], s26 offen
    v_add_u32 v20, 2, v22
    v_lshrrev_b32 v21, 4, v20
    v_lshlrev_b32 v21, 10, v21
    v_lshl_add_u32 v21, v2, 4, v21
    v_bfe_u32 v23, v20, 3, 1
    v_lshl_add_u32 v21, v23, 9, v21
    v_and_b32 v23, 7, v20
    v_lshl_add_u32 v21, v23, 1, v21
    buffer_store_dword v65, v21, s[12:15], s26 offen
    v_add_u32 v20, 8, v22
    v_lshrrev_b32 v21, 4, v20
    v_lshlrev_b32 v21, 10, v21
    v_lshl_add_u32 v21, v2, 4, v21
    v_bfe_u32 v23, v20, 3, 1
    v_lshl_add_u32 v21, v23, 9, v21
    v_and_b32 v23, 7, v20
    v_lshl_add_u32 v21, v23, 1, v21
    buffer_store_dword v66, v21, s[12:15], s26 offen
    v_add_u32 v20, 10, v22
    v_lshrrev_b32 v21, 4, v20
    v_lshlrev_b32 v21, 10, v21
    v_lshl_add_u32 v21, v2, 4, v21
    v_bfe_u32 v23, v20, 3, 1
    v_lshl_add_u32 v21, v23, 9, v21
    v_and_b32 v23, 7, v20
    v_lshl_add_u32 v21, v23, 1, v21
    buffer_store_dword v67, v21, s[12:15], s26 offen
    v_add_u32 v20, 16, v22
    v_lshrrev_b32 v21, 4, v20
    v_lshlrev_b32 v21, 10, v21
    v_lshl_add_u32 v21, v2, 4, v21
    v_bfe_u32 v23, v20, 3, 1
    v_lshl_add_u32 v21, v23, 9, v21
    v_and_b32 v23, 7, v20
    v_lshl_add_u32 v21, v23, 1, v21
    s_mov_b64 exec, s[30:31]
    buffer_store_dword v68, v21, s[12:15], s26 offen
    s_mov_b64 exec, -1
L_b2_l0_kernel_end:
    s_endpgm
.globl outb_l0_kernel
.p2align 8
.type outb_l0_kernel,@function
outb_l0_kernel:
    s_cmp_ge_u32 s2, 288
    s_cbranch_scc1 L_outb_l0_kernel_end
    s_load_dwordx2 s[4:5], s[0:1], 72
    s_load_dwordx2 s[6:7], s[0:1], 0
    s_load_dwordx2 s[36:37], s[0:1], 56
    v_lshrrev_b32 v1, 6, v0
    s_nop 0
    v_readfirstlane_b32 s3, v1
    v_and_b32 v1, 63, v0
    v_and_b32 v2, 31, v1
    v_lshrrev_b32 v3, 5, v1
    v_lshlrev_b32 v4, 4, v1
    s_mov_b32 s30, -1
    s_mov_b32 s31, 0
    s_waitcnt lgkmcnt(0)
    s_mov_b32 s12, s4
    s_mov_b32 s13, s5
    s_mov_b32 s14, 268435456
    s_mov_b32 s15, 0x00020000
    s_add_u32 s8, s4, 8470528
    s_addc_u32 s9, s5, 0
    s_mov_b32 s10, 2359296
    s_mov_b32 s11, 0x00020000
    s_add_u32 s40, s4, 10829824
    s_addc_u32 s41, s5, 0
    s_mov_b32 s42, 2359296
    s_mov_b32 s43, 0x00020000
    s_mul_i32 s16, s2, 7282
    s_lshr_b32 s16, s16, 16
    s_mul_i32 s17, s16, 9
    s_sub_u32 s17, s2, s17
    s_lshl_b32 s16, s16, 1
    s_and_b32 s18, s3, 1
    s_add_u32 s16, s16, s18
    s_lshl_b32 s17, s17, 1
    s_lshr_b32 s18, s3, 1
    s_add_u32 s17, s17, s18
    s_mul_i32 s19, s17, 36864
    s_add_u32 s19, s19, 7741440
    s_lshl_b32 s20, s16, 5
    v_add_u32 v5, s20, v2
    v_mul_u32_u24 v5, 1152, v5
    v_lshl_add_u32 v6, v3, 4, v5
    s_mul_i32 s21, s16, 36864
    s_add_u32 s21, s21, 15548416
    buffer_load_dwordx4 v[40:43], v4, s[12:15], s19 offen
    buffer_load_dwordx4 v[44:47], v4, s[12:15], s21 offen
    s_add_u32 s19, s19, 1024
    s_add_u32 s21, s21, 1024
    buffer_load_dwordx4 v[48:51], v4, s[12:15], s19 offen
    buffer_load_dwordx4 v[52:55], v4, s[12:15], s21 offen
    s_add_u32 s19, s19, 1024
    s_add_u32 s21, s21, 1024
    buffer_load_dwordx4 v[56:59], v4, s[12:15], s19 offen
    buffer_load_dwordx4 v[60:63], v4, s[12:15], s21 offen
    s_add_u32 s19, s19, 1024
    s_add_u32 s21, s21, 1024
    buffer_load_dwordx4 v[64:67], v4, s[12:15], s19 offen
    buffer_load_dwordx4 v[68:71], v4, s[12:15], s21 offen
    s_add_u32 s19, s19, 1024
    s_add_u32 s21, s21, 1024
    buffer_load_dwordx4 v[72:75], v4, s[12:15], s19 offen
    buffer_load_dwordx4 v[76:79], v4, s[12:15], s21 offen
    s_add_u32 s19, s19, 1024
    s_add_u32 s21, s21, 1024
    buffer_load_dwordx4 v[80:83], v4, s[12:15], s19 offen
    buffer_load_dwordx4 v[84:87], v4, s[12:15], s21 offen
    s_add_u32 s19, s19, 1024
    s_add_u32 s21, s21, 1024
    buffer_load_dwordx4 v[88:91], v4, s[12:15], s19 offen
    buffer_load_dwordx4 v[92:95], v4, s[12:15], s21 offen
    s_add_u32 s19, s19, 1024
    s_add_u32 s21, s21, 1024
    buffer_load_dwordx4 v[96:99], v4, s[12:15], s19 offen
    buffer_load_dwordx4 v[100:103], v4, s[12:15], s21 offen
    s_add_u32 s19, s19, 1024
    s_add_u32 s21, s21, 1024
    buffer_load_dwordx4 v[104:107], v4, s[12:15], s19 offen
    buffer_load_dwordx4 v[108:111], v4, s[12:15], s21 offen
    s_add_u32 s19, s19, 1024
    s_add_u32 s21, s21, 1024
    buffer_load_dwordx4 v[112:115], v4, s[12:15], s19 offen
    buffer_load_dwordx4 v[116:119], v4, s[12:15], s21 offen
    s_add_u32 s19, s19, 1024
    s_add_u32 s21, s21, 1024
    buffer_load_dwordx4 v[120:123], v4, s[12:15], s19 offen
    buffer_load_dwordx4 v[124:127], v4, s[12:15], s21 offen
    s_add_u32 s19, s19, 1024
    s_add_u32 s21, s21, 1024
    buffer_load_dwordx4 v[128:131], v4, s[12:15], s19 offen
    buffer_load_dwordx4 v[132:135], v4, s[12:15], s21 offen
    s_add_u32 s19, s19, 1024
    s_add_u32 s21, s21, 1024
    buffer_load_dwordx4 v[136:139], v4, s[12:15], s19 offen
    buffer_load_dwordx4 v[140:143], v4, s[12:15], s21 offen
    s_add_u32 s19, s19, 1024
    s_add_u32 s21, s21, 1024
    buffer_load_dwordx4 v[144:147], v4, s[12:15], s19 offen
    buffer_load_dwordx4 v[148:151], v4, s[12:15], s21 offen
    s_add_u32 s19, s19, 1024
    s_add_u32 s21, s21, 1024
    buffer_load_dwordx4 v[152:155], v4, s[12:15], s19 offen
    buffer_load_dwordx4 v[156:159], v4, s[12:15], s21 offen
    s_add_u32 s19, s19, 1024
    s_add_u32 s21, s21, 1024
    s_waitcnt vmcnt(28)
    v_mfma_f32_32x32x16_bf16 v[16:31], v[40:43], v[44:47], 0
    buffer_load_dwordx4 v[40:43], v4, s[12:15], s19 offen
    buffer_load_dwordx4 v[44:47], v4, s[12:15], s21 offen
    s_add_u32 s19, s19, 1024
    s_add_u32 s21, s21, 1024
    s_waitcnt vmcnt(28)
    v_mfma_f32_32x32x16_bf16 v[16:31], v[48:51], v[52:55], v[16:31]
    buffer_load_dwordx4 v[48:51], v4, s[12:15], s19 offen
    buffer_load_dwordx4 v[52:55], v4, s[12:15], s21 offen
    s_add_u32 s19, s19, 1024
    s_add_u32 s21, s21, 1024
    s_waitcnt vmcnt(28)
    v_mfma_f32_32x32x16_bf16 v[16:31], v[56:59], v[60:63], v[16:31]
    buffer_load_dwordx4 v[56:59], v4, s[12:15], s19 offen
    buffer_load_dwordx4 v[60:63], v4, s[12:15], s21 offen
    s_add_u32 s19, s19, 1024
    s_add_u32 s21, s21, 1024
    s_waitcnt vmcnt(28)
    v_mfma_f32_32x32x16_bf16 v[16:31], v[64:67], v[68:71], v[16:31]
    buffer_load_dwordx4 v[64:67], v4, s[12:15], s19 offen
    buffer_load_dwordx4 v[68:71], v4, s[12:15], s21 offen
    s_add_u32 s19, s19, 1024
    s_add_u32 s21, s21, 1024
    s_waitcnt vmcnt(28)
    v_mfma_f32_32x32x16_bf16 v[16:31], v[72:75], v[76:79], v[16:31]
    buffer_load_dwordx4 v[72:75], v4, s[12:15], s19 offen
    buffer_load_dwordx4 v[76:79], v4, s[12:15], s21 offen
    s_add_u32 s19, s19, 1024
    s_add_u32 s21, s21, 1024
    s_waitcnt vmcnt(28)
    v_mfma_f32_32x32x16_bf16 v[16:31], v[80:83], v[84:87], v[16:31]
    buffer_load_dwordx4 v[80:83], v4, s[12:15], s19 offen
    buffer_load_dwordx4 v[84:87], v4, s[12:15], s21 offen
    s_add_u32 s19, s19, 1024
    s_add_u32 s21, s21, 1024
    s_waitcnt vmcnt(28)
    v_mfma_f32_32x32x16_bf16 v[16:31], v[88:91], v[92:95], v[16:31]
    buffer_load_dwordx4 v[88:91], v4, s[12:15], s19 offen
    buffer_load_dwordx4 v[92:95], v4, s[12:15], s21 offen
    s_add_u32 s19, s19, 1024
    s_add_u32 s21, s21, 1024
    s_waitcnt vmcnt(28)
    v_mfma_f32_32x32x16_bf16 v[16:31], v[96:99], v[100:103], v[16:31]
    buffer_load_dwordx4 v[96:99], v4, s[12:15], s19 offen
    buffer_load_dwordx4 v[100:103], v4, s[12:15], s21 offen
    s_add_u32 s19, s19, 1024
    s_add_u32 s21, s21, 1024
    s_waitcnt vmcnt(28)
    v_mfma_f32_32x32x16_bf16 v[16:31], v[104:107], v[108:111], v[16:31]
    buffer_load_dwordx4 v[104:107], v4, s[12:15], s19 offen
    buffer_load_dwordx4 v[108:111], v4, s[12:15], s21 offen
    s_add_u32 s19, s19, 1024
    s_add_u32 s21, s21, 1024
    s_waitcnt vmcnt(28)
    v_mfma_f32_32x32x16_bf16 v[16:31], v[112:115], v[116:119], v[16:31]
    buffer_load_dwordx4 v[112:115], v4, s[12:15], s19 offen
    buffer_load_dwordx4 v[116:119], v4, s[12:15], s21 offen
    s_add_u32 s19, s19, 1024
    s_add_u32 s21, s21, 1024
    s_waitcnt vmcnt(28)
    v_mfma_f32_32x32x16_bf16 v[16:31], v[120:123], v[124:127], v[16:31]
    buffer_load_dwordx4 v[120:123], v4, s[12:15], s19 offen
    buffer_load_dwordx4 v[124:127], v4, s[12:15], s21 offen
    s_add_u32 s19, s19, 1024
    s_add_u32 s21, s21, 1024
    s_waitcnt vmcnt(28)
    v_mfma_f32_32x32x16_bf16 v[16:31], v[128:131], v[132:135], v[16:31]
    buffer_load_dwordx4 v[128:131], v4, s[12:15], s19 offen
    buffer_load_dwordx4 v[132:135], v4, s[12:15], s21 offen
    s_add_u32 s19, s19, 1024
    s_add_u32 s21, s21, 1024
    s_waitcnt vmcnt(28)
    v_mfma_f32_32x32x16_bf16 v[16:31], v[136:139], v[140:143], v[16:31]
    buffer_load_dwordx4 v[136:139], v4, s[12:15], s19 offen
    buffer_load_dwordx4 v[140:143], v4, s[12:15], s21 offen
    s_add_u32 s19, s19, 1024
    s_add_u32 s21, s21, 1024
    s_waitcnt vmcnt(28)
    v_mfma_f32_32x32x16_bf16 v[16:31], v[144:147], v[148:151], v[16:31]
    buffer_load_dwordx4 v[144:147], v4, s[12:15], s19 offen
    buffer_load_dwordx4 v[148:151], v4, s[12:15], s21 offen
    s_add_u32 s19, s19, 1024
    s_add_u32 s21, s21, 1024
    s_waitcnt vmcnt(28)
    v_mfma_f32_32x32x16_bf16 v[16:31], v[152:155], v[156:159], v[16:31]
    buffer_load_dwordx4 v[152:155], v4, s[12:15], s19 offen
    buffer_load_dwordx4 v[156:159], v4, s[12:15], s21 offen
    s_add_u32 s19, s19, 1024
    s_add_u32 s21, s21, 1024
    s_waitcnt vmcnt(28)
    v_mfma_f32_32x32x16_bf16 v[16:31], v[40:43], v[44:47], v[16:31]
    buffer_load_dwordx4 v[40:43], v4, s[12:15], s19 offen
    buffer_load_dwordx4 v[44:47], v4, s[12:15], s21 offen
    s_add_u32 s19, s19, 1024
    s_add_u32 s21, s21, 1024
    s_waitcnt vmcnt(28)
    v_mfma_f32_32x32x16_bf16 v[16:31], v[48:51], v[52:55], v[16:31]
    buffer_load_dwordx4 v[48:51], v4, s[12:15], s19 offen
    buffer_load_dwordx4 v[52:55], v4, s[12:15], s21 offen
    s_add_u32 s19, s19, 1024
    s_add_u32 s21, s21, 1024
    s_waitcnt vmcnt(28)
    v_mfma_f32_32x32x16_bf16 v[16:31], v[56:59], v[60:63], v[16:31]
    buffer_load_dwordx4 v[56:59], v4, s[12:15], s19 offen
    buffer_load_dwordx4 v[60:63], v4, s[12:15], s21 offen
    s_add_u32 s19, s19, 1024
    s_add_u32 s21, s21, 1024
    s_waitcnt vmcnt(28)
    v_mfma_f32_32x32x16_bf16 v[16:31], v[64:67], v[68:71], v[16:31]
    buffer_load_dwordx4 v[64:67], v4, s[12:15], s19 offen
    buffer_load_dwordx4 v[68:71], v4, s[12:15], s21 offen
    s_add_u32 s19, s19, 1024
    s_add_u32 s21, s21, 1024
    s_waitcnt vmcnt(28)
    v_mfma_f32_32x32x16_bf16 v[16:31], v[72:75], v[76:79], v[16:31]
    buffer_load_dwordx4 v[72:75], v4, s[12:15], s19 offen
    buffer_load_dwordx4 v[76:79], v4, s[12:15], s21 offen
    s_add_u32 s19, s19, 1024
    s_add_u32 s21, s21, 1024
    s_waitcnt vmcnt(28)
    v_mfma_f32_32x32x16_bf16 v[16:31], v[80:83], v[84:87], v[16:31]
    buffer_load_dwordx4 v[80:83], v4, s[12:15], s19 offen
    buffer_load_dwordx4 v[84:87], v4, s[12:15], s21 offen
    s_add_u32 s19, s19, 1024
    s_add_u32 s21, s21, 1024
    s_waitcnt vmcnt(28)
    v_mfma_f32_32x32x16_bf16 v[16:31], v[88:91], v[92:95], v[16:31]
    s_waitcnt vmcnt(26)
    v_mfma_f32_32x32x16_bf16 v[16:31], v[96:99], v[100:103], v[16:31]
    s_waitcnt vmcnt(24)
    v_mfma_f32_32x32x16_bf16 v[16:31], v[104:107], v[108:111], v[16:31]
    s_waitcnt vmcnt(22)
    v_mfma_f32_32x32x16_bf16 v[16:31], v[112:115], v[116:119], v[16:31]
    s_waitcnt vmcnt(20)
    v_mfma_f32_32x32x16_bf16 v[16:31], v[120:123], v[124:127], v[16:31]
    s_waitcnt vmcnt(18)
    v_mfma_f32_32x32x16_bf16 v[16:31], v[128:131], v[132:135], v[16:31]
    s_waitcnt vmcnt(16)
    v_mfma_f32_32x32x16_bf16 v[16:31], v[136:139], v[140:143], v[16:31]
    s_waitcnt vmcnt(14)
    v_mfma_f32_32x32x16_bf16 v[16:31], v[144:147], v[148:151], v[16:31]
    s_waitcnt vmcnt(12)
    v_mfma_f32_32x32x16_bf16 v[16:31], v[152:155], v[156:159], v[16:31]
    s_waitcnt vmcnt(10)
    v_mfma_f32_32x32x16_bf16 v[16:31], v[40:43], v[44:47], v[16:31]
    s_waitcnt vmcnt(8)
    v_mfma_f32_32x32x16_bf16 v[16:31], v[48:51], v[52:55], v[16:31]
    s_waitcnt vmcnt(6)
    v_mfma_f32_32x32x16_bf16 v[16:31], v[56:59], v[60:63], v[16:31]
    s_waitcnt vmcnt(4)
    v_mfma_f32_32x32x16_bf16 v[16:31], v[64:67], v[68:71], v[16:31]
    s_waitcnt vmcnt(2)
    v_mfma_f32_32x32x16_bf16 v[16:31], v[72:75], v[76:79], v[16:31]
    s_waitcnt vmcnt(0)
    v_mfma_f32_32x32x16_bf16 v[16:31], v[80:83], v[84:87], v[16:31]
    s_lshl_b32 s20, s17, 6
    v_lshl_add_u32 v7, v3, 3, v5
    v_add_u32 v7, s20, v7
    buffer_load_dwordx2 v[8:9], v7, s[8:11], 0 offen offset:0
    buffer_load_dwordx2 v[10:11], v7, s[8:11], 0 offen offset:16
    buffer_load_dwordx2 v[12:13], v7, s[8:11], 0 offen offset:32
    buffer_load_dwordx2 v[14:15], v7, s[8:11], 0 offen offset:48
    s_nop 15
    v_cvt_pk_bf16_f32 v90, v16, v17
    v_cvt_pk_bf16_f32 v91, v18, v19
    v_cvt_pk_bf16_f32 v92, v20, v21
    v_cvt_pk_bf16_f32 v93, v22, v23
    v_cvt_pk_bf16_f32 v94, v24, v25
    v_cvt_pk_bf16_f32 v95, v26, v27
    v_cvt_pk_bf16_f32 v96, v28, v29
    v_cvt_pk_bf16_f32 v97, v30, v31
    s_waitcnt vmcnt(0)
    v_lshlrev_b32 v100, 16, v90
    v_and_b32 v101, 0xffff0000, v90
    v_lshlrev_b32 v102, 16, v8
    v_and_b32 v103, 0xffff0000, v8
    v_add_f32 v100, v100, v102
    v_add_f32 v101, v101, v103
    v_cvt_pk_bf16_f32 v90, v100, v101
    v_lshlrev_b32 v100, 16, v91
    v_and_b32 v101, 0xffff0000, v91
    v_lshlrev_b32 v102, 16, v9
    v_and_b32 v103, 0xffff0000, v9
    v_add_f32 v100, v100, v102
    v_add_f32 v101, v101, v103
    v_cvt_pk_bf16_f32 v91, v100, v101
    v_lshlrev_b32 v100, 16, v92
    v_and_b32 v101, 0xffff0000, v92
    v_lshlrev_b32 v102, 16, v10
    v_and_b32 v103, 0xffff0000, v10
    v_add_f32 v100, v100, v102
    v_add_f32 v101, v101, v103
    v_cvt_pk_bf16_f32 v92, v100, v101
    v_lshlrev_b32 v100, 16, v93
    v_and_b32 v101, 0xffff0000, v93
    v_lshlrev_b32 v102, 16, v11
    v_and_b32 v103, 0xffff0000, v11
    v_add_f32 v100, v100, v102
    v_add_f32 v101, v101, v103
    v_cvt_pk_bf16_f32 v93, v100, v101
    v_lshlrev_b32 v100, 16, v94
    v_and_b32 v101, 0xffff0000, v94
    v_lshlrev_b32 v102, 16, v12
    v_and_b32 v103, 0xffff0000, v12
    v_add_f32 v100, v100, v102
    v_add_f32 v101, v101, v103
    v_cvt_pk_bf16_f32 v94, v100, v101
    v_lshlrev_b32 v100, 16, v95
    v_and_b32 v101, 0xffff0000, v95
    v_lshlrev_b32 v102, 16, v13
    v_and_b32 v103, 0xffff0000, v13
    v_add_f32 v100, v100, v102
    v_add_f32 v101, v101, v103
    v_cvt_pk_bf16_f32 v95, v100, v101
    v_lshlrev_b32 v100, 16, v96
    v_and_b32 v101, 0xffff0000, v96
    v_lshlrev_b32 v102, 16, v14
    v_and_b32 v103, 0xffff0000, v14
    v_add_f32 v100, v100, v102
    v_add_f32 v101, v101, v103
    v_cvt_pk_bf16_f32 v96, v100, v101
    v_lshlrev_b32 v100, 16, v97
    v_and_b32 v101, 0xffff0000, v97
    v_lshlrev_b32 v102, 16, v15
    v_and_b32 v103, 0xffff0000, v15
    v_add_f32 v100, v100, v102
    v_add_f32 v101, v101, v103
    v_cvt_pk_bf16_f32 v97, v100, v101
    buffer_store_dwordx2 v[90:91], v7, s[40:43], 0 offen offset:0
    buffer_store_dwordx2 v[92:93], v7, s[40:43], 0 offen offset:16
    buffer_store_dwordx2 v[94:95], v7, s[40:43], 0 offen offset:32
    buffer_store_dwordx2 v[96:97], v7, s[40:43], 0 offen offset:48
L_outb_l0_kernel_end:
    s_endpgm
.globl a1_l1_kernel
.p2align 8
.type a1_l1_kernel,@function
a1_l1_kernel:
    s_cmp_ge_u32 s2, 256
    s_cbranch_scc1 L_a1_l1_kernel_end
    s_load_dwordx2 s[4:5], s[0:1], 72
    s_load_dwordx2 s[6:7], s[0:1], 0
    v_lshrrev_b32 v1, 6, v0
    s_nop 0
    v_readfirstlane_b32 s3, v1
    v_and_b32 v1, 63, v0
    v_and_b32 v2, 31, v1
    v_lshrrev_b32 v3, 5, v1
    v_lshlrev_b32 v4, 4, v1
    s_lshr_b32 s16, s2, 3
    s_and_b32 s17, s2, 7
    s_lshl_b32 s17, s17, 2
    s_add_u32 s18, s17, s3
    s_mov_b32 s30, -1
    s_mov_b32 s31, 0
    s_waitcnt lgkmcnt(0)
    s_mov_b32 s12, s4
    s_mov_b32 s13, s5
    s_mov_b32 s14, 268435456
    s_mov_b32 s15, 0x00020000
    s_add_u32 s8, s4, 10829824
    s_addc_u32 s9, s5, 0
    s_mov_b32 s10, 2359296
    s_mov_b32 s11, 0x00020000
    s_lshl_b32 s19, s16, 6
    s_lshl_b32 s20, s3, 4
    s_add_u32 s19, s19, s20
    v_lshrrev_b32 v5, 3, v1
    v_add_u32 v5, s19, v5
    v_mul_u32_u24 v5, 1152, v5
    v_and_b32 v6, 7, v1
    v_lshl_add_u32 v5, v6, 4, v5
    buffer_load_dwordx4 v[16:19], v5, s[8:11], 0 offen offset:0
    buffer_load_dwordx4 v[20:23], v5, s[8:11], 0 offen offset:128
    buffer_load_dwordx4 v[24:27], v5, s[8:11], 0 offen offset:256
    buffer_load_dwordx4 v[28:31], v5, s[8:11], 0 offen offset:384
    buffer_load_dwordx4 v[32:35], v5, s[8:11], 0 offen offset:512
    buffer_load_dwordx4 v[36:39], v5, s[8:11], 0 offen offset:640
    buffer_load_dwordx4 v[40:43], v5, s[8:11], 0 offen offset:768
    buffer_load_dwordx4 v[44:47], v5, s[8:11], 0 offen offset:896
    buffer_load_dwordx4 v[48:51], v5, s[8:11], 0 offen offset:1024
    v_add_u32 v5, 9216, v5
    buffer_load_dwordx4 v[52:55], v5, s[8:11], 0 offen offset:0
    buffer_load_dwordx4 v[56:59], v5, s[8:11], 0 offen offset:128
    buffer_load_dwordx4 v[60:63], v5, s[8:11], 0 offen offset:256
    buffer_load_dwordx4 v[64:67], v5, s[8:11], 0 offen offset:384
    buffer_load_dwordx4 v[68:71], v5, s[8:11], 0 offen offset:512
    buffer_load_dwordx4 v[72:75], v5, s[8:11], 0 offen offset:640
    buffer_load_dwordx4 v[76:79], v5, s[8:11], 0 offen offset:768
    buffer_load_dwordx4 v[80:83], v5, s[8:11], 0 offen offset:896
    buffer_load_dwordx4 v[84:87], v5, s[8:11], 0 offen offset:1024
    s_mul_i32 s19, s18, 36864
    s_add_u32 s19, s19, 0
    s_add_u32 s20, s19, 1179648
    s_add_u32 s21, s19, 2359296
    s_waitcnt vmcnt(9)
    v_lshlrev_b32 v100, 16, v16
    v_and_b32 v101, 0xffff0000, v16
    v_lshlrev_b32 v102, 16, v17
    v_and_b32 v103, 0xffff0000, v17
    v_lshlrev_b32 v104, 16, v18
    v_and_b32 v105, 0xffff0000, v18
    v_lshlrev_b32 v106, 16, v19
    v_and_b32 v107, 0xffff0000, v19
    v_lshlrev_b32 v108, 16, v20
    v_and_b32 v109, 0xffff0000, v20
    v_lshlrev_b32 v110, 16, v21
    v_and_b32 v111, 0xffff0000, v21
    v_lshlrev_b32 v112, 16, v22
    v_and_b32 v113, 0xffff0000, v22
    v_lshlrev_b32 v114, 16, v23
    v_and_b32 v115, 0xffff0000, v23
    v_lshlrev_b32 v116, 16, v24
    v_and_b32 v117, 0xffff0000, v24
    v_lshlrev_b32 v118, 16, v25
    v_and_b32 v119, 0xffff0000, v25
    v_lshlrev_b32 v120, 16, v26
    v_and_b32 v121, 0xffff0000, v26
    v_lshlrev_b32 v122, 16, v27
    v_and_b32 v123, 0xffff0000, v27
    v_lshlrev_b32 v124, 16, v28
    v_and_b32 v125, 0xffff0000, v28
    v_lshlrev_b32 v126, 16, v29
    v_and_b32 v127, 0xffff0000, v29
    v_lshlrev_b32 v128, 16, v30
    v_and_b32 v129, 0xffff0000, v30
    v_lshlrev_b32 v130, 16, v31
    v_and_b32 v131, 0xffff0000, v31
    v_lshlrev_b32 v132, 16, v32
    v_and_b32 v133, 0xffff0000, v32
    v_lshlrev_b32 v134, 16, v33
    v_and_b32 v135, 0xffff0000, v33
    v_lshlrev_b32 v136, 16, v34
    v_and_b32 v137, 0xffff0000, v34
    v_lshlrev_b32 v138, 16, v35
    v_and_b32 v139, 0xffff0000, v35
    v_lshlrev_b32 v140, 16, v36
    v_and_b32 v141, 0xffff0000, v36
    v_lshlrev_b32 v142, 16, v37
    v_and_b32 v143, 0xffff0000, v37
    v_lshlrev_b32 v144, 16, v38
    v_and_b32 v145, 0xffff0000, v38
    v_lshlrev_b32 v146, 16, v39
    v_and_b32 v147, 0xffff0000, v39
    v_lshlrev_b32 v148, 16, v40
    v_and_b32 v149, 0xffff0000, v40
    v_lshlrev_b32 v150, 16, v41
    v_and_b32 v151, 0xffff0000, v41
    v_lshlrev_b32 v152, 16, v42
    v_and_b32 v153, 0xffff0000, v42
    v_lshlrev_b32 v154, 16, v43
    v_and_b32 v155, 0xffff0000, v43
    v_lshlrev_b32 v156, 16, v44
    v_and_b32 v157, 0xffff0000, v44
    v_lshlrev_b32 v158, 16, v45
    v_and_b32 v159, 0xffff0000, v45
    v_lshlrev_b32 v160, 16, v46
    v_and_b32 v161, 0xffff0000, v46
    v_lshlrev_b32 v162, 16, v47
    v_and_b32 v163, 0xffff0000, v47
    v_lshlrev_b32 v164, 16, v48
    v_and_b32 v165, 0xffff0000, v48
    v_lshlrev_b32 v166, 16, v49
    v_and_b32 v167, 0xffff0000, v49
    v_lshlrev_b32 v168, 16, v50
    v_and_b32 v169, 0xffff0000, v50
    v_lshlrev_b32 v170, 16, v51
    v_and_b32 v171, 0xffff0000, v51
    v_add_f32 v90, v100, v101
    v_add_f32 v91, v102, v103
    v_add_f32 v90, v90, v104
    v_add_f32 v91, v91, v105
    v_add_f32 v90, v90, v106
    v_add_f32 v91, v91, v107
    v_add_f32 v90, v90, v108
    v_add_f32 v91, v91, v109
    v_add_f32 v90, v90, v110
    v_add_f32 v91, v91, v111
    v_add_f32 v90, v90, v112
    v_add_f32 v91, v91, v113
    v_add_f32 v90, v90, v114
    v_add_f32 v91, v91, v115
    v_add_f32 v90, v90, v116
    v_add_f32 v91, v91, v117
    v_add_f32 v90, v90, v118
    v_add_f32 v91, v91, v119
    v_add_f32 v90, v90, v120
    v_add_f32 v91, v91, v121
    v_add_f32 v90, v90, v122
    v_add_f32 v91, v91, v123
    v_add_f32 v90, v90, v124
    v_add_f32 v91, v91, v125
    v_add_f32 v90, v90, v126
    v_add_f32 v91, v91, v127
    v_add_f32 v90, v90, v128
    v_add_f32 v91, v91, v129
    v_add_f32 v90, v90, v130
    v_add_f32 v91, v91, v131
    v_add_f32 v90, v90, v132
    v_add_f32 v91, v91, v133
    v_add_f32 v90, v90, v134
    v_add_f32 v91, v91, v135
    v_add_f32 v90, v90, v136
    v_add_f32 v91, v91, v137
    v_add_f32 v90, v90, v138
    v_add_f32 v91, v91, v139
    v_add_f32 v90, v90, v140
    v_add_f32 v91, v91, v141
    v_add_f32 v90, v90, v142
    v_add_f32 v91, v91, v143
    v_add_f32 v90, v90, v144
    v_add_f32 v91, v91, v145
    v_add_f32 v90, v90, v146
    v_add_f32 v91, v91, v147
    v_add_f32 v90, v90, v148
    v_add_f32 v91, v91, v149
    v_add_f32 v90, v90, v150
    v_add_f32 v91, v91, v151
    v_add_f32 v90, v90, v152
    v_add_f32 v91, v91, v153
    v_add_f32 v90, v90, v154
    v_add_f32 v91, v91, v155
    v_add_f32 v90, v90, v156
    v_add_f32 v91, v91, v157
    v_add_f32 v90, v90, v158
    v_add_f32 v91, v91, v159
    v_add_f32 v90, v90, v160
    v_add_f32 v91, v91, v161
    v_add_f32 v90, v90, v162
    v_add_f32 v91, v91, v163
    v_add_f32 v90, v90, v164
    v_add_f32 v91, v91, v165
    v_add_f32 v90, v90, v166
    v_add_f32 v91, v91, v167
    v_add_f32 v90, v90, v168
    v_add_f32 v91, v91, v169
    v_add_f32 v90, v90, v170
    v_add_f32 v91, v91, v171
    v_add_f32 v90, v90, v91
    s_nop 1
    v_add_f32_dpp v90, v90, v90 quad_perm:[1,0,3,2] row_mask:0xf bank_mask:0xf
    s_nop 1
    v_add_f32_dpp v90, v90, v90 quad_perm:[2,3,0,1] row_mask:0xf bank_mask:0xf
    s_nop 1
    v_add_f32_dpp v90, v90, v90 row_half_mirror row_mask:0xf bank_mask:0xf
    v_mul_f32 v90, 0x3ae38e39, v90
    v_sub_f32 v92, v100, v90
    v_mul_f32 v91, v92, v92
    v_sub_f32 v92, v101, v90
    v_fmac_f32 v91, v92, v92
    v_sub_f32 v92, v102, v90
    v_fmac_f32 v91, v92, v92
    v_sub_f32 v92, v103, v90
    v_fmac_f32 v91, v92, v92
    v_sub_f32 v92, v104, v90
    v_fmac_f32 v91, v92, v92
    v_sub_f32 v92, v105, v90
    v_fmac_f32 v91, v92, v92
    v_sub_f32 v92, v106, v90
    v_fmac_f32 v91, v92, v92
    v_sub_f32 v92, v107, v90
    v_fmac_f32 v91, v92, v92
    v_sub_f32 v92, v108, v90
    v_fmac_f32 v91, v92, v92
    v_sub_f32 v92, v109, v90
    v_fmac_f32 v91, v92, v92
    v_sub_f32 v92, v110, v90
    v_fmac_f32 v91, v92, v92
    v_sub_f32 v92, v111, v90
    v_fmac_f32 v91, v92, v92
    v_sub_f32 v92, v112, v90
    v_fmac_f32 v91, v92, v92
    v_sub_f32 v92, v113, v90
    v_fmac_f32 v91, v92, v92
    v_sub_f32 v92, v114, v90
    v_fmac_f32 v91, v92, v92
    v_sub_f32 v92, v115, v90
    v_fmac_f32 v91, v92, v92
    v_sub_f32 v92, v116, v90
    v_fmac_f32 v91, v92, v92
    v_sub_f32 v92, v117, v90
    v_fmac_f32 v91, v92, v92
    v_sub_f32 v92, v118, v90
    v_fmac_f32 v91, v92, v92
    v_sub_f32 v92, v119, v90
    v_fmac_f32 v91, v92, v92
    v_sub_f32 v92, v120, v90
    v_fmac_f32 v91, v92, v92
    v_sub_f32 v92, v121, v90
    v_fmac_f32 v91, v92, v92
    v_sub_f32 v92, v122, v90
    v_fmac_f32 v91, v92, v92
    v_sub_f32 v92, v123, v90
    v_fmac_f32 v91, v92, v92
    v_sub_f32 v92, v124, v90
    v_fmac_f32 v91, v92, v92
    v_sub_f32 v92, v125, v90
    v_fmac_f32 v91, v92, v92
    v_sub_f32 v92, v126, v90
    v_fmac_f32 v91, v92, v92
    v_sub_f32 v92, v127, v90
    v_fmac_f32 v91, v92, v92
    v_sub_f32 v92, v128, v90
    v_fmac_f32 v91, v92, v92
    v_sub_f32 v92, v129, v90
    v_fmac_f32 v91, v92, v92
    v_sub_f32 v92, v130, v90
    v_fmac_f32 v91, v92, v92
    v_sub_f32 v92, v131, v90
    v_fmac_f32 v91, v92, v92
    v_sub_f32 v92, v132, v90
    v_fmac_f32 v91, v92, v92
    v_sub_f32 v92, v133, v90
    v_fmac_f32 v91, v92, v92
    v_sub_f32 v92, v134, v90
    v_fmac_f32 v91, v92, v92
    v_sub_f32 v92, v135, v90
    v_fmac_f32 v91, v92, v92
    v_sub_f32 v92, v136, v90
    v_fmac_f32 v91, v92, v92
    v_sub_f32 v92, v137, v90
    v_fmac_f32 v91, v92, v92
    v_sub_f32 v92, v138, v90
    v_fmac_f32 v91, v92, v92
    v_sub_f32 v92, v139, v90
    v_fmac_f32 v91, v92, v92
    v_sub_f32 v92, v140, v90
    v_fmac_f32 v91, v92, v92
    v_sub_f32 v92, v141, v90
    v_fmac_f32 v91, v92, v92
    v_sub_f32 v92, v142, v90
    v_fmac_f32 v91, v92, v92
    v_sub_f32 v92, v143, v90
    v_fmac_f32 v91, v92, v92
    v_sub_f32 v92, v144, v90
    v_fmac_f32 v91, v92, v92
    v_sub_f32 v92, v145, v90
    v_fmac_f32 v91, v92, v92
    v_sub_f32 v92, v146, v90
    v_fmac_f32 v91, v92, v92
    v_sub_f32 v92, v147, v90
    v_fmac_f32 v91, v92, v92
    v_sub_f32 v92, v148, v90
    v_fmac_f32 v91, v92, v92
    v_sub_f32 v92, v149, v90
    v_fmac_f32 v91, v92, v92
    v_sub_f32 v92, v150, v90
    v_fmac_f32 v91, v92, v92
    v_sub_f32 v92, v151, v90
    v_fmac_f32 v91, v92, v92
    v_sub_f32 v92, v152, v90
    v_fmac_f32 v91, v92, v92
    v_sub_f32 v92, v153, v90
    v_fmac_f32 v91, v92, v92
    v_sub_f32 v92, v154, v90
    v_fmac_f32 v91, v92, v92
    v_sub_f32 v92, v155, v90
    v_fmac_f32 v91, v92, v92
    v_sub_f32 v92, v156, v90
    v_fmac_f32 v91, v92, v92
    v_sub_f32 v92, v157, v90
    v_fmac_f32 v91, v92, v92
    v_sub_f32 v92, v158, v90
    v_fmac_f32 v91, v92, v92
    v_sub_f32 v92, v159, v90
    v_fmac_f32 v91, v92, v92
    v_sub_f32 v92, v160, v90
    v_fmac_f32 v91, v92, v92
    v_sub_f32 v92, v161, v90
    v_fmac_f32 v91, v92, v92
    v_sub_f32 v92, v162, v90
    v_fmac_f32 v91, v92, v92
    v_sub_f32 v92, v163, v90
    v_fmac_f32 v91, v92, v92
    v_sub_f32 v92, v164, v90
    v_fmac_f32 v91, v92, v92
    v_sub_f32 v92, v165, v90
    v_fmac_f32 v91, v92, v92
    v_sub_f32 v92, v166, v90
    v_fmac_f32 v91, v92, v92
    v_sub_f32 v92, v167, v90
    v_fmac_f32 v91, v92, v92
    v_sub_f32 v92, v168, v90
    v_fmac_f32 v91, v92, v92
    v_sub_f32 v92, v169, v90
    v_fmac_f32 v91, v92, v92
    v_sub_f32 v92, v170, v90
    v_fmac_f32 v91, v92, v92
    v_sub_f32 v92, v171, v90
    v_fmac_f32 v91, v92, v92
    s_nop 1
    v_add_f32_dpp v91, v91, v91 quad_perm:[1,0,3,2] row_mask:0xf bank_mask:0xf
    s_nop 1
    v_add_f32_dpp v91, v91, v91 quad_perm:[2,3,0,1] row_mask:0xf bank_mask:0xf
    s_nop 1
    v_add_f32_dpp v91, v91, v91 row_half_mirror row_mask:0xf bank_mask:0xf
    v_mul_f32 v91, 0x3ae38e39, v91
    v_cvt_pk_bf16_f32 v92, v90, v91
    v_lshlrev_b32 v90, 16, v92
    v_and_b32 v91, 0xffff0000, v92
    v_add_f32 v91, 0x3727c5ac, v91
    v_cvt_pk_bf16_f32 v91, v91, v91
    v_lshlrev_b32 v91, 16, v91
    v_sqrt_f32 v91, v91
    s_nop 0
    v_cvt_pk_bf16_f32 v91, v91, v91
    v_lshlrev_b32 v91, 16, v91
    v_rcp_f32 v91, v91
    s_nop 0
    v_sub_f32 v100, v100, v90
    v_sub_f32 v101, v101, v90
    v_cvt_pk_bf16_f32 v16, v100, v101
    v_lshlrev_b32 v100, 16, v16
    v_and_b32 v101, 0xffff0000, v16
    v_mul_f32 v100, v100, v91
    v_mul_f32 v101, v101, v91
    v_cvt_pk_bf16_f32 v16, v100, v101
    v_sub_f32 v102, v102, v90
    v_sub_f32 v103, v103, v90
    v_cvt_pk_bf16_f32 v17, v102, v103
    v_lshlrev_b32 v102, 16, v17
    v_and_b32 v103, 0xffff0000, v17
    v_mul_f32 v102, v102, v91
    v_mul_f32 v103, v103, v91
    v_cvt_pk_bf16_f32 v17, v102, v103
    v_sub_f32 v104, v104, v90
    v_sub_f32 v105, v105, v90
    v_cvt_pk_bf16_f32 v18, v104, v105
    v_lshlrev_b32 v104, 16, v18
    v_and_b32 v105, 0xffff0000, v18
    v_mul_f32 v104, v104, v91
    v_mul_f32 v105, v105, v91
    v_cvt_pk_bf16_f32 v18, v104, v105
    v_sub_f32 v106, v106, v90
    v_sub_f32 v107, v107, v90
    v_cvt_pk_bf16_f32 v19, v106, v107
    v_lshlrev_b32 v106, 16, v19
    v_and_b32 v107, 0xffff0000, v19
    v_mul_f32 v106, v106, v91
    v_mul_f32 v107, v107, v91
    v_cvt_pk_bf16_f32 v19, v106, v107
    v_sub_f32 v108, v108, v90
    v_sub_f32 v109, v109, v90
    v_cvt_pk_bf16_f32 v20, v108, v109
    v_lshlrev_b32 v108, 16, v20
    v_and_b32 v109, 0xffff0000, v20
    v_mul_f32 v108, v108, v91
    v_mul_f32 v109, v109, v91
    v_cvt_pk_bf16_f32 v20, v108, v109
    v_sub_f32 v110, v110, v90
    v_sub_f32 v111, v111, v90
    v_cvt_pk_bf16_f32 v21, v110, v111
    v_lshlrev_b32 v110, 16, v21
    v_and_b32 v111, 0xffff0000, v21
    v_mul_f32 v110, v110, v91
    v_mul_f32 v111, v111, v91
    v_cvt_pk_bf16_f32 v21, v110, v111
    v_sub_f32 v112, v112, v90
    v_sub_f32 v113, v113, v90
    v_cvt_pk_bf16_f32 v22, v112, v113
    v_lshlrev_b32 v112, 16, v22
    v_and_b32 v113, 0xffff0000, v22
    v_mul_f32 v112, v112, v91
    v_mul_f32 v113, v113, v91
    v_cvt_pk_bf16_f32 v22, v112, v113
    v_sub_f32 v114, v114, v90
    v_sub_f32 v115, v115, v90
    v_cvt_pk_bf16_f32 v23, v114, v115
    v_lshlrev_b32 v114, 16, v23
    v_and_b32 v115, 0xffff0000, v23
    v_mul_f32 v114, v114, v91
    v_mul_f32 v115, v115, v91
    v_cvt_pk_bf16_f32 v23, v114, v115
    v_sub_f32 v116, v116, v90
    v_sub_f32 v117, v117, v90
    v_cvt_pk_bf16_f32 v24, v116, v117
    v_lshlrev_b32 v116, 16, v24
    v_and_b32 v117, 0xffff0000, v24
    v_mul_f32 v116, v116, v91
    v_mul_f32 v117, v117, v91
    v_cvt_pk_bf16_f32 v24, v116, v117
    v_sub_f32 v118, v118, v90
    v_sub_f32 v119, v119, v90
    v_cvt_pk_bf16_f32 v25, v118, v119
    v_lshlrev_b32 v118, 16, v25
    v_and_b32 v119, 0xffff0000, v25
    v_mul_f32 v118, v118, v91
    v_mul_f32 v119, v119, v91
    v_cvt_pk_bf16_f32 v25, v118, v119
    v_sub_f32 v120, v120, v90
    v_sub_f32 v121, v121, v90
    v_cvt_pk_bf16_f32 v26, v120, v121
    v_lshlrev_b32 v120, 16, v26
    v_and_b32 v121, 0xffff0000, v26
    v_mul_f32 v120, v120, v91
    v_mul_f32 v121, v121, v91
    v_cvt_pk_bf16_f32 v26, v120, v121
    v_sub_f32 v122, v122, v90
    v_sub_f32 v123, v123, v90
    v_cvt_pk_bf16_f32 v27, v122, v123
    v_lshlrev_b32 v122, 16, v27
    v_and_b32 v123, 0xffff0000, v27
    v_mul_f32 v122, v122, v91
    v_mul_f32 v123, v123, v91
    v_cvt_pk_bf16_f32 v27, v122, v123
    v_sub_f32 v124, v124, v90
    v_sub_f32 v125, v125, v90
    v_cvt_pk_bf16_f32 v28, v124, v125
    v_lshlrev_b32 v124, 16, v28
    v_and_b32 v125, 0xffff0000, v28
    v_mul_f32 v124, v124, v91
    v_mul_f32 v125, v125, v91
    v_cvt_pk_bf16_f32 v28, v124, v125
    v_sub_f32 v126, v126, v90
    v_sub_f32 v127, v127, v90
    v_cvt_pk_bf16_f32 v29, v126, v127
    v_lshlrev_b32 v126, 16, v29
    v_and_b32 v127, 0xffff0000, v29
    v_mul_f32 v126, v126, v91
    v_mul_f32 v127, v127, v91
    v_cvt_pk_bf16_f32 v29, v126, v127
    v_sub_f32 v128, v128, v90
    v_sub_f32 v129, v129, v90
    v_cvt_pk_bf16_f32 v30, v128, v129
    v_lshlrev_b32 v128, 16, v30
    v_and_b32 v129, 0xffff0000, v30
    v_mul_f32 v128, v128, v91
    v_mul_f32 v129, v129, v91
    v_cvt_pk_bf16_f32 v30, v128, v129
    v_sub_f32 v130, v130, v90
    v_sub_f32 v131, v131, v90
    v_cvt_pk_bf16_f32 v31, v130, v131
    v_lshlrev_b32 v130, 16, v31
    v_and_b32 v131, 0xffff0000, v31
    v_mul_f32 v130, v130, v91
    v_mul_f32 v131, v131, v91
    v_cvt_pk_bf16_f32 v31, v130, v131
    v_sub_f32 v132, v132, v90
    v_sub_f32 v133, v133, v90
    v_cvt_pk_bf16_f32 v32, v132, v133
    v_lshlrev_b32 v132, 16, v32
    v_and_b32 v133, 0xffff0000, v32
    v_mul_f32 v132, v132, v91
    v_mul_f32 v133, v133, v91
    v_cvt_pk_bf16_f32 v32, v132, v133
    v_sub_f32 v134, v134, v90
    v_sub_f32 v135, v135, v90
    v_cvt_pk_bf16_f32 v33, v134, v135
    v_lshlrev_b32 v134, 16, v33
    v_and_b32 v135, 0xffff0000, v33
    v_mul_f32 v134, v134, v91
    v_mul_f32 v135, v135, v91
    v_cvt_pk_bf16_f32 v33, v134, v135
    v_sub_f32 v136, v136, v90
    v_sub_f32 v137, v137, v90
    v_cvt_pk_bf16_f32 v34, v136, v137
    v_lshlrev_b32 v136, 16, v34
    v_and_b32 v137, 0xffff0000, v34
    v_mul_f32 v136, v136, v91
    v_mul_f32 v137, v137, v91
    v_cvt_pk_bf16_f32 v34, v136, v137
    v_sub_f32 v138, v138, v90
    v_sub_f32 v139, v139, v90
    v_cvt_pk_bf16_f32 v35, v138, v139
    v_lshlrev_b32 v138, 16, v35
    v_and_b32 v139, 0xffff0000, v35
    v_mul_f32 v138, v138, v91
    v_mul_f32 v139, v139, v91
    v_cvt_pk_bf16_f32 v35, v138, v139
    v_sub_f32 v140, v140, v90
    v_sub_f32 v141, v141, v90
    v_cvt_pk_bf16_f32 v36, v140, v141
    v_lshlrev_b32 v140, 16, v36
    v_and_b32 v141, 0xffff0000, v36
    v_mul_f32 v140, v140, v91
    v_mul_f32 v141, v141, v91
    v_cvt_pk_bf16_f32 v36, v140, v141
    v_sub_f32 v142, v142, v90
    v_sub_f32 v143, v143, v90
    v_cvt_pk_bf16_f32 v37, v142, v143
    v_lshlrev_b32 v142, 16, v37
    v_and_b32 v143, 0xffff0000, v37
    v_mul_f32 v142, v142, v91
    v_mul_f32 v143, v143, v91
    v_cvt_pk_bf16_f32 v37, v142, v143
    v_sub_f32 v144, v144, v90
    v_sub_f32 v145, v145, v90
    v_cvt_pk_bf16_f32 v38, v144, v145
    v_lshlrev_b32 v144, 16, v38
    v_and_b32 v145, 0xffff0000, v38
    v_mul_f32 v144, v144, v91
    v_mul_f32 v145, v145, v91
    v_cvt_pk_bf16_f32 v38, v144, v145
    v_sub_f32 v146, v146, v90
    v_sub_f32 v147, v147, v90
    v_cvt_pk_bf16_f32 v39, v146, v147
    v_lshlrev_b32 v146, 16, v39
    v_and_b32 v147, 0xffff0000, v39
    v_mul_f32 v146, v146, v91
    v_mul_f32 v147, v147, v91
    v_cvt_pk_bf16_f32 v39, v146, v147
    v_sub_f32 v148, v148, v90
    v_sub_f32 v149, v149, v90
    v_cvt_pk_bf16_f32 v40, v148, v149
    v_lshlrev_b32 v148, 16, v40
    v_and_b32 v149, 0xffff0000, v40
    v_mul_f32 v148, v148, v91
    v_mul_f32 v149, v149, v91
    v_cvt_pk_bf16_f32 v40, v148, v149
    v_sub_f32 v150, v150, v90
    v_sub_f32 v151, v151, v90
    v_cvt_pk_bf16_f32 v41, v150, v151
    v_lshlrev_b32 v150, 16, v41
    v_and_b32 v151, 0xffff0000, v41
    v_mul_f32 v150, v150, v91
    v_mul_f32 v151, v151, v91
    v_cvt_pk_bf16_f32 v41, v150, v151
    v_sub_f32 v152, v152, v90
    v_sub_f32 v153, v153, v90
    v_cvt_pk_bf16_f32 v42, v152, v153
    v_lshlrev_b32 v152, 16, v42
    v_and_b32 v153, 0xffff0000, v42
    v_mul_f32 v152, v152, v91
    v_mul_f32 v153, v153, v91
    v_cvt_pk_bf16_f32 v42, v152, v153
    v_sub_f32 v154, v154, v90
    v_sub_f32 v155, v155, v90
    v_cvt_pk_bf16_f32 v43, v154, v155
    v_lshlrev_b32 v154, 16, v43
    v_and_b32 v155, 0xffff0000, v43
    v_mul_f32 v154, v154, v91
    v_mul_f32 v155, v155, v91
    v_cvt_pk_bf16_f32 v43, v154, v155
    v_sub_f32 v156, v156, v90
    v_sub_f32 v157, v157, v90
    v_cvt_pk_bf16_f32 v44, v156, v157
    v_lshlrev_b32 v156, 16, v44
    v_and_b32 v157, 0xffff0000, v44
    v_mul_f32 v156, v156, v91
    v_mul_f32 v157, v157, v91
    v_cvt_pk_bf16_f32 v44, v156, v157
    v_sub_f32 v158, v158, v90
    v_sub_f32 v159, v159, v90
    v_cvt_pk_bf16_f32 v45, v158, v159
    v_lshlrev_b32 v158, 16, v45
    v_and_b32 v159, 0xffff0000, v45
    v_mul_f32 v158, v158, v91
    v_mul_f32 v159, v159, v91
    v_cvt_pk_bf16_f32 v45, v158, v159
    v_sub_f32 v160, v160, v90
    v_sub_f32 v161, v161, v90
    v_cvt_pk_bf16_f32 v46, v160, v161
    v_lshlrev_b32 v160, 16, v46
    v_and_b32 v161, 0xffff0000, v46
    v_mul_f32 v160, v160, v91
    v_mul_f32 v161, v161, v91
    v_cvt_pk_bf16_f32 v46, v160, v161
    v_sub_f32 v162, v162, v90
    v_sub_f32 v163, v163, v90
    v_cvt_pk_bf16_f32 v47, v162, v163
    v_lshlrev_b32 v162, 16, v47
    v_and_b32 v163, 0xffff0000, v47
    v_mul_f32 v162, v162, v91
    v_mul_f32 v163, v163, v91
    v_cvt_pk_bf16_f32 v47, v162, v163
    v_sub_f32 v164, v164, v90
    v_sub_f32 v165, v165, v90
    v_cvt_pk_bf16_f32 v48, v164, v165
    v_lshlrev_b32 v164, 16, v48
    v_and_b32 v165, 0xffff0000, v48
    v_mul_f32 v164, v164, v91
    v_mul_f32 v165, v165, v91
    v_cvt_pk_bf16_f32 v48, v164, v165
    v_sub_f32 v166, v166, v90
    v_sub_f32 v167, v167, v90
    v_cvt_pk_bf16_f32 v49, v166, v167
    v_lshlrev_b32 v166, 16, v49
    v_and_b32 v167, 0xffff0000, v49
    v_mul_f32 v166, v166, v91
    v_mul_f32 v167, v167, v91
    v_cvt_pk_bf16_f32 v49, v166, v167
    v_sub_f32 v168, v168, v90
    v_sub_f32 v169, v169, v90
    v_cvt_pk_bf16_f32 v50, v168, v169
    v_lshlrev_b32 v168, 16, v50
    v_and_b32 v169, 0xffff0000, v50
    v_mul_f32 v168, v168, v91
    v_mul_f32 v169, v169, v91
    v_cvt_pk_bf16_f32 v50, v168, v169
    v_sub_f32 v170, v170, v90
    v_sub_f32 v171, v171, v90
    v_cvt_pk_bf16_f32 v51, v170, v171
    v_lshlrev_b32 v170, 16, v51
    v_and_b32 v171, 0xffff0000, v51
    v_mul_f32 v170, v170, v91
    v_mul_f32 v171, v171, v91
    v_cvt_pk_bf16_f32 v51, v170, v171
    s_lshl_b32 s22, s3, 4
    s_add_u32 s22, s22, 0
    s_lshr_b32 s23, s22, 5
    s_mul_i32 s23, s23, 36864
    s_and_b32 s22, s22, 31
    v_lshrrev_b32 v7, 3, v1
    v_add_u32 v7, s22, v7
    v_lshlrev_b32 v7, 4, v7
    v_add_u32 v7, s23, v7
    v_and_b32 v6, 7, v1
    v_lshrrev_b32 v8, 1, v6
    v_lshl_add_u32 v7, v8, 10, v7
    v_and_b32 v8, 1, v6
    v_lshl_add_u32 v7, v8, 9, v7
    ds_write_b128 v7, v[16:19] offset:0
    ds_write_b128 v7, v[20:23] offset:4096
    ds_write_b128 v7, v[24:27] offset:8192
    ds_write_b128 v7, v[28:31] offset:12288
    ds_write_b128 v7, v[32:35] offset:16384
    ds_write_b128 v7, v[36:39] offset:20480
    ds_write_b128 v7, v[40:43] offset:24576
    ds_write_b128 v7, v[44:47] offset:28672
    ds_write_b128 v7, v[48:51] offset:32768
    s_waitcnt vmcnt(0)
    v_lshlrev_b32 v100, 16, v52
    v_and_b32 v101, 0xffff0000, v52
    v_lshlrev_b32 v102, 16, v53
    v_and_b32 v103, 0xffff0000, v53
    v_lshlrev_b32 v104, 16, v54
    v_and_b32 v105, 0xffff0000, v54
    v_lshlrev_b32 v106, 16, v55
    v_and_b32 v107, 0xffff0000, v55
    v_lshlrev_b32 v108, 16, v56
    v_and_b32 v109, 0xffff0000, v56
    v_lshlrev_b32 v110, 16, v57
    v_and_b32 v111, 0xffff0000, v57
    v_lshlrev_b32 v112, 16, v58
    v_and_b32 v113, 0xffff0000, v58
    v_lshlrev_b32 v114, 16, v59
    v_and_b32 v115, 0xffff0000, v59
    v_lshlrev_b32 v116, 16, v60
    v_and_b32 v117, 0xffff0000, v60
    v_lshlrev_b32 v118, 16, v61
    v_and_b32 v119, 0xffff0000, v61
    v_lshlrev_b32 v120, 16, v62
    v_and_b32 v121, 0xffff0000, v62
    v_lshlrev_b32 v122, 16, v63
    v_and_b32 v123, 0xffff0000, v63
    v_lshlrev_b32 v124, 16, v64
    v_and_b32 v125, 0xffff0000, v64
    v_lshlrev_b32 v126, 16, v65
    v_and_b32 v127, 0xffff0000, v65
    v_lshlrev_b32 v128, 16, v66
    v_and_b32 v129, 0xffff0000, v66
    v_lshlrev_b32 v130, 16, v67
    v_and_b32 v131, 0xffff0000, v67
    v_lshlrev_b32 v132, 16, v68
    v_and_b32 v133, 0xffff0000, v68
    v_lshlrev_b32 v134, 16, v69
    v_and_b32 v135, 0xffff0000, v69
    v_lshlrev_b32 v136, 16, v70
    v_and_b32 v137, 0xffff0000, v70
    v_lshlrev_b32 v138, 16, v71
    v_and_b32 v139, 0xffff0000, v71
    v_lshlrev_b32 v140, 16, v72
    v_and_b32 v141, 0xffff0000, v72
    v_lshlrev_b32 v142, 16, v73
    v_and_b32 v143, 0xffff0000, v73
    v_lshlrev_b32 v144, 16, v74
    v_and_b32 v145, 0xffff0000, v74
    v_lshlrev_b32 v146, 16, v75
    v_and_b32 v147, 0xffff0000, v75
    v_lshlrev_b32 v148, 16, v76
    v_and_b32 v149, 0xffff0000, v76
    v_lshlrev_b32 v150, 16, v77
    v_and_b32 v151, 0xffff0000, v77
    v_lshlrev_b32 v152, 16, v78
    v_and_b32 v153, 0xffff0000, v78
    v_lshlrev_b32 v154, 16, v79
    v_and_b32 v155, 0xffff0000, v79
    v_lshlrev_b32 v156, 16, v80
    v_and_b32 v157, 0xffff0000, v80
    v_lshlrev_b32 v158, 16, v81
    v_and_b32 v159, 0xffff0000, v81
    v_lshlrev_b32 v160, 16, v82
    v_and_b32 v161, 0xffff0000, v82
    v_lshlrev_b32 v162, 16, v83
    v_and_b32 v163, 0xffff0000, v83
    v_lshlrev_b32 v164, 16, v84
    v_and_b32 v165, 0xffff0000, v84
    v_lshlrev_b32 v166, 16, v85
    v_and_b32 v167, 0xffff0000, v85
    v_lshlrev_b32 v168, 16, v86
    v_and_b32 v169, 0xffff0000, v86
    v_lshlrev_b32 v170, 16, v87
    v_and_b32 v171, 0xffff0000, v87
    v_add_f32 v90, v100, v101
    v_add_f32 v91, v102, v103
    v_add_f32 v90, v90, v104
    v_add_f32 v91, v91, v105
    v_add_f32 v90, v90, v106
    v_add_f32 v91, v91, v107
    v_add_f32 v90, v90, v108
    v_add_f32 v91, v91, v109
    v_add_f32 v90, v90, v110
    v_add_f32 v91, v91, v111
    v_add_f32 v90, v90, v112
    v_add_f32 v91, v91, v113
    v_add_f32 v90, v90, v114
    v_add_f32 v91, v91, v115
    v_add_f32 v90, v90, v116
    v_add_f32 v91, v91, v117
    v_add_f32 v90, v90, v118
    v_add_f32 v91, v91, v119
    v_add_f32 v90, v90, v120
    v_add_f32 v91, v91, v121
    v_add_f32 v90, v90, v122
    v_add_f32 v91, v91, v123
    v_add_f32 v90, v90, v124
    v_add_f32 v91, v91, v125
    v_add_f32 v90, v90, v126
    v_add_f32 v91, v91, v127
    v_add_f32 v90, v90, v128
    v_add_f32 v91, v91, v129
    v_add_f32 v90, v90, v130
    v_add_f32 v91, v91, v131
    v_add_f32 v90, v90, v132
    v_add_f32 v91, v91, v133
    v_add_f32 v90, v90, v134
    v_add_f32 v91, v91, v135
    v_add_f32 v90, v90, v136
    v_add_f32 v91, v91, v137
    v_add_f32 v90, v90, v138
    v_add_f32 v91, v91, v139
    v_add_f32 v90, v90, v140
    v_add_f32 v91, v91, v141
    v_add_f32 v90, v90, v142
    v_add_f32 v91, v91, v143
    v_add_f32 v90, v90, v144
    v_add_f32 v91, v91, v145
    v_add_f32 v90, v90, v146
    v_add_f32 v91, v91, v147
    v_add_f32 v90, v90, v148
    v_add_f32 v91, v91, v149
    v_add_f32 v90, v90, v150
    v_add_f32 v91, v91, v151
    v_add_f32 v90, v90, v152
    v_add_f32 v91, v91, v153
    v_add_f32 v90, v90, v154
    v_add_f32 v91, v91, v155
    v_add_f32 v90, v90, v156
    v_add_f32 v91, v91, v157
    v_add_f32 v90, v90, v158
    v_add_f32 v91, v91, v159
    v_add_f32 v90, v90, v160
    v_add_f32 v91, v91, v161
    v_add_f32 v90, v90, v162
    v_add_f32 v91, v91, v163
    v_add_f32 v90, v90, v164
    v_add_f32 v91, v91, v165
    v_add_f32 v90, v90, v166
    v_add_f32 v91, v91, v167
    v_add_f32 v90, v90, v168
    v_add_f32 v91, v91, v169
    v_add_f32 v90, v90, v170
    v_add_f32 v91, v91, v171
    v_add_f32 v90, v90, v91
    s_nop 1
    v_add_f32_dpp v90, v90, v90 quad_perm:[1,0,3,2] row_mask:0xf bank_mask:0xf
    s_nop 1
    v_add_f32_dpp v90, v90, v90 quad_perm:[2,3,0,1] row_mask:0xf bank_mask:0xf
    s_nop 1
    v_add_f32_dpp v90, v90, v90 row_half_mirror row_mask:0xf bank_mask:0xf
    v_mul_f32 v90, 0x3ae38e39, v90
    v_sub_f32 v92, v100, v90
    v_mul_f32 v91, v92, v92
    v_sub_f32 v92, v101, v90
    v_fmac_f32 v91, v92, v92
    v_sub_f32 v92, v102, v90
    v_fmac_f32 v91, v92, v92
    v_sub_f32 v92, v103, v90
    v_fmac_f32 v91, v92, v92
    v_sub_f32 v92, v104, v90
    v_fmac_f32 v91, v92, v92
    v_sub_f32 v92, v105, v90
    v_fmac_f32 v91, v92, v92
    v_sub_f32 v92, v106, v90
    v_fmac_f32 v91, v92, v92
    v_sub_f32 v92, v107, v90
    v_fmac_f32 v91, v92, v92
    v_sub_f32 v92, v108, v90
    v_fmac_f32 v91, v92, v92
    v_sub_f32 v92, v109, v90
    v_fmac_f32 v91, v92, v92
    v_sub_f32 v92, v110, v90
    v_fmac_f32 v91, v92, v92
    v_sub_f32 v92, v111, v90
    v_fmac_f32 v91, v92, v92
    v_sub_f32 v92, v112, v90
    v_fmac_f32 v91, v92, v92
    v_sub_f32 v92, v113, v90
    v_fmac_f32 v91, v92, v92
    v_sub_f32 v92, v114, v90
    v_fmac_f32 v91, v92, v92
    v_sub_f32 v92, v115, v90
    v_fmac_f32 v91, v92, v92
    v_sub_f32 v92, v116, v90
    v_fmac_f32 v91, v92, v92
    v_sub_f32 v92, v117, v90
    v_fmac_f32 v91, v92, v92
    v_sub_f32 v92, v118, v90
    v_fmac_f32 v91, v92, v92
    v_sub_f32 v92, v119, v90
    v_fmac_f32 v91, v92, v92
    v_sub_f32 v92, v120, v90
    v_fmac_f32 v91, v92, v92
    v_sub_f32 v92, v121, v90
    v_fmac_f32 v91, v92, v92
    v_sub_f32 v92, v122, v90
    v_fmac_f32 v91, v92, v92
    v_sub_f32 v92, v123, v90
    v_fmac_f32 v91, v92, v92
    v_sub_f32 v92, v124, v90
    v_fmac_f32 v91, v92, v92
    v_sub_f32 v92, v125, v90
    v_fmac_f32 v91, v92, v92
    v_sub_f32 v92, v126, v90
    v_fmac_f32 v91, v92, v92
    v_sub_f32 v92, v127, v90
    v_fmac_f32 v91, v92, v92
    v_sub_f32 v92, v128, v90
    v_fmac_f32 v91, v92, v92
    v_sub_f32 v92, v129, v90
    v_fmac_f32 v91, v92, v92
    v_sub_f32 v92, v130, v90
    v_fmac_f32 v91, v92, v92
    v_sub_f32 v92, v131, v90
    v_fmac_f32 v91, v92, v92
    v_sub_f32 v92, v132, v90
    v_fmac_f32 v91, v92, v92
    v_sub_f32 v92, v133, v90
    v_fmac_f32 v91, v92, v92
    v_sub_f32 v92, v134, v90
    v_fmac_f32 v91, v92, v92
    v_sub_f32 v92, v135, v90
    v_fmac_f32 v91, v92, v92
    v_sub_f32 v92, v136, v90
    v_fmac_f32 v91, v92, v92
    v_sub_f32 v92, v137, v90
    v_fmac_f32 v91, v92, v92
    v_sub_f32 v92, v138, v90
    v_fmac_f32 v91, v92, v92
    v_sub_f32 v92, v139, v90
    v_fmac_f32 v91, v92, v92
    v_sub_f32 v92, v140, v90
    v_fmac_f32 v91, v92, v92
    v_sub_f32 v92, v141, v90
    v_fmac_f32 v91, v92, v92
    v_sub_f32 v92, v142, v90
    v_fmac_f32 v91, v92, v92
    v_sub_f32 v92, v143, v90
    v_fmac_f32 v91, v92, v92
    v_sub_f32 v92, v144, v90
    v_fmac_f32 v91, v92, v92
    v_sub_f32 v92, v145, v90
    v_fmac_f32 v91, v92, v92
    v_sub_f32 v92, v146, v90
    v_fmac_f32 v91, v92, v92
    v_sub_f32 v92, v147, v90
    v_fmac_f32 v91, v92, v92
    v_sub_f32 v92, v148, v90
    v_fmac_f32 v91, v92, v92
    v_sub_f32 v92, v149, v90
    v_fmac_f32 v91, v92, v92
    v_sub_f32 v92, v150, v90
    v_fmac_f32 v91, v92, v92
    v_sub_f32 v92, v151, v90
    v_fmac_f32 v91, v92, v92
    v_sub_f32 v92, v152, v90
    v_fmac_f32 v91, v92, v92
    v_sub_f32 v92, v153, v90
    v_fmac_f32 v91, v92, v92
    v_sub_f32 v92, v154, v90
    v_fmac_f32 v91, v92, v92
    v_sub_f32 v92, v155, v90
    v_fmac_f32 v91, v92, v92
    v_sub_f32 v92, v156, v90
    v_fmac_f32 v91, v92, v92
    v_sub_f32 v92, v157, v90
    v_fmac_f32 v91, v92, v92
    v_sub_f32 v92, v158, v90
    v_fmac_f32 v91, v92, v92
    v_sub_f32 v92, v159, v90
    v_fmac_f32 v91, v92, v92
    v_sub_f32 v92, v160, v90
    v_fmac_f32 v91, v92, v92
    v_sub_f32 v92, v161, v90
    v_fmac_f32 v91, v92, v92
    v_sub_f32 v92, v162, v90
    v_fmac_f32 v91, v92, v92
    v_sub_f32 v92, v163, v90
    v_fmac_f32 v91, v92, v92
    v_sub_f32 v92, v164, v90
    v_fmac_f32 v91, v92, v92
    v_sub_f32 v92, v165, v90
    v_fmac_f32 v91, v92, v92
    v_sub_f32 v92, v166, v90
    v_fmac_f32 v91, v92, v92
    v_sub_f32 v92, v167, v90
    v_fmac_f32 v91, v92, v92
    v_sub_f32 v92, v168, v90
    v_fmac_f32 v91, v92, v92
    v_sub_f32 v92, v169, v90
    v_fmac_f32 v91, v92, v92
    v_sub_f32 v92, v170, v90
    v_fmac_f32 v91, v92, v92
    v_sub_f32 v92, v171, v90
    v_fmac_f32 v91, v92, v92
    s_nop 1
    v_add_f32_dpp v91, v91, v91 quad_perm:[1,0,3,2] row_mask:0xf bank_mask:0xf
    s_nop 1
    v_add_f32_dpp v91, v91, v91 quad_perm:[2,3,0,1] row_mask:0xf bank_mask:0xf
    s_nop 1
    v_add_f32_dpp v91, v91, v91 row_half_mirror row_mask:0xf bank_mask:0xf
    v_mul_f32 v91, 0x3ae38e39, v91
    v_cvt_pk_bf16_f32 v92, v90, v91
    v_lshlrev_b32 v90, 16, v92
    v_and_b32 v91, 0xffff0000, v92
    v_add_f32 v91, 0x3727c5ac, v91
    v_cvt_pk_bf16_f32 v91, v91, v91
    v_lshlrev_b32 v91, 16, v91
    v_sqrt_f32 v91, v91
    s_nop 0
    v_cvt_pk_bf16_f32 v91, v91, v91
    v_lshlrev_b32 v91, 16, v91
    v_rcp_f32 v91, v91
    s_nop 0
    v_sub_f32 v100, v100, v90
    v_sub_f32 v101, v101, v90
    v_cvt_pk_bf16_f32 v52, v100, v101
    v_lshlrev_b32 v100, 16, v52
    v_and_b32 v101, 0xffff0000, v52
    v_mul_f32 v100, v100, v91
    v_mul_f32 v101, v101, v91
    v_cvt_pk_bf16_f32 v52, v100, v101
    v_sub_f32 v102, v102, v90
    v_sub_f32 v103, v103, v90
    v_cvt_pk_bf16_f32 v53, v102, v103
    v_lshlrev_b32 v102, 16, v53
    v_and_b32 v103, 0xffff0000, v53
    v_mul_f32 v102, v102, v91
    v_mul_f32 v103, v103, v91
    v_cvt_pk_bf16_f32 v53, v102, v103
    v_sub_f32 v104, v104, v90
    v_sub_f32 v105, v105, v90
    v_cvt_pk_bf16_f32 v54, v104, v105
    v_lshlrev_b32 v104, 16, v54
    v_and_b32 v105, 0xffff0000, v54
    v_mul_f32 v104, v104, v91
    v_mul_f32 v105, v105, v91
    v_cvt_pk_bf16_f32 v54, v104, v105
    v_sub_f32 v106, v106, v90
    v_sub_f32 v107, v107, v90
    v_cvt_pk_bf16_f32 v55, v106, v107
    v_lshlrev_b32 v106, 16, v55
    v_and_b32 v107, 0xffff0000, v55
    v_mul_f32 v106, v106, v91
    v_mul_f32 v107, v107, v91
    v_cvt_pk_bf16_f32 v55, v106, v107
    v_sub_f32 v108, v108, v90
    v_sub_f32 v109, v109, v90
    v_cvt_pk_bf16_f32 v56, v108, v109
    v_lshlrev_b32 v108, 16, v56
    v_and_b32 v109, 0xffff0000, v56
    v_mul_f32 v108, v108, v91
    v_mul_f32 v109, v109, v91
    v_cvt_pk_bf16_f32 v56, v108, v109
    v_sub_f32 v110, v110, v90
    v_sub_f32 v111, v111, v90
    v_cvt_pk_bf16_f32 v57, v110, v111
    v_lshlrev_b32 v110, 16, v57
    v_and_b32 v111, 0xffff0000, v57
    v_mul_f32 v110, v110, v91
    v_mul_f32 v111, v111, v91
    v_cvt_pk_bf16_f32 v57, v110, v111
    v_sub_f32 v112, v112, v90
    v_sub_f32 v113, v113, v90
    v_cvt_pk_bf16_f32 v58, v112, v113
    v_lshlrev_b32 v112, 16, v58
    v_and_b32 v113, 0xffff0000, v58
    v_mul_f32 v112, v112, v91
    v_mul_f32 v113, v113, v91
    v_cvt_pk_bf16_f32 v58, v112, v113
    v_sub_f32 v114, v114, v90
    v_sub_f32 v115, v115, v90
    v_cvt_pk_bf16_f32 v59, v114, v115
    v_lshlrev_b32 v114, 16, v59
    v_and_b32 v115, 0xffff0000, v59
    v_mul_f32 v114, v114, v91
    v_mul_f32 v115, v115, v91
    v_cvt_pk_bf16_f32 v59, v114, v115
    v_sub_f32 v116, v116, v90
    v_sub_f32 v117, v117, v90
    v_cvt_pk_bf16_f32 v60, v116, v117
    v_lshlrev_b32 v116, 16, v60
    v_and_b32 v117, 0xffff0000, v60
    v_mul_f32 v116, v116, v91
    v_mul_f32 v117, v117, v91
    v_cvt_pk_bf16_f32 v60, v116, v117
    v_sub_f32 v118, v118, v90
    v_sub_f32 v119, v119, v90
    v_cvt_pk_bf16_f32 v61, v118, v119
    v_lshlrev_b32 v118, 16, v61
    v_and_b32 v119, 0xffff0000, v61
    v_mul_f32 v118, v118, v91
    v_mul_f32 v119, v119, v91
    v_cvt_pk_bf16_f32 v61, v118, v119
    v_sub_f32 v120, v120, v90
    v_sub_f32 v121, v121, v90
    v_cvt_pk_bf16_f32 v62, v120, v121
    v_lshlrev_b32 v120, 16, v62
    v_and_b32 v121, 0xffff0000, v62
    v_mul_f32 v120, v120, v91
    v_mul_f32 v121, v121, v91
    v_cvt_pk_bf16_f32 v62, v120, v121
    v_sub_f32 v122, v122, v90
    v_sub_f32 v123, v123, v90
    v_cvt_pk_bf16_f32 v63, v122, v123
    v_lshlrev_b32 v122, 16, v63
    v_and_b32 v123, 0xffff0000, v63
    v_mul_f32 v122, v122, v91
    v_mul_f32 v123, v123, v91
    v_cvt_pk_bf16_f32 v63, v122, v123
    v_sub_f32 v124, v124, v90
    v_sub_f32 v125, v125, v90
    v_cvt_pk_bf16_f32 v64, v124, v125
    v_lshlrev_b32 v124, 16, v64
    v_and_b32 v125, 0xffff0000, v64
    v_mul_f32 v124, v124, v91
    v_mul_f32 v125, v125, v91
    v_cvt_pk_bf16_f32 v64, v124, v125
    v_sub_f32 v126, v126, v90
    v_sub_f32 v127, v127, v90
    v_cvt_pk_bf16_f32 v65, v126, v127
    v_lshlrev_b32 v126, 16, v65
    v_and_b32 v127, 0xffff0000, v65
    v_mul_f32 v126, v126, v91
    v_mul_f32 v127, v127, v91
    v_cvt_pk_bf16_f32 v65, v126, v127
    v_sub_f32 v128, v128, v90
    v_sub_f32 v129, v129, v90
    v_cvt_pk_bf16_f32 v66, v128, v129
    v_lshlrev_b32 v128, 16, v66
    v_and_b32 v129, 0xffff0000, v66
    v_mul_f32 v128, v128, v91
    v_mul_f32 v129, v129, v91
    v_cvt_pk_bf16_f32 v66, v128, v129
    v_sub_f32 v130, v130, v90
    v_sub_f32 v131, v131, v90
    v_cvt_pk_bf16_f32 v67, v130, v131
    v_lshlrev_b32 v130, 16, v67
    v_and_b32 v131, 0xffff0000, v67
    v_mul_f32 v130, v130, v91
    v_mul_f32 v131, v131, v91
    v_cvt_pk_bf16_f32 v67, v130, v131
    v_sub_f32 v132, v132, v90
    v_sub_f32 v133, v133, v90
    v_cvt_pk_bf16_f32 v68, v132, v133
    v_lshlrev_b32 v132, 16, v68
    v_and_b32 v133, 0xffff0000, v68
    v_mul_f32 v132, v132, v91
    v_mul_f32 v133, v133, v91
    v_cvt_pk_bf16_f32 v68, v132, v133
    v_sub_f32 v134, v134, v90
    v_sub_f32 v135, v135, v90
    v_cvt_pk_bf16_f32 v69, v134, v135
    v_lshlrev_b32 v134, 16, v69
    v_and_b32 v135, 0xffff0000, v69
    v_mul_f32 v134, v134, v91
    v_mul_f32 v135, v135, v91
    v_cvt_pk_bf16_f32 v69, v134, v135
    v_sub_f32 v136, v136, v90
    v_sub_f32 v137, v137, v90
    v_cvt_pk_bf16_f32 v70, v136, v137
    v_lshlrev_b32 v136, 16, v70
    v_and_b32 v137, 0xffff0000, v70
    v_mul_f32 v136, v136, v91
    v_mul_f32 v137, v137, v91
    v_cvt_pk_bf16_f32 v70, v136, v137
    v_sub_f32 v138, v138, v90
    v_sub_f32 v139, v139, v90
    v_cvt_pk_bf16_f32 v71, v138, v139
    v_lshlrev_b32 v138, 16, v71
    v_and_b32 v139, 0xffff0000, v71
    v_mul_f32 v138, v138, v91
    v_mul_f32 v139, v139, v91
    v_cvt_pk_bf16_f32 v71, v138, v139
    v_sub_f32 v140, v140, v90
    v_sub_f32 v141, v141, v90
    v_cvt_pk_bf16_f32 v72, v140, v141
    v_lshlrev_b32 v140, 16, v72
    v_and_b32 v141, 0xffff0000, v72
    v_mul_f32 v140, v140, v91
    v_mul_f32 v141, v141, v91
    v_cvt_pk_bf16_f32 v72, v140, v141
    v_sub_f32 v142, v142, v90
    v_sub_f32 v143, v143, v90
    v_cvt_pk_bf16_f32 v73, v142, v143
    v_lshlrev_b32 v142, 16, v73
    v_and_b32 v143, 0xffff0000, v73
    v_mul_f32 v142, v142, v91
    v_mul_f32 v143, v143, v91
    v_cvt_pk_bf16_f32 v73, v142, v143
    v_sub_f32 v144, v144, v90
    v_sub_f32 v145, v145, v90
    v_cvt_pk_bf16_f32 v74, v144, v145
    v_lshlrev_b32 v144, 16, v74
    v_and_b32 v145, 0xffff0000, v74
    v_mul_f32 v144, v144, v91
    v_mul_f32 v145, v145, v91
    v_cvt_pk_bf16_f32 v74, v144, v145
    v_sub_f32 v146, v146, v90
    v_sub_f32 v147, v147, v90
    v_cvt_pk_bf16_f32 v75, v146, v147
    v_lshlrev_b32 v146, 16, v75
    v_and_b32 v147, 0xffff0000, v75
    v_mul_f32 v146, v146, v91
    v_mul_f32 v147, v147, v91
    v_cvt_pk_bf16_f32 v75, v146, v147
    v_sub_f32 v148, v148, v90
    v_sub_f32 v149, v149, v90
    v_cvt_pk_bf16_f32 v76, v148, v149
    v_lshlrev_b32 v148, 16, v76
    v_and_b32 v149, 0xffff0000, v76
    v_mul_f32 v148, v148, v91
    v_mul_f32 v149, v149, v91
    v_cvt_pk_bf16_f32 v76, v148, v149
    v_sub_f32 v150, v150, v90
    v_sub_f32 v151, v151, v90
    v_cvt_pk_bf16_f32 v77, v150, v151
    v_lshlrev_b32 v150, 16, v77
    v_and_b32 v151, 0xffff0000, v77
    v_mul_f32 v150, v150, v91
    v_mul_f32 v151, v151, v91
    v_cvt_pk_bf16_f32 v77, v150, v151
    v_sub_f32 v152, v152, v90
    v_sub_f32 v153, v153, v90
    v_cvt_pk_bf16_f32 v78, v152, v153
    v_lshlrev_b32 v152, 16, v78
    v_and_b32 v153, 0xffff0000, v78
    v_mul_f32 v152, v152, v91
    v_mul_f32 v153, v153, v91
    v_cvt_pk_bf16_f32 v78, v152, v153
    v_sub_f32 v154, v154, v90
    v_sub_f32 v155, v155, v90
    v_cvt_pk_bf16_f32 v79, v154, v155
    v_lshlrev_b32 v154, 16, v79
    v_and_b32 v155, 0xffff0000, v79
    v_mul_f32 v154, v154, v91
    v_mul_f32 v155, v155, v91
    v_cvt_pk_bf16_f32 v79, v154, v155
    v_sub_f32 v156, v156, v90
    v_sub_f32 v157, v157, v90
    v_cvt_pk_bf16_f32 v80, v156, v157
    v_lshlrev_b32 v156, 16, v80
    v_and_b32 v157, 0xffff0000, v80
    v_mul_f32 v156, v156, v91
    v_mul_f32 v157, v157, v91
    v_cvt_pk_bf16_f32 v80, v156, v157
    v_sub_f32 v158, v158, v90
    v_sub_f32 v159, v159, v90
    v_cvt_pk_bf16_f32 v81, v158, v159
    v_lshlrev_b32 v158, 16, v81
    v_and_b32 v159, 0xffff0000, v81
    v_mul_f32 v158, v158, v91
    v_mul_f32 v159, v159, v91
    v_cvt_pk_bf16_f32 v81, v158, v159
    v_sub_f32 v160, v160, v90
    v_sub_f32 v161, v161, v90
    v_cvt_pk_bf16_f32 v82, v160, v161
    v_lshlrev_b32 v160, 16, v82
    v_and_b32 v161, 0xffff0000, v82
    v_mul_f32 v160, v160, v91
    v_mul_f32 v161, v161, v91
    v_cvt_pk_bf16_f32 v82, v160, v161
    v_sub_f32 v162, v162, v90
    v_sub_f32 v163, v163, v90
    v_cvt_pk_bf16_f32 v83, v162, v163
    v_lshlrev_b32 v162, 16, v83
    v_and_b32 v163, 0xffff0000, v83
    v_mul_f32 v162, v162, v91
    v_mul_f32 v163, v163, v91
    v_cvt_pk_bf16_f32 v83, v162, v163
    v_sub_f32 v164, v164, v90
    v_sub_f32 v165, v165, v90
    v_cvt_pk_bf16_f32 v84, v164, v165
    v_lshlrev_b32 v164, 16, v84
    v_and_b32 v165, 0xffff0000, v84
    v_mul_f32 v164, v164, v91
    v_mul_f32 v165, v165, v91
    v_cvt_pk_bf16_f32 v84, v164, v165
    v_sub_f32 v166, v166, v90
    v_sub_f32 v167, v167, v90
    v_cvt_pk_bf16_f32 v85, v166, v167
    v_lshlrev_b32 v166, 16, v85
    v_and_b32 v167, 0xffff0000, v85
    v_mul_f32 v166, v166, v91
    v_mul_f32 v167, v167, v91
    v_cvt_pk_bf16_f32 v85, v166, v167
    v_sub_f32 v168, v168, v90
    v_sub_f32 v169, v169, v90
    v_cvt_pk_bf16_f32 v86, v168, v169
    v_lshlrev_b32 v168, 16, v86
    v_and_b32 v169, 0xffff0000, v86
    v_mul_f32 v168, v168, v91
    v_mul_f32 v169, v169, v91
    v_cvt_pk_bf16_f32 v86, v168, v169
    v_sub_f32 v170, v170, v90
    v_sub_f32 v171, v171, v90
    v_cvt_pk_bf16_f32 v87, v170, v171
    v_lshlrev_b32 v170, 16, v87
    v_and_b32 v171, 0xffff0000, v87
    v_mul_f32 v170, v170, v91
    v_mul_f32 v171, v171, v91
    v_cvt_pk_bf16_f32 v87, v170, v171
    s_lshl_b32 s22, s3, 4
    s_add_u32 s22, s22, 8
    s_lshr_b32 s23, s22, 5
    s_mul_i32 s23, s23, 36864
    s_and_b32 s22, s22, 31
    v_lshrrev_b32 v7, 3, v1
    v_add_u32 v7, s22, v7
    v_lshlrev_b32 v7, 4, v7
    v_add_u32 v7, s23, v7
    v_and_b32 v6, 7, v1
    v_lshrrev_b32 v8, 1, v6
    v_lshl_add_u32 v7, v8, 10, v7
    v_and_b32 v8, 1, v6
    v_lshl_add_u32 v7, v8, 9, v7
    ds_write_b128 v7, v[52:55] offset:0
    ds_write_b128 v7, v[56:59] offset:4096
    ds_write_b128 v7, v[60:63] offset:8192
    ds_write_b128 v7, v[64:67] offset:12288
    ds_write_b128 v7, v[68:71] offset:16384
    ds_write_b128 v7, v[72:75] offset:20480
    ds_write_b128 v7, v[76:79] offset:24576
    ds_write_b128 v7, v[80:83] offset:28672
    ds_write_b128 v7, v[84:87] offset:32768
    s_waitcnt lgkmcnt(0)
    s_barrier
    v_mov_b32 v100, 0
    v_mov_b32 v101, 0
    v_mov_b32 v102, 0
    v_mov_b32 v103, 0
    v_mov_b32 v104, 0
    v_mov_b32 v105, 0
    v_mov_b32 v106, 0
    v_mov_b32 v107, 0
    v_mov_b32 v108, 0
    v_mov_b32 v109, 0
    v_mov_b32 v110, 0
    v_mov_b32 v111, 0
    v_mov_b32 v112, 0
    v_mov_b32 v113, 0
    v_mov_b32 v114, 0
    v_mov_b32 v115, 0
    v_mov_b32 v116, 0
    v_mov_b32 v117, 0
    v_mov_b32 v118, 0
    v_mov_b32 v119, 0
    v_mov_b32 v120, 0
    v_mov_b32 v121, 0
    v_mov_b32 v122, 0
    v_mov_b32 v123, 0
    v_mov_b32 v124, 0
    v_mov_b32 v125, 0
    v_mov_b32 v126, 0
    v_mov_b32 v127, 0
    v_mov_b32 v128, 0
    v_mov_b32 v129, 0
    v_mov_b32 v130, 0
    v_mov_b32 v131, 0
    v_mov_b32 v132, 0
    v_mov_b32 v133, 0
    v_mov_b32 v134, 0
    v_mov_b32 v135, 0
    v_mov_b32 v136, 0
    v_mov_b32 v137, 0
    v_mov_b32 v138, 0
    v_mov_b32 v139, 0
    v_mov_b32 v140, 0
    v_mov_b32 v141, 0
    v_mov_b32 v142, 0
    v_mov_b32 v143, 0
    v_mov_b32 v144, 0
    v_mov_b32 v145, 0
    v_mov_b32 v146, 0
    v_mov_b32 v147, 0
    v_mov_b32 v148, 0
    v_mov_b32 v149, 0
    v_mov_b32 v150, 0
    v_mov_b32 v151, 0
    v_mov_b32 v152, 0
    v_mov_b32 v153, 0
    v_mov_b32 v154, 0
    v_mov_b32 v155, 0
    v_mov_b32 v156, 0
    v_mov_b32 v157, 0
    v_mov_b32 v158, 0
    v_mov_b32 v159, 0
    v_mov_b32 v160, 0
    v_mov_b32 v161, 0
    v_mov_b32 v162, 0
    v_mov_b32 v163, 0
    v_mov_b32 v164, 0
    v_mov_b32 v165, 0
    v_mov_b32 v166, 0
    v_mov_b32 v167, 0
    v_mov_b32 v168, 0
    v_mov_b32 v169, 0
    v_mov_b32 v170, 0
    v_mov_b32 v171, 0
    v_mov_b32 v172, 0
    v_mov_b32 v173, 0
    v_mov_b32 v174, 0
    v_mov_b32 v175, 0
    v_mov_b32 v176, 0
    v_mov_b32 v177, 0
    v_mov_b32 v178, 0
    v_mov_b32 v179, 0
    v_mov_b32 v180, 0
    v_mov_b32 v181, 0
    v_mov_b32 v182, 0
    v_mov_b32 v183, 0
    v_mov_b32 v184, 0
    v_mov_b32 v185, 0
    v_mov_b32 v186, 0
    v_mov_b32 v187, 0
    v_mov_b32 v188, 0
    v_mov_b32 v189, 0
    v_mov_b32 v190, 0
    v_mov_b32 v191, 0
    v_mov_b32 v192, 0
    v_mov_b32 v193, 0
    v_mov_b32 v194, 0
    v_mov_b32 v195, 0
    v_add_u32 v5, 36864, v4
    buffer_load_dwordx4 v[16:19], v4, s[12:15], s19 offen
    buffer_load_dwordx4 v[20:23], v4, s[12:15], s20 offen
    buffer_load_dwordx4 v[24:27], v4, s[12:15], s21 offen
    s_add_u32 s19, s19, 1024
    s_add_u32 s20, s20, 1024
    s_add_u32 s21, s21, 1024
    buffer_load_dwordx4 v[28:31], v4, s[12:15], s19 offen
    buffer_load_dwordx4 v[32:35], v4, s[12:15], s20 offen
    buffer_load_dwordx4 v[36:39], v4, s[12:15], s21 offen
    s_add_u32 s19, s19, 1024
    s_add_u32 s20, s20, 1024
    s_add_u32 s21, s21, 1024
    buffer_load_dwordx4 v[40:43], v4, s[12:15], s19 offen
    buffer_load_dwordx4 v[44:47], v4, s[12:15], s20 offen
    buffer_load_dwordx4 v[48:51], v4, s[12:15], s21 offen
    s_add_u32 s19, s19, 1024
    s_add_u32 s20, s20, 1024
    s_add_u32 s21, s21, 1024
    ds_read_b128 v[64:67], v4 offset:0
    ds_read_b128 v[68:71], v5 offset:0
    buffer_load_dwordx4 v[52:55], v4, s[12:15], s19 offen
    buffer_load_dwordx4 v[56:59], v4, s[12:15], s20 offen
    buffer_load_dwordx4 v[60:63], v4, s[12:15], s21 offen
    s_add_u32 s19, s19, 1024
    s_add_u32 s20, s20, 1024
    s_add_u32 s21, s21, 1024
    ds_read_b128 v[72:75], v4 offset:1024
    ds_read_b128 v[76:79], v5 offset:1024
    s_waitcnt vmcnt(9) lgkmcnt(2)
    v_mfma_f32_32x32x16_bf16 v[100:115], v[16:19], v[64:67], v[100:115]
    v_mfma_f32_32x32x16_bf16 v[132:147], v[20:23], v[64:67], v[132:147]
    v_mfma_f32_32x32x16_bf16 v[164:179], v[64:67], v[24:27], v[164:179]
    v_mfma_f32_32x32x16_bf16 v[116:131], v[16:19], v[68:71], v[116:131]
    v_mfma_f32_32x32x16_bf16 v[148:163], v[20:23], v[68:71], v[148:163]
    v_mfma_f32_32x32x16_bf16 v[180:195], v[68:71], v[24:27], v[180:195]
    buffer_load_dwordx4 v[16:19], v4, s[12:15], s19 offen
    buffer_load_dwordx4 v[20:23], v4, s[12:15], s20 offen
    buffer_load_dwordx4 v[24:27], v4, s[12:15], s21 offen
    s_add_u32 s19, s19, 1024
    s_add_u32 s20, s20, 1024
    s_add_u32 s21, s21, 1024
    ds_read_b128 v[80:83], v4 offset:2048
    ds_read_b128 v[84:87], v5 offset:2048
    s_waitcnt vmcnt(9) lgkmcnt(2)
    v_mfma_f32_32x32x16_bf16 v[100:115], v[28:31], v[72:75], v[100:115]
    v_mfma_f32_32x32x16_bf16 v[132:147], v[32:35], v[72:75], v[132:147]
    v_mfma_f32_32x32x16_bf16 v[164:179], v[72:75], v[36:39], v[164:179]
    v_mfma_f32_32x32x16_bf16 v[116:131], v[28:31], v[76:79], v[116:131]
    v_mfma_f32_32x32x16_bf16 v[148:163], v[32:35], v[76:79], v[148:163]
    v_mfma_f32_32x32x16_bf16 v[180:195], v[76:79], v[36:39], v[180:195]
    buffer_load_dwordx4 v[28:31], v4, s[12:15], s19 offen
    buffer_load_dwordx4 v[32:35], v4, s[12:15], s20 offen
    buffer_load_dwordx4 v[36:39], v4, s[12:15], s21 offen
    s_add_u32 s19, s19, 1024
    s_add_u32 s20, s20, 1024
    s_add_u32 s21, s21, 1024
    ds_read_b128 v[64:67], v4 offset:3072
    ds_read_b128 v[68:71], v5 offset:3072
    s_waitcnt vmcnt(9) lgkmcnt(2)
    v_mfma_f32_32x32x16_bf16 v[100:115], v[40:43], v[80:83], v[100:115]
    v_mfma_f32_32x32x16_bf16 v[132:147], v[44:47], v[80:83], v[132:147]
    v_mfma_f32_32x32x16_bf16 v[164:179], v[80:83], v[48:51], v[164:179]
    v_mfma_f32_32x32x16_bf16 v[116:131], v[40:43], v[84:87], v[116:131]
    v_mfma_f32_32x32x16_bf16 v[148:163], v[44:47], v[84:87], v[148:163]
    v_mfma_f32_32x32x16_bf16 v[180:195], v[84:87], v[48:51], v[180:195]
    buffer_load_dwordx4 v[40:43], v4, s[12:15], s19 offen
    buffer_load_dwordx4 v[44:47], v4, s[12:15], s20 offen
    buffer_load_dwordx4 v[48:51], v4, s[12:15], s21 offen
    s_add_u32 s19, s19, 1024
    s_add_u32 s20, s20, 1024
    s_add_u32 s21, s21, 1024
    ds_read_b128 v[72:75], v4 offset:4096
    ds_read_b128 v[76:79], v5 offset:4096
    s_waitcnt vmcnt(9) lgkmcnt(2)
    v_mfma_f32_32x32x16_bf16 v[100:115], v[52:55], v[64:67], v[100:115]
    v_mfma_f32_32x32x16_bf16 v[132:147], v[56:59], v[64:67], v[132:147]
    v_mfma_f32_32x32x16_bf16 v[164:179], v[64:67], v[60:63], v[164:179]
    v_mfma_f32_32x32x16_bf16 v[116:131], v[52:55], v[68:71], v[116:131]
    v_mfma_f32_32x32x16_bf16 v[148:163], v[56:59], v[68:71], v[148:163]
    v_mfma_f32_32x32x16_bf16 v[180:195], v[68:71], v[60:63], v[180:195]
    buffer_load_dwordx4 v[52:55], v4, s[12:15], s19 offen
    buffer_load_dwordx4 v[56:59], v4, s[12:15], s20 offen
    buffer_load_dwordx4 v[60:63], v4, s[12:15], s21 offen
    s_add_u32 s19, s19, 1024
    s_add_u32 s20, s20, 1024
    s_add_u32 s21, s21, 1024
    ds_read_b128 v[80:83], v4 offset:5120
    ds_read_b128 v[84:87], v5 offset:5120
    s_waitcnt vmcnt(9) lgkmcnt(2)
    v_mfma_f32_32x32x16_bf16 v[100:115], v[16:19], v[72:75], v[100:115]
    v_mfma_f32_32x32x16_bf16 v[132:147], v[20:23], v[72:75], v[132:147]
    v_mfma_f32_32x32x16_bf16 v[164:179], v[72:75], v[24:27], v[164:179]
    v_mfma_f32_32x32x16_bf16 v[116:131], v[16:19], v[76:79], v[116:131]
    v_mfma_f32_32x32x16_bf16 v[148:163], v[20:23], v[76:79], v[148:163]
    v_mfma_f32_32x32x16_bf16 v[180:195], v[76:79], v[24:27], v[180:195]
    buffer_load_dwordx4 v[16:19], v4, s[12:15], s19 offen
    buffer_load_dwordx4 v[20:23], v4, s[12:15], s20 offen
    buffer_load_dwordx4 v[24:27], v4, s[12:15], s21 offen
    s_add_u32 s19, s19, 1024
    s_add_u32 s20, s20, 1024
    s_add_u32 s21, s21, 1024
    ds_read_b128 v[64:67], v4 offset:6144
    ds_read_b128 v[68:71], v5 offset:6144
    s_waitcnt vmcnt(9) lgkmcnt(2)
    v_mfma_f32_32x32x16_bf16 v[100:115], v[28:31], v[80:83], v[100:115]
    v_mfma_f32_32x32x16_bf16 v[132:147], v[32:35], v[80:83], v[132:147]
    v_mfma_f32_32x32x16_bf16 v[164:179], v[80:83], v[36:39], v[164:179]
    v_mfma_f32_32x32x16_bf16 v[116:131], v[28:31], v[84:87], v[116:131]
    v_mfma_f32_32x32x16_bf16 v[148:163], v[32:35], v[84:87], v[148:163]
    v_mfma_f32_32x32x16_bf16 v[180:195], v[84:87], v[36:39], v[180:195]
    buffer_load_dwordx4 v[28:31], v4, s[12:15], s19 offen
    buffer_load_dwordx4 v[32:35], v4, s[12:15], s20 offen
    buffer_load_dwordx4 v[36:39], v4, s[12:15], s21 offen
    s_add_u32 s19, s19, 1024
    s_add_u32 s20, s20, 1024
    s_add_u32 s21, s21, 1024
    ds_read_b128 v[72:75], v4 offset:7168
    ds_read_b128 v[76:79], v5 offset:7168
    s_waitcnt vmcnt(9) lgkmcnt(2)
    v_mfma_f32_32x32x16_bf16 v[100:115], v[40:43], v[64:67], v[100:115]
    v_mfma_f32_32x32x16_bf16 v[132:147], v[44:47], v[64:67], v[132:147]
    v_mfma_f32_32x32x16_bf16 v[164:179], v[64:67], v[48:51], v[164:179]
    v_mfma_f32_32x32x16_bf16 v[116:131], v[40:43], v[68:71], v[116:131]
    v_mfma_f32_32x32x16_bf16 v[148:163], v[44:47], v[68:71], v[148:163]
    v_mfma_f32_32x32x16_bf16 v[180:195], v[68:71], v[48:51], v[180:195]
    buffer_load_dwordx4 v[40:43], v4, s[12:15], s19 offen
    buffer_load_dwordx4 v[44:47], v4, s[12:15], s20 offen
    buffer_load_dwordx4 v[48:51], v4, s[12:15], s21 offen
    s_add_u32 s19, s19, 1024
    s_add_u32 s20, s20, 1024
    s_add_u32 s21, s21, 1024
    ds_read_b128 v[80:83], v4 offset:8192
    ds_read_b128 v[84:87], v5 offset:8192
    s_waitcnt vmcnt(9) lgkmcnt(2)
    v_mfma_f32_32x32x16_bf16 v[100:115], v[52:55], v[72:75], v[100:115]
    v_mfma_f32_32x32x16_bf16 v[132:147], v[56:59], v[72:75], v[132:147]
    v_mfma_f32_32x32x16_bf16 v[164:179], v[72:75], v[60:63], v[164:179]
    v_mfma_f32_32x32x16_bf16 v[116:131], v[52:55], v[76:79], v[116:131]
    v_mfma_f32_32x32x16_bf16 v[148:163], v[56:59], v[76:79], v[148:163]
    v_mfma_f32_32x32x16_bf16 v[180:195], v[76:79], v[60:63], v[180:195]
    buffer_load_dwordx4 v[52:55], v4, s[12:15], s19 offen
    buffer_load_dwordx4 v[56:59], v4, s[12:15], s20 offen
    buffer_load_dwordx4 v[60:63], v4, s[12:15], s21 offen
    s_add_u32 s19, s19, 1024
    s_add_u32 s20, s20, 1024
    s_add_u32 s21, s21, 1024
    ds_read_b128 v[64:67], v4 offset:9216
    ds_read_b128 v[68:71], v5 offset:9216
    s_waitcnt vmcnt(9) lgkmcnt(2)
    v_mfma_f32_32x32x16_bf16 v[100:115], v[16:19], v[80:83], v[100:115]
    v_mfma_f32_32x32x16_bf16 v[132:147], v[20:23], v[80:83], v[132:147]
    v_mfma_f32_32x32x16_bf16 v[164:179], v[80:83], v[24:27], v[164:179]
    v_mfma_f32_32x32x16_bf16 v[116:131], v[16:19], v[84:87], v[116:131]
    v_mfma_f32_32x32x16_bf16 v[148:163], v[20:23], v[84:87], v[148:163]
    v_mfma_f32_32x32x16_bf16 v[180:195], v[84:87], v[24:27], v[180:195]
    buffer_load_dwordx4 v[16:19], v4, s[12:15], s19 offen
    buffer_load_dwordx4 v[20:23], v4, s[12:15], s20 offen
    buffer_load_dwordx4 v[24:27], v4, s[12:15], s21 offen
    s_add_u32 s19, s19, 1024
    s_add_u32 s20, s20, 1024
    s_add_u32 s21, s21, 1024
    ds_read_b128 v[72:75], v4 offset:10240
    ds_read_b128 v[76:79], v5 offset:10240
    s_waitcnt vmcnt(9) lgkmcnt(2)
    v_mfma_f32_32x32x16_bf16 v[100:115], v[28:31], v[64:67], v[100:115]
    v_mfma_f32_32x32x16_bf16 v[132:147], v[32:35], v[64:67], v[132:147]
    v_mfma_f32_32x32x16_bf16 v[164:179], v[64:67], v[36:39], v[164:179]
    v_mfma_f32_32x32x16_bf16 v[116:131], v[28:31], v[68:71], v[116:131]
    v_mfma_f32_32x32x16_bf16 v[148:163], v[32:35], v[68:71], v[148:163]
    v_mfma_f32_32x32x16_bf16 v[180:195], v[68:71], v[36:39], v[180:195]
    buffer_load_dwordx4 v[28:31], v4, s[12:15], s19 offen
    buffer_load_dwordx4 v[32:35], v4, s[12:15], s20 offen
    buffer_load_dwordx4 v[36:39], v4, s[12:15], s21 offen
    s_add_u32 s19, s19, 1024
    s_add_u32 s20, s20, 1024
    s_add_u32 s21, s21, 1024
    ds_read_b128 v[80:83], v4 offset:11264
    ds_read_b128 v[84:87], v5 offset:11264
    s_waitcnt vmcnt(9) lgkmcnt(2)
    v_mfma_f32_32x32x16_bf16 v[100:115], v[40:43], v[72:75], v[100:115]
    v_mfma_f32_32x32x16_bf16 v[132:147], v[44:47], v[72:75], v[132:147]
    v_mfma_f32_32x32x16_bf16 v[164:179], v[72:75], v[48:51], v[164:179]
    v_mfma_f32_32x32x16_bf16 v[116:131], v[40:43], v[76:79], v[116:131]
    v_mfma_f32_32x32x16_bf16 v[148:163], v[44:47], v[76:79], v[148:163]
    v_mfma_f32_32x32x16_bf16 v[180:195], v[76:79], v[48:51], v[180:195]
    buffer_load_dwordx4 v[40:43], v4, s[12:15], s19 offen
    buffer_load_dwordx4 v[44:47], v4, s[12:15], s20 offen
    buffer_load_dwordx4 v[48:51], v4, s[12:15], s21 offen
    s_add_u32 s19, s19, 1024
    s_add_u32 s20, s20, 1024
    s_add_u32 s21, s21, 1024
    ds_read_b128 v[64:67], v4 offset:12288
    ds_read_b128 v[68:71], v5 offset:12288
    s_waitcnt vmcnt(9) lgkmcnt(2)
    v_mfma_f32_32x32x16_bf16 v[100:115], v[52:55], v[80:83], v[100:115]
    v_mfma_f32_32x32x16_bf16 v[132:147], v[56:59], v[80:83], v[132:147]
    v_mfma_f32_32x32x16_bf16 v[164:179], v[80:83], v[60:63], v[164:179]
    v_mfma_f32_32x32x16_bf16 v[116:131], v[52:55], v[84:87], v[116:131]
    v_mfma_f32_32x32x16_bf16 v[148:163], v[56:59], v[84:87], v[148:163]
    v_mfma_f32_32x32x16_bf16 v[180:195], v[84:87], v[60:63], v[180:195]
    buffer_load_dwordx4 v[52:55], v4, s[12:15], s19 offen
    buffer_load_dwordx4 v[56:59], v4, s[12:15], s20 offen
    buffer_load_dwordx4 v[60:63], v4, s[12:15], s21 offen
    s_add_u32 s19, s19, 1024
    s_add_u32 s20, s20, 1024
    s_add_u32 s21, s21, 1024
    ds_read_b128 v[72:75], v4 offset:13312
    ds_read_b128 v[76:79], v5 offset:13312
    s_waitcnt vmcnt(9) lgkmcnt(2)
    v_mfma_f32_32x32x16_bf16 v[100:115], v[16:19], v[64:67], v[100:115]
    v_mfma_f32_32x32x16_bf16 v[132:147], v[20:23], v[64:67], v[132:147]
    v_mfma_f32_32x32x16_bf16 v[164:179], v[64:67], v[24:27], v[164:179]
    v_mfma_f32_32x32x16_bf16 v[116:131], v[16:19], v[68:71], v[116:131]
    v_mfma_f32_32x32x16_bf16 v[148:163], v[20:23], v[68:71], v[148:163]
    v_mfma_f32_32x32x16_bf16 v[180:195], v[68:71], v[24:27], v[180:195]
    buffer_load_dwordx4 v[16:19], v4, s[12:15], s19 offen
    buffer_load_dwordx4 v[20:23], v4, s[12:15], s20 offen
    buffer_load_dwordx4 v[24:27], v4, s[12:15], s21 offen
    s_add_u32 s19, s19, 1024
    s_add_u32 s20, s20, 1024
    s_add_u32 s21, s21, 1024
    ds_read_b128 v[80:83], v4 offset:14336
    ds_read_b128 v[84:87], v5 offset:14336
    s_waitcnt vmcnt(9) lgkmcnt(2)
    v_mfma_f32_32x32x16_bf16 v[100:115], v[28:31], v[72:75], v[100:115]
    v_mfma_f32_32x32x16_bf16 v[132:147], v[32:35], v[72:75], v[132:147]
    v_mfma_f32_32x32x16_bf16 v[164:179], v[72:75], v[36:39], v[164:179]
    v_mfma_f32_32x32x16_bf16 v[116:131], v[28:31], v[76:79], v[116:131]
    v_mfma_f32_32x32x16_bf16 v[148:163], v[32:35], v[76:79], v[148:163]
    v_mfma_f32_32x32x16_bf16 v[180:195], v[76:79], v[36:39], v[180:195]
    buffer_load_dwordx4 v[28:31], v4, s[12:15], s19 offen
    buffer_load_dwordx4 v[32:35], v4, s[12:15], s20 offen
    buffer_load_dwordx4 v[36:39], v4, s[12:15], s21 offen
    s_add_u32 s19, s19, 1024
    s_add_u32 s20, s20, 1024
    s_add_u32 s21, s21, 1024
    ds_read_b128 v[64:67], v4 offset:15360
    ds_read_b128 v[68:71], v5 offset:15360
    s_waitcnt vmcnt(9) lgkmcnt(2)
    v_mfma_f32_32x32x16_bf16 v[100:115], v[40:43], v[80:83], v[100:115]
    v_mfma_f32_32x32x16_bf16 v[132:147], v[44:47], v[80:83], v[132:147]
    v_mfma_f32_32x32x16_bf16 v[164:179], v[80:83], v[48:51], v[164:179]
    v_mfma_f32_32x32x16_bf16 v[116:131], v[40:43], v[84:87], v[116:131]
    v_mfma_f32_32x32x16_bf16 v[148:163], v[44:47], v[84:87], v[148:163]
    v_mfma_f32_32x32x16_bf16 v[180:195], v[84:87], v[48:51], v[180:195]
    buffer_load_dwordx4 v[40:43], v4, s[12:15], s19 offen
    buffer_load_dwordx4 v[44:47], v4, s[12:15], s20 offen
    buffer_load_dwordx4 v[48:51], v4, s[12:15], s21 offen
    s_add_u32 s19, s19, 1024
    s_add_u32 s20, s20, 1024
    s_add_u32 s21, s21, 1024
    ds_read_b128 v[72:75], v4 offset:16384
    ds_read_b128 v[76:79], v5 offset:16384
    s_waitcnt vmcnt(9) lgkmcnt(2)
    v_mfma_f32_32x32x16_bf16 v[100:115], v[52:55], v[64:67], v[100:115]
    v_mfma_f32_32x32x16_bf16 v[132:147], v[56:59], v[64:67], v[132:147]
    v_mfma_f32_32x32x16_bf16 v[164:179], v[64:67], v[60:63], v[164:179]
    v_mfma_f32_32x32x16_bf16 v[116:131], v[52:55], v[68:71], v[116:131]
    v_mfma_f32_32x32x16_bf16 v[148:163], v[56:59], v[68:71], v[148:163]
    v_mfma_f32_32x32x16_bf16 v[180:195], v[68:71], v[60:63], v[180:195]
    buffer_load_dwordx4 v[52:55], v4, s[12:15], s19 offen
    buffer_load_dwordx4 v[56:59], v4, s[12:15], s20 offen
    buffer_load_dwordx4 v[60:63], v4, s[12:15], s21 offen
    s_add_u32 s19, s19, 1024
    s_add_u32 s20, s20, 1024
    s_add_u32 s21, s21, 1024
    ds_read_b128 v[80:83], v4 offset:17408
    ds_read_b128 v[84:87], v5 offset:17408
    s_waitcnt vmcnt(9) lgkmcnt(2)
    v_mfma_f32_32x32x16_bf16 v[100:115], v[16:19], v[72:75], v[100:115]
    v_mfma_f32_32x32x16_bf16 v[132:147], v[20:23], v[72:75], v[132:147]
    v_mfma_f32_32x32x16_bf16 v[164:179], v[72:75], v[24:27], v[164:179]
    v_mfma_f32_32x32x16_bf16 v[116:131], v[16:19], v[76:79], v[116:131]
    v_mfma_f32_32x32x16_bf16 v[148:163], v[20:23], v[76:79], v[148:163]
    v_mfma_f32_32x32x16_bf16 v[180:195], v[76:79], v[24:27], v[180:195]
    buffer_load_dwordx4 v[16:19], v4, s[12:15], s19 offen
    buffer_load_dwordx4 v[20:23], v4, s[12:15], s20 offen
    buffer_load_dwordx4 v[24:27], v4, s[12:15], s21 offen
    s_add_u32 s19, s19, 1024
    s_add_u32 s20, s20, 1024
    s_add_u32 s21, s21, 1024
    ds_read_b128 v[64:67], v4 offset:18432
    ds_read_b128 v[68:71], v5 offset:18432
    s_waitcnt vmcnt(9) lgkmcnt(2)
    v_mfma_f32_32x32x16_bf16 v[100:115], v[28:31], v[80:83], v[100:115]
    v_mfma_f32_32x32x16_bf16 v[132:147], v[32:35], v[80:83], v[132:147]
    v_mfma_f32_32x32x16_bf16 v[164:179], v[80:83], v[36:39], v[164:179]
    v_mfma_f32_32x32x16_bf16 v[116:131], v[28:31], v[84:87], v[116:131]
    v_mfma_f32_32x32x16_bf16 v[148:163], v[32:35], v[84:87], v[148:163]
    v_mfma_f32_32x32x16_bf16 v[180:195], v[84:87], v[36:39], v[180:195]
    buffer_load_dwordx4 v[28:31], v4, s[12:15], s19 offen
    buffer_load_dwordx4 v[32:35], v4, s[12:15], s20 offen
    buffer_load_dwordx4 v[36:39], v4, s[12:15], s21 offen
    s_add_u32 s19, s19, 1024
    s_add_u32 s20, s20, 1024
    s_add_u32 s21, s21, 1024
    ds_read_b128 v[72:75], v4 offset:19456
    ds_read_b128 v[76:79], v5 offset:19456
    s_waitcnt vmcnt(9) lgkmcnt(2)
    v_mfma_f32_32x32x16_bf16 v[100:115], v[40:43], v[64:67], v[100:115]
    v_mfma_f32_32x32x16_bf16 v[132:147], v[44:47], v[64:67], v[132:147]
    v_mfma_f32_32x32x16_bf16 v[164:179], v[64:67], v[48:51], v[164:179]
    v_mfma_f32_32x32x16_bf16 v[116:131], v[40:43], v[68:71], v[116:131]
    v_mfma_f32_32x32x16_bf16 v[148:163], v[44:47], v[68:71], v[148:163]
    v_mfma_f32_32x32x16_bf16 v[180:195], v[68:71], v[48:51], v[180:195]
    buffer_load_dwordx4 v[40:43], v4, s[12:15], s19 offen
    buffer_load_dwordx4 v[44:47], v4, s[12:15], s20 offen
    buffer_load_dwordx4 v[48:51], v4, s[12:15], s21 offen
    s_add_u32 s19, s19, 1024
    s_add_u32 s20, s20, 1024
    s_add_u32 s21, s21, 1024
    ds_read_b128 v[80:83], v4 offset:20480
    ds_read_b128 v[84:87], v5 offset:20480
    s_waitcnt vmcnt(9) lgkmcnt(2)
    v_mfma_f32_32x32x16_bf16 v[100:115], v[52:55], v[72:75], v[100:115]
    v_mfma_f32_32x32x16_bf16 v[132:147], v[56:59], v[72:75], v[132:147]
    v_mfma_f32_32x32x16_bf16 v[164:179], v[72:75], v[60:63], v[164:179]
    v_mfma_f32_32x32x16_bf16 v[116:131], v[52:55], v[76:79], v[116:131]
    v_mfma_f32_32x32x16_bf16 v[148:163], v[56:59], v[76:79], v[148:163]
    v_mfma_f32_32x32x16_bf16 v[180:195], v[76:79], v[60:63], v[180:195]
    buffer_load_dwordx4 v[52:55], v4, s[12:15], s19 offen
    buffer_load_dwordx4 v[56:59], v4, s[12:15], s20 offen
    buffer_load_dwordx4 v[60:63], v4, s[12:15], s21 offen
    s_add_u32 s19, s19, 1024
    s_add_u32 s20, s20, 1024
    s_add_u32 s21, s21, 1024
    ds_read_b128 v[64:67], v4 offset:21504
    ds_read_b128 v[68:71], v5 offset:21504
    s_waitcnt vmcnt(9) lgkmcnt(2)
    v_mfma_f32_32x32x16_bf16 v[100:115], v[16:19], v[80:83], v[100:115]
    v_mfma_f32_32x32x16_bf16 v[132:147], v[20:23], v[80:83], v[132:147]
    v_mfma_f32_32x32x16_bf16 v[164:179], v[80:83], v[24:27], v[164:179]
    v_mfma_f32_32x32x16_bf16 v[116:131], v[16:19], v[84:87], v[116:131]
    v_mfma_f32_32x32x16_bf16 v[148:163], v[20:23], v[84:87], v[148:163]
    v_mfma_f32_32x32x16_bf16 v[180:195], v[84:87], v[24:27], v[180:195]
    buffer_load_dwordx4 v[16:19], v4, s[12:15], s19 offen
    buffer_load_dwordx4 v[20:23], v4, s[12:15], s20 offen
    buffer_load_dwordx4 v[24:27], v4, s[12:15], s21 offen
    s_add_u32 s19, s19, 1024
    s_add_u32 s20, s20, 1024
    s_add_u32 s21, s21, 1024
    ds_read_b128 v[72:75], v4 offset:22528
    ds_read_b128 v[76:79], v5 offset:22528
    s_waitcnt vmcnt(9) lgkmcnt(2)
    v_mfma_f32_32x32x16_bf16 v[100:115], v[28:31], v[64:67], v[100:115]
    v_mfma_f32_32x32x16_bf16 v[132:147], v[32:35], v[64:67], v[132:147]
    v_mfma_f32_32x32x16_bf16 v[164:179], v[64:67], v[36:39], v[164:179]
    v_mfma_f32_32x32x16_bf16 v[116:131], v[28:31], v[68:71], v[116:131]
    v_mfma_f32_32x32x16_bf16 v[148:163], v[32:35], v[68:71], v[148:163]
    v_mfma_f32_32x32x16_bf16 v[180:195], v[68:71], v[36:39], v[180:195]
    buffer_load_dwordx4 v[28:31], v4, s[12:15], s19 offen
    buffer_load_dwordx4 v[32:35], v4, s[12:15], s20 offen
    buffer_load_dwordx4 v[36:39], v4, s[12:15], s21 offen
    s_add_u32 s19, s19, 1024
    s_add_u32 s20, s20, 1024
    s_add_u32 s21, s21, 1024
    ds_read_b128 v[80:83], v4 offset:23552
    ds_read_b128 v[84:87], v5 offset:23552
    s_waitcnt vmcnt(9) lgkmcnt(2)
    v_mfma_f32_32x32x16_bf16 v[100:115], v[40:43], v[72:75], v[100:115]
    v_mfma_f32_32x32x16_bf16 v[132:147], v[44:47], v[72:75], v[132:147]
    v_mfma_f32_32x32x16_bf16 v[164:179], v[72:75], v[48:51], v[164:179]
    v_mfma_f32_32x32x16_bf16 v[116:131], v[40:43], v[76:79], v[116:131]
    v_mfma_f32_32x32x16_bf16 v[148:163], v[44:47], v[76:79], v[148:163]
    v_mfma_f32_32x32x16_bf16 v[180:195], v[76:79], v[48:51], v[180:195]
    buffer_load_dwordx4 v[40:43], v4, s[12:15], s19 offen
    buffer_load_dwordx4 v[44:47], v4, s[12:15], s20 offen
    buffer_load_dwordx4 v[48:51], v4, s[12:15], s21 offen
    s_add_u32 s19, s19, 1024
    s_add_u32 s20, s20, 1024
    s_add_u32 s21, s21, 1024
    ds_read_b128 v[64:67], v4 offset:24576
    ds_read_b128 v[68:71], v5 offset:24576
    s_waitcnt vmcnt(9) lgkmcnt(2)
    v_mfma_f32_32x32x16_bf16 v[100:115], v[52:55], v[80:83], v[100:115]
    v_mfma_f32_32x32x16_bf16 v[132:147], v[56:59], v[80:83], v[132:147]
    v_mfma_f32_32x32x16_bf16 v[164:179], v[80:83], v[60:63], v[164:179]
    v_mfma_f32_32x32x16_bf16 v[116:131], v[52:55], v[84:87], v[116:131]
    v_mfma_f32_32x32x16_bf16 v[148:163], v[56:59], v[84:87], v[148:163]
    v_mfma_f32_32x32x16_bf16 v[180:195], v[84:87], v[60:63], v[180:195]
    buffer_load_dwordx4 v[52:55], v4, s[12:15], s19 offen
    buffer_load_dwordx4 v[56:59], v4, s[12:15], s20 offen
    buffer_load_dwordx4 v[60:63], v4, s[12:15], s21 offen
    s_add_u32 s19, s19, 1024
    s_add_u32 s20, s20, 1024
    s_add_u32 s21, s21, 1024
    ds_read_b128 v[72:75], v4 offset:25600
    ds_read_b128 v[76:79], v5 offset:25600
    s_waitcnt vmcnt(9) lgkmcnt(2)
    v_mfma_f32_32x32x16_bf16 v[100:115], v[16:19], v[64:67], v[100:115]
    v_mfma_f32_32x32x16_bf16 v[132:147], v[20:23], v[64:67], v[132:147]
    v_mfma_f32_32x32x16_bf16 v[164:179], v[64:67], v[24:27], v[164:179]
    v_mfma_f32_32x32x16_bf16 v[116:131], v[16:19], v[68:71], v[116:131]
    v_mfma_f32_32x32x16_bf16 v[148:163], v[20:23], v[68:71], v[148:163]
    v_mfma_f32_32x32x16_bf16 v[180:195], v[68:71], v[24:27], v[180:195]
    buffer_load_dwordx4 v[16:19], v4, s[12:15], s19 offen
    buffer_load_dwordx4 v[20:23], v4, s[12:15], s20 offen
    buffer_load_dwordx4 v[24:27], v4, s[12:15], s21 offen
    s_add_u32 s19, s19, 1024
    s_add_u32 s20, s20, 1024
    s_add_u32 s21, s21, 1024
    ds_read_b128 v[80:83], v4 offset:26624
    ds_read_b128 v[84:87], v5 offset:26624
    s_waitcnt vmcnt(9) lgkmcnt(2)
    v_mfma_f32_32x32x16_bf16 v[100:115], v[28:31], v[72:75], v[100:115]
    v_mfma_f32_32x32x16_bf16 v[132:147], v[32:35], v[72:75], v[132:147]
    v_mfma_f32_32x32x16_bf16 v[164:179], v[72:75], v[36:39], v[164:179]
    v_mfma_f32_32x32x16_bf16 v[116:131], v[28:31], v[76:79], v[116:131]
    v_mfma_f32_32x32x16_bf16 v[148:163], v[32:35], v[76:79], v[148:163]
    v_mfma_f32_32x32x16_bf16 v[180:195], v[76:79], v[36:39], v[180:195]
    buffer_load_dwordx4 v[28:31], v4, s[12:15], s19 offen
    buffer_load_dwordx4 v[32:35], v4, s[12:15], s20 offen
    buffer_load_dwordx4 v[36:39], v4, s[12:15], s21 offen
    s_add_u32 s19, s19, 1024
    s_add_u32 s20, s20, 1024
    s_add_u32 s21, s21, 1024
    ds_read_b128 v[64:67], v4 offset:27648
    ds_read_b128 v[68:71], v5 offset:27648
    s_waitcnt vmcnt(9) lgkmcnt(2)
    v_mfma_f32_32x32x16_bf16 v[100:115], v[40:43], v[80:83], v[100:115]
    v_mfma_f32_32x32x16_bf16 v[132:147], v[44:47], v[80:83], v[132:147]
    v_mfma_f32_32x32x16_bf16 v[164:179], v[80:83], v[48:51], v[164:179]
    v_mfma_f32_32x32x16_bf16 v[116:131], v[40:43], v[84:87], v[116:131]
    v_mfma_f32_32x32x16_bf16 v[148:163], v[44:47], v[84:87], v[148:163]
    v_mfma_f32_32x32x16_bf16 v[180:195], v[84:87], v[48:51], v[180:195]
    buffer_load_dwordx4 v[40:43], v4, s[12:15], s19 offen
    buffer_load_dwordx4 v[44:47], v4, s[12:15], s20 offen
    buffer_load_dwordx4 v[48:51], v4, s[12:15], s21 offen
    s_add_u32 s19, s19, 1024
    s_add_u32 s20, s20, 1024
    s_add_u32 s21, s21, 1024
    ds_read_b128 v[72:75], v4 offset:28672
    ds_read_b128 v[76:79], v5 offset:28672
    s_waitcnt vmcnt(9) lgkmcnt(2)
    v_mfma_f32_32x32x16_bf16 v[100:115], v[52:55], v[64:67], v[100:115]
    v_mfma_f32_32x32x16_bf16 v[132:147], v[56:59], v[64:67], v[132:147]
    v_mfma_f32_32x32x16_bf16 v[164:179], v[64:67], v[60:63], v[164:179]
    v_mfma_f32_32x32x16_bf16 v[116:131], v[52:55], v[68:71], v[116:131]
    v_mfma_f32_32x32x16_bf16 v[148:163], v[56:59], v[68:71], v[148:163]
    v_mfma_f32_32x32x16_bf16 v[180:195], v[68:71], v[60:63], v[180:195]
    buffer_load_dwordx4 v[52:55], v4, s[12:15], s19 offen
    buffer_load_dwordx4 v[56:59], v4, s[12:15], s20 offen
    buffer_load_dwordx4 v[60:63], v4, s[12:15], s21 offen
    s_add_u32 s19, s19, 1024
    s_add_u32 s20, s20, 1024
    s_add_u32 s21, s21, 1024
    ds_read_b128 v[80:83], v4 offset:29696
    ds_read_b128 v[84:87], v5 offset:29696
    s_waitcnt vmcnt(9) lgkmcnt(2)
    v_mfma_f32_32x32x16_bf16 v[100:115], v[16:19], v[72:75], v[100:115]
    v_mfma_f32_32x32x16_bf16 v[132:147], v[20:23], v[72:75], v[132:147]
    v_mfma_f32_32x32x16_bf16 v[164:179], v[72:75], v[24:27], v[164:179]
    v_mfma_f32_32x32x16_bf16 v[116:131], v[16:19], v[76:79], v[116:131]
    v_mfma_f32_32x32x16_bf16 v[148:163], v[20:23], v[76:79], v[148:163]
    v_mfma_f32_32x32x16_bf16 v[180:195], v[76:79], v[24:27], v[180:195]
    buffer_load_dwordx4 v[16:19], v4, s[12:15], s19 offen
    buffer_load_dwordx4 v[20:23], v4, s[12:15], s20 offen
    buffer_load_dwordx4 v[24:27], v4, s[12:15], s21 offen
    s_add_u32 s19, s19, 1024
    s_add_u32 s20, s20, 1024
    s_add_u32 s21, s21, 1024
    ds_read_b128 v[64:67], v4 offset:30720
    ds_read_b128 v[68:71], v5 offset:30720
    s_waitcnt vmcnt(9) lgkmcnt(2)
    v_mfma_f32_32x32x16_bf16 v[100:115], v[28:31], v[80:83], v[100:115]
    v_mfma_f32_32x32x16_bf16 v[132:147], v[32:35], v[80:83], v[132:147]
    v_mfma_f32_32x32x16_bf16 v[164:179], v[80:83], v[36:39], v[164:179]
    v_mfma_f32_32x32x16_bf16 v[116:131], v[28:31], v[84:87], v[116:131]
    v_mfma_f32_32x32x16_bf16 v[148:163], v[32:35], v[84:87], v[148:163]
    v_mfma_f32_32x32x16_bf16 v[180:195], v[84:87], v[36:39], v[180:195]
    buffer_load_dwordx4 v[28:31], v4, s[12:15], s19 offen
    buffer_load_dwordx4 v[32:35], v4, s[12:15], s20 offen
    buffer_load_dwordx4 v[36:39], v4, s[12:15], s21 offen
    s_add_u32 s19, s19, 1024
    s_add_u32 s20, s20, 1024
    s_add_u32 s21, s21, 1024
    ds_read_b128 v[72:75], v4 offset:31744
    ds_read_b128 v[76:79], v5 offset:31744
    s_waitcnt vmcnt(9) lgkmcnt(2)
    v_mfma_f32_32x32x16_bf16 v[100:115], v[40:43], v[64:67], v[100:115]
    v_mfma_f32_32x32x16_bf16 v[132:147], v[44:47], v[64:67], v[132:147]
    v_mfma_f32_32x32x16_bf16 v[164:179], v[64:67], v[48:51], v[164:179]
    v_mfma_f32_32x32x16_bf16 v[116:131], v[40:43], v[68:71], v[116:131]
    v_mfma_f32_32x32x16_bf16 v[148:163], v[44:47], v[68:71], v[148:163]
    v_mfma_f32_32x32x16_bf16 v[180:195], v[68:71], v[48:51], v[180:195]
    buffer_load_dwordx4 v[40:43], v4, s[12:15], s19 offen
    buffer_load_dwordx4 v[44:47], v4, s[12:15], s20 offen
    buffer_load_dwordx4 v[48:51], v4, s[12:15], s21 offen
    s_add_u32 s19, s19, 1024
    s_add_u32 s20, s20, 1024
    s_add_u32 s21, s21, 1024
    ds_read_b128 v[80:83], v4 offset:32768
    ds_read_b128 v[84:87], v5 offset:32768
    s_waitcnt vmcnt(9) lgkmcnt(2)
    v_mfma_f32_32x32x16_bf16 v[100:115], v[52:55], v[72:75], v[100:115]
    v_mfma_f32_32x32x16_bf16 v[132:147], v[56:59], v[72:75], v[132:147]
    v_mfma_f32_32x32x16_bf16 v[164:179], v[72:75], v[60:63], v[164:179]
    v_mfma_f32_32x32x16_bf16 v[116:131], v[52:55], v[76:79], v[116:131]
    v_mfma_f32_32x32x16_bf16 v[148:163], v[56:59], v[76:79], v[148:163]
    v_mfma_f32_32x32x16_bf16 v[180:195], v[76:79], v[60:63], v[180:195]
    buffer_load_dwordx4 v[52:55], v4, s[12:15], s19 offen
    buffer_load_dwordx4 v[56:59], v4, s[12:15], s20 offen
    buffer_load_dwordx4 v[60:63], v4, s[12:15], s21 offen
    s_add_u32 s19, s19, 1024
    s_add_u32 s20, s20, 1024
    s_add_u32 s21, s21, 1024
    ds_read_b128 v[64:67], v4 offset:33792
    ds_read_b128 v[68:71], v5 offset:33792
    s_waitcnt vmcnt(9) lgkmcnt(2)
    v_mfma_f32_32x32x16_bf16 v[100:115], v[16:19], v[80:83], v[100:115]
    v_mfma_f32_32x32x16_bf16 v[132:147], v[20:23], v[80:83], v[132:147]
    v_mfma_f32_32x32x16_bf16 v[164:179], v[80:83], v[24:27], v[164:179]
    v_mfma_f32_32x32x16_bf16 v[116:131], v[16:19], v[84:87], v[116:131]
    v_mfma_f32_32x32x16_bf16 v[148:163], v[20:23], v[84:87], v[148:163]
    v_mfma_f32_32x32x16_bf16 v[180:195], v[84:87], v[24:27], v[180:195]
    ds_read_b128 v[72:75], v4 offset:34816
    ds_read_b128 v[76:79], v5 offset:34816
    s_waitcnt vmcnt(6) lgkmcnt(2)
    v_mfma_f32_32x32x16_bf16 v[100:115], v[28:31], v[64:67], v[100:115]
    v_mfma_f32_32x32x16_bf16 v[132:147], v[32:35], v[64:67], v[132:147]
    v_mfma_f32_32x32x16_bf16 v[164:179], v[64:67], v[36:39], v[164:179]
    v_mfma_f32_32x32x16_bf16 v[116:131], v[28:31], v[68:71], v[116:131]
    v_mfma_f32_32x32x16_bf16 v[148:163], v[32:35], v[68:71], v[148:163]
    v_mfma_f32_32x32x16_bf16 v[180:195], v[68:71], v[36:39], v[180:195]
    ds_read_b128 v[80:83], v4 offset:35840
    ds_read_b128 v[84:87], v5 offset:35840
    s_waitcnt vmcnt(3) lgkmcnt(2)
    v_mfma_f32_32x32x16_bf16 v[100:115], v[40:43], v[72:75], v[100:115]
    v_mfma_f32_32x32x16_bf16 v[132:147], v[44:47], v[72:75], v[132:147]
    v_mfma_f32_32x32x16_bf16 v[164:179], v[72:75], v[48:51], v[164:179]
    v_mfma_f32_32x32x16_bf16 v[116:131], v[40:43], v[76:79], v[116:131]
    v_mfma_f32_32x32x16_bf16 v[148:163], v[44:47], v[76:79], v[148:163]
    v_mfma_f32_32x32x16_bf16 v[180:195], v[76:79], v[48:51], v[180:195]
    s_waitcnt vmcnt(0) lgkmcnt(0)
    v_mfma_f32_32x32x16_bf16 v[100:115], v[52:55], v[80:83], v[100:115]
    v_mfma_f32_32x32x16_bf16 v[132:147], v[56:59], v[80:83], v[132:147]
    v_mfma_f32_32x32x16_bf16 v[164:179], v[80:83], v[60:63], v[164:179]
    v_mfma_f32_32x32x16_bf16 v[116:131], v[52:55], v[84:87], v[116:131]
    v_mfma_f32_32x32x16_bf16 v[148:163], v[56:59], v[84:87], v[148:163]
    v_mfma_f32_32x32x16_bf16 v[180:195], v[84:87], v[60:63], v[180:195]
    s_nop 15
    v_cmp_eq_u32 s[34:35], 18, v2
    v_mov_b32 v6, 1.0
    s_nop 1
    v_cndmask_b32 v164, v164, v6, s[34:35]
    v_cndmask_b32 v165, v165, v6, s[34:35]
    v_cndmask_b32 v166, v166, v6, s[34:35]
    v_cndmask_b32 v167, v167, v6, s[34:35]
    v_cndmask_b32 v168, v168, v6, s[34:35]
    v_cndmask_b32 v169, v169, v6, s[34:35]
    v_cndmask_b32 v170, v170, v6, s[34:35]
    v_cndmask_b32 v171, v171, v6, s[34:35]
    v_cndmask_b32 v172, v172, v6, s[34:35]
    v_cndmask_b32 v173, v173, v6, s[34:35]
    v_cndmask_b32 v174, v174, v6, s[34:35]
    v_cndmask_b32 v175, v175, v6, s[34:35]
    v_cndmask_b32 v176, v176, v6, s[34:35]
    v_cndmask_b32 v177, v177, v6, s[34:35]
    v_cndmask_b32 v178, v178, v6, s[34:35]
    v_cndmask_b32 v179, v179, v6, s[34:35]
    v_cndmask_b32 v180, v180, v6, s[34:35]
    v_cndmask_b32 v181, v181, v6, s[34:35]
    v_cndmask_b32 v182, v182, v6, s[34:35]
    v_cndmask_b32 v183, v183, v6, s[34:35]
    v_cndmask_b32 v184, v184, v6, s[34:35]
    v_cndmask_b32 v185, v185, v6, s[34:35]
    v_cndmask_b32 v186, v186, v6, s[34:35]
    v_cndmask_b32 v187, v187, v6, s[34:35]
    v_cndmask_b32 v188, v188, v6, s[34:35]
    v_cndmask_b32 v189, v189, v6, s[34:35]
    v_cndmask_b32 v190, v190, v6, s[34:35]
    v_cndmask_b32 v191, v191, v6, s[34:35]
    v_cndmask_b32 v192, v192, v6, s[34:35]
    v_cndmask_b32 v193, v193, v6, s[34:35]
    v_cndmask_b32 v194, v194, v6, s[34:35]
    v_cndmask_b32 v195, v195, v6, s[34:35]
    s_lshl_b32 s22, s18, 11
    s_add_u32 s22, s22, 8404992
    buffer_load_dwordx4 v[200:203], v4, s[12:15], s22 offen
    buffer_load_dwordx4 v[204:207], v4, s[12:15], s22 offen offset:1024
    v_mov_b32 v208, 0
    v_mov_b32 v224, 0
    v_mov_b32 v209, 0
    v_mov_b32 v225, 0
    v_mov_b32 v210, 0
    v_mov_b32 v226, 0
    v_mov_b32 v211, 0
    v_mov_b32 v227, 0
    v_mov_b32 v212, 0
    v_mov_b32 v228, 0
    v_mov_b32 v213, 0
    v_mov_b32 v229, 0
    v_mov_b32 v214, 0
    v_mov_b32 v230, 0
    v_mov_b32 v215, 0
    v_mov_b32 v231, 0
    v_mov_b32 v216, 0
    v_mov_b32 v232, 0
    v_mov_b32 v217, 0
    v_mov_b32 v233, 0
    v_mov_b32 v218, 0
    v_mov_b32 v234, 0
    v_mov_b32 v219, 0
    v_mov_b32 v235, 0
    v_mov_b32 v220, 0
    v_mov_b32 v236, 0
    v_mov_b32 v221, 0
    v_mov_b32 v237, 0
    v_mov_b32 v222, 0
    v_mov_b32 v238, 0
    v_mov_b32 v223, 0
    v_mov_b32 v239, 0
    v_and_b32 v8, 3, v2
    v_lshrrev_b32 v9, 2, v2
    v_and_b32 v9, 1, v9
    v_lshl_or_b32 v8, v9, 3, v8
    v_lshrrev_b32 v9, 3, v2
    v_and_b32 v9, 1, v9
    v_lshl_or_b32 v8, v9, 2, v8
    v_and_b32 v9, 16, v2
    v_or_b32 v8, v8, v9
    s_mul_i32 s22, s3, 5120
    s_add_u32 s22, s22, 73728
    v_mul_u32_u24 v9, 320, v3
    v_lshl_add_u32 v8, v8, 1, v9
    v_add_u32 v8, s22, v8
    v_mul_u32_u24 v9, 80, v2
    v_lshl_add_u32 v9, v3, 4, v9
    v_add_u32 v9, s22, v9
    s_waitcnt vmcnt(0)
    s_lshl_b32 s22, s18, 6
    s_lshl_b32 s23, s16, 1
    s_add_u32 s22, s22, s23
    s_add_u32 s22, s22, 0
    s_lshl_b32 s23, s22, 12
    s_add_u32 s23, s23, 17907712
    v_cvt_pk_bf16_f32 v16, v100, v101
    v_cvt_pk_bf16_f32 v17, v102, v103
    v_cvt_pk_bf16_f32 v18, v104, v105
    v_cvt_pk_bf16_f32 v19, v106, v107
    v_cvt_pk_bf16_f32 v20, v108, v109
    v_cvt_pk_bf16_f32 v21, v110, v111
    v_cvt_pk_bf16_f32 v22, v112, v113
    v_cvt_pk_bf16_f32 v23, v114, v115
    s_nop 1
    v_mfma_f32_32x32x16_bf16 v[24:39], v[200:203], v[16:19], 0
    v_mfma_f32_32x32x16_bf16 v[24:39], v[204:207], v[20:23], v[24:39]
    s_nop 15
    v_cvt_pk_bf16_f32 v72, v24, v25
    v_lshlrev_b32 v40, 16, v72
    v_and_b32 v41, 0xffff0000, v72
    v_cvt_pk_bf16_f32 v72, v26, v27
    v_lshlrev_b32 v42, 16, v72
    v_and_b32 v43, 0xffff0000, v72
    v_cvt_pk_bf16_f32 v72, v28, v29
    v_lshlrev_b32 v44, 16, v72
    v_and_b32 v45, 0xffff0000, v72
    v_cvt_pk_bf16_f32 v72, v30, v31
    v_lshlrev_b32 v46, 16, v72
    v_and_b32 v47, 0xffff0000, v72
    v_cvt_pk_bf16_f32 v72, v32, v33
    v_lshlrev_b32 v48, 16, v72
    v_and_b32 v49, 0xffff0000, v72
    v_max3_f32 v72, v40, v41, v42
    v_max3_f32 v72, v72, v43, v44
    v_max3_f32 v72, v72, v45, v46
    v_max_f32 v72, v72, v47
    v_min3_f32 v73, v40, v41, v42
    v_min3_f32 v73, v73, v43, v44
    v_min3_f32 v73, v73, v45, v46
    v_min_f32 v73, v73, v47
    v_max_f32 v74, v48, v49
    v_min_f32 v75, v48, v49
    v_mov_b32 v76, 4286578688
    v_mov_b32 v77, 2139095040
    v_cndmask_b32 v74, v76, v74, s[30:31]
    v_cndmask_b32 v75, v77, v75, s[30:31]
    v_max_f32 v72, v72, v74
    v_min_f32 v73, v73, v75
    v_mov_b32 v76, v72
    s_nop 1
    v_permlane32_swap_b32 v72, v76
    v_max_f32 v72, v72, v76
    v_mov_b32 v76, v73
    s_nop 1
    v_permlane32_swap_b32 v73, v76
    v_min_f32 v73, v73, v76
    s_mov_b32 s32, 1069066811
    v_sub_f32 v24, v40, v72
    v_sub_f32 v40, v73, v40
    v_sub_f32 v25, v41, v72
    v_sub_f32 v41, v73, v41
    v_sub_f32 v26, v42, v72
    v_sub_f32 v42, v73, v42
    v_sub_f32 v27, v43, v72
    v_sub_f32 v43, v73, v43
    v_sub_f32 v28, v44, v72
    v_sub_f32 v44, v73, v44
    v_sub_f32 v29, v45, v72
    v_sub_f32 v45, v73, v45
    v_sub_f32 v30, v46, v72
    v_sub_f32 v46, v73, v46
    v_sub_f32 v31, v47, v72
    v_sub_f32 v47, v73, v47
    v_sub_f32 v32, v48, v72
    v_sub_f32 v48, v73, v48
    v_sub_f32 v33, v49, v72
    v_sub_f32 v49, v73, v49
    v_mul_f32 v24, s32, v24
    v_mul_f32 v40, s32, v40
    v_mul_f32 v25, s32, v25
    v_mul_f32 v41, s32, v41
    v_mul_f32 v26, s32, v26
    v_mul_f32 v42, s32, v42
    v_mul_f32 v27, s32, v27
    v_mul_f32 v43, s32, v43
    v_mul_f32 v28, s32, v28
    v_mul_f32 v44, s32, v44
    v_mul_f32 v29, s32, v29
    v_mul_f32 v45, s32, v45
    v_mul_f32 v30, s32, v30
    v_mul_f32 v46, s32, v46
    v_mul_f32 v31, s32, v31
    v_mul_f32 v47, s32, v47
    v_mul_f32 v32, s32, v32
    v_mul_f32 v48, s32, v48
    v_mul_f32 v33, s32, v33
    v_mul_f32 v49, s32, v49
    v_exp_f32 v24, v24
    v_exp_f32 v40, v40
    v_exp_f32 v25, v25
    v_exp_f32 v41, v41
    v_exp_f32 v26, v26
    v_exp_f32 v42, v42
    v_exp_f32 v27, v27
    v_exp_f32 v43, v43
    v_exp_f32 v28, v28
    v_exp_f32 v44, v44
    v_exp_f32 v29, v29
    v_exp_f32 v45, v45
    v_exp_f32 v30, v30
    v_exp_f32 v46, v46
    v_exp_f32 v31, v31
    v_exp_f32 v47, v47
    v_exp_f32 v32, v32
    v_exp_f32 v48, v48
    v_exp_f32 v33, v33
    v_exp_f32 v49, v49
    s_nop 0
    v_cndmask_b32 v32, 0, v32, s[30:31]
    v_cndmask_b32 v48, 0, v48, s[30:31]
    v_cndmask_b32 v33, 0, v33, s[30:31]
    v_cndmask_b32 v49, 0, v49, s[30:31]
    v_add_f32 v72, v24, v25
    v_add_f32 v73, v40, v41
    v_add_f32 v72, v72, v26
    v_add_f32 v73, v73, v42
    v_add_f32 v72, v72, v27
    v_add_f32 v73, v73, v43
    v_add_f32 v72, v72, v28
    v_add_f32 v73, v73, v44
    v_add_f32 v72, v72, v29
    v_add_f32 v73, v73, v45
    v_add_f32 v72, v72, v30
    v_add_f32 v73, v73, v46
    v_add_f32 v72, v72, v31
    v_add_f32 v73, v73, v47
    v_add_f32 v72, v72, v32
    v_add_f32 v73, v73, v48
    v_add_f32 v72, v72, v33
    v_add_f32 v73, v73, v49
    v_mov_b32 v76, v72
    s_nop 1
    v_permlane32_swap_b32 v72, v76
    v_add_f32 v72, v72, v76
    v_mov_b32 v76, v73
    s_nop 1
    v_permlane32_swap_b32 v73, v76
    v_add_f32 v73, v73, v76
    v_rcp_f32 v72, v72
    v_rcp_f32 v73, v73
    s_nop 0
    v_mul_f32 v24, v24, v72
    v_mul_f32 v40, v40, v73
    v_mul_f32 v25, v25, v72
    v_mul_f32 v41, v41, v73
    v_mul_f32 v26, v26, v72
    v_mul_f32 v42, v42, v73
    v_mul_f32 v27, v27, v72
    v_mul_f32 v43, v43, v73
    v_mul_f32 v28, v28, v72
    v_mul_f32 v44, v44, v73
    v_mul_f32 v29, v29, v72
    v_mul_f32 v45, v45, v73
    v_mul_f32 v30, v30, v72
    v_mul_f32 v46, v46, v73
    v_mul_f32 v31, v31, v72
    v_mul_f32 v47, v47, v73
    v_mul_f32 v32, v32, v72
    v_mul_f32 v48, v48, v73
    v_mul_f32 v33, v33, v72
    v_mul_f32 v49, v49, v73
    v_cvt_pk_bf16_f32 v56, v24, v25
    v_cvt_pk_bf16_f32 v64, v40, v41
    v_cvt_pk_bf16_f32 v57, v26, v27
    v_cvt_pk_bf16_f32 v65, v42, v43
    v_cvt_pk_bf16_f32 v58, v28, v29
    v_cvt_pk_bf16_f32 v66, v44, v45
    v_cvt_pk_bf16_f32 v59, v30, v31
    v_cvt_pk_bf16_f32 v67, v46, v47
    v_cvt_pk_bf16_f32 v60, v32, v33
    v_cvt_pk_bf16_f32 v68, v48, v49
    v_mov_b32 v61, 0
    v_mov_b32 v69, 0
    v_mov_b32 v62, 0
    v_mov_b32 v70, 0
    v_mov_b32 v63, 0
    v_mov_b32 v71, 0
    buffer_store_dwordx4 v[56:59], v4, s[12:15], s23 offen offset:0
    buffer_store_dwordx4 v[60:63], v4, s[12:15], s23 offen offset:1024
    buffer_store_dwordx4 v[64:67], v4, s[12:15], s23 offen offset:2048
    buffer_store_dwordx4 v[68:71], v4, s[12:15], s23 offen offset:3072
    s_nop 2
    v_cvt_pk_bf16_f32 v16, v132, v133
    v_cvt_pk_bf16_f32 v17, v134, v135
    v_cvt_pk_bf16_f32 v18, v136, v137
    v_cvt_pk_bf16_f32 v19, v138, v139
    v_cvt_pk_bf16_f32 v20, v140, v141
    v_cvt_pk_bf16_f32 v21, v142, v143
    v_cvt_pk_bf16_f32 v22, v144, v145
    v_cvt_pk_bf16_f32 v23, v146, v147
    s_nop 1
    v_mfma_f32_32x32x16_bf16 v[24:39], v[200:203], v[16:19], 0
    v_mfma_f32_32x32x16_bf16 v[24:39], v[204:207], v[20:23], v[24:39]
    s_nop 15
    v_cvt_pk_bf16_f32 v72, v24, v25
    v_lshlrev_b32 v40, 16, v72
    v_and_b32 v41, 0xffff0000, v72
    v_cvt_pk_bf16_f32 v72, v26, v27
    v_lshlrev_b32 v42, 16, v72
    v_and_b32 v43, 0xffff0000, v72
    v_cvt_pk_bf16_f32 v72, v28, v29
    v_lshlrev_b32 v44, 16, v72
    v_and_b32 v45, 0xffff0000, v72
    v_cvt_pk_bf16_f32 v72, v30, v31
    v_lshlrev_b32 v46, 16, v72
    v_and_b32 v47, 0xffff0000, v72
    v_cvt_pk_bf16_f32 v72, v32, v33
    v_lshlrev_b32 v48, 16, v72
    v_and_b32 v49, 0xffff0000, v72
    v_max3_f32 v72, v40, v41, v42
    v_max3_f32 v72, v72, v43, v44
    v_max3_f32 v72, v72, v45, v46
    v_max_f32 v72, v72, v47
    v_min3_f32 v73, v40, v41, v42
    v_min3_f32 v73, v73, v43, v44
    v_min3_f32 v73, v73, v45, v46
    v_min_f32 v73, v73, v47
    v_max_f32 v74, v48, v49
    v_min_f32 v75, v48, v49
    v_mov_b32 v76, 4286578688
    v_mov_b32 v77, 2139095040
    v_cndmask_b32 v74, v76, v74, s[30:31]
    v_cndmask_b32 v75, v77, v75, s[30:31]
    v_max_f32 v72, v72, v74
    v_min_f32 v73, v73, v75
    v_mov_b32 v76, v72
    s_nop 1
    v_permlane32_swap_b32 v72, v76
    v_max_f32 v72, v72, v76
    v_mov_b32 v76, v73
    s_nop 1
    v_permlane32_swap_b32 v73, v76
    v_min_f32 v73, v73, v76
    s_mov_b32 s32, 1069066811
    v_sub_f32 v24, v40, v72
    v_sub_f32 v40, v73, v40
    v_sub_f32 v25, v41, v72
    v_sub_f32 v41, v73, v41
    v_sub_f32 v26, v42, v72
    v_sub_f32 v42, v73, v42
    v_sub_f32 v27, v43, v72
    v_sub_f32 v43, v73, v43
    v_sub_f32 v28, v44, v72
    v_sub_f32 v44, v73, v44
    v_sub_f32 v29, v45, v72
    v_sub_f32 v45, v73, v45
    v_sub_f32 v30, v46, v72
    v_sub_f32 v46, v73, v46
    v_sub_f32 v31, v47, v72
    v_sub_f32 v47, v73, v47
    v_sub_f32 v32, v48, v72
    v_sub_f32 v48, v73, v48
    v_sub_f32 v33, v49, v72
    v_sub_f32 v49, v73, v49
    v_mul_f32 v24, s32, v24
    v_mul_f32 v40, s32, v40
    v_mul_f32 v25, s32, v25
    v_mul_f32 v41, s32, v41
    v_mul_f32 v26, s32, v26
    v_mul_f32 v42, s32, v42
    v_mul_f32 v27, s32, v27
    v_mul_f32 v43, s32, v43
    v_mul_f32 v28, s32, v28
    v_mul_f32 v44, s32, v44
    v_mul_f32 v29, s32, v29
    v_mul_f32 v45, s32, v45
    v_mul_f32 v30, s32, v30
    v_mul_f32 v46, s32, v46
    v_mul_f32 v31, s32, v31
    v_mul_f32 v47, s32, v47
    v_mul_f32 v32, s32, v32
    v_mul_f32 v48, s32, v48
    v_mul_f32 v33, s32, v33
    v_mul_f32 v49, s32, v49
    v_exp_f32 v24, v24
    v_exp_f32 v40, v40
    v_exp_f32 v25, v25
    v_exp_f32 v41, v41
    v_exp_f32 v26, v26
    v_exp_f32 v42, v42
    v_exp_f32 v27, v27
    v_exp_f32 v43, v43
    v_exp_f32 v28, v28
    v_exp_f32 v44, v44
    v_exp_f32 v29, v29
    v_exp_f32 v45, v45
    v_exp_f32 v30, v30
    v_exp_f32 v46, v46
    v_exp_f32 v31, v31
    v_exp_f32 v47, v47
    v_exp_f32 v32, v32
    v_exp_f32 v48, v48
    v_exp_f32 v33, v33
    v_exp_f32 v49, v49
    s_nop 0
    v_cndmask_b32 v32, 0, v32, s[30:31]
    v_cndmask_b32 v48, 0, v48, s[30:31]
    v_cndmask_b32 v33, 0, v33, s[30:31]
    v_cndmask_b32 v49, 0, v49, s[30:31]
    v_add_f32 v72, v24, v25
    v_add_f32 v73, v40, v41
    v_add_f32 v72, v72, v26
    v_add_f32 v73, v73, v42
    v_add_f32 v72, v72, v27
    v_add_f32 v73, v73, v43
    v_add_f32 v72, v72, v28
    v_add_f32 v73, v73, v44
    v_add_f32 v72, v72, v29
    v_add_f32 v73, v73, v45
    v_add_f32 v72, v72, v30
    v_add_f32 v73, v73, v46
    v_add_f32 v72, v72, v31
    v_add_f32 v73, v73, v47
    v_add_f32 v72, v72, v32
    v_add_f32 v73, v73, v48
    v_add_f32 v72, v72, v33
    v_add_f32 v73, v73, v49
    v_mov_b32 v76, v72
    s_nop 1
    v_permlane32_swap_b32 v72, v76
    v_add_f32 v72, v72, v76
    v_mov_b32 v76, v73
    s_nop 1
    v_permlane32_swap_b32 v73, v76
    v_add_f32 v73, v73, v76
    v_rcp_f32 v72, v72
    v_rcp_f32 v73, v73
    s_nop 0
    v_mul_f32 v24, v24, v72
    v_mul_f32 v40, v40, v73
    v_mul_f32 v25, v25, v72
    v_mul_f32 v41, v41, v73
    v_mul_f32 v26, v26, v72
    v_mul_f32 v42, v42, v73
    v_mul_f32 v27, v27, v72
    v_mul_f32 v43, v43, v73
    v_mul_f32 v28, v28, v72
    v_mul_f32 v44, v44, v73
    v_mul_f32 v29, v29, v72
    v_mul_f32 v45, v45, v73
    v_mul_f32 v30, v30, v72
    v_mul_f32 v46, v46, v73
    v_mul_f32 v31, v31, v72
    v_mul_f32 v47, v47, v73
    v_mul_f32 v32, v32, v72
    v_mul_f32 v48, v48, v73
    v_mul_f32 v33, v33, v72
    v_mul_f32 v49, v49, v73
    v_cvt_pk_bf16_f32 v56, v24, v25
    v_cvt_pk_bf16_f32 v64, v40, v41
    v_cvt_pk_bf16_f32 v57, v26, v27
    v_cvt_pk_bf16_f32 v65, v42, v43
    v_cvt_pk_bf16_f32 v58, v28, v29
    v_cvt_pk_bf16_f32 v66, v44, v45
    v_cvt_pk_bf16_f32 v59, v30, v31
    v_cvt_pk_bf16_f32 v67, v46, v47
    v_cvt_pk_bf16_f32 v60, v32, v33
    v_cvt_pk_bf16_f32 v68, v48, v49
    v_mov_b32 v61, 0
    v_mov_b32 v69, 0
    v_mov_b32 v62, 0
    v_mov_b32 v70, 0
    v_mov_b32 v63, 0
    v_mov_b32 v71, 0
    ds_write_b16 v8, v56 offset:0
    ds_write_b16_d16_hi v8, v56 offset:80
    ds_write_b16 v8, v57 offset:160
    ds_write_b16_d16_hi v8, v57 offset:240
    ds_write_b16 v8, v58 offset:640
    ds_write_b16_d16_hi v8, v58 offset:720
    ds_write_b16 v8, v59 offset:800
    ds_write_b16_d16_hi v8, v59 offset:880
    ds_write_b16 v8, v60 offset:1280
    ds_write_b16_d16_hi v8, v60 offset:1360
    ds_write_b16 v8, v64 offset:2560
    ds_write_b16_d16_hi v8, v64 offset:2640
    ds_write_b16 v8, v65 offset:2720
    ds_write_b16_d16_hi v8, v65 offset:2800
    ds_write_b16 v8, v66 offset:3200
    ds_write_b16_d16_hi v8, v66 offset:3280
    ds_write_b16 v8, v67 offset:3360
    ds_write_b16_d16_hi v8, v67 offset:3440
    ds_write_b16 v8, v68 offset:3840
    ds_write_b16_d16_hi v8, v68 offset:3920
    s_waitcnt lgkmcnt(0)
    ds_read_b128 v[40:43], v9 offset:0
    ds_read_b128 v[44:47], v9 offset:32
    ds_read_b128 v[48:51], v9 offset:2560
    ds_read_b128 v[52:55], v9 offset:2592
    v_cvt_pk_bf16_f32 v16, v164, v165
    v_cvt_pk_bf16_f32 v17, v166, v167
    v_cvt_pk_bf16_f32 v18, v168, v169
    v_cvt_pk_bf16_f32 v19, v170, v171
    v_cvt_pk_bf16_f32 v20, v172, v173
    v_cvt_pk_bf16_f32 v21, v174, v175
    v_cvt_pk_bf16_f32 v22, v176, v177
    v_cvt_pk_bf16_f32 v23, v178, v179
    s_waitcnt lgkmcnt(0)
    s_nop 1
    v_mfma_f32_32x32x16_bf16 v[208:223], v[40:43], v[16:19], v[208:223]
    v_mfma_f32_32x32x16_bf16 v[224:239], v[48:51], v[16:19], v[224:239]
    v_mfma_f32_32x32x16_bf16 v[208:223], v[44:47], v[20:23], v[208:223]
    v_mfma_f32_32x32x16_bf16 v[224:239], v[52:55], v[20:23], v[224:239]
    s_lshl_b32 s22, s18, 6
    s_lshl_b32 s23, s16, 1
    s_add_u32 s22, s22, s23
    s_add_u32 s22, s22, 1
    s_lshl_b32 s23, s22, 12
    s_add_u32 s23, s23, 17907712
    v_cvt_pk_bf16_f32 v16, v116, v117
    v_cvt_pk_bf16_f32 v17, v118, v119
    v_cvt_pk_bf16_f32 v18, v120, v121
    v_cvt_pk_bf16_f32 v19, v122, v123
    v_cvt_pk_bf16_f32 v20, v124, v125
    v_cvt_pk_bf16_f32 v21, v126, v127
    v_cvt_pk_bf16_f32 v22, v128, v129
    v_cvt_pk_bf16_f32 v23, v130, v131
    s_nop 1
    v_mfma_f32_32x32x16_bf16 v[24:39], v[200:203], v[16:19], 0
    v_mfma_f32_32x32x16_bf16 v[24:39], v[204:207], v[20:23], v[24:39]
    s_nop 15
    v_cvt_pk_bf16_f32 v72, v24, v25
    v_lshlrev_b32 v40, 16, v72
    v_and_b32 v41, 0xffff0000, v72
    v_cvt_pk_bf16_f32 v72, v26, v27
    v_lshlrev_b32 v42, 16, v72
    v_and_b32 v43, 0xffff0000, v72
    v_cvt_pk_bf16_f32 v72, v28, v29
    v_lshlrev_b32 v44, 16, v72
    v_and_b32 v45, 0xffff0000, v72
    v_cvt_pk_bf16_f32 v72, v30, v31
    v_lshlrev_b32 v46, 16, v72
    v_and_b32 v47, 0xffff0000, v72
    v_cvt_pk_bf16_f32 v72, v32, v33
    v_lshlrev_b32 v48, 16, v72
    v_and_b32 v49, 0xffff0000, v72
    v_max3_f32 v72, v40, v41, v42
    v_max3_f32 v72, v72, v43, v44
    v_max3_f32 v72, v72, v45, v46
    v_max_f32 v72, v72, v47
    v_min3_f32 v73, v40, v41, v42
    v_min3_f32 v73, v73, v43, v44
    v_min3_f32 v73, v73, v45, v46
    v_min_f32 v73, v73, v47
    v_max_f32 v74, v48, v49
    v_min_f32 v75, v48, v49
    v_mov_b32 v76, 4286578688
    v_mov_b32 v77, 2139095040
    v_cndmask_b32 v74, v76, v74, s[30:31]
    v_cndmask_b32 v75, v77, v75, s[30:31]
    v_max_f32 v72, v72, v74
    v_min_f32 v73, v73, v75
    v_mov_b32 v76, v72
    s_nop 1
    v_permlane32_swap_b32 v72, v76
    v_max_f32 v72, v72, v76
    v_mov_b32 v76, v73
    s_nop 1
    v_permlane32_swap_b32 v73, v76
    v_min_f32 v73, v73, v76
    s_mov_b32 s32, 1069066811
    v_sub_f32 v24, v40, v72
    v_sub_f32 v40, v73, v40
    v_sub_f32 v25, v41, v72
    v_sub_f32 v41, v73, v41
    v_sub_f32 v26, v42, v72
    v_sub_f32 v42, v73, v42
    v_sub_f32 v27, v43, v72
    v_sub_f32 v43, v73, v43
    v_sub_f32 v28, v44, v72
    v_sub_f32 v44, v73, v44
    v_sub_f32 v29, v45, v72
    v_sub_f32 v45, v73, v45
    v_sub_f32 v30, v46, v72
    v_sub_f32 v46, v73, v46
    v_sub_f32 v31, v47, v72
    v_sub_f32 v47, v73, v47
    v_sub_f32 v32, v48, v72
    v_sub_f32 v48, v73, v48
    v_sub_f32 v33, v49, v72
    v_sub_f32 v49, v73, v49
    v_mul_f32 v24, s32, v24
    v_mul_f32 v40, s32, v40
    v_mul_f32 v25, s32, v25
    v_mul_f32 v41, s32, v41
    v_mul_f32 v26, s32, v26
    v_mul_f32 v42, s32, v42
    v_mul_f32 v27, s32, v27
    v_mul_f32 v43, s32, v43
    v_mul_f32 v28, s32, v28
    v_mul_f32 v44, s32, v44
    v_mul_f32 v29, s32, v29
    v_mul_f32 v45, s32, v45
    v_mul_f32 v30, s32, v30
    v_mul_f32 v46, s32, v46
    v_mul_f32 v31, s32, v31
    v_mul_f32 v47, s32, v47
    v_mul_f32 v32, s32, v32
    v_mul_f32 v48, s32, v48
    v_mul_f32 v33, s32, v33
    v_mul_f32 v49, s32, v49
    v_exp_f32 v24, v24
    v_exp_f32 v40, v40
    v_exp_f32 v25, v25
    v_exp_f32 v41, v41
    v_exp_f32 v26, v26
    v_exp_f32 v42, v42
    v_exp_f32 v27, v27
    v_exp_f32 v43, v43
    v_exp_f32 v28, v28
    v_exp_f32 v44, v44
    v_exp_f32 v29, v29
    v_exp_f32 v45, v45
    v_exp_f32 v30, v30
    v_exp_f32 v46, v46
    v_exp_f32 v31, v31
    v_exp_f32 v47, v47
    v_exp_f32 v32, v32
    v_exp_f32 v48, v48
    v_exp_f32 v33, v33
    v_exp_f32 v49, v49
    s_nop 0
    v_cndmask_b32 v32, 0, v32, s[30:31]
    v_cndmask_b32 v48, 0, v48, s[30:31]
    v_cndmask_b32 v33, 0, v33, s[30:31]
    v_cndmask_b32 v49, 0, v49, s[30:31]
    v_add_f32 v72, v24, v25
    v_add_f32 v73, v40, v41
    v_add_f32 v72, v72, v26
    v_add_f32 v73, v73, v42
    v_add_f32 v72, v72, v27
    v_add_f32 v73, v73, v43
    v_add_f32 v72, v72, v28
    v_add_f32 v73, v73, v44
    v_add_f32 v72, v72, v29
    v_add_f32 v73, v73, v45
    v_add_f32 v72, v72, v30
    v_add_f32 v73, v73, v46
    v_add_f32 v72, v72, v31
    v_add_f32 v73, v73, v47
    v_add_f32 v72, v72, v32
    v_add_f32 v73, v73, v48
    v_add_f32 v72, v72, v33
    v_add_f32 v73, v73, v49
    v_mov_b32 v76, v72
    s_nop 1
    v_permlane32_swap_b32 v72, v76
    v_add_f32 v72, v72, v76
    v_mov_b32 v76, v73
    s_nop 1
    v_permlane32_swap_b32 v73, v76
    v_add_f32 v73, v73, v76
    v_rcp_f32 v72, v72
    v_rcp_f32 v73, v73
    s_nop 0
    v_mul_f32 v24, v24, v72
    v_mul_f32 v40, v40, v73
    v_mul_f32 v25, v25, v72
    v_mul_f32 v41, v41, v73
    v_mul_f32 v26, v26, v72
    v_mul_f32 v42, v42, v73
    v_mul_f32 v27, v27, v72
    v_mul_f32 v43, v43, v73
    v_mul_f32 v28, v28, v72
    v_mul_f32 v44, v44, v73
    v_mul_f32 v29, v29, v72
    v_mul_f32 v45, v45, v73
    v_mul_f32 v30, v30, v72
    v_mul_f32 v46, v46, v73
    v_mul_f32 v31, v31, v72
    v_mul_f32 v47, v47, v73
    v_mul_f32 v32, v32, v72
    v_mul_f32 v48, v48, v73
    v_mul_f32 v33, v33, v72
    v_mul_f32 v49, v49, v73
    v_cvt_pk_bf16_f32 v56, v24, v25
    v_cvt_pk_bf16_f32 v64, v40, v41
    v_cvt_pk_bf16_f32 v57, v26, v27
    v_cvt_pk_bf16_f32 v65, v42, v43
    v_cvt_pk_bf16_f32 v58, v28, v29
    v_cvt_pk_bf16_f32 v66, v44, v45
    v_cvt_pk_bf16_f32 v59, v30, v31
    v_cvt_pk_bf16_f32 v67, v46, v47
    v_cvt_pk_bf16_f32 v60, v32, v33
    v_cvt_pk_bf16_f32 v68, v48, v49
    v_mov_b32 v61, 0
    v_mov_b32 v69, 0
    v_mov_b32 v62, 0
    v_mov_b32 v70, 0
    v_mov_b32 v63, 0
    v_mov_b32 v71, 0
    buffer_store_dwordx4 v[56:59], v4, s[12:15], s23 offen offset:0
    buffer_store_dwordx4 v[60:63], v4, s[12:15], s23 offen offset:1024
    buffer_store_dwordx4 v[64:67], v4, s[12:15], s23 offen offset:2048
    buffer_store_dwordx4 v[68:71], v4, s[12:15], s23 offen offset:3072
    s_nop 2
    v_cvt_pk_bf16_f32 v16, v148, v149
    v_cvt_pk_bf16_f32 v17, v150, v151
    v_cvt_pk_bf16_f32 v18, v152, v153
    v_cvt_pk_bf16_f32 v19, v154, v155
    v_cvt_pk_bf16_f32 v20, v156, v157
    v_cvt_pk_bf16_f32 v21, v158, v159
    v_cvt_pk_bf16_f32 v22, v160, v161
    v_cvt_pk_bf16_f32 v23, v162, v163
    s_nop 1
    v_mfma_f32_32x32x16_bf16 v[24:39], v[200:203], v[16:19], 0
    v_mfma_f32_32x32x16_bf16 v[24:39], v[204:207], v[20:23], v[24:39]
    s_nop 15
    v_cvt_pk_bf16_f32 v72, v24, v25
    v_lshlrev_b32 v40, 16, v72
    v_and_b32 v41, 0xffff0000, v72
    v_cvt_pk_bf16_f32 v72, v26, v27
    v_lshlrev_b32 v42, 16, v72
    v_and_b32 v43, 0xffff0000, v72
    v_cvt_pk_bf16_f32 v72, v28, v29
    v_lshlrev_b32 v44, 16, v72
    v_and_b32 v45, 0xffff0000, v72
    v_cvt_pk_bf16_f32 v72, v30, v31
    v_lshlrev_b32 v46, 16, v72
    v_and_b32 v47, 0xffff0000, v72
    v_cvt_pk_bf16_f32 v72, v32, v33
    v_lshlrev_b32 v48, 16, v72
    v_and_b32 v49, 0xffff0000, v72
    v_max3_f32 v72, v40, v41, v42
    v_max3_f32 v72, v72, v43, v44
    v_max3_f32 v72, v72, v45, v46
    v_max_f32 v72, v72, v47
    v_min3_f32 v73, v40, v41, v42
    v_min3_f32 v73, v73, v43, v44
    v_min3_f32 v73, v73, v45, v46
    v_min_f32 v73, v73, v47
    v_max_f32 v74, v48, v49
    v_min_f32 v75, v48, v49
    v_mov_b32 v76, 4286578688
    v_mov_b32 v77, 2139095040
    v_cndmask_b32 v74, v76, v74, s[30:31]
    v_cndmask_b32 v75, v77, v75, s[30:31]
    v_max_f32 v72, v72, v74
    v_min_f32 v73, v73, v75
    v_mov_b32 v76, v72
    s_nop 1
    v_permlane32_swap_b32 v72, v76
    v_max_f32 v72, v72, v76
    v_mov_b32 v76, v73
    s_nop 1
    v_permlane32_swap_b32 v73, v76
    v_min_f32 v73, v73, v76
    s_mov_b32 s32, 1069066811
    v_sub_f32 v24, v40, v72
    v_sub_f32 v40, v73, v40
    v_sub_f32 v25, v41, v72
    v_sub_f32 v41, v73, v41
    v_sub_f32 v26, v42, v72
    v_sub_f32 v42, v73, v42
    v_sub_f32 v27, v43, v72
    v_sub_f32 v43, v73, v43
    v_sub_f32 v28, v44, v72
    v_sub_f32 v44, v73, v44
    v_sub_f32 v29, v45, v72
    v_sub_f32 v45, v73, v45
    v_sub_f32 v30, v46, v72
    v_sub_f32 v46, v73, v46
    v_sub_f32 v31, v47, v72
    v_sub_f32 v47, v73, v47
    v_sub_f32 v32, v48, v72
    v_sub_f32 v48, v73, v48
    v_sub_f32 v33, v49, v72
    v_sub_f32 v49, v73, v49
    v_mul_f32 v24, s32, v24
    v_mul_f32 v40, s32, v40
    v_mul_f32 v25, s32, v25
    v_mul_f32 v41, s32, v41
    v_mul_f32 v26, s32, v26
    v_mul_f32 v42, s32, v42
    v_mul_f32 v27, s32, v27
    v_mul_f32 v43, s32, v43
    v_mul_f32 v28, s32, v28
    v_mul_f32 v44, s32, v44
    v_mul_f32 v29, s32, v29
    v_mul_f32 v45, s32, v45
    v_mul_f32 v30, s32, v30
    v_mul_f32 v46, s32, v46
    v_mul_f32 v31, s32, v31
    v_mul_f32 v47, s32, v47
    v_mul_f32 v32, s32, v32
    v_mul_f32 v48, s32, v48
    v_mul_f32 v33, s32, v33
    v_mul_f32 v49, s32, v49
    v_exp_f32 v24, v24
    v_exp_f32 v40, v40
    v_exp_f32 v25, v25
    v_exp_f32 v41, v41
    v_exp_f32 v26, v26
    v_exp_f32 v42, v42
    v_exp_f32 v27, v27
    v_exp_f32 v43, v43
    v_exp_f32 v28, v28
    v_exp_f32 v44, v44
    v_exp_f32 v29, v29
    v_exp_f32 v45, v45
    v_exp_f32 v30, v30
    v_exp_f32 v46, v46
    v_exp_f32 v31, v31
    v_exp_f32 v47, v47
    v_exp_f32 v32, v32
    v_exp_f32 v48, v48
    v_exp_f32 v33, v33
    v_exp_f32 v49, v49
    s_nop 0
    v_cndmask_b32 v32, 0, v32, s[30:31]
    v_cndmask_b32 v48, 0, v48, s[30:31]
    v_cndmask_b32 v33, 0, v33, s[30:31]
    v_cndmask_b32 v49, 0, v49, s[30:31]
    v_add_f32 v72, v24, v25
    v_add_f32 v73, v40, v41
    v_add_f32 v72, v72, v26
    v_add_f32 v73, v73, v42
    v_add_f32 v72, v72, v27
    v_add_f32 v73, v73, v43
    v_add_f32 v72, v72, v28
    v_add_f32 v73, v73, v44
    v_add_f32 v72, v72, v29
    v_add_f32 v73, v73, v45
    v_add_f32 v72, v72, v30
    v_add_f32 v73, v73, v46
    v_add_f32 v72, v72, v31
    v_add_f32 v73, v73, v47
    v_add_f32 v72, v72, v32
    v_add_f32 v73, v73, v48
    v_add_f32 v72, v72, v33
    v_add_f32 v73, v73, v49
    v_mov_b32 v76, v72
    s_nop 1
    v_permlane32_swap_b32 v72, v76
    v_add_f32 v72, v72, v76
    v_mov_b32 v76, v73
    s_nop 1
    v_permlane32_swap_b32 v73, v76
    v_add_f32 v73, v73, v76
    v_rcp_f32 v72, v72
    v_rcp_f32 v73, v73
    s_nop 0
    v_mul_f32 v24, v24, v72
    v_mul_f32 v40, v40, v73
    v_mul_f32 v25, v25, v72
    v_mul_f32 v41, v41, v73
    v_mul_f32 v26, v26, v72
    v_mul_f32 v42, v42, v73
    v_mul_f32 v27, v27, v72
    v_mul_f32 v43, v43, v73
    v_mul_f32 v28, v28, v72
    v_mul_f32 v44, v44, v73
    v_mul_f32 v29, v29, v72
    v_mul_f32 v45, v45, v73
    v_mul_f32 v30, v30, v72
    v_mul_f32 v46, v46, v73
    v_mul_f32 v31, v31, v72
    v_mul_f32 v47, v47, v73
    v_mul_f32 v32, v32, v72
    v_mul_f32 v48, v48, v73
    v_mul_f32 v33, v33, v72
    v_mul_f32 v49, v49, v73
    v_cvt_pk_bf16_f32 v56, v24, v25
    v_cvt_pk_bf16_f32 v64, v40, v41
    v_cvt_pk_bf16_f32 v57, v26, v27
    v_cvt_pk_bf16_f32 v65, v42, v43
    v_cvt_pk_bf16_f32 v58, v28, v29
    v_cvt_pk_bf16_f32 v66, v44, v45
    v_cvt_pk_bf16_f32 v59, v30, v31
    v_cvt_pk_bf16_f32 v67, v46, v47
    v_cvt_pk_bf16_f32 v60, v32, v33
    v_cvt_pk_bf16_f32 v68, v48, v49
    v_mov_b32 v61, 0
    v_mov_b32 v69, 0
    v_mov_b32 v62, 0
    v_mov_b32 v70, 0
    v_mov_b32 v63, 0
    v_mov_b32 v71, 0
    ds_write_b16 v8, v56 offset:0
    ds_write_b16_d16_hi v8, v56 offset:80
    ds_write_b16 v8, v57 offset:160
    ds_write_b16_d16_hi v8, v57 offset:240
    ds_write_b16 v8, v58 offset:640
    ds_write_b16_d16_hi v8, v58 offset:720
    ds_write_b16 v8, v59 offset:800
    ds_write_b16_d16_hi v8, v59 offset:880
    ds_write_b16 v8, v60 offset:1280
    ds_write_b16_d16_hi v8, v60 offset:1360
    ds_write_b16 v8, v64 offset:2560
    ds_write_b16_d16_hi v8, v64 offset:2640
    ds_write_b16 v8, v65 offset:2720
    ds_write_b16_d16_hi v8, v65 offset:2800
    ds_write_b16 v8, v66 offset:3200
    ds_write_b16_d16_hi v8, v66 offset:3280
    ds_write_b16 v8, v67 offset:3360
    ds_write_b16_d16_hi v8, v67 offset:3440
    ds_write_b16 v8, v68 offset:3840
    ds_write_b16_d16_hi v8, v68 offset:3920
    s_waitcnt lgkmcnt(0)
    ds_read_b128 v[40:43], v9 offset:0
    ds_read_b128 v[44:47], v9 offset:32
    ds_read_b128 v[48:51], v9 offset:2560
    ds_read_b128 v[52:55], v9 offset:2592
    v_cvt_pk_bf16_f32 v16, v180, v181
    v_cvt_pk_bf16_f32 v17, v182, v183
    v_cvt_pk_bf16_f32 v18, v184, v185
    v_cvt_pk_bf16_f32 v19, v186, v187
    v_cvt_pk_bf16_f32 v20, v188, v189
    v_cvt_pk_bf16_f32 v21, v190, v191
    v_cvt_pk_bf16_f32 v22, v192, v193
    v_cvt_pk_bf16_f32 v23, v194, v195
    s_waitcnt lgkmcnt(0)
    s_nop 1
    v_mfma_f32_32x32x16_bf16 v[208:223], v[40:43], v[16:19], v[208:223]
    v_mfma_f32_32x32x16_bf16 v[224:239], v[48:51], v[16:19], v[224:239]
    v_mfma_f32_32x32x16_bf16 v[208:223], v[44:47], v[20:23], v[208:223]
    v_mfma_f32_32x32x16_bf16 v[224:239], v[52:55], v[20:23], v[224:239]
    s_nop 15
    s_lshl_b32 s22, s18, 5
    s_add_u32 s22, s22, s16
    s_lshl_b32 s22, s22, 13
    s_add_u32 s22, s22, 26296320
    buffer_store_dwordx4 v[208:211], v4, s[12:15], s22 offen offset:0
    buffer_store_dwordx4 v[212:215], v4, s[12:15], s22 offen offset:1024
    buffer_store_dwordx4 v[216:219], v4, s[12:15], s22 offen offset:2048
    buffer_store_dwordx4 v[220:223], v4, s[12:15], s22 offen offset:3072
    s_add_u32 s22, s22, 4096
    buffer_store_dwordx4 v[224:227], v4, s[12:15], s22 offen offset:0
    buffer_store_dwordx4 v[228:231], v4, s[12:15], s22 offen offset:1024
    buffer_store_dwordx4 v[232:235], v4, s[12:15], s22 offen offset:2048
    buffer_store_dwordx4 v[236:239], v4, s[12:15], s22 offen offset:3072
    s_add_u32 s22, s22, 4096
L_a1_l1_kernel_end:
    s_endpgm
.globl a2_l1_kernel
.p2align 8
.type a2_l1_kernel,@function
a2_l1_kernel:
    s_cmp_ge_u32 s2, 256
    s_cbranch_scc1 L_a2_l1_kernel_end
    s_load_dwordx2 s[4:5], s[0:1], 72
    s_load_dwordx2 s[6:7], s[0:1], 0
    s_load_dwordx2 s[36:37], s[0:1], 56
    v_lshrrev_b32 v1, 6, v0
    s_nop 0
    v_readfirstlane_b32 s3, v1
    v_and_b32 v1, 63, v0
    v_and_b32 v2, 31, v1
    v_lshrrev_b32 v3, 5, v1
    v_lshlrev_b32 v4, 4, v1
    s_mov_b32 s30, -1
    s_mov_b32 s31, 0
    s_waitcnt lgkmcnt(0)
    s_mov_b32 s12, s4
    s_mov_b32 s13, s5
    s_mov_b32 s14, 268435456
    s_mov_b32 s15, 0x00020000
    s_mov_b32 s25, 15548416
    s_lshr_b32 s18, s2, 3
    s_and_b32 s16, s2, 7
    s_lshl_b32 s22, s18, 5
    s_lshl_b32 s23, s3, 3
    s_add_u32 s22, s22, s23
    s_lshl_b32 s22, s22, 13
    s_add_u32 s22, s22, 26296320
    buffer_load_dwordx4 v[64:67], v4, s[12:15], s22 offen offset:0
    buffer_load_dwordx4 v[68:71], v4, s[12:15], s22 offen offset:1024
    buffer_load_dwordx4 v[72:75], v4, s[12:15], s22 offen offset:2048
    buffer_load_dwordx4 v[76:79], v4, s[12:15], s22 offen offset:3072
    s_add_u32 s22, s22, 4096
    buffer_load_dwordx4 v[80:83], v4, s[12:15], s22 offen offset:0
    buffer_load_dwordx4 v[84:87], v4, s[12:15], s22 offen offset:1024
    buffer_load_dwordx4 v[88:91], v4, s[12:15], s22 offen offset:2048
    buffer_load_dwordx4 v[92:95], v4, s[12:15], s22 offen offset:3072
    s_add_u32 s22, s22, 4096
    buffer_load_dwordx4 v[96:99], v4, s[12:15], s22 offen offset:0
    buffer_load_dwordx4 v[100:103], v4, s[12:15], s22 offen offset:1024
    buffer_load_dwordx4 v[104:107], v4, s[12:15], s22 offen offset:2048
    buffer_load_dwordx4 v[108:111], v4, s[12:15], s22 offen offset:3072
    s_add_u32 s22, s22, 4096
    buffer_load_dwordx4 v[112:115], v4, s[12:15], s22 offen offset:0
    buffer_load_dwordx4 v[116:119], v4, s[12:15], s22 offen offset:1024
    buffer_load_dwordx4 v[120:123], v4, s[12:15], s22 offen offset:2048
    buffer_load_dwordx4 v[124:127], v4, s[12:15], s22 offen offset:3072
    s_add_u32 s22, s22, 4096
    buffer_load_dwordx4 v[128:131], v4, s[12:15], s22 offen offset:0
    buffer_load_dwordx4 v[132:135], v4, s[12:15], s22 offen offset:1024
    buffer_load_dwordx4 v[136:139], v4, s[12:15], s22 offen offset:2048
    buffer_load_dwordx4 v[140:143], v4, s[12:15], s22 offen offset:3072
    s_add_u32 s22, s22, 4096
    buffer_load_dwordx4 v[144:147], v4, s[12:15], s22 offen offset:0
    buffer_load_dwordx4 v[148:151], v4, s[12:15], s22 offen offset:1024
    buffer_load_dwordx4 v[152:155], v4, s[12:15], s22 offen offset:2048
    buffer_load_dwordx4 v[156:159], v4, s[12:15], s22 offen offset:3072
    s_add_u32 s22, s22, 4096
    buffer_load_dwordx4 v[160:163], v4, s[12:15], s22 offen offset:0
    buffer_load_dwordx4 v[164:167], v4, s[12:15], s22 offen offset:1024
    buffer_load_dwordx4 v[168:171], v4, s[12:15], s22 offen offset:2048
    buffer_load_dwordx4 v[172:175], v4, s[12:15], s22 offen offset:3072
    s_add_u32 s22, s22, 4096
    buffer_load_dwordx4 v[176:179], v4, s[12:15], s22 offen offset:0
    buffer_load_dwordx4 v[180:183], v4, s[12:15], s22 offen offset:1024
    buffer_load_dwordx4 v[184:187], v4, s[12:15], s22 offen offset:2048
    buffer_load_dwordx4 v[188:191], v4, s[12:15], s22 offen offset:3072
    s_add_u32 s22, s22, 4096
    s_waitcnt vmcnt(0)
    v_mov_b32 v16, v64
    v_mov_b32 v17, v65
    v_mov_b32 v18, v66
    v_mov_b32 v19, v67
    v_mov_b32 v20, v68
    v_mov_b32 v21, v69
    v_mov_b32 v22, v70
    v_mov_b32 v23, v71
    v_mov_b32 v24, v72
    v_mov_b32 v25, v73
    v_mov_b32 v26, v74
    v_mov_b32 v27, v75
    v_mov_b32 v28, v76
    v_mov_b32 v29, v77
    v_mov_b32 v30, v78
    v_mov_b32 v31, v79
    v_mov_b32 v32, v80
    v_mov_b32 v33, v81
    v_mov_b32 v34, v82
    v_mov_b32 v35, v83
    v_mov_b32 v36, v84
    v_mov_b32 v37, v85
    v_mov_b32 v38, v86
    v_mov_b32 v39, v87
    v_mov_b32 v40, v88
    v_mov_b32 v41, v89
    v_mov_b32 v42, v90
    v_mov_b32 v43, v91
    v_mov_b32 v44, v92
    v_mov_b32 v45, v93
    v_mov_b32 v46, v94
    v_mov_b32 v47, v95
    v_add_f32 v16, v16, v96
    v_add_f32 v17, v17, v97
    v_add_f32 v18, v18, v98
    v_add_f32 v19, v19, v99
    v_add_f32 v20, v20, v100
    v_add_f32 v21, v21, v101
    v_add_f32 v22, v22, v102
    v_add_f32 v23, v23, v103
    v_add_f32 v24, v24, v104
    v_add_f32 v25, v25, v105
    v_add_f32 v26, v26, v106
    v_add_f32 v27, v27, v107
    v_add_f32 v28, v28, v108
    v_add_f32 v29, v29, v109
    v_add_f32 v30, v30, v110
    v_add_f32 v31, v31, v111
    v_add_f32 v32, v32, v112
    v_add_f32 v33, v33, v113
    v_add_f32 v34, v34, v114
    v_add_f32 v35, v35, v115
    v_add_f32 v36, v36, v116
    v_add_f32 v37, v37, v117
    v_add_f32 v38, v38, v118
    v_add_f32 v39, v39, v119
    v_add_f32 v40, v40, v120
    v_add_f32 v41, v41, v121
    v_add_f32 v42, v42, v122
    v_add_f32 v43, v43, v123
    v_add_f32 v44, v44, v124
    v_add_f32 v45, v45, v125
    v_add_f32 v46, v46, v126
    v_add_f32 v47, v47, v127
    v_add_f32 v16, v16, v128
    v_add_f32 v17, v17, v129
    v_add_f32 v18, v18, v130
    v_add_f32 v19, v19, v131
    v_add_f32 v20, v20, v132
    v_add_f32 v21, v21, v133
    v_add_f32 v22, v22, v134
    v_add_f32 v23, v23, v135
    v_add_f32 v24, v24, v136
    v_add_f32 v25, v25, v137
    v_add_f32 v26, v26, v138
    v_add_f32 v27, v27, v139
    v_add_f32 v28, v28, v140
    v_add_f32 v29, v29, v141
    v_add_f32 v30, v30, v142
    v_add_f32 v31, v31, v143
    v_add_f32 v32, v32, v144
    v_add_f32 v33, v33, v145
    v_add_f32 v34, v34, v146
    v_add_f32 v35, v35, v147
    v_add_f32 v36, v36, v148
    v_add_f32 v37, v37, v149
    v_add_f32 v38, v38, v150
    v_add_f32 v39, v39, v151
    v_add_f32 v40, v40, v152
    v_add_f32 v41, v41, v153
    v_add_f32 v42, v42, v154
    v_add_f32 v43, v43, v155
    v_add_f32 v44, v44, v156
    v_add_f32 v45, v45, v157
    v_add_f32 v46, v46, v158
    v_add_f32 v47, v47, v159
    v_add_f32 v16, v16, v160
    v_add_f32 v17, v17, v161
    v_add_f32 v18, v18, v162
    v_add_f32 v19, v19, v163
    v_add_f32 v20, v20, v164
    v_add_f32 v21, v21, v165
    v_add_f32 v22, v22, v166
    v_add_f32 v23, v23, v167
    v_add_f32 v24, v24, v168
    v_add_f32 v25, v25, v169
    v_add_f32 v26, v26, v170
    v_add_f32 v27, v27, v171
    v_add_f32 v28, v28, v172
    v_add_f32 v29, v29, v173
    v_add_f32 v30, v30, v174
    v_add_f32 v31, v31, v175
    v_add_f32 v32, v32, v176
    v_add_f32 v33, v33, v177
    v_add_f32 v34, v34, v178
    v_add_f32 v35, v35, v179
    v_add_f32 v36, v36, v180
    v_add_f32 v37, v37, v181
    v_add_f32 v38, v38, v182
    v_add_f32 v39, v39, v183
    v_add_f32 v40, v40, v184
    v_add_f32 v41, v41, v185
    v_add_f32 v42, v42, v186
    v_add_f32 v43, v43, v187
    v_add_f32 v44, v44, v188
    v_add_f32 v45, v45, v189
    v_add_f32 v46, v46, v190
    v_add_f32 v47, v47, v191
    buffer_load_dwordx4 v[64:67], v4, s[12:15], s22 offen offset:0
    buffer_load_dwordx4 v[68:71], v4, s[12:15], s22 offen offset:1024
    buffer_load_dwordx4 v[72:75], v4, s[12:15], s22 offen offset:2048
    buffer_load_dwordx4 v[76:79], v4, s[12:15], s22 offen offset:3072
    s_add_u32 s22, s22, 4096
    buffer_load_dwordx4 v[80:83], v4, s[12:15], s22 offen offset:0
    buffer_load_dwordx4 v[84:87], v4, s[12:15], s22 offen offset:1024
    buffer_load_dwordx4 v[88:91], v4, s[12:15], s22 offen offset:2048
    buffer_load_dwordx4 v[92:95], v4, s[12:15], s22 offen offset:3072
    s_add_u32 s22, s22, 4096
    buffer_load_dwordx4 v[96:99], v4, s[12:15], s22 offen offset:0
    buffer_load_dwordx4 v[100:103], v4, s[12:15], s22 offen offset:1024
    buffer_load_dwordx4 v[104:107], v4, s[12:15], s22 offen offset:2048
    buffer_load_dwordx4 v[108:111], v4, s[12:15], s22 offen offset:3072
    s_add_u32 s22, s22, 4096
    buffer_load_dwordx4 v[112:115], v4, s[12:15], s22 offen offset:0
    buffer_load_dwordx4 v[116:119], v4, s[12:15], s22 offen offset:1024
    buffer_load_dwordx4 v[120:123], v4, s[12:15], s22 offen offset:2048
    buffer_load_dwordx4 v[124:127], v4, s[12:15], s22 offen offset:3072
    s_add_u32 s22, s22, 4096
    buffer_load_dwordx4 v[128:131], v4, s[12:15], s22 offen offset:0
    buffer_load_dwordx4 v[132:135], v4, s[12:15], s22 offen offset:1024
    buffer_load_dwordx4 v[136:139], v4, s[12:15], s22 offen offset:2048
    buffer_load_dwordx4 v[140:143], v4, s[12:15], s22 offen offset:3072
    s_add_u32 s22, s22, 4096
    buffer_load_dwordx4 v[144:147], v4, s[12:15], s22 offen offset:0
    buffer_load_dwordx4 v[148:151], v4, s[12:15], s22 offen offset:1024
    buffer_load_dwordx4 v[152:155], v4, s[12:15], s22 offen offset:2048
    buffer_load_dwordx4 v[156:159], v4, s[12:15], s22 offen offset:3072
    s_add_u32 s22, s22, 4096
    buffer_load_dwordx4 v[160:163], v4, s[12:15], s22 offen offset:0
    buffer_load_dwordx4 v[164:167], v4, s[12:15], s22 offen offset:1024
    buffer_load_dwordx4 v[168:171], v4, s[12:15], s22 offen offset:2048
    buffer_load_dwordx4 v[172:175], v4, s[12:15], s22 offen offset:3072
    s_add_u32 s22, s22, 4096
    buffer_load_dwordx4 v[176:179], v4, s[12:15], s22 offen offset:0
    buffer_load_dwordx4 v[180:183], v4, s[12:15], s22 offen offset:1024
    buffer_load_dwordx4 v[184:187], v4, s[12:15], s22 offen offset:2048
    buffer_load_dwordx4 v[188:191], v4, s[12:15], s22 offen offset:3072
    s_add_u32 s22, s22, 4096
    s_waitcnt vmcnt(0)
    v_add_f32 v16, v16, v64
    v_add_f32 v17, v17, v65
    v_add_f32 v18, v18, v66
    v_add_f32 v19, v19, v67
    v_add_f32 v20, v20, v68
    v_add_f32 v21, v21, v69
    v_add_f32 v22, v22, v70
    v_add_f32 v23, v23, v71
    v_add_f32 v24, v24, v72
    v_add_f32 v25, v25, v73
    v_add_f32 v26, v26, v74
    v_add_f32 v27, v27, v75
    v_add_f32 v28, v28, v76
    v_add_f32 v29, v29, v77
    v_add_f32 v30, v30, v78
    v_add_f32 v31, v31, v79
    v_add_f32 v32, v32, v80
    v_add_f32 v33, v33, v81
    v_add_f32 v34, v34, v82
    v_add_f32 v35, v35, v83
    v_add_f32 v36, v36, v84
    v_add_f32 v37, v37, v85
    v_add_f32 v38, v38, v86
    v_add_f32 v39, v39, v87
    v_add_f32 v40, v40, v88
    v_add_f32 v41, v41, v89
    v_add_f32 v42, v42, v90
    v_add_f32 v43, v43, v91
    v_add_f32 v44, v44, v92
    v_add_f32 v45, v45, v93
    v_add_f32 v46, v46, v94
    v_add_f32 v47, v47, v95
    v_add_f32 v16, v16, v96
    v_add_f32 v17, v17, v97
    v_add_f32 v18, v18, v98
    v_add_f32 v19, v19, v99
    v_add_f32 v20, v20, v100
    v_add_f32 v21, v21, v101
    v_add_f32 v22, v22, v102
    v_add_f32 v23, v23, v103
    v_add_f32 v24, v24, v104
    v_add_f32 v25, v25, v105
    v_add_f32 v26, v26, v106
    v_add_f32 v27, v27, v107
    v_add_f32 v28, v28, v108
    v_add_f32 v29, v29, v109
    v_add_f32 v30, v30, v110
    v_add_f32 v31, v31, v111
    v_add_f32 v32, v32, v112
    v_add_f32 v33, v33, v113
    v_add_f32 v34, v34, v114
    v_add_f32 v35, v35, v115
    v_add_f32 v36, v36, v116
    v_add_f32 v37, v37, v117
    v_add_f32 v38, v38, v118
    v_add_f32 v39, v39, v119
    v_add_f32 v40, v40, v120
    v_add_f32 v41, v41, v121
    v_add_f32 v42, v42, v122
    v_add_f32 v43, v43, v123
    v_add_f32 v44, v44, v124
    v_add_f32 v45, v45, v125
    v_add_f32 v46, v46, v126
    v_add_f32 v47, v47, v127
    v_add_f32 v16, v16, v128
    v_add_f32 v17, v17, v129
    v_add_f32 v18, v18, v130
    v_add_f32 v19, v19, v131
    v_add_f32 v20, v20, v132
    v_add_f32 v21, v21, v133
    v_add_f32 v22, v22, v134
    v_add_f32 v23, v23, v135
    v_add_f32 v24, v24, v136
    v_add_f32 v25, v25, v137
    v_add_f32 v26, v26, v138
    v_add_f32 v27, v27, v139
    v_add_f32 v28, v28, v140
    v_add_f32 v29, v29, v141
    v_add_f32 v30, v30, v142
    v_add_f32 v31, v31, v143
    v_add_f32 v32, v32, v144
    v_add_f32 v33, v33, v145
    v_add_f32 v34, v34, v146
    v_add_f32 v35, v35, v147
    v_add_f32 v36, v36, v148
    v_add_f32 v37, v37, v149
    v_add_f32 v38, v38, v150
    v_add_f32 v39, v39, v151
    v_add_f32 v40, v40, v152
    v_add_f32 v41, v41, v153
    v_add_f32 v42, v42, v154
    v_add_f32 v43, v43, v155
    v_add_f32 v44, v44, v156
    v_add_f32 v45, v45, v157
    v_add_f32 v46, v46, v158
    v_add_f32 v47, v47, v159
    v_add_f32 v16, v16, v160
    v_add_f32 v17, v17, v161
    v_add_f32 v18, v18, v162
    v_add_f32 v19, v19, v163
    v_add_f32 v20, v20, v164
    v_add_f32 v21, v21, v165
    v_add_f32 v22, v22, v166
    v_add_f32 v23, v23, v167
    v_add_f32 v24, v24, v168
    v_add_f32 v25, v25, v169
    v_add_f32 v26, v26, v170
    v_add_f32 v27, v27, v171
    v_add_f32 v28, v28, v172
    v_add_f32 v29, v29, v173
    v_add_f32 v30, v30, v174
    v_add_f32 v31, v31, v175
    v_add_f32 v32, v32, v176
    v_add_f32 v33, v33, v177
    v_add_f32 v34, v34, v178
    v_add_f32 v35, v35, v179
    v_add_f32 v36, v36, v180
    v_add_f32 v37, v37, v181
    v_add_f32 v38, v38, v182
    v_add_f32 v39, v39, v183
    v_add_f32 v40, v40, v184
    v_add_f32 v41, v41, v185
    v_add_f32 v42, v42, v186
    v_add_f32 v43, v43, v187
    v_add_f32 v44, v44, v188
    v_add_f32 v45, v45, v189
    v_add_f32 v46, v46, v190
    v_add_f32 v47, v47, v191
    s_lshl_b32 s22, s3, 13
    v_add_u32 v5, s22, v4
    ds_write_b128 v5, v[16:19] offset:0
    ds_write_b128 v5, v[20:23] offset:1024
    ds_write_b128 v5, v[24:27] offset:2048
    ds_write_b128 v5, v[28:31] offset:3072
    ds_write_b128 v5, v[32:35] offset:4096
    ds_write_b128 v5, v[36:39] offset:5120
    ds_write_b128 v5, v[40:43] offset:6144
    ds_write_b128 v5, v[44:47] offset:7168
    s_waitcnt lgkmcnt(0)
    s_barrier
    ds_read_b128 v[64:67], v4 offset:0
    ds_read_b128 v[68:71], v4 offset:1024
    ds_read_b128 v[72:75], v4 offset:2048
    ds_read_b128 v[76:79], v4 offset:3072
    ds_read_b128 v[80:83], v4 offset:4096
    ds_read_b128 v[84:87], v4 offset:5120
    ds_read_b128 v[88:91], v4 offset:6144
    ds_read_b128 v[92:95], v4 offset:7168
    ds_read_b128 v[96:99], v4 offset:8192
    ds_read_b128 v[100:103], v4 offset:9216
    ds_read_b128 v[104:107], v4 offset:10240
    ds_read_b128 v[108:111], v4 offset:11264
    ds_read_b128 v[112:115], v4 offset:12288
    ds_read_b128 v[116:119], v4 offset:13312
    ds_read_b128 v[120:123], v4 offset:14336
    ds_read_b128 v[124:127], v4 offset:15360
    ds_read_b128 v[128:131], v4 offset:16384
    ds_read_b128 v[132:135], v4 offset:17408
    ds_read_b128 v[136:139], v4 offset:18432
    ds_read_b128 v[140:143], v4 offset:19456
    ds_read_b128 v[144:147], v4 offset:20480
    ds_read_b128 v[148:151], v4 offset:21504
    ds_read_b128 v[152:155], v4 offset:22528
    ds_read_b128 v[156:159], v4 offset:23552
    ds_read_b128 v[160:163], v4 offset:24576
    ds_read_b128 v[164:167], v4 offset:25600
    ds_read_b128 v[168:171], v4 offset:26624
    ds_read_b128 v[172:175], v4 offset:27648
    ds_read_b128 v[176:179], v4 offset:28672
    ds_read_b128 v[180:183], v4 offset:29696
    ds_read_b128 v[184:187], v4 offset:30720
    ds_read_b128 v[188:191], v4 offset:31744
    s_waitcnt lgkmcnt(0)
    v_add_f32 v16, v64, v96
    v_add_f32 v128, v128, v160
    v_add_f32 v16, v16, v128
    v_add_f32 v17, v65, v97
    v_add_f32 v129, v129, v161
    v_add_f32 v17, v17, v129
    v_add_f32 v18, v66, v98
    v_add_f32 v130, v130, v162
    v_add_f32 v18, v18, v130
    v_add_f32 v19, v67, v99
    v_add_f32 v131, v131, v163
    v_add_f32 v19, v19, v131
    v_add_f32 v20, v68, v100
    v_add_f32 v132, v132, v164
    v_add_f32 v20, v20, v132
    v_add_f32 v21, v69, v101
    v_add_f32 v133, v133, v165
    v_add_f32 v21, v21, v133
    v_add_f32 v22, v70, v102
    v_add_f32 v134, v134, v166
    v_add_f32 v22, v22, v134
    v_add_f32 v23, v71, v103
    v_add_f32 v135, v135, v167
    v_add_f32 v23, v23, v135
    v_add_f32 v24, v72, v104
    v_add_f32 v136, v136, v168
    v_add_f32 v24, v24, v136
    v_add_f32 v25, v73, v105
    v_add_f32 v137, v137, v169
    v_add_f32 v25, v25, v137
    v_add_f32 v26, v74, v106
    v_add_f32 v138, v138, v170
    v_add_f32 v26, v26, v138
    v_add_f32 v27, v75, v107
    v_add_f32 v139, v139, v171
    v_add_f32 v27, v27, v139
    v_add_f32 v28, v76, v108
    v_add_f32 v140, v140, v172
    v_add_f32 v28, v28, v140
    v_add_f32 v29, v77, v109
    v_add_f32 v141, v141, v173
    v_add_f32 v29, v29, v141
    v_add_f32 v30, v78, v110
    v_add_f32 v142, v142, v174
    v_add_f32 v30, v30, v142
    v_add_f32 v31, v79, v111
    v_add_f32 v143, v143, v175
    v_add_f32 v31, v31, v143
    v_add_f32 v32, v80, v112
    v_add_f32 v144, v144, v176
    v_add_f32 v32, v32, v144
    v_add_f32 v33, v81, v113
    v_add_f32 v145, v145, v177
    v_add_f32 v33, v33, v145
    v_add_f32 v34, v82, v114
    v_add_f32 v146, v146, v178
    v_add_f32 v34, v34, v146
    v_add_f32 v35, v83, v115
    v_add_f32 v147, v147, v179
    v_add_f32 v35, v35, v147
    v_add_f32 v36, v84, v116
    v_add_f32 v148, v148, v180
    v_add_f32 v36, v36, v148
    v_add_f32 v37, v85, v117
    v_add_f32 v149, v149, v181
    v_add_f32 v37, v37, v149
    v_add_f32 v38, v86, v118
    v_add_f32 v150, v150, v182
    v_add_f32 v38, v38, v150
    v_add_f32 v39, v87, v119
    v_add_f32 v151, v151, v183
    v_add_f32 v39, v39, v151
    v_add_f32 v40, v88, v120
    v_add_f32 v152, v152, v184
    v_add_f32 v40, v40, v152
    v_add_f32 v41, v89, v121
    v_add_f32 v153, v153, v185
    v_add_f32 v41, v41, v153
    v_add_f32 v42, v90, v122
    v_add_f32 v154, v154, v186
    v_add_f32 v42, v42, v154
    v_add_f32 v43, v91, v123
    v_add_f32 v155, v155, v187
    v_add_f32 v43, v43, v155
    v_add_f32 v44, v92, v124
    v_add_f32 v156, v156, v188
    v_add_f32 v44, v44, v156
    v_add_f32 v45, v93, v125
    v_add_f32 v157, v157, v189
    v_add_f32 v45, v45, v157
    v_add_f32 v46, v94, v126
    v_add_f32 v158, v158, v190
    v_add_f32 v46, v46, v158
    v_add_f32 v47, v95, v127
    v_add_f32 v159, v159, v191
    v_add_f32 v47, v47, v159
    v_cvt_pk_bf16_f32 v48, v16, v17
    v_cvt_pk_bf16_f32 v49, v18, v19
    v_cvt_pk_bf16_f32 v50, v20, v21
    v_cvt_pk_bf16_f32 v51, v22, v23
    v_cvt_pk_bf16_f32 v52, v24, v25
    v_cndmask_b32 v52, 0, v52, s[30:31]
    v_mov_b32 v53, 0
    v_mov_b32 v54, 0
    v_mov_b32 v55, 0
    v_cvt_pk_bf16_f32 v56, v32, v33
    v_cvt_pk_bf16_f32 v57, v34, v35
    v_cvt_pk_bf16_f32 v58, v36, v37
    v_cvt_pk_bf16_f32 v59, v38, v39
    v_cvt_pk_bf16_f32 v60, v40, v41
    v_cndmask_b32 v60, 0, v60, s[30:31]
    v_mov_b32 v61, 0
    v_mov_b32 v62, 0
    v_mov_b32 v63, 0
    s_lshl_b32 s22, s16, 3
    s_lshl_b32 s23, s3, 1
    s_add_u32 s22, s22, s23
    s_add_u32 s22, s22, 0
    s_lshl_b32 s23, s18, 6
    s_add_u32 s23, s23, s22
    s_lshl_b32 s23, s23, 12
    s_add_u32 s23, s23, 17907712
    buffer_load_dwordx4 v[64:67], v4, s[12:15], s23 offen offset:0
    buffer_load_dwordx4 v[68:71], v4, s[12:15], s23 offen offset:1024
    buffer_load_dwordx4 v[72:75], v4, s[12:15], s23 offen offset:2048
    buffer_load_dwordx4 v[76:79], v4, s[12:15], s23 offen offset:3072
    s_lshl_b32 s22, s22, 5
    v_add_u32 v6, s22, v2
    v_mul_u32_u24 v6, 1152, v6
    s_mul_i32 s23, s18, 36
    v_lshl_add_u32 v6, v3, 3, v6
    v_add_u32 v6, s23, v6
    s_waitcnt vmcnt(0)
    v_mfma_f32_32x32x16_bf16 v[80:95], v[48:51], v[64:67], 0
    v_mfma_f32_32x32x16_bf16 v[80:95], v[52:55], v[68:71], v[80:95]
    v_mfma_f32_32x32x16_bf16 v[80:95], v[56:59], v[72:75], v[80:95]
    v_mfma_f32_32x32x16_bf16 v[80:95], v[60:63], v[76:79], v[80:95]
    s_nop 15
    v_mov_b32 v8, v90
    v_mov_b32 v9, v90
    s_nop 1
    v_permlane32_swap_b32 v8, v9
    v_cvt_pk_bf16_f32 v8, v8, v8
    v_lshlrev_b32 v8, 16, v8
    v_add_f32 v8, 0x358637bd, v8
    v_cvt_pk_bf16_f32 v8, v8, v8
    v_lshlrev_b32 v8, 16, v8
    v_rcp_f32 v8, v8
    s_nop 0
    v_cvt_pk_bf16_f32 v9, v80, v81
    v_lshlrev_b32 v80, 16, v9
    v_and_b32 v81, 0xffff0000, v9
    v_mul_f32 v80, v80, v8
    v_mul_f32 v81, v81, v8
    v_cvt_pk_bf16_f32 v100, v80, v81
    v_cvt_pk_bf16_f32 v9, v82, v83
    v_lshlrev_b32 v82, 16, v9
    v_and_b32 v83, 0xffff0000, v9
    v_mul_f32 v82, v82, v8
    v_mul_f32 v83, v83, v8
    v_cvt_pk_bf16_f32 v101, v82, v83
    v_cvt_pk_bf16_f32 v9, v84, v85
    v_lshlrev_b32 v84, 16, v9
    v_and_b32 v85, 0xffff0000, v9
    v_mul_f32 v84, v84, v8
    v_mul_f32 v85, v85, v8
    v_cvt_pk_bf16_f32 v102, v84, v85
    v_cvt_pk_bf16_f32 v9, v86, v87
    v_lshlrev_b32 v86, 16, v9
    v_and_b32 v87, 0xffff0000, v9
    v_mul_f32 v86, v86, v8
    v_mul_f32 v87, v87, v8
    v_cvt_pk_bf16_f32 v103, v86, v87
    v_cvt_pk_bf16_f32 v9, v88, v89
    v_lshlrev_b32 v88, 16, v9
    v_and_b32 v89, 0xffff0000, v9
    v_mul_f32 v88, v88, v8
    v_mul_f32 v89, v89, v8
    v_cvt_pk_bf16_f32 v104, v88, v89
    s_lshr_b32 s22, s22, 5
    s_mul_i32 s26, s22, 36864
    s_add_u32 s26, s26, 15548416
    s_mul_i32 s27, s18, 18
    v_lshlrev_b32 v112, 2, v3
    v_add_u32 v112, s27, v112
    v_add_u32 v110, 0, v112
    v_lshrrev_b32 v111, 4, v110
    v_lshlrev_b32 v111, 10, v111
    v_lshl_add_u32 v111, v2, 4, v111
    v_bfe_u32 v113, v110, 3, 1
    v_lshl_add_u32 v111, v113, 9, v111
    v_and_b32 v113, 7, v110
    v_lshl_add_u32 v111, v113, 1, v111
    buffer_store_dword v100, v111, s[12:15], s26 offen
    v_add_u32 v110, 2, v112
    v_lshrrev_b32 v111, 4, v110
    v_lshlrev_b32 v111, 10, v111
    v_lshl_add_u32 v111, v2, 4, v111
    v_bfe_u32 v113, v110, 3, 1
    v_lshl_add_u32 v111, v113, 9, v111
    v_and_b32 v113, 7, v110
    v_lshl_add_u32 v111, v113, 1, v111
    buffer_store_dword v101, v111, s[12:15], s26 offen
    v_add_u32 v110, 8, v112
    v_lshrrev_b32 v111, 4, v110
    v_lshlrev_b32 v111, 10, v111
    v_lshl_add_u32 v111, v2, 4, v111
    v_bfe_u32 v113, v110, 3, 1
    v_lshl_add_u32 v111, v113, 9, v111
    v_and_b32 v113, 7, v110
    v_lshl_add_u32 v111, v113, 1, v111
    buffer_store_dword v102, v111, s[12:15], s26 offen
    v_add_u32 v110, 10, v112
    v_lshrrev_b32 v111, 4, v110
    v_lshlrev_b32 v111, 10, v111
    v_lshl_add_u32 v111, v2, 4, v111
    v_bfe_u32 v113, v110, 3, 1
    v_lshl_add_u32 v111, v113, 9, v111
    v_and_b32 v113, 7, v110
    v_lshl_add_u32 v111, v113, 1, v111
    buffer_store_dword v103, v111, s[12:15], s26 offen
    v_add_u32 v110, 16, v112
    v_lshrrev_b32 v111, 4, v110
    v_lshlrev_b32 v111, 10, v111
    v_lshl_add_u32 v111, v2, 4, v111
    v_bfe_u32 v113, v110, 3, 1
    v_lshl_add_u32 v111, v113, 9, v111
    v_and_b32 v113, 7, v110
    v_lshl_add_u32 v111, v113, 1, v111
    s_mov_b64 exec, s[30:31]
    buffer_store_dword v104, v111, s[12:15], s26 offen
    s_mov_b64 exec, -1
    s_lshl_b32 s22, s16, 3
    s_lshl_b32 s23, s3, 1
    s_add_u32 s22, s22, s23
    s_add_u32 s22, s22, 1
    s_lshl_b32 s23, s18, 6
    s_add_u32 s23, s23, s22
    s_lshl_b32 s23, s23, 12
    s_add_u32 s23, s23, 17907712
    buffer_load_dwordx4 v[64:67], v4, s[12:15], s23 offen offset:0
    buffer_load_dwordx4 v[68:71], v4, s[12:15], s23 offen offset:1024
    buffer_load_dwordx4 v[72:75], v4, s[12:15], s23 offen offset:2048
    buffer_load_dwordx4 v[76:79], v4, s[12:15], s23 offen offset:3072
    s_lshl_b32 s22, s22, 5
    v_add_u32 v6, s22, v2
    v_mul_u32_u24 v6, 1152, v6
    s_mul_i32 s23, s18, 36
    v_lshl_add_u32 v6, v3, 3, v6
    v_add_u32 v6, s23, v6
    s_waitcnt vmcnt(0)
    v_mfma_f32_32x32x16_bf16 v[80:95], v[48:51], v[64:67], 0
    v_mfma_f32_32x32x16_bf16 v[80:95], v[52:55], v[68:71], v[80:95]
    v_mfma_f32_32x32x16_bf16 v[80:95], v[56:59], v[72:75], v[80:95]
    v_mfma_f32_32x32x16_bf16 v[80:95], v[60:63], v[76:79], v[80:95]
    s_nop 15
    v_mov_b32 v8, v90
    v_mov_b32 v9, v90
    s_nop 1
    v_permlane32_swap_b32 v8, v9
    v_cvt_pk_bf16_f32 v8, v8, v8
    v_lshlrev_b32 v8, 16, v8
    v_add_f32 v8, 0x358637bd, v8
    v_cvt_pk_bf16_f32 v8, v8, v8
    v_lshlrev_b32 v8, 16, v8
    v_rcp_f32 v8, v8
    s_nop 0
    v_cvt_pk_bf16_f32 v9, v80, v81
    v_lshlrev_b32 v80, 16, v9
    v_and_b32 v81, 0xffff0000, v9
    v_mul_f32 v80, v80, v8
    v_mul_f32 v81, v81, v8
    v_cvt_pk_bf16_f32 v100, v80, v81
    v_cvt_pk_bf16_f32 v9, v82, v83
    v_lshlrev_b32 v82, 16, v9
    v_and_b32 v83, 0xffff0000, v9
    v_mul_f32 v82, v82, v8
    v_mul_f32 v83, v83, v8
    v_cvt_pk_bf16_f32 v101, v82, v83
    v_cvt_pk_bf16_f32 v9, v84, v85
    v_lshlrev_b32 v84, 16, v9
    v_and_b32 v85, 0xffff0000, v9
    v_mul_f32 v84, v84, v8
    v_mul_f32 v85, v85, v8
    v_cvt_pk_bf16_f32 v102, v84, v85
    v_cvt_pk_bf16_f32 v9, v86, v87
    v_lshlrev_b32 v86, 16, v9
    v_and_b32 v87, 0xffff0000, v9
    v_mul_f32 v86, v86, v8
    v_mul_f32 v87, v87, v8
    v_cvt_pk_bf16_f32 v103, v86, v87
    v_cvt_pk_bf16_f32 v9, v88, v89
    v_lshlrev_b32 v88, 16, v9
    v_and_b32 v89, 0xffff0000, v9
    v_mul_f32 v88, v88, v8
    v_mul_f32 v89, v89, v8
    v_cvt_pk_bf16_f32 v104, v88, v89
    s_lshr_b32 s22, s22, 5
    s_mul_i32 s26, s22, 36864
    s_add_u32 s26, s26, 15548416
    s_mul_i32 s27, s18, 18
    v_lshlrev_b32 v112, 2, v3
    v_add_u32 v112, s27, v112
    v_add_u32 v110, 0, v112
    v_lshrrev_b32 v111, 4, v110
    v_lshlrev_b32 v111, 10, v111
    v_lshl_add_u32 v111, v2, 4, v111
    v_bfe_u32 v113, v110, 3, 1
    v_lshl_add_u32 v111, v113, 9, v111
    v_and_b32 v113, 7, v110
    v_lshl_add_u32 v111, v113, 1, v111
    buffer_store_dword v100, v111, s[12:15], s26 offen
    v_add_u32 v110, 2, v112
    v_lshrrev_b32 v111, 4, v110
    v_lshlrev_b32 v111, 10, v111
    v_lshl_add_u32 v111, v2, 4, v111
    v_bfe_u32 v113, v110, 3, 1
    v_lshl_add_u32 v111, v113, 9, v111
    v_and_b32 v113, 7, v110
    v_lshl_add_u32 v111, v113, 1, v111
    buffer_store_dword v101, v111, s[12:15], s26 offen
    v_add_u32 v110, 8, v112
    v_lshrrev_b32 v111, 4, v110
    v_lshlrev_b32 v111, 10, v111
    v_lshl_add_u32 v111, v2, 4, v111
    v_bfe_u32 v113, v110, 3, 1
    v_lshl_add_u32 v111, v113, 9, v111
    v_and_b32 v113, 7, v110
    v_lshl_add_u32 v111, v113, 1, v111
    buffer_store_dword v102, v111, s[12:15], s26 offen
    v_add_u32 v110, 10, v112
    v_lshrrev_b32 v111, 4, v110
    v_lshlrev_b32 v111, 10, v111
    v_lshl_add_u32 v111, v2, 4, v111
    v_bfe_u32 v113, v110, 3, 1
    v_lshl_add_u32 v111, v113, 9, v111
    v_and_b32 v113, 7, v110
    v_lshl_add_u32 v111, v113, 1, v111
    buffer_store_dword v103, v111, s[12:15], s26 offen
    v_add_u32 v110, 16, v112
    v_lshrrev_b32 v111, 4, v110
    v_lshlrev_b32 v111, 10, v111
    v_lshl_add_u32 v111, v2, 4, v111
    v_bfe_u32 v113, v110, 3, 1
    v_lshl_add_u32 v111, v113, 9, v111
    v_and_b32 v113, 7, v110
    v_lshl_add_u32 v111, v113, 1, v111
    s_mov_b64 exec, s[30:31]
    buffer_store_dword v104, v111, s[12:15], s26 offen
    s_mov_b64 exec, -1
L_a2_l1_kernel_end:
    s_endpgm
.globl outa_l1_kernel
.p2align 8
.type outa_l1_kernel,@function
outa_l1_kernel:
    s_cmp_ge_u32 s2, 288
    s_cbranch_scc1 L_outa_l1_kernel_end
    s_load_dwordx2 s[4:5], s[0:1], 72
    s_load_dwordx2 s[6:7], s[0:1], 0
    s_load_dwordx2 s[36:37], s[0:1], 56
    v_lshrrev_b32 v1, 6, v0
    s_nop 0
    v_readfirstlane_b32 s3, v1
    v_and_b32 v1, 63, v0
    v_and_b32 v2, 31, v1
    v_lshrrev_b32 v3, 5, v1
    v_lshlrev_b32 v4, 4, v1
    s_mov_b32 s30, -1
    s_mov_b32 s31, 0
    s_waitcnt lgkmcnt(0)
    s_mov_b32 s12, s4
    s_mov_b32 s13, s5
    s_mov_b32 s14, 268435456
    s_mov_b32 s15, 0x00020000
    s_add_u32 s8, s4, 10829824
    s_addc_u32 s9, s5, 0
    s_mov_b32 s10, 2359296
    s_mov_b32 s11, 0x00020000
    s_add_u32 s40, s4, 13189120
    s_addc_u32 s41, s5, 0
    s_mov_b32 s42, 2359296
    s_mov_b32 s43, 0x00020000
    s_mul_i32 s16, s2, 7282
    s_lshr_b32 s16, s16, 16
    s_mul_i32 s17, s16, 9
    s_sub_u32 s17, s2, s17
    s_lshl_b32 s16, s16, 1
    s_and_b32 s18, s3, 1
    s_add_u32 s16, s16, s18
    s_lshl_b32 s17, s17, 1
    s_lshr_b32 s18, s3, 1
    s_add_u32 s17, s17, s18
    s_mul_i32 s19, s17, 36864
    s_add_u32 s19, s19, 7077888
    s_lshl_b32 s20, s16, 5
    v_add_u32 v5, s20, v2
    v_mul_u32_u24 v5, 1152, v5
    v_lshl_add_u32 v6, v3, 4, v5
    s_mul_i32 s21, s16, 36864
    s_add_u32 s21, s21, 15548416
    buffer_load_dwordx4 v[40:43], v4, s[12:15], s19 offen
    buffer_load_dwordx4 v[44:47], v4, s[12:15], s21 offen
    s_add_u32 s19, s19, 1024
    s_add_u32 s21, s21, 1024
    buffer_load_dwordx4 v[48:51], v4, s[12:15], s19 offen
    buffer_load_dwordx4 v[52:55], v4, s[12:15], s21 offen
    s_add_u32 s19, s19, 1024
    s_add_u32 s21, s21, 1024
    buffer_load_dwordx4 v[56:59], v4, s[12:15], s19 offen
    buffer_load_dwordx4 v[60:63], v4, s[12:15], s21 offen
    s_add_u32 s19, s19, 1024
    s_add_u32 s21, s21, 1024
    buffer_load_dwordx4 v[64:67], v4, s[12:15], s19 offen
    buffer_load_dwordx4 v[68:71], v4, s[12:15], s21 offen
    s_add_u32 s19, s19, 1024
    s_add_u32 s21, s21, 1024
    buffer_load_dwordx4 v[72:75], v4, s[12:15], s19 offen
    buffer_load_dwordx4 v[76:79], v4, s[12:15], s21 offen
    s_add_u32 s19, s19, 1024
    s_add_u32 s21, s21, 1024
    buffer_load_dwordx4 v[80:83], v4, s[12:15], s19 offen
    buffer_load_dwordx4 v[84:87], v4, s[12:15], s21 offen
    s_add_u32 s19, s19, 1024
    s_add_u32 s21, s21, 1024
    buffer_load_dwordx4 v[88:91], v4, s[12:15], s19 offen
    buffer_load_dwordx4 v[92:95], v4, s[12:15], s21 offen
    s_add_u32 s19, s19, 1024
    s_add_u32 s21, s21, 1024
    buffer_load_dwordx4 v[96:99], v4, s[12:15], s19 offen
    buffer_load_dwordx4 v[100:103], v4, s[12:15], s21 offen
    s_add_u32 s19, s19, 1024
    s_add_u32 s21, s21, 1024
    buffer_load_dwordx4 v[104:107], v4, s[12:15], s19 offen
    buffer_load_dwordx4 v[108:111], v4, s[12:15], s21 offen
    s_add_u32 s19, s19, 1024
    s_add_u32 s21, s21, 1024
    buffer_load_dwordx4 v[112:115], v4, s[12:15], s19 offen
    buffer_load_dwordx4 v[116:119], v4, s[12:15], s21 offen
    s_add_u32 s19, s19, 1024
    s_add_u32 s21, s21, 1024
    buffer_load_dwordx4 v[120:123], v4, s[12:15], s19 offen
    buffer_load_dwordx4 v[124:127], v4, s[12:15], s21 offen
    s_add_u32 s19, s19, 1024
    s_add_u32 s21, s21, 1024
    buffer_load_dwordx4 v[128:131], v4, s[12:15], s19 offen
    buffer_load_dwordx4 v[132:135], v4, s[12:15], s21 offen
    s_add_u32 s19, s19, 1024
    s_add_u32 s21, s21, 1024
    buffer_load_dwordx4 v[136:139], v4, s[12:15], s19 offen
    buffer_load_dwordx4 v[140:143], v4, s[12:15], s21 offen
    s_add_u32 s19, s19, 1024
    s_add_u32 s21, s21, 1024
    buffer_load_dwordx4 v[144:147], v4, s[12:15], s19 offen
    buffer_load_dwordx4 v[148:151], v4, s[12:15], s21 offen
    s_add_u32 s19, s19, 1024
    s_add_u32 s21, s21, 1024
    buffer_load_dwordx4 v[152:155], v4, s[12:15], s19 offen
    buffer_load_dwordx4 v[156:159], v4, s[12:15], s21 offen
    s_add_u32 s19, s19, 1024
    s_add_u32 s21, s21, 1024
    s_waitcnt vmcnt(28)
    v_mfma_f32_32x32x16_bf16 v[16:31], v[40:43], v[44:47], 0
    buffer_load_dwordx4 v[40:43], v4, s[12:15], s19 offen
    buffer_load_dwordx4 v[44:47], v4, s[12:15], s21 offen
    s_add_u32 s19, s19, 1024
    s_add_u32 s21, s21, 1024
    s_waitcnt vmcnt(28)
    v_mfma_f32_32x32x16_bf16 v[16:31], v[48:51], v[52:55], v[16:31]
    buffer_load_dwordx4 v[48:51], v4, s[12:15], s19 offen
    buffer_load_dwordx4 v[52:55], v4, s[12:15], s21 offen
    s_add_u32 s19, s19, 1024
    s_add_u32 s21, s21, 1024
    s_waitcnt vmcnt(28)
    v_mfma_f32_32x32x16_bf16 v[16:31], v[56:59], v[60:63], v[16:31]
    buffer_load_dwordx4 v[56:59], v4, s[12:15], s19 offen
    buffer_load_dwordx4 v[60:63], v4, s[12:15], s21 offen
    s_add_u32 s19, s19, 1024
    s_add_u32 s21, s21, 1024
    s_waitcnt vmcnt(28)
    v_mfma_f32_32x32x16_bf16 v[16:31], v[64:67], v[68:71], v[16:31]
    buffer_load_dwordx4 v[64:67], v4, s[12:15], s19 offen
    buffer_load_dwordx4 v[68:71], v4, s[12:15], s21 offen
    s_add_u32 s19, s19, 1024
    s_add_u32 s21, s21, 1024
    s_waitcnt vmcnt(28)
    v_mfma_f32_32x32x16_bf16 v[16:31], v[72:75], v[76:79], v[16:31]
    buffer_load_dwordx4 v[72:75], v4, s[12:15], s19 offen
    buffer_load_dwordx4 v[76:79], v4, s[12:15], s21 offen
    s_add_u32 s19, s19, 1024
    s_add_u32 s21, s21, 1024
    s_waitcnt vmcnt(28)
    v_mfma_f32_32x32x16_bf16 v[16:31], v[80:83], v[84:87], v[16:31]
    buffer_load_dwordx4 v[80:83], v4, s[12:15], s19 offen
    buffer_load_dwordx4 v[84:87], v4, s[12:15], s21 offen
    s_add_u32 s19, s19, 1024
    s_add_u32 s21, s21, 1024
    s_waitcnt vmcnt(28)
    v_mfma_f32_32x32x16_bf16 v[16:31], v[88:91], v[92:95], v[16:31]
    buffer_load_dwordx4 v[88:91], v4, s[12:15], s19 offen
    buffer_load_dwordx4 v[92:95], v4, s[12:15], s21 offen
    s_add_u32 s19, s19, 1024
    s_add_u32 s21, s21, 1024
    s_waitcnt vmcnt(28)
    v_mfma_f32_32x32x16_bf16 v[16:31], v[96:99], v[100:103], v[16:31]
    buffer_load_dwordx4 v[96:99], v4, s[12:15], s19 offen
    buffer_load_dwordx4 v[100:103], v4, s[12:15], s21 offen
    s_add_u32 s19, s19, 1024
    s_add_u32 s21, s21, 1024
    s_waitcnt vmcnt(28)
    v_mfma_f32_32x32x16_bf16 v[16:31], v[104:107], v[108:111], v[16:31]
    buffer_load_dwordx4 v[104:107], v4, s[12:15], s19 offen
    buffer_load_dwordx4 v[108:111], v4, s[12:15], s21 offen
    s_add_u32 s19, s19, 1024
    s_add_u32 s21, s21, 1024
    s_waitcnt vmcnt(28)
    v_mfma_f32_32x32x16_bf16 v[16:31], v[112:115], v[116:119], v[16:31]
    buffer_load_dwordx4 v[112:115], v4, s[12:15], s19 offen
    buffer_load_dwordx4 v[116:119], v4, s[12:15], s21 offen
    s_add_u32 s19, s19, 1024
    s_add_u32 s21, s21, 1024
    s_waitcnt vmcnt(28)
    v_mfma_f32_32x32x16_bf16 v[16:31], v[120:123], v[124:127], v[16:31]
    buffer_load_dwordx4 v[120:123], v4, s[12:15], s19 offen
    buffer_load_dwordx4 v[124:127], v4, s[12:15], s21 offen
    s_add_u32 s19, s19, 1024
    s_add_u32 s21, s21, 1024
    s_waitcnt vmcnt(28)
    v_mfma_f32_32x32x16_bf16 v[16:31], v[128:131], v[132:135], v[16:31]
    buffer_load_dwordx4 v[128:131], v4, s[12:15], s19 offen
    buffer_load_dwordx4 v[132:135], v4, s[12:15], s21 offen
    s_add_u32 s19, s19, 1024
    s_add_u32 s21, s21, 1024
    s_waitcnt vmcnt(28)
    v_mfma_f32_32x32x16_bf16 v[16:31], v[136:139], v[140:143], v[16:31]
    buffer_load_dwordx4 v[136:139], v4, s[12:15], s19 offen
    buffer_load_dwordx4 v[140:143], v4, s[12:15], s21 offen
    s_add_u32 s19, s19, 1024
    s_add_u32 s21, s21, 1024
    s_waitcnt vmcnt(28)
    v_mfma_f32_32x32x16_bf16 v[16:31], v[144:147], v[148:151], v[16:31]
    buffer_load_dwordx4 v[144:147], v4, s[12:15], s19 offen
    buffer_load_dwordx4 v[148:151], v4, s[12:15], s21 offen
    s_add_u32 s19, s19, 1024
    s_add_u32 s21, s21, 1024
    s_waitcnt vmcnt(28)
    v_mfma_f32_32x32x16_bf16 v[16:31], v[152:155], v[156:159], v[16:31]
    buffer_load_dwordx4 v[152:155], v4, s[12:15], s19 offen
    buffer_load_dwordx4 v[156:159], v4, s[12:15], s21 offen
    s_add_u32 s19, s19, 1024
    s_add_u32 s21, s21, 1024
    s_waitcnt vmcnt(28)
    v_mfma_f32_32x32x16_bf16 v[16:31], v[40:43], v[44:47], v[16:31]
    buffer_load_dwordx4 v[40:43], v4, s[12:15], s19 offen
    buffer_load_dwordx4 v[44:47], v4, s[12:15], s21 offen
    s_add_u32 s19, s19, 1024
    s_add_u32 s21, s21, 1024
    s_waitcnt vmcnt(28)
    v_mfma_f32_32x32x16_bf16 v[16:31], v[48:51], v[52:55], v[16:31]
    buffer_load_dwordx4 v[48:51], v4, s[12:15], s19 offen
    buffer_load_dwordx4 v[52:55], v4, s[12:15], s21 offen
    s_add_u32 s19, s19, 1024
    s_add_u32 s21, s21, 1024
    s_waitcnt vmcnt(28)
    v_mfma_f32_32x32x16_bf16 v[16:31], v[56:59], v[60:63], v[16:31]
    buffer_load_dwordx4 v[56:59], v4, s[12:15], s19 offen
    buffer_load_dwordx4 v[60:63], v4, s[12:15], s21 offen
    s_add_u32 s19, s19, 1024
    s_add_u32 s21, s21, 1024
    s_waitcnt vmcnt(28)
    v_mfma_f32_32x32x16_bf16 v[16:31], v[64:67], v[68:71], v[16:31]
    buffer_load_dwordx4 v[64:67], v4, s[12:15], s19 offen
    buffer_load_dwordx4 v[68:71], v4, s[12:15], s21 offen
    s_add_u32 s19, s19, 1024
    s_add_u32 s21, s21, 1024
    s_waitcnt vmcnt(28)
    v_mfma_f32_32x32x16_bf16 v[16:31], v[72:75], v[76:79], v[16:31]
    buffer_load_dwordx4 v[72:75], v4, s[12:15], s19 offen
    buffer_load_dwordx4 v[76:79], v4, s[12:15], s21 offen
    s_add_u32 s19, s19, 1024
    s_add_u32 s21, s21, 1024
    s_waitcnt vmcnt(28)
    v_mfma_f32_32x32x16_bf16 v[16:31], v[80:83], v[84:87], v[16:31]
    buffer_load_dwordx4 v[80:83], v4, s[12:15], s19 offen
    buffer_load_dwordx4 v[84:87], v4, s[12:15], s21 offen
    s_add_u32 s19, s19, 1024
    s_add_u32 s21, s21, 1024
    s_waitcnt vmcnt(28)
    v_mfma_f32_32x32x16_bf16 v[16:31], v[88:91], v[92:95], v[16:31]
    s_waitcnt vmcnt(26)
    v_mfma_f32_32x32x16_bf16 v[16:31], v[96:99], v[100:103], v[16:31]
    s_waitcnt vmcnt(24)
    v_mfma_f32_32x32x16_bf16 v[16:31], v[104:107], v[108:111], v[16:31]
    s_waitcnt vmcnt(22)
    v_mfma_f32_32x32x16_bf16 v[16:31], v[112:115], v[116:119], v[16:31]
    s_waitcnt vmcnt(20)
    v_mfma_f32_32x32x16_bf16 v[16:31], v[120:123], v[124:127], v[16:31]
    s_waitcnt vmcnt(18)
    v_mfma_f32_32x32x16_bf16 v[16:31], v[128:131], v[132:135], v[16:31]
    s_waitcnt vmcnt(16)
    v_mfma_f32_32x32x16_bf16 v[16:31], v[136:139], v[140:143], v[16:31]
    s_waitcnt vmcnt(14)
    v_mfma_f32_32x32x16_bf16 v[16:31], v[144:147], v[148:151], v[16:31]
    s_waitcnt vmcnt(12)
    v_mfma_f32_32x32x16_bf16 v[16:31], v[152:155], v[156:159], v[16:31]
    s_waitcnt vmcnt(10)
    v_mfma_f32_32x32x16_bf16 v[16:31], v[40:43], v[44:47], v[16:31]
    s_waitcnt vmcnt(8)
    v_mfma_f32_32x32x16_bf16 v[16:31], v[48:51], v[52:55], v[16:31]
    s_waitcnt vmcnt(6)
    v_mfma_f32_32x32x16_bf16 v[16:31], v[56:59], v[60:63], v[16:31]
    s_waitcnt vmcnt(4)
    v_mfma_f32_32x32x16_bf16 v[16:31], v[64:67], v[68:71], v[16:31]
    s_waitcnt vmcnt(2)
    v_mfma_f32_32x32x16_bf16 v[16:31], v[72:75], v[76:79], v[16:31]
    s_waitcnt vmcnt(0)
    v_mfma_f32_32x32x16_bf16 v[16:31], v[80:83], v[84:87], v[16:31]
    s_lshl_b32 s20, s17, 6
    v_lshl_add_u32 v7, v3, 3, v5
    v_add_u32 v7, s20, v7
    buffer_load_dwordx2 v[8:9], v7, s[8:11], 0 offen offset:0
    buffer_load_dwordx2 v[10:11], v7, s[8:11], 0 offen offset:16
    buffer_load_dwordx2 v[12:13], v7, s[8:11], 0 offen offset:32
    buffer_load_dwordx2 v[14:15], v7, s[8:11], 0 offen offset:48
    s_nop 15
    v_cvt_pk_bf16_f32 v90, v16, v17
    v_cvt_pk_bf16_f32 v91, v18, v19
    v_cvt_pk_bf16_f32 v92, v20, v21
    v_cvt_pk_bf16_f32 v93, v22, v23
    v_cvt_pk_bf16_f32 v94, v24, v25
    v_cvt_pk_bf16_f32 v95, v26, v27
    v_cvt_pk_bf16_f32 v96, v28, v29
    v_cvt_pk_bf16_f32 v97, v30, v31
    s_waitcnt vmcnt(0)
    v_lshlrev_b32 v100, 16, v90
    v_and_b32 v101, 0xffff0000, v90
    v_lshlrev_b32 v102, 16, v8
    v_and_b32 v103, 0xffff0000, v8
    v_add_f32 v100, v100, v102
    v_add_f32 v101, v101, v103
    v_cvt_pk_bf16_f32 v90, v100, v101
    v_lshlrev_b32 v100, 16, v91
    v_and_b32 v101, 0xffff0000, v91
    v_lshlrev_b32 v102, 16, v9
    v_and_b32 v103, 0xffff0000, v9
    v_add_f32 v100, v100, v102
    v_add_f32 v101, v101, v103
    v_cvt_pk_bf16_f32 v91, v100, v101
    v_lshlrev_b32 v100, 16, v92
    v_and_b32 v101, 0xffff0000, v92
    v_lshlrev_b32 v102, 16, v10
    v_and_b32 v103, 0xffff0000, v10
    v_add_f32 v100, v100, v102
    v_add_f32 v101, v101, v103
    v_cvt_pk_bf16_f32 v92, v100, v101
    v_lshlrev_b32 v100, 16, v93
    v_and_b32 v101, 0xffff0000, v93
    v_lshlrev_b32 v102, 16, v11
    v_and_b32 v103, 0xffff0000, v11
    v_add_f32 v100, v100, v102
    v_add_f32 v101, v101, v103
    v_cvt_pk_bf16_f32 v93, v100, v101
    v_lshlrev_b32 v100, 16, v94
    v_and_b32 v101, 0xffff0000, v94
    v_lshlrev_b32 v102, 16, v12
    v_and_b32 v103, 0xffff0000, v12
    v_add_f32 v100, v100, v102
    v_add_f32 v101, v101, v103
    v_cvt_pk_bf16_f32 v94, v100, v101
    v_lshlrev_b32 v100, 16, v95
    v_and_b32 v101, 0xffff0000, v95
    v_lshlrev_b32 v102, 16, v13
    v_and_b32 v103, 0xffff0000, v13
    v_add_f32 v100, v100, v102
    v_add_f32 v101, v101, v103
    v_cvt_pk_bf16_f32 v95, v100, v101
    v_lshlrev_b32 v100, 16, v96
    v_and_b32 v101, 0xffff0000, v96
    v_lshlrev_b32 v102, 16, v14
    v_and_b32 v103, 0xffff0000, v14
    v_add_f32 v100, v100, v102
    v_add_f32 v101, v101, v103
    v_cvt_pk_bf16_f32 v96, v100, v101
    v_lshlrev_b32 v100, 16, v97
    v_and_b32 v101, 0xffff0000, v97
    v_lshlrev_b32 v102, 16, v15
    v_and_b32 v103, 0xffff0000, v15
    v_add_f32 v100, v100, v102
    v_add_f32 v101, v101, v103
    v_cvt_pk_bf16_f32 v97, v100, v101
    buffer_store_dwordx2 v[90:91], v7, s[40:43], 0 offen offset:0
    buffer_store_dwordx2 v[92:93], v7, s[40:43], 0 offen offset:16
    buffer_store_dwordx2 v[94:95], v7, s[40:43], 0 offen offset:32
    buffer_store_dwordx2 v[96:97], v7, s[40:43], 0 offen offset:48
L_outa_l1_kernel_end:
    s_endpgm
.globl b1_l1_kernel
.p2align 8
.type b1_l1_kernel,@function
b1_l1_kernel:
    s_cmp_ge_u32 s2, 256
    s_cbranch_scc1 L_b1_l1_kernel_end
    s_load_dwordx2 s[4:5], s[0:1], 72
    s_load_dwordx2 s[6:7], s[0:1], 0
    v_lshrrev_b32 v1, 6, v0
    s_nop 0
    v_readfirstlane_b32 s3, v1
    v_and_b32 v1, 63, v0
    v_and_b32 v2, 31, v1
    v_lshrrev_b32 v3, 5, v1
    v_lshlrev_b32 v4, 4, v1
    s_lshr_b32 s16, s2, 3
    s_and_b32 s17, s2, 7
    s_lshl_b32 s17, s17, 2
    s_add_u32 s18, s17, s3
    s_mov_b32 s30, -1
    s_mov_b32 s31, 0
    s_waitcnt lgkmcnt(0)
    s_mov_b32 s12, s4
    s_mov_b32 s13, s5
    s_mov_b32 s14, 268435456
    s_mov_b32 s15, 0x00020000
    s_add_u32 s8, s4, 13189120
    s_addc_u32 s9, s5, 0
    s_mov_b32 s10, 2359296
    s_mov_b32 s11, 0x00020000
    s_lshl_b32 s19, s16, 6
    s_lshl_b32 s20, s3, 4
    s_add_u32 s19, s19, s20
    v_lshrrev_b32 v5, 3, v1
    v_add_u32 v5, s19, v5
    v_mul_u32_u24 v5, 1152, v5
    v_and_b32 v6, 7, v1
    v_lshl_add_u32 v5, v6, 4, v5
    buffer_load_dwordx4 v[16:19], v5, s[8:11], 0 offen offset:0
    buffer_load_dwordx4 v[20:23], v5, s[8:11], 0 offen offset:128
    buffer_load_dwordx4 v[24:27], v5, s[8:11], 0 offen offset:256
    buffer_load_dwordx4 v[28:31], v5, s[8:11], 0 offen offset:384
    buffer_load_dwordx4 v[32:35], v5, s[8:11], 0 offen offset:512
    buffer_load_dwordx4 v[36:39], v5, s[8:11], 0 offen offset:640
    buffer_load_dwordx4 v[40:43], v5, s[8:11], 0 offen offset:768
    buffer_load_dwordx4 v[44:47], v5, s[8:11], 0 offen offset:896
    buffer_load_dwordx4 v[48:51], v5, s[8:11], 0 offen offset:1024
    v_add_u32 v5, 9216, v5
    buffer_load_dwordx4 v[52:55], v5, s[8:11], 0 offen offset:0
    buffer_load_dwordx4 v[56:59], v5, s[8:11], 0 offen offset:128
    buffer_load_dwordx4 v[60:63], v5, s[8:11], 0 offen offset:256
    buffer_load_dwordx4 v[64:67], v5, s[8:11], 0 offen offset:384
    buffer_load_dwordx4 v[68:71], v5, s[8:11], 0 offen offset:512
    buffer_load_dwordx4 v[72:75], v5, s[8:11], 0 offen offset:640
    buffer_load_dwordx4 v[76:79], v5, s[8:11], 0 offen offset:768
    buffer_load_dwordx4 v[80:83], v5, s[8:11], 0 offen offset:896
    buffer_load_dwordx4 v[84:87], v5, s[8:11], 0 offen offset:1024
    s_mul_i32 s19, s18, 36864
    s_add_u32 s19, s19, 3538944
    s_add_u32 s20, s19, 1179648
    s_add_u32 s21, s19, 2359296
    s_waitcnt vmcnt(9)
    v_lshlrev_b32 v100, 16, v16
    v_and_b32 v101, 0xffff0000, v16
    v_lshlrev_b32 v102, 16, v17
    v_and_b32 v103, 0xffff0000, v17
    v_lshlrev_b32 v104, 16, v18
    v_and_b32 v105, 0xffff0000, v18
    v_lshlrev_b32 v106, 16, v19
    v_and_b32 v107, 0xffff0000, v19
    v_lshlrev_b32 v108, 16, v20
    v_and_b32 v109, 0xffff0000, v20
    v_lshlrev_b32 v110, 16, v21
    v_and_b32 v111, 0xffff0000, v21
    v_lshlrev_b32 v112, 16, v22
    v_and_b32 v113, 0xffff0000, v22
    v_lshlrev_b32 v114, 16, v23
    v_and_b32 v115, 0xffff0000, v23
    v_lshlrev_b32 v116, 16, v24
    v_and_b32 v117, 0xffff0000, v24
    v_lshlrev_b32 v118, 16, v25
    v_and_b32 v119, 0xffff0000, v25
    v_lshlrev_b32 v120, 16, v26
    v_and_b32 v121, 0xffff0000, v26
    v_lshlrev_b32 v122, 16, v27
    v_and_b32 v123, 0xffff0000, v27
    v_lshlrev_b32 v124, 16, v28
    v_and_b32 v125, 0xffff0000, v28
    v_lshlrev_b32 v126, 16, v29
    v_and_b32 v127, 0xffff0000, v29
    v_lshlrev_b32 v128, 16, v30
    v_and_b32 v129, 0xffff0000, v30
    v_lshlrev_b32 v130, 16, v31
    v_and_b32 v131, 0xffff0000, v31
    v_lshlrev_b32 v132, 16, v32
    v_and_b32 v133, 0xffff0000, v32
    v_lshlrev_b32 v134, 16, v33
    v_and_b32 v135, 0xffff0000, v33
    v_lshlrev_b32 v136, 16, v34
    v_and_b32 v137, 0xffff0000, v34
    v_lshlrev_b32 v138, 16, v35
    v_and_b32 v139, 0xffff0000, v35
    v_lshlrev_b32 v140, 16, v36
    v_and_b32 v141, 0xffff0000, v36
    v_lshlrev_b32 v142, 16, v37
    v_and_b32 v143, 0xffff0000, v37
    v_lshlrev_b32 v144, 16, v38
    v_and_b32 v145, 0xffff0000, v38
    v_lshlrev_b32 v146, 16, v39
    v_and_b32 v147, 0xffff0000, v39
    v_lshlrev_b32 v148, 16, v40
    v_and_b32 v149, 0xffff0000, v40
    v_lshlrev_b32 v150, 16, v41
    v_and_b32 v151, 0xffff0000, v41
    v_lshlrev_b32 v152, 16, v42
    v_and_b32 v153, 0xffff0000, v42
    v_lshlrev_b32 v154, 16, v43
    v_and_b32 v155, 0xffff0000, v43
    v_lshlrev_b32 v156, 16, v44
    v_and_b32 v157, 0xffff0000, v44
    v_lshlrev_b32 v158, 16, v45
    v_and_b32 v159, 0xffff0000, v45
    v_lshlrev_b32 v160, 16, v46
    v_and_b32 v161, 0xffff0000, v46
    v_lshlrev_b32 v162, 16, v47
    v_and_b32 v163, 0xffff0000, v47
    v_lshlrev_b32 v164, 16, v48
    v_and_b32 v165, 0xffff0000, v48
    v_lshlrev_b32 v166, 16, v49
    v_and_b32 v167, 0xffff0000, v49
    v_lshlrev_b32 v168, 16, v50
    v_and_b32 v169, 0xffff0000, v50
    v_lshlrev_b32 v170, 16, v51
    v_and_b32 v171, 0xffff0000, v51
    v_add_f32 v90, v100, v101
    v_add_f32 v91, v102, v103
    v_add_f32 v90, v90, v104
    v_add_f32 v91, v91, v105
    v_add_f32 v90, v90, v106
    v_add_f32 v91, v91, v107
    v_add_f32 v90, v90, v108
    v_add_f32 v91, v91, v109
    v_add_f32 v90, v90, v110
    v_add_f32 v91, v91, v111
    v_add_f32 v90, v90, v112
    v_add_f32 v91, v91, v113
    v_add_f32 v90, v90, v114
    v_add_f32 v91, v91, v115
    v_add_f32 v90, v90, v116
    v_add_f32 v91, v91, v117
    v_add_f32 v90, v90, v118
    v_add_f32 v91, v91, v119
    v_add_f32 v90, v90, v120
    v_add_f32 v91, v91, v121
    v_add_f32 v90, v90, v122
    v_add_f32 v91, v91, v123
    v_add_f32 v90, v90, v124
    v_add_f32 v91, v91, v125
    v_add_f32 v90, v90, v126
    v_add_f32 v91, v91, v127
    v_add_f32 v90, v90, v128
    v_add_f32 v91, v91, v129
    v_add_f32 v90, v90, v130
    v_add_f32 v91, v91, v131
    v_add_f32 v90, v90, v132
    v_add_f32 v91, v91, v133
    v_add_f32 v90, v90, v134
    v_add_f32 v91, v91, v135
    v_add_f32 v90, v90, v136
    v_add_f32 v91, v91, v137
    v_add_f32 v90, v90, v138
    v_add_f32 v91, v91, v139
    v_add_f32 v90, v90, v140
    v_add_f32 v91, v91, v141
    v_add_f32 v90, v90, v142
    v_add_f32 v91, v91, v143
    v_add_f32 v90, v90, v144
    v_add_f32 v91, v91, v145
    v_add_f32 v90, v90, v146
    v_add_f32 v91, v91, v147
    v_add_f32 v90, v90, v148
    v_add_f32 v91, v91, v149
    v_add_f32 v90, v90, v150
    v_add_f32 v91, v91, v151
    v_add_f32 v90, v90, v152
    v_add_f32 v91, v91, v153
    v_add_f32 v90, v90, v154
    v_add_f32 v91, v91, v155
    v_add_f32 v90, v90, v156
    v_add_f32 v91, v91, v157
    v_add_f32 v90, v90, v158
    v_add_f32 v91, v91, v159
    v_add_f32 v90, v90, v160
    v_add_f32 v91, v91, v161
    v_add_f32 v90, v90, v162
    v_add_f32 v91, v91, v163
    v_add_f32 v90, v90, v164
    v_add_f32 v91, v91, v165
    v_add_f32 v90, v90, v166
    v_add_f32 v91, v91, v167
    v_add_f32 v90, v90, v168
    v_add_f32 v91, v91, v169
    v_add_f32 v90, v90, v170
    v_add_f32 v91, v91, v171
    v_add_f32 v90, v90, v91
    s_nop 1
    v_add_f32_dpp v90, v90, v90 quad_perm:[1,0,3,2] row_mask:0xf bank_mask:0xf
    s_nop 1
    v_add_f32_dpp v90, v90, v90 quad_perm:[2,3,0,1] row_mask:0xf bank_mask:0xf
    s_nop 1
    v_add_f32_dpp v90, v90, v90 row_half_mirror row_mask:0xf bank_mask:0xf
    v_mul_f32 v90, 0x3ae38e39, v90
    v_sub_f32 v92, v100, v90
    v_mul_f32 v91, v92, v92
    v_sub_f32 v92, v101, v90
    v_fmac_f32 v91, v92, v92
    v_sub_f32 v92, v102, v90
    v_fmac_f32 v91, v92, v92
    v_sub_f32 v92, v103, v90
    v_fmac_f32 v91, v92, v92
    v_sub_f32 v92, v104, v90
    v_fmac_f32 v91, v92, v92
    v_sub_f32 v92, v105, v90
    v_fmac_f32 v91, v92, v92
    v_sub_f32 v92, v106, v90
    v_fmac_f32 v91, v92, v92
    v_sub_f32 v92, v107, v90
    v_fmac_f32 v91, v92, v92
    v_sub_f32 v92, v108, v90
    v_fmac_f32 v91, v92, v92
    v_sub_f32 v92, v109, v90
    v_fmac_f32 v91, v92, v92
    v_sub_f32 v92, v110, v90
    v_fmac_f32 v91, v92, v92
    v_sub_f32 v92, v111, v90
    v_fmac_f32 v91, v92, v92
    v_sub_f32 v92, v112, v90
    v_fmac_f32 v91, v92, v92
    v_sub_f32 v92, v113, v90
    v_fmac_f32 v91, v92, v92
    v_sub_f32 v92, v114, v90
    v_fmac_f32 v91, v92, v92
    v_sub_f32 v92, v115, v90
    v_fmac_f32 v91, v92, v92
    v_sub_f32 v92, v116, v90
    v_fmac_f32 v91, v92, v92
    v_sub_f32 v92, v117, v90
    v_fmac_f32 v91, v92, v92
    v_sub_f32 v92, v118, v90
    v_fmac_f32 v91, v92, v92
    v_sub_f32 v92, v119, v90
    v_fmac_f32 v91, v92, v92
    v_sub_f32 v92, v120, v90
    v_fmac_f32 v91, v92, v92
    v_sub_f32 v92, v121, v90
    v_fmac_f32 v91, v92, v92
    v_sub_f32 v92, v122, v90
    v_fmac_f32 v91, v92, v92
    v_sub_f32 v92, v123, v90
    v_fmac_f32 v91, v92, v92
    v_sub_f32 v92, v124, v90
    v_fmac_f32 v91, v92, v92
    v_sub_f32 v92, v125, v90
    v_fmac_f32 v91, v92, v92
    v_sub_f32 v92, v126, v90
    v_fmac_f32 v91, v92, v92
    v_sub_f32 v92, v127, v90
    v_fmac_f32 v91, v92, v92
    v_sub_f32 v92, v128, v90
    v_fmac_f32 v91, v92, v92
    v_sub_f32 v92, v129, v90
    v_fmac_f32 v91, v92, v92
    v_sub_f32 v92, v130, v90
    v_fmac_f32 v91, v92, v92
    v_sub_f32 v92, v131, v90
    v_fmac_f32 v91, v92, v92
    v_sub_f32 v92, v132, v90
    v_fmac_f32 v91, v92, v92
    v_sub_f32 v92, v133, v90
    v_fmac_f32 v91, v92, v92
    v_sub_f32 v92, v134, v90
    v_fmac_f32 v91, v92, v92
    v_sub_f32 v92, v135, v90
    v_fmac_f32 v91, v92, v92
    v_sub_f32 v92, v136, v90
    v_fmac_f32 v91, v92, v92
    v_sub_f32 v92, v137, v90
    v_fmac_f32 v91, v92, v92
    v_sub_f32 v92, v138, v90
    v_fmac_f32 v91, v92, v92
    v_sub_f32 v92, v139, v90
    v_fmac_f32 v91, v92, v92
    v_sub_f32 v92, v140, v90
    v_fmac_f32 v91, v92, v92
    v_sub_f32 v92, v141, v90
    v_fmac_f32 v91, v92, v92
    v_sub_f32 v92, v142, v90
    v_fmac_f32 v91, v92, v92
    v_sub_f32 v92, v143, v90
    v_fmac_f32 v91, v92, v92
    v_sub_f32 v92, v144, v90
    v_fmac_f32 v91, v92, v92
    v_sub_f32 v92, v145, v90
    v_fmac_f32 v91, v92, v92
    v_sub_f32 v92, v146, v90
    v_fmac_f32 v91, v92, v92
    v_sub_f32 v92, v147, v90
    v_fmac_f32 v91, v92, v92
    v_sub_f32 v92, v148, v90
    v_fmac_f32 v91, v92, v92
    v_sub_f32 v92, v149, v90
    v_fmac_f32 v91, v92, v92
    v_sub_f32 v92, v150, v90
    v_fmac_f32 v91, v92, v92
    v_sub_f32 v92, v151, v90
    v_fmac_f32 v91, v92, v92
    v_sub_f32 v92, v152, v90
    v_fmac_f32 v91, v92, v92
    v_sub_f32 v92, v153, v90
    v_fmac_f32 v91, v92, v92
    v_sub_f32 v92, v154, v90
    v_fmac_f32 v91, v92, v92
    v_sub_f32 v92, v155, v90
    v_fmac_f32 v91, v92, v92
    v_sub_f32 v92, v156, v90
    v_fmac_f32 v91, v92, v92
    v_sub_f32 v92, v157, v90
    v_fmac_f32 v91, v92, v92
    v_sub_f32 v92, v158, v90
    v_fmac_f32 v91, v92, v92
    v_sub_f32 v92, v159, v90
    v_fmac_f32 v91, v92, v92
    v_sub_f32 v92, v160, v90
    v_fmac_f32 v91, v92, v92
    v_sub_f32 v92, v161, v90
    v_fmac_f32 v91, v92, v92
    v_sub_f32 v92, v162, v90
    v_fmac_f32 v91, v92, v92
    v_sub_f32 v92, v163, v90
    v_fmac_f32 v91, v92, v92
    v_sub_f32 v92, v164, v90
    v_fmac_f32 v91, v92, v92
    v_sub_f32 v92, v165, v90
    v_fmac_f32 v91, v92, v92
    v_sub_f32 v92, v166, v90
    v_fmac_f32 v91, v92, v92
    v_sub_f32 v92, v167, v90
    v_fmac_f32 v91, v92, v92
    v_sub_f32 v92, v168, v90
    v_fmac_f32 v91, v92, v92
    v_sub_f32 v92, v169, v90
    v_fmac_f32 v91, v92, v92
    v_sub_f32 v92, v170, v90
    v_fmac_f32 v91, v92, v92
    v_sub_f32 v92, v171, v90
    v_fmac_f32 v91, v92, v92
    s_nop 1
    v_add_f32_dpp v91, v91, v91 quad_perm:[1,0,3,2] row_mask:0xf bank_mask:0xf
    s_nop 1
    v_add_f32_dpp v91, v91, v91 quad_perm:[2,3,0,1] row_mask:0xf bank_mask:0xf
    s_nop 1
    v_add_f32_dpp v91, v91, v91 row_half_mirror row_mask:0xf bank_mask:0xf
    v_mul_f32 v91, 0x3ae38e39, v91
    v_cvt_pk_bf16_f32 v92, v90, v91
    v_lshlrev_b32 v90, 16, v92
    v_and_b32 v91, 0xffff0000, v92
    v_add_f32 v91, 0x3727c5ac, v91
    v_cvt_pk_bf16_f32 v91, v91, v91
    v_lshlrev_b32 v91, 16, v91
    v_sqrt_f32 v91, v91
    s_nop 0
    v_cvt_pk_bf16_f32 v91, v91, v91
    v_lshlrev_b32 v91, 16, v91
    v_rcp_f32 v91, v91
    s_nop 0
    v_sub_f32 v100, v100, v90
    v_sub_f32 v101, v101, v90
    v_cvt_pk_bf16_f32 v16, v100, v101
    v_lshlrev_b32 v100, 16, v16
    v_and_b32 v101, 0xffff0000, v16
    v_mul_f32 v100, v100, v91
    v_mul_f32 v101, v101, v91
    v_cvt_pk_bf16_f32 v16, v100, v101
    v_sub_f32 v102, v102, v90
    v_sub_f32 v103, v103, v90
    v_cvt_pk_bf16_f32 v17, v102, v103
    v_lshlrev_b32 v102, 16, v17
    v_and_b32 v103, 0xffff0000, v17
    v_mul_f32 v102, v102, v91
    v_mul_f32 v103, v103, v91
    v_cvt_pk_bf16_f32 v17, v102, v103
    v_sub_f32 v104, v104, v90
    v_sub_f32 v105, v105, v90
    v_cvt_pk_bf16_f32 v18, v104, v105
    v_lshlrev_b32 v104, 16, v18
    v_and_b32 v105, 0xffff0000, v18
    v_mul_f32 v104, v104, v91
    v_mul_f32 v105, v105, v91
    v_cvt_pk_bf16_f32 v18, v104, v105
    v_sub_f32 v106, v106, v90
    v_sub_f32 v107, v107, v90
    v_cvt_pk_bf16_f32 v19, v106, v107
    v_lshlrev_b32 v106, 16, v19
    v_and_b32 v107, 0xffff0000, v19
    v_mul_f32 v106, v106, v91
    v_mul_f32 v107, v107, v91
    v_cvt_pk_bf16_f32 v19, v106, v107
    v_sub_f32 v108, v108, v90
    v_sub_f32 v109, v109, v90
    v_cvt_pk_bf16_f32 v20, v108, v109
    v_lshlrev_b32 v108, 16, v20
    v_and_b32 v109, 0xffff0000, v20
    v_mul_f32 v108, v108, v91
    v_mul_f32 v109, v109, v91
    v_cvt_pk_bf16_f32 v20, v108, v109
    v_sub_f32 v110, v110, v90
    v_sub_f32 v111, v111, v90
    v_cvt_pk_bf16_f32 v21, v110, v111
    v_lshlrev_b32 v110, 16, v21
    v_and_b32 v111, 0xffff0000, v21
    v_mul_f32 v110, v110, v91
    v_mul_f32 v111, v111, v91
    v_cvt_pk_bf16_f32 v21, v110, v111
    v_sub_f32 v112, v112, v90
    v_sub_f32 v113, v113, v90
    v_cvt_pk_bf16_f32 v22, v112, v113
    v_lshlrev_b32 v112, 16, v22
    v_and_b32 v113, 0xffff0000, v22
    v_mul_f32 v112, v112, v91
    v_mul_f32 v113, v113, v91
    v_cvt_pk_bf16_f32 v22, v112, v113
    v_sub_f32 v114, v114, v90
    v_sub_f32 v115, v115, v90
    v_cvt_pk_bf16_f32 v23, v114, v115
    v_lshlrev_b32 v114, 16, v23
    v_and_b32 v115, 0xffff0000, v23
    v_mul_f32 v114, v114, v91
    v_mul_f32 v115, v115, v91
    v_cvt_pk_bf16_f32 v23, v114, v115
    v_sub_f32 v116, v116, v90
    v_sub_f32 v117, v117, v90
    v_cvt_pk_bf16_f32 v24, v116, v117
    v_lshlrev_b32 v116, 16, v24
    v_and_b32 v117, 0xffff0000, v24
    v_mul_f32 v116, v116, v91
    v_mul_f32 v117, v117, v91
    v_cvt_pk_bf16_f32 v24, v116, v117
    v_sub_f32 v118, v118, v90
    v_sub_f32 v119, v119, v90
    v_cvt_pk_bf16_f32 v25, v118, v119
    v_lshlrev_b32 v118, 16, v25
    v_and_b32 v119, 0xffff0000, v25
    v_mul_f32 v118, v118, v91
    v_mul_f32 v119, v119, v91
    v_cvt_pk_bf16_f32 v25, v118, v119
    v_sub_f32 v120, v120, v90
    v_sub_f32 v121, v121, v90
    v_cvt_pk_bf16_f32 v26, v120, v121
    v_lshlrev_b32 v120, 16, v26
    v_and_b32 v121, 0xffff0000, v26
    v_mul_f32 v120, v120, v91
    v_mul_f32 v121, v121, v91
    v_cvt_pk_bf16_f32 v26, v120, v121
    v_sub_f32 v122, v122, v90
    v_sub_f32 v123, v123, v90
    v_cvt_pk_bf16_f32 v27, v122, v123
    v_lshlrev_b32 v122, 16, v27
    v_and_b32 v123, 0xffff0000, v27
    v_mul_f32 v122, v122, v91
    v_mul_f32 v123, v123, v91
    v_cvt_pk_bf16_f32 v27, v122, v123
    v_sub_f32 v124, v124, v90
    v_sub_f32 v125, v125, v90
    v_cvt_pk_bf16_f32 v28, v124, v125
    v_lshlrev_b32 v124, 16, v28
    v_and_b32 v125, 0xffff0000, v28
    v_mul_f32 v124, v124, v91
    v_mul_f32 v125, v125, v91
    v_cvt_pk_bf16_f32 v28, v124, v125
    v_sub_f32 v126, v126, v90
    v_sub_f32 v127, v127, v90
    v_cvt_pk_bf16_f32 v29, v126, v127
    v_lshlrev_b32 v126, 16, v29
    v_and_b32 v127, 0xffff0000, v29
    v_mul_f32 v126, v126, v91
    v_mul_f32 v127, v127, v91
    v_cvt_pk_bf16_f32 v29, v126, v127
    v_sub_f32 v128, v128, v90
    v_sub_f32 v129, v129, v90
    v_cvt_pk_bf16_f32 v30, v128, v129
    v_lshlrev_b32 v128, 16, v30
    v_and_b32 v129, 0xffff0000, v30
    v_mul_f32 v128, v128, v91
    v_mul_f32 v129, v129, v91
    v_cvt_pk_bf16_f32 v30, v128, v129
    v_sub_f32 v130, v130, v90
    v_sub_f32 v131, v131, v90
    v_cvt_pk_bf16_f32 v31, v130, v131
    v_lshlrev_b32 v130, 16, v31
    v_and_b32 v131, 0xffff0000, v31
    v_mul_f32 v130, v130, v91
    v_mul_f32 v131, v131, v91
    v_cvt_pk_bf16_f32 v31, v130, v131
    v_sub_f32 v132, v132, v90
    v_sub_f32 v133, v133, v90
    v_cvt_pk_bf16_f32 v32, v132, v133
    v_lshlrev_b32 v132, 16, v32
    v_and_b32 v133, 0xffff0000, v32
    v_mul_f32 v132, v132, v91
    v_mul_f32 v133, v133, v91
    v_cvt_pk_bf16_f32 v32, v132, v133
    v_sub_f32 v134, v134, v90
    v_sub_f32 v135, v135, v90
    v_cvt_pk_bf16_f32 v33, v134, v135
    v_lshlrev_b32 v134, 16, v33
    v_and_b32 v135, 0xffff0000, v33
    v_mul_f32 v134, v134, v91
    v_mul_f32 v135, v135, v91
    v_cvt_pk_bf16_f32 v33, v134, v135
    v_sub_f32 v136, v136, v90
    v_sub_f32 v137, v137, v90
    v_cvt_pk_bf16_f32 v34, v136, v137
    v_lshlrev_b32 v136, 16, v34
    v_and_b32 v137, 0xffff0000, v34
    v_mul_f32 v136, v136, v91
    v_mul_f32 v137, v137, v91
    v_cvt_pk_bf16_f32 v34, v136, v137
    v_sub_f32 v138, v138, v90
    v_sub_f32 v139, v139, v90
    v_cvt_pk_bf16_f32 v35, v138, v139
    v_lshlrev_b32 v138, 16, v35
    v_and_b32 v139, 0xffff0000, v35
    v_mul_f32 v138, v138, v91
    v_mul_f32 v139, v139, v91
    v_cvt_pk_bf16_f32 v35, v138, v139
    v_sub_f32 v140, v140, v90
    v_sub_f32 v141, v141, v90
    v_cvt_pk_bf16_f32 v36, v140, v141
    v_lshlrev_b32 v140, 16, v36
    v_and_b32 v141, 0xffff0000, v36
    v_mul_f32 v140, v140, v91
    v_mul_f32 v141, v141, v91
    v_cvt_pk_bf16_f32 v36, v140, v141
    v_sub_f32 v142, v142, v90
    v_sub_f32 v143, v143, v90
    v_cvt_pk_bf16_f32 v37, v142, v143
    v_lshlrev_b32 v142, 16, v37
    v_and_b32 v143, 0xffff0000, v37
    v_mul_f32 v142, v142, v91
    v_mul_f32 v143, v143, v91
    v_cvt_pk_bf16_f32 v37, v142, v143
    v_sub_f32 v144, v144, v90
    v_sub_f32 v145, v145, v90
    v_cvt_pk_bf16_f32 v38, v144, v145
    v_lshlrev_b32 v144, 16, v38
    v_and_b32 v145, 0xffff0000, v38
    v_mul_f32 v144, v144, v91
    v_mul_f32 v145, v145, v91
    v_cvt_pk_bf16_f32 v38, v144, v145
    v_sub_f32 v146, v146, v90
    v_sub_f32 v147, v147, v90
    v_cvt_pk_bf16_f32 v39, v146, v147
    v_lshlrev_b32 v146, 16, v39
    v_and_b32 v147, 0xffff0000, v39
    v_mul_f32 v146, v146, v91
    v_mul_f32 v147, v147, v91
    v_cvt_pk_bf16_f32 v39, v146, v147
    v_sub_f32 v148, v148, v90
    v_sub_f32 v149, v149, v90
    v_cvt_pk_bf16_f32 v40, v148, v149
    v_lshlrev_b32 v148, 16, v40
    v_and_b32 v149, 0xffff0000, v40
    v_mul_f32 v148, v148, v91
    v_mul_f32 v149, v149, v91
    v_cvt_pk_bf16_f32 v40, v148, v149
    v_sub_f32 v150, v150, v90
    v_sub_f32 v151, v151, v90
    v_cvt_pk_bf16_f32 v41, v150, v151
    v_lshlrev_b32 v150, 16, v41
    v_and_b32 v151, 0xffff0000, v41
    v_mul_f32 v150, v150, v91
    v_mul_f32 v151, v151, v91
    v_cvt_pk_bf16_f32 v41, v150, v151
    v_sub_f32 v152, v152, v90
    v_sub_f32 v153, v153, v90
    v_cvt_pk_bf16_f32 v42, v152, v153
    v_lshlrev_b32 v152, 16, v42
    v_and_b32 v153, 0xffff0000, v42
    v_mul_f32 v152, v152, v91
    v_mul_f32 v153, v153, v91
    v_cvt_pk_bf16_f32 v42, v152, v153
    v_sub_f32 v154, v154, v90
    v_sub_f32 v155, v155, v90
    v_cvt_pk_bf16_f32 v43, v154, v155
    v_lshlrev_b32 v154, 16, v43
    v_and_b32 v155, 0xffff0000, v43
    v_mul_f32 v154, v154, v91
    v_mul_f32 v155, v155, v91
    v_cvt_pk_bf16_f32 v43, v154, v155
    v_sub_f32 v156, v156, v90
    v_sub_f32 v157, v157, v90
    v_cvt_pk_bf16_f32 v44, v156, v157
    v_lshlrev_b32 v156, 16, v44
    v_and_b32 v157, 0xffff0000, v44
    v_mul_f32 v156, v156, v91
    v_mul_f32 v157, v157, v91
    v_cvt_pk_bf16_f32 v44, v156, v157
    v_sub_f32 v158, v158, v90
    v_sub_f32 v159, v159, v90
    v_cvt_pk_bf16_f32 v45, v158, v159
    v_lshlrev_b32 v158, 16, v45
    v_and_b32 v159, 0xffff0000, v45
    v_mul_f32 v158, v158, v91
    v_mul_f32 v159, v159, v91
    v_cvt_pk_bf16_f32 v45, v158, v159
    v_sub_f32 v160, v160, v90
    v_sub_f32 v161, v161, v90
    v_cvt_pk_bf16_f32 v46, v160, v161
    v_lshlrev_b32 v160, 16, v46
    v_and_b32 v161, 0xffff0000, v46
    v_mul_f32 v160, v160, v91
    v_mul_f32 v161, v161, v91
    v_cvt_pk_bf16_f32 v46, v160, v161
    v_sub_f32 v162, v162, v90
    v_sub_f32 v163, v163, v90
    v_cvt_pk_bf16_f32 v47, v162, v163
    v_lshlrev_b32 v162, 16, v47
    v_and_b32 v163, 0xffff0000, v47
    v_mul_f32 v162, v162, v91
    v_mul_f32 v163, v163, v91
    v_cvt_pk_bf16_f32 v47, v162, v163
    v_sub_f32 v164, v164, v90
    v_sub_f32 v165, v165, v90
    v_cvt_pk_bf16_f32 v48, v164, v165
    v_lshlrev_b32 v164, 16, v48
    v_and_b32 v165, 0xffff0000, v48
    v_mul_f32 v164, v164, v91
    v_mul_f32 v165, v165, v91
    v_cvt_pk_bf16_f32 v48, v164, v165
    v_sub_f32 v166, v166, v90
    v_sub_f32 v167, v167, v90
    v_cvt_pk_bf16_f32 v49, v166, v167
    v_lshlrev_b32 v166, 16, v49
    v_and_b32 v167, 0xffff0000, v49
    v_mul_f32 v166, v166, v91
    v_mul_f32 v167, v167, v91
    v_cvt_pk_bf16_f32 v49, v166, v167
    v_sub_f32 v168, v168, v90
    v_sub_f32 v169, v169, v90
    v_cvt_pk_bf16_f32 v50, v168, v169
    v_lshlrev_b32 v168, 16, v50
    v_and_b32 v169, 0xffff0000, v50
    v_mul_f32 v168, v168, v91
    v_mul_f32 v169, v169, v91
    v_cvt_pk_bf16_f32 v50, v168, v169
    v_sub_f32 v170, v170, v90
    v_sub_f32 v171, v171, v90
    v_cvt_pk_bf16_f32 v51, v170, v171
    v_lshlrev_b32 v170, 16, v51
    v_and_b32 v171, 0xffff0000, v51
    v_mul_f32 v170, v170, v91
    v_mul_f32 v171, v171, v91
    v_cvt_pk_bf16_f32 v51, v170, v171
    s_lshl_b32 s22, s3, 4
    s_add_u32 s22, s22, 0
    s_lshr_b32 s23, s22, 5
    s_mul_i32 s23, s23, 36864
    s_and_b32 s22, s22, 31
    v_lshrrev_b32 v7, 3, v1
    v_add_u32 v7, s22, v7
    v_lshlrev_b32 v7, 4, v7
    v_add_u32 v7, s23, v7
    v_and_b32 v6, 7, v1
    v_lshrrev_b32 v8, 1, v6
    v_lshl_add_u32 v7, v8, 10, v7
    v_and_b32 v8, 1, v6
    v_lshl_add_u32 v7, v8, 9, v7
    ds_write_b128 v7, v[16:19] offset:0
    ds_write_b128 v7, v[20:23] offset:4096
    ds_write_b128 v7, v[24:27] offset:8192
    ds_write_b128 v7, v[28:31] offset:12288
    ds_write_b128 v7, v[32:35] offset:16384
    ds_write_b128 v7, v[36:39] offset:20480
    ds_write_b128 v7, v[40:43] offset:24576
    ds_write_b128 v7, v[44:47] offset:28672
    ds_write_b128 v7, v[48:51] offset:32768
    s_waitcnt vmcnt(0)
    v_lshlrev_b32 v100, 16, v52
    v_and_b32 v101, 0xffff0000, v52
    v_lshlrev_b32 v102, 16, v53
    v_and_b32 v103, 0xffff0000, v53
    v_lshlrev_b32 v104, 16, v54
    v_and_b32 v105, 0xffff0000, v54
    v_lshlrev_b32 v106, 16, v55
    v_and_b32 v107, 0xffff0000, v55
    v_lshlrev_b32 v108, 16, v56
    v_and_b32 v109, 0xffff0000, v56
    v_lshlrev_b32 v110, 16, v57
    v_and_b32 v111, 0xffff0000, v57
    v_lshlrev_b32 v112, 16, v58
    v_and_b32 v113, 0xffff0000, v58
    v_lshlrev_b32 v114, 16, v59
    v_and_b32 v115, 0xffff0000, v59
    v_lshlrev_b32 v116, 16, v60
    v_and_b32 v117, 0xffff0000, v60
    v_lshlrev_b32 v118, 16, v61
    v_and_b32 v119, 0xffff0000, v61
    v_lshlrev_b32 v120, 16, v62
    v_and_b32 v121, 0xffff0000, v62
    v_lshlrev_b32 v122, 16, v63
    v_and_b32 v123, 0xffff0000, v63
    v_lshlrev_b32 v124, 16, v64
    v_and_b32 v125, 0xffff0000, v64
    v_lshlrev_b32 v126, 16, v65
    v_and_b32 v127, 0xffff0000, v65
    v_lshlrev_b32 v128, 16, v66
    v_and_b32 v129, 0xffff0000, v66
    v_lshlrev_b32 v130, 16, v67
    v_and_b32 v131, 0xffff0000, v67
    v_lshlrev_b32 v132, 16, v68
    v_and_b32 v133, 0xffff0000, v68
    v_lshlrev_b32 v134, 16, v69
    v_and_b32 v135, 0xffff0000, v69
    v_lshlrev_b32 v136, 16, v70
    v_and_b32 v137, 0xffff0000, v70
    v_lshlrev_b32 v138, 16, v71
    v_and_b32 v139, 0xffff0000, v71
    v_lshlrev_b32 v140, 16, v72
    v_and_b32 v141, 0xffff0000, v72
    v_lshlrev_b32 v142, 16, v73
    v_and_b32 v143, 0xffff0000, v73
    v_lshlrev_b32 v144, 16, v74
    v_and_b32 v145, 0xffff0000, v74
    v_lshlrev_b32 v146, 16, v75
    v_and_b32 v147, 0xffff0000, v75
    v_lshlrev_b32 v148, 16, v76
    v_and_b32 v149, 0xffff0000, v76
    v_lshlrev_b32 v150, 16, v77
    v_and_b32 v151, 0xffff0000, v77
    v_lshlrev_b32 v152, 16, v78
    v_and_b32 v153, 0xffff0000, v78
    v_lshlrev_b32 v154, 16, v79
    v_and_b32 v155, 0xffff0000, v79
    v_lshlrev_b32 v156, 16, v80
    v_and_b32 v157, 0xffff0000, v80
    v_lshlrev_b32 v158, 16, v81
    v_and_b32 v159, 0xffff0000, v81
    v_lshlrev_b32 v160, 16, v82
    v_and_b32 v161, 0xffff0000, v82
    v_lshlrev_b32 v162, 16, v83
    v_and_b32 v163, 0xffff0000, v83
    v_lshlrev_b32 v164, 16, v84
    v_and_b32 v165, 0xffff0000, v84
    v_lshlrev_b32 v166, 16, v85
    v_and_b32 v167, 0xffff0000, v85
    v_lshlrev_b32 v168, 16, v86
    v_and_b32 v169, 0xffff0000, v86
    v_lshlrev_b32 v170, 16, v87
    v_and_b32 v171, 0xffff0000, v87
    v_add_f32 v90, v100, v101
    v_add_f32 v91, v102, v103
    v_add_f32 v90, v90, v104
    v_add_f32 v91, v91, v105
    v_add_f32 v90, v90, v106
    v_add_f32 v91, v91, v107
    v_add_f32 v90, v90, v108
    v_add_f32 v91, v91, v109
    v_add_f32 v90, v90, v110
    v_add_f32 v91, v91, v111
    v_add_f32 v90, v90, v112
    v_add_f32 v91, v91, v113
    v_add_f32 v90, v90, v114
    v_add_f32 v91, v91, v115
    v_add_f32 v90, v90, v116
    v_add_f32 v91, v91, v117
    v_add_f32 v90, v90, v118
    v_add_f32 v91, v91, v119
    v_add_f32 v90, v90, v120
    v_add_f32 v91, v91, v121
    v_add_f32 v90, v90, v122
    v_add_f32 v91, v91, v123
    v_add_f32 v90, v90, v124
    v_add_f32 v91, v91, v125
    v_add_f32 v90, v90, v126
    v_add_f32 v91, v91, v127
    v_add_f32 v90, v90, v128
    v_add_f32 v91, v91, v129
    v_add_f32 v90, v90, v130
    v_add_f32 v91, v91, v131
    v_add_f32 v90, v90, v132
    v_add_f32 v91, v91, v133
    v_add_f32 v90, v90, v134
    v_add_f32 v91, v91, v135
    v_add_f32 v90, v90, v136
    v_add_f32 v91, v91, v137
    v_add_f32 v90, v90, v138
    v_add_f32 v91, v91, v139
    v_add_f32 v90, v90, v140
    v_add_f32 v91, v91, v141
    v_add_f32 v90, v90, v142
    v_add_f32 v91, v91, v143
    v_add_f32 v90, v90, v144
    v_add_f32 v91, v91, v145
    v_add_f32 v90, v90, v146
    v_add_f32 v91, v91, v147
    v_add_f32 v90, v90, v148
    v_add_f32 v91, v91, v149
    v_add_f32 v90, v90, v150
    v_add_f32 v91, v91, v151
    v_add_f32 v90, v90, v152
    v_add_f32 v91, v91, v153
    v_add_f32 v90, v90, v154
    v_add_f32 v91, v91, v155
    v_add_f32 v90, v90, v156
    v_add_f32 v91, v91, v157
    v_add_f32 v90, v90, v158
    v_add_f32 v91, v91, v159
    v_add_f32 v90, v90, v160
    v_add_f32 v91, v91, v161
    v_add_f32 v90, v90, v162
    v_add_f32 v91, v91, v163
    v_add_f32 v90, v90, v164
    v_add_f32 v91, v91, v165
    v_add_f32 v90, v90, v166
    v_add_f32 v91, v91, v167
    v_add_f32 v90, v90, v168
    v_add_f32 v91, v91, v169
    v_add_f32 v90, v90, v170
    v_add_f32 v91, v91, v171
    v_add_f32 v90, v90, v91
    s_nop 1
    v_add_f32_dpp v90, v90, v90 quad_perm:[1,0,3,2] row_mask:0xf bank_mask:0xf
    s_nop 1
    v_add_f32_dpp v90, v90, v90 quad_perm:[2,3,0,1] row_mask:0xf bank_mask:0xf
    s_nop 1
    v_add_f32_dpp v90, v90, v90 row_half_mirror row_mask:0xf bank_mask:0xf
    v_mul_f32 v90, 0x3ae38e39, v90
    v_sub_f32 v92, v100, v90
    v_mul_f32 v91, v92, v92
    v_sub_f32 v92, v101, v90
    v_fmac_f32 v91, v92, v92
    v_sub_f32 v92, v102, v90
    v_fmac_f32 v91, v92, v92
    v_sub_f32 v92, v103, v90
    v_fmac_f32 v91, v92, v92
    v_sub_f32 v92, v104, v90
    v_fmac_f32 v91, v92, v92
    v_sub_f32 v92, v105, v90
    v_fmac_f32 v91, v92, v92
    v_sub_f32 v92, v106, v90
    v_fmac_f32 v91, v92, v92
    v_sub_f32 v92, v107, v90
    v_fmac_f32 v91, v92, v92
    v_sub_f32 v92, v108, v90
    v_fmac_f32 v91, v92, v92
    v_sub_f32 v92, v109, v90
    v_fmac_f32 v91, v92, v92
    v_sub_f32 v92, v110, v90
    v_fmac_f32 v91, v92, v92
    v_sub_f32 v92, v111, v90
    v_fmac_f32 v91, v92, v92
    v_sub_f32 v92, v112, v90
    v_fmac_f32 v91, v92, v92
    v_sub_f32 v92, v113, v90
    v_fmac_f32 v91, v92, v92
    v_sub_f32 v92, v114, v90
    v_fmac_f32 v91, v92, v92
    v_sub_f32 v92, v115, v90
    v_fmac_f32 v91, v92, v92
    v_sub_f32 v92, v116, v90
    v_fmac_f32 v91, v92, v92
    v_sub_f32 v92, v117, v90
    v_fmac_f32 v91, v92, v92
    v_sub_f32 v92, v118, v90
    v_fmac_f32 v91, v92, v92
    v_sub_f32 v92, v119, v90
    v_fmac_f32 v91, v92, v92
    v_sub_f32 v92, v120, v90
    v_fmac_f32 v91, v92, v92
    v_sub_f32 v92, v121, v90
    v_fmac_f32 v91, v92, v92
    v_sub_f32 v92, v122, v90
    v_fmac_f32 v91, v92, v92
    v_sub_f32 v92, v123, v90
    v_fmac_f32 v91, v92, v92
    v_sub_f32 v92, v124, v90
    v_fmac_f32 v91, v92, v92
    v_sub_f32 v92, v125, v90
    v_fmac_f32 v91, v92, v92
    v_sub_f32 v92, v126, v90
    v_fmac_f32 v91, v92, v92
    v_sub_f32 v92, v127, v90
    v_fmac_f32 v91, v92, v92
    v_sub_f32 v92, v128, v90
    v_fmac_f32 v91, v92, v92
    v_sub_f32 v92, v129, v90
    v_fmac_f32 v91, v92, v92
    v_sub_f32 v92, v130, v90
    v_fmac_f32 v91, v92, v92
    v_sub_f32 v92, v131, v90
    v_fmac_f32 v91, v92, v92
    v_sub_f32 v92, v132, v90
    v_fmac_f32 v91, v92, v92
    v_sub_f32 v92, v133, v90
    v_fmac_f32 v91, v92, v92
    v_sub_f32 v92, v134, v90
    v_fmac_f32 v91, v92, v92
    v_sub_f32 v92, v135, v90
    v_fmac_f32 v91, v92, v92
    v_sub_f32 v92, v136, v90
    v_fmac_f32 v91, v92, v92
    v_sub_f32 v92, v137, v90
    v_fmac_f32 v91, v92, v92
    v_sub_f32 v92, v138, v90
    v_fmac_f32 v91, v92, v92
    v_sub_f32 v92, v139, v90
    v_fmac_f32 v91, v92, v92
    v_sub_f32 v92, v140, v90
    v_fmac_f32 v91, v92, v92
    v_sub_f32 v92, v141, v90
    v_fmac_f32 v91, v92, v92
    v_sub_f32 v92, v142, v90
    v_fmac_f32 v91, v92, v92
    v_sub_f32 v92, v143, v90
    v_fmac_f32 v91, v92, v92
    v_sub_f32 v92, v144, v90
    v_fmac_f32 v91, v92, v92
    v_sub_f32 v92, v145, v90
    v_fmac_f32 v91, v92, v92
    v_sub_f32 v92, v146, v90
    v_fmac_f32 v91, v92, v92
    v_sub_f32 v92, v147, v90
    v_fmac_f32 v91, v92, v92
    v_sub_f32 v92, v148, v90
    v_fmac_f32 v91, v92, v92
    v_sub_f32 v92, v149, v90
    v_fmac_f32 v91, v92, v92
    v_sub_f32 v92, v150, v90
    v_fmac_f32 v91, v92, v92
    v_sub_f32 v92, v151, v90
    v_fmac_f32 v91, v92, v92
    v_sub_f32 v92, v152, v90
    v_fmac_f32 v91, v92, v92
    v_sub_f32 v92, v153, v90
    v_fmac_f32 v91, v92, v92
    v_sub_f32 v92, v154, v90
    v_fmac_f32 v91, v92, v92
    v_sub_f32 v92, v155, v90
    v_fmac_f32 v91, v92, v92
    v_sub_f32 v92, v156, v90
    v_fmac_f32 v91, v92, v92
    v_sub_f32 v92, v157, v90
    v_fmac_f32 v91, v92, v92
    v_sub_f32 v92, v158, v90
    v_fmac_f32 v91, v92, v92
    v_sub_f32 v92, v159, v90
    v_fmac_f32 v91, v92, v92
    v_sub_f32 v92, v160, v90
    v_fmac_f32 v91, v92, v92
    v_sub_f32 v92, v161, v90
    v_fmac_f32 v91, v92, v92
    v_sub_f32 v92, v162, v90
    v_fmac_f32 v91, v92, v92
    v_sub_f32 v92, v163, v90
    v_fmac_f32 v91, v92, v92
    v_sub_f32 v92, v164, v90
    v_fmac_f32 v91, v92, v92
    v_sub_f32 v92, v165, v90
    v_fmac_f32 v91, v92, v92
    v_sub_f32 v92, v166, v90
    v_fmac_f32 v91, v92, v92
    v_sub_f32 v92, v167, v90
    v_fmac_f32 v91, v92, v92
    v_sub_f32 v92, v168, v90
    v_fmac_f32 v91, v92, v92
    v_sub_f32 v92, v169, v90
    v_fmac_f32 v91, v92, v92
    v_sub_f32 v92, v170, v90
    v_fmac_f32 v91, v92, v92
    v_sub_f32 v92, v171, v90
    v_fmac_f32 v91, v92, v92
    s_nop 1
    v_add_f32_dpp v91, v91, v91 quad_perm:[1,0,3,2] row_mask:0xf bank_mask:0xf
    s_nop 1
    v_add_f32_dpp v91, v91, v91 quad_perm:[2,3,0,1] row_mask:0xf bank_mask:0xf
    s_nop 1
    v_add_f32_dpp v91, v91, v91 row_half_mirror row_mask:0xf bank_mask:0xf
    v_mul_f32 v91, 0x3ae38e39, v91
    v_cvt_pk_bf16_f32 v92, v90, v91
    v_lshlrev_b32 v90, 16, v92
    v_and_b32 v91, 0xffff0000, v92
    v_add_f32 v91, 0x3727c5ac, v91
    v_cvt_pk_bf16_f32 v91, v91, v91
    v_lshlrev_b32 v91, 16, v91
    v_sqrt_f32 v91, v91
    s_nop 0
    v_cvt_pk_bf16_f32 v91, v91, v91
    v_lshlrev_b32 v91, 16, v91
    v_rcp_f32 v91, v91
    s_nop 0
    v_sub_f32 v100, v100, v90
    v_sub_f32 v101, v101, v90
    v_cvt_pk_bf16_f32 v52, v100, v101
    v_lshlrev_b32 v100, 16, v52
    v_and_b32 v101, 0xffff0000, v52
    v_mul_f32 v100, v100, v91
    v_mul_f32 v101, v101, v91
    v_cvt_pk_bf16_f32 v52, v100, v101
    v_sub_f32 v102, v102, v90
    v_sub_f32 v103, v103, v90
    v_cvt_pk_bf16_f32 v53, v102, v103
    v_lshlrev_b32 v102, 16, v53
    v_and_b32 v103, 0xffff0000, v53
    v_mul_f32 v102, v102, v91
    v_mul_f32 v103, v103, v91
    v_cvt_pk_bf16_f32 v53, v102, v103
    v_sub_f32 v104, v104, v90
    v_sub_f32 v105, v105, v90
    v_cvt_pk_bf16_f32 v54, v104, v105
    v_lshlrev_b32 v104, 16, v54
    v_and_b32 v105, 0xffff0000, v54
    v_mul_f32 v104, v104, v91
    v_mul_f32 v105, v105, v91
    v_cvt_pk_bf16_f32 v54, v104, v105
    v_sub_f32 v106, v106, v90
    v_sub_f32 v107, v107, v90
    v_cvt_pk_bf16_f32 v55, v106, v107
    v_lshlrev_b32 v106, 16, v55
    v_and_b32 v107, 0xffff0000, v55
    v_mul_f32 v106, v106, v91
    v_mul_f32 v107, v107, v91
    v_cvt_pk_bf16_f32 v55, v106, v107
    v_sub_f32 v108, v108, v90
    v_sub_f32 v109, v109, v90
    v_cvt_pk_bf16_f32 v56, v108, v109
    v_lshlrev_b32 v108, 16, v56
    v_and_b32 v109, 0xffff0000, v56
    v_mul_f32 v108, v108, v91
    v_mul_f32 v109, v109, v91
    v_cvt_pk_bf16_f32 v56, v108, v109
    v_sub_f32 v110, v110, v90
    v_sub_f32 v111, v111, v90
    v_cvt_pk_bf16_f32 v57, v110, v111
    v_lshlrev_b32 v110, 16, v57
    v_and_b32 v111, 0xffff0000, v57
    v_mul_f32 v110, v110, v91
    v_mul_f32 v111, v111, v91
    v_cvt_pk_bf16_f32 v57, v110, v111
    v_sub_f32 v112, v112, v90
    v_sub_f32 v113, v113, v90
    v_cvt_pk_bf16_f32 v58, v112, v113
    v_lshlrev_b32 v112, 16, v58
    v_and_b32 v113, 0xffff0000, v58
    v_mul_f32 v112, v112, v91
    v_mul_f32 v113, v113, v91
    v_cvt_pk_bf16_f32 v58, v112, v113
    v_sub_f32 v114, v114, v90
    v_sub_f32 v115, v115, v90
    v_cvt_pk_bf16_f32 v59, v114, v115
    v_lshlrev_b32 v114, 16, v59
    v_and_b32 v115, 0xffff0000, v59
    v_mul_f32 v114, v114, v91
    v_mul_f32 v115, v115, v91
    v_cvt_pk_bf16_f32 v59, v114, v115
    v_sub_f32 v116, v116, v90
    v_sub_f32 v117, v117, v90
    v_cvt_pk_bf16_f32 v60, v116, v117
    v_lshlrev_b32 v116, 16, v60
    v_and_b32 v117, 0xffff0000, v60
    v_mul_f32 v116, v116, v91
    v_mul_f32 v117, v117, v91
    v_cvt_pk_bf16_f32 v60, v116, v117
    v_sub_f32 v118, v118, v90
    v_sub_f32 v119, v119, v90
    v_cvt_pk_bf16_f32 v61, v118, v119
    v_lshlrev_b32 v118, 16, v61
    v_and_b32 v119, 0xffff0000, v61
    v_mul_f32 v118, v118, v91
    v_mul_f32 v119, v119, v91
    v_cvt_pk_bf16_f32 v61, v118, v119
    v_sub_f32 v120, v120, v90
    v_sub_f32 v121, v121, v90
    v_cvt_pk_bf16_f32 v62, v120, v121
    v_lshlrev_b32 v120, 16, v62
    v_and_b32 v121, 0xffff0000, v62
    v_mul_f32 v120, v120, v91
    v_mul_f32 v121, v121, v91
    v_cvt_pk_bf16_f32 v62, v120, v121
    v_sub_f32 v122, v122, v90
    v_sub_f32 v123, v123, v90
    v_cvt_pk_bf16_f32 v63, v122, v123
    v_lshlrev_b32 v122, 16, v63
    v_and_b32 v123, 0xffff0000, v63
    v_mul_f32 v122, v122, v91
    v_mul_f32 v123, v123, v91
    v_cvt_pk_bf16_f32 v63, v122, v123
    v_sub_f32 v124, v124, v90
    v_sub_f32 v125, v125, v90
    v_cvt_pk_bf16_f32 v64, v124, v125
    v_lshlrev_b32 v124, 16, v64
    v_and_b32 v125, 0xffff0000, v64
    v_mul_f32 v124, v124, v91
    v_mul_f32 v125, v125, v91
    v_cvt_pk_bf16_f32 v64, v124, v125
    v_sub_f32 v126, v126, v90
    v_sub_f32 v127, v127, v90
    v_cvt_pk_bf16_f32 v65, v126, v127
    v_lshlrev_b32 v126, 16, v65
    v_and_b32 v127, 0xffff0000, v65
    v_mul_f32 v126, v126, v91
    v_mul_f32 v127, v127, v91
    v_cvt_pk_bf16_f32 v65, v126, v127
    v_sub_f32 v128, v128, v90
    v_sub_f32 v129, v129, v90
    v_cvt_pk_bf16_f32 v66, v128, v129
    v_lshlrev_b32 v128, 16, v66
    v_and_b32 v129, 0xffff0000, v66
    v_mul_f32 v128, v128, v91
    v_mul_f32 v129, v129, v91
    v_cvt_pk_bf16_f32 v66, v128, v129
    v_sub_f32 v130, v130, v90
    v_sub_f32 v131, v131, v90
    v_cvt_pk_bf16_f32 v67, v130, v131
    v_lshlrev_b32 v130, 16, v67
    v_and_b32 v131, 0xffff0000, v67
    v_mul_f32 v130, v130, v91
    v_mul_f32 v131, v131, v91
    v_cvt_pk_bf16_f32 v67, v130, v131
    v_sub_f32 v132, v132, v90
    v_sub_f32 v133, v133, v90
    v_cvt_pk_bf16_f32 v68, v132, v133
    v_lshlrev_b32 v132, 16, v68
    v_and_b32 v133, 0xffff0000, v68
    v_mul_f32 v132, v132, v91
    v_mul_f32 v133, v133, v91
    v_cvt_pk_bf16_f32 v68, v132, v133
    v_sub_f32 v134, v134, v90
    v_sub_f32 v135, v135, v90
    v_cvt_pk_bf16_f32 v69, v134, v135
    v_lshlrev_b32 v134, 16, v69
    v_and_b32 v135, 0xffff0000, v69
    v_mul_f32 v134, v134, v91
    v_mul_f32 v135, v135, v91
    v_cvt_pk_bf16_f32 v69, v134, v135
    v_sub_f32 v136, v136, v90
    v_sub_f32 v137, v137, v90
    v_cvt_pk_bf16_f32 v70, v136, v137
    v_lshlrev_b32 v136, 16, v70
    v_and_b32 v137, 0xffff0000, v70
    v_mul_f32 v136, v136, v91
    v_mul_f32 v137, v137, v91
    v_cvt_pk_bf16_f32 v70, v136, v137
    v_sub_f32 v138, v138, v90
    v_sub_f32 v139, v139, v90
    v_cvt_pk_bf16_f32 v71, v138, v139
    v_lshlrev_b32 v138, 16, v71
    v_and_b32 v139, 0xffff0000, v71
    v_mul_f32 v138, v138, v91
    v_mul_f32 v139, v139, v91
    v_cvt_pk_bf16_f32 v71, v138, v139
    v_sub_f32 v140, v140, v90
    v_sub_f32 v141, v141, v90
    v_cvt_pk_bf16_f32 v72, v140, v141
    v_lshlrev_b32 v140, 16, v72
    v_and_b32 v141, 0xffff0000, v72
    v_mul_f32 v140, v140, v91
    v_mul_f32 v141, v141, v91
    v_cvt_pk_bf16_f32 v72, v140, v141
    v_sub_f32 v142, v142, v90
    v_sub_f32 v143, v143, v90
    v_cvt_pk_bf16_f32 v73, v142, v143
    v_lshlrev_b32 v142, 16, v73
    v_and_b32 v143, 0xffff0000, v73
    v_mul_f32 v142, v142, v91
    v_mul_f32 v143, v143, v91
    v_cvt_pk_bf16_f32 v73, v142, v143
    v_sub_f32 v144, v144, v90
    v_sub_f32 v145, v145, v90
    v_cvt_pk_bf16_f32 v74, v144, v145
    v_lshlrev_b32 v144, 16, v74
    v_and_b32 v145, 0xffff0000, v74
    v_mul_f32 v144, v144, v91
    v_mul_f32 v145, v145, v91
    v_cvt_pk_bf16_f32 v74, v144, v145
    v_sub_f32 v146, v146, v90
    v_sub_f32 v147, v147, v90
    v_cvt_pk_bf16_f32 v75, v146, v147
    v_lshlrev_b32 v146, 16, v75
    v_and_b32 v147, 0xffff0000, v75
    v_mul_f32 v146, v146, v91
    v_mul_f32 v147, v147, v91
    v_cvt_pk_bf16_f32 v75, v146, v147
    v_sub_f32 v148, v148, v90
    v_sub_f32 v149, v149, v90
    v_cvt_pk_bf16_f32 v76, v148, v149
    v_lshlrev_b32 v148, 16, v76
    v_and_b32 v149, 0xffff0000, v76
    v_mul_f32 v148, v148, v91
    v_mul_f32 v149, v149, v91
    v_cvt_pk_bf16_f32 v76, v148, v149
    v_sub_f32 v150, v150, v90
    v_sub_f32 v151, v151, v90
    v_cvt_pk_bf16_f32 v77, v150, v151
    v_lshlrev_b32 v150, 16, v77
    v_and_b32 v151, 0xffff0000, v77
    v_mul_f32 v150, v150, v91
    v_mul_f32 v151, v151, v91
    v_cvt_pk_bf16_f32 v77, v150, v151
    v_sub_f32 v152, v152, v90
    v_sub_f32 v153, v153, v90
    v_cvt_pk_bf16_f32 v78, v152, v153
    v_lshlrev_b32 v152, 16, v78
    v_and_b32 v153, 0xffff0000, v78
    v_mul_f32 v152, v152, v91
    v_mul_f32 v153, v153, v91
    v_cvt_pk_bf16_f32 v78, v152, v153
    v_sub_f32 v154, v154, v90
    v_sub_f32 v155, v155, v90
    v_cvt_pk_bf16_f32 v79, v154, v155
    v_lshlrev_b32 v154, 16, v79
    v_and_b32 v155, 0xffff0000, v79
    v_mul_f32 v154, v154, v91
    v_mul_f32 v155, v155, v91
    v_cvt_pk_bf16_f32 v79, v154, v155
    v_sub_f32 v156, v156, v90
    v_sub_f32 v157, v157, v90
    v_cvt_pk_bf16_f32 v80, v156, v157
    v_lshlrev_b32 v156, 16, v80
    v_and_b32 v157, 0xffff0000, v80
    v_mul_f32 v156, v156, v91
    v_mul_f32 v157, v157, v91
    v_cvt_pk_bf16_f32 v80, v156, v157
    v_sub_f32 v158, v158, v90
    v_sub_f32 v159, v159, v90
    v_cvt_pk_bf16_f32 v81, v158, v159
    v_lshlrev_b32 v158, 16, v81
    v_and_b32 v159, 0xffff0000, v81
    v_mul_f32 v158, v158, v91
    v_mul_f32 v159, v159, v91
    v_cvt_pk_bf16_f32 v81, v158, v159
    v_sub_f32 v160, v160, v90
    v_sub_f32 v161, v161, v90
    v_cvt_pk_bf16_f32 v82, v160, v161
    v_lshlrev_b32 v160, 16, v82
    v_and_b32 v161, 0xffff0000, v82
    v_mul_f32 v160, v160, v91
    v_mul_f32 v161, v161, v91
    v_cvt_pk_bf16_f32 v82, v160, v161
    v_sub_f32 v162, v162, v90
    v_sub_f32 v163, v163, v90
    v_cvt_pk_bf16_f32 v83, v162, v163
    v_lshlrev_b32 v162, 16, v83
    v_and_b32 v163, 0xffff0000, v83
    v_mul_f32 v162, v162, v91
    v_mul_f32 v163, v163, v91
    v_cvt_pk_bf16_f32 v83, v162, v163
    v_sub_f32 v164, v164, v90
    v_sub_f32 v165, v165, v90
    v_cvt_pk_bf16_f32 v84, v164, v165
    v_lshlrev_b32 v164, 16, v84
    v_and_b32 v165, 0xffff0000, v84
    v_mul_f32 v164, v164, v91
    v_mul_f32 v165, v165, v91
    v_cvt_pk_bf16_f32 v84, v164, v165
    v_sub_f32 v166, v166, v90
    v_sub_f32 v167, v167, v90
    v_cvt_pk_bf16_f32 v85, v166, v167
    v_lshlrev_b32 v166, 16, v85
    v_and_b32 v167, 0xffff0000, v85
    v_mul_f32 v166, v166, v91
    v_mul_f32 v167, v167, v91
    v_cvt_pk_bf16_f32 v85, v166, v167
    v_sub_f32 v168, v168, v90
    v_sub_f32 v169, v169, v90
    v_cvt_pk_bf16_f32 v86, v168, v169
    v_lshlrev_b32 v168, 16, v86
    v_and_b32 v169, 0xffff0000, v86
    v_mul_f32 v168, v168, v91
    v_mul_f32 v169, v169, v91
    v_cvt_pk_bf16_f32 v86, v168, v169
    v_sub_f32 v170, v170, v90
    v_sub_f32 v171, v171, v90
    v_cvt_pk_bf16_f32 v87, v170, v171
    v_lshlrev_b32 v170, 16, v87
    v_and_b32 v171, 0xffff0000, v87
    v_mul_f32 v170, v170, v91
    v_mul_f32 v171, v171, v91
    v_cvt_pk_bf16_f32 v87, v170, v171
    s_lshl_b32 s22, s3, 4
    s_add_u32 s22, s22, 8
    s_lshr_b32 s23, s22, 5
    s_mul_i32 s23, s23, 36864
    s_and_b32 s22, s22, 31
    v_lshrrev_b32 v7, 3, v1
    v_add_u32 v7, s22, v7
    v_lshlrev_b32 v7, 4, v7
    v_add_u32 v7, s23, v7
    v_and_b32 v6, 7, v1
    v_lshrrev_b32 v8, 1, v6
    v_lshl_add_u32 v7, v8, 10, v7
    v_and_b32 v8, 1, v6
    v_lshl_add_u32 v7, v8, 9, v7
    ds_write_b128 v7, v[52:55] offset:0
    ds_write_b128 v7, v[56:59] offset:4096
    ds_write_b128 v7, v[60:63] offset:8192
    ds_write_b128 v7, v[64:67] offset:12288
    ds_write_b128 v7, v[68:71] offset:16384
    ds_write_b128 v7, v[72:75] offset:20480
    ds_write_b128 v7, v[76:79] offset:24576
    ds_write_b128 v7, v[80:83] offset:28672
    ds_write_b128 v7, v[84:87] offset:32768
    s_waitcnt lgkmcnt(0)
    s_barrier
    v_mov_b32 v100, 0
    v_mov_b32 v101, 0
    v_mov_b32 v102, 0
    v_mov_b32 v103, 0
    v_mov_b32 v104, 0
    v_mov_b32 v105, 0
    v_mov_b32 v106, 0
    v_mov_b32 v107, 0
    v_mov_b32 v108, 0
    v_mov_b32 v109, 0
    v_mov_b32 v110, 0
    v_mov_b32 v111, 0
    v_mov_b32 v112, 0
    v_mov_b32 v113, 0
    v_mov_b32 v114, 0
    v_mov_b32 v115, 0
    v_mov_b32 v116, 0
    v_mov_b32 v117, 0
    v_mov_b32 v118, 0
    v_mov_b32 v119, 0
    v_mov_b32 v120, 0
    v_mov_b32 v121, 0
    v_mov_b32 v122, 0
    v_mov_b32 v123, 0
    v_mov_b32 v124, 0
    v_mov_b32 v125, 0
    v_mov_b32 v126, 0
    v_mov_b32 v127, 0
    v_mov_b32 v128, 0
    v_mov_b32 v129, 0
    v_mov_b32 v130, 0
    v_mov_b32 v131, 0
    v_mov_b32 v132, 0
    v_mov_b32 v133, 0
    v_mov_b32 v134, 0
    v_mov_b32 v135, 0
    v_mov_b32 v136, 0
    v_mov_b32 v137, 0
    v_mov_b32 v138, 0
    v_mov_b32 v139, 0
    v_mov_b32 v140, 0
    v_mov_b32 v141, 0
    v_mov_b32 v142, 0
    v_mov_b32 v143, 0
    v_mov_b32 v144, 0
    v_mov_b32 v145, 0
    v_mov_b32 v146, 0
    v_mov_b32 v147, 0
    v_mov_b32 v148, 0
    v_mov_b32 v149, 0
    v_mov_b32 v150, 0
    v_mov_b32 v151, 0
    v_mov_b32 v152, 0
    v_mov_b32 v153, 0
    v_mov_b32 v154, 0
    v_mov_b32 v155, 0
    v_mov_b32 v156, 0
    v_mov_b32 v157, 0
    v_mov_b32 v158, 0
    v_mov_b32 v159, 0
    v_mov_b32 v160, 0
    v_mov_b32 v161, 0
    v_mov_b32 v162, 0
    v_mov_b32 v163, 0
    v_mov_b32 v164, 0
    v_mov_b32 v165, 0
    v_mov_b32 v166, 0
    v_mov_b32 v167, 0
    v_mov_b32 v168, 0
    v_mov_b32 v169, 0
    v_mov_b32 v170, 0
    v_mov_b32 v171, 0
    v_mov_b32 v172, 0
    v_mov_b32 v173, 0
    v_mov_b32 v174, 0
    v_mov_b32 v175, 0
    v_mov_b32 v176, 0
    v_mov_b32 v177, 0
    v_mov_b32 v178, 0
    v_mov_b32 v179, 0
    v_mov_b32 v180, 0
    v_mov_b32 v181, 0
    v_mov_b32 v182, 0
    v_mov_b32 v183, 0
    v_mov_b32 v184, 0
    v_mov_b32 v185, 0
    v_mov_b32 v186, 0
    v_mov_b32 v187, 0
    v_mov_b32 v188, 0
    v_mov_b32 v189, 0
    v_mov_b32 v190, 0
    v_mov_b32 v191, 0
    v_mov_b32 v192, 0
    v_mov_b32 v193, 0
    v_mov_b32 v194, 0
    v_mov_b32 v195, 0
    v_add_u32 v5, 36864, v4
    buffer_load_dwordx4 v[16:19], v4, s[12:15], s19 offen
    buffer_load_dwordx4 v[20:23], v4, s[12:15], s20 offen
    buffer_load_dwordx4 v[24:27], v4, s[12:15], s21 offen
    s_add_u32 s19, s19, 1024
    s_add_u32 s20, s20, 1024
    s_add_u32 s21, s21, 1024
    buffer_load_dwordx4 v[28:31], v4, s[12:15], s19 offen
    buffer_load_dwordx4 v[32:35], v4, s[12:15], s20 offen
    buffer_load_dwordx4 v[36:39], v4, s[12:15], s21 offen
    s_add_u32 s19, s19, 1024
    s_add_u32 s20, s20, 1024
    s_add_u32 s21, s21, 1024
    buffer_load_dwordx4 v[40:43], v4, s[12:15], s19 offen
    buffer_load_dwordx4 v[44:47], v4, s[12:15], s20 offen
    buffer_load_dwordx4 v[48:51], v4, s[12:15], s21 offen
    s_add_u32 s19, s19, 1024
    s_add_u32 s20, s20, 1024
    s_add_u32 s21, s21, 1024
    ds_read_b128 v[64:67], v4 offset:0
    ds_read_b128 v[68:71], v5 offset:0
    buffer_load_dwordx4 v[52:55], v4, s[12:15], s19 offen
    buffer_load_dwordx4 v[56:59], v4, s[12:15], s20 offen
    buffer_load_dwordx4 v[60:63], v4, s[12:15], s21 offen
    s_add_u32 s19, s19, 1024
    s_add_u32 s20, s20, 1024
    s_add_u32 s21, s21, 1024
    ds_read_b128 v[72:75], v4 offset:1024
    ds_read_b128 v[76:79], v5 offset:1024
    s_waitcnt vmcnt(9) lgkmcnt(2)
    v_mfma_f32_32x32x16_bf16 v[100:115], v[16:19], v[64:67], v[100:115]
    v_mfma_f32_32x32x16_bf16 v[132:147], v[20:23], v[64:67], v[132:147]
    v_mfma_f32_32x32x16_bf16 v[164:179], v[64:67], v[24:27], v[164:179]
    v_mfma_f32_32x32x16_bf16 v[116:131], v[16:19], v[68:71], v[116:131]
    v_mfma_f32_32x32x16_bf16 v[148:163], v[20:23], v[68:71], v[148:163]
    v_mfma_f32_32x32x16_bf16 v[180:195], v[68:71], v[24:27], v[180:195]
    buffer_load_dwordx4 v[16:19], v4, s[12:15], s19 offen
    buffer_load_dwordx4 v[20:23], v4, s[12:15], s20 offen
    buffer_load_dwordx4 v[24:27], v4, s[12:15], s21 offen
    s_add_u32 s19, s19, 1024
    s_add_u32 s20, s20, 1024
    s_add_u32 s21, s21, 1024
    ds_read_b128 v[80:83], v4 offset:2048
    ds_read_b128 v[84:87], v5 offset:2048
    s_waitcnt vmcnt(9) lgkmcnt(2)
    v_mfma_f32_32x32x16_bf16 v[100:115], v[28:31], v[72:75], v[100:115]
    v_mfma_f32_32x32x16_bf16 v[132:147], v[32:35], v[72:75], v[132:147]
    v_mfma_f32_32x32x16_bf16 v[164:179], v[72:75], v[36:39], v[164:179]
    v_mfma_f32_32x32x16_bf16 v[116:131], v[28:31], v[76:79], v[116:131]
    v_mfma_f32_32x32x16_bf16 v[148:163], v[32:35], v[76:79], v[148:163]
    v_mfma_f32_32x32x16_bf16 v[180:195], v[76:79], v[36:39], v[180:195]
    buffer_load_dwordx4 v[28:31], v4, s[12:15], s19 offen
    buffer_load_dwordx4 v[32:35], v4, s[12:15], s20 offen
    buffer_load_dwordx4 v[36:39], v4, s[12:15], s21 offen
    s_add_u32 s19, s19, 1024
    s_add_u32 s20, s20, 1024
    s_add_u32 s21, s21, 1024
    ds_read_b128 v[64:67], v4 offset:3072
    ds_read_b128 v[68:71], v5 offset:3072
    s_waitcnt vmcnt(9) lgkmcnt(2)
    v_mfma_f32_32x32x16_bf16 v[100:115], v[40:43], v[80:83], v[100:115]
    v_mfma_f32_32x32x16_bf16 v[132:147], v[44:47], v[80:83], v[132:147]
    v_mfma_f32_32x32x16_bf16 v[164:179], v[80:83], v[48:51], v[164:179]
    v_mfma_f32_32x32x16_bf16 v[116:131], v[40:43], v[84:87], v[116:131]
    v_mfma_f32_32x32x16_bf16 v[148:163], v[44:47], v[84:87], v[148:163]
    v_mfma_f32_32x32x16_bf16 v[180:195], v[84:87], v[48:51], v[180:195]
    buffer_load_dwordx4 v[40:43], v4, s[12:15], s19 offen
    buffer_load_dwordx4 v[44:47], v4, s[12:15], s20 offen
    buffer_load_dwordx4 v[48:51], v4, s[12:15], s21 offen
    s_add_u32 s19, s19, 1024
    s_add_u32 s20, s20, 1024
    s_add_u32 s21, s21, 1024
    ds_read_b128 v[72:75], v4 offset:4096
    ds_read_b128 v[76:79], v5 offset:4096
    s_waitcnt vmcnt(9) lgkmcnt(2)
    v_mfma_f32_32x32x16_bf16 v[100:115], v[52:55], v[64:67], v[100:115]
    v_mfma_f32_32x32x16_bf16 v[132:147], v[56:59], v[64:67], v[132:147]
    v_mfma_f32_32x32x16_bf16 v[164:179], v[64:67], v[60:63], v[164:179]
    v_mfma_f32_32x32x16_bf16 v[116:131], v[52:55], v[68:71], v[116:131]
    v_mfma_f32_32x32x16_bf16 v[148:163], v[56:59], v[68:71], v[148:163]
    v_mfma_f32_32x32x16_bf16 v[180:195], v[68:71], v[60:63], v[180:195]
    buffer_load_dwordx4 v[52:55], v4, s[12:15], s19 offen
    buffer_load_dwordx4 v[56:59], v4, s[12:15], s20 offen
    buffer_load_dwordx4 v[60:63], v4, s[12:15], s21 offen
    s_add_u32 s19, s19, 1024
    s_add_u32 s20, s20, 1024
    s_add_u32 s21, s21, 1024
    ds_read_b128 v[80:83], v4 offset:5120
    ds_read_b128 v[84:87], v5 offset:5120
    s_waitcnt vmcnt(9) lgkmcnt(2)
    v_mfma_f32_32x32x16_bf16 v[100:115], v[16:19], v[72:75], v[100:115]
    v_mfma_f32_32x32x16_bf16 v[132:147], v[20:23], v[72:75], v[132:147]
    v_mfma_f32_32x32x16_bf16 v[164:179], v[72:75], v[24:27], v[164:179]
    v_mfma_f32_32x32x16_bf16 v[116:131], v[16:19], v[76:79], v[116:131]
    v_mfma_f32_32x32x16_bf16 v[148:163], v[20:23], v[76:79], v[148:163]
    v_mfma_f32_32x32x16_bf16 v[180:195], v[76:79], v[24:27], v[180:195]
    buffer_load_dwordx4 v[16:19], v4, s[12:15], s19 offen
    buffer_load_dwordx4 v[20:23], v4, s[12:15], s20 offen
    buffer_load_dwordx4 v[24:27], v4, s[12:15], s21 offen
    s_add_u32 s19, s19, 1024
    s_add_u32 s20, s20, 1024
    s_add_u32 s21, s21, 1024
    ds_read_b128 v[64:67], v4 offset:6144
    ds_read_b128 v[68:71], v5 offset:6144
    s_waitcnt vmcnt(9) lgkmcnt(2)
    v_mfma_f32_32x32x16_bf16 v[100:115], v[28:31], v[80:83], v[100:115]
    v_mfma_f32_32x32x16_bf16 v[132:147], v[32:35], v[80:83], v[132:147]
    v_mfma_f32_32x32x16_bf16 v[164:179], v[80:83], v[36:39], v[164:179]
    v_mfma_f32_32x32x16_bf16 v[116:131], v[28:31], v[84:87], v[116:131]
    v_mfma_f32_32x32x16_bf16 v[148:163], v[32:35], v[84:87], v[148:163]
    v_mfma_f32_32x32x16_bf16 v[180:195], v[84:87], v[36:39], v[180:195]
    buffer_load_dwordx4 v[28:31], v4, s[12:15], s19 offen
    buffer_load_dwordx4 v[32:35], v4, s[12:15], s20 offen
    buffer_load_dwordx4 v[36:39], v4, s[12:15], s21 offen
    s_add_u32 s19, s19, 1024
    s_add_u32 s20, s20, 1024
    s_add_u32 s21, s21, 1024
    ds_read_b128 v[72:75], v4 offset:7168
    ds_read_b128 v[76:79], v5 offset:7168
    s_waitcnt vmcnt(9) lgkmcnt(2)
    v_mfma_f32_32x32x16_bf16 v[100:115], v[40:43], v[64:67], v[100:115]
    v_mfma_f32_32x32x16_bf16 v[132:147], v[44:47], v[64:67], v[132:147]
    v_mfma_f32_32x32x16_bf16 v[164:179], v[64:67], v[48:51], v[164:179]
    v_mfma_f32_32x32x16_bf16 v[116:131], v[40:43], v[68:71], v[116:131]
    v_mfma_f32_32x32x16_bf16 v[148:163], v[44:47], v[68:71], v[148:163]
    v_mfma_f32_32x32x16_bf16 v[180:195], v[68:71], v[48:51], v[180:195]
    buffer_load_dwordx4 v[40:43], v4, s[12:15], s19 offen
    buffer_load_dwordx4 v[44:47], v4, s[12:15], s20 offen
    buffer_load_dwordx4 v[48:51], v4, s[12:15], s21 offen
    s_add_u32 s19, s19, 1024
    s_add_u32 s20, s20, 1024
    s_add_u32 s21, s21, 1024
    ds_read_b128 v[80:83], v4 offset:8192
    ds_read_b128 v[84:87], v5 offset:8192
    s_waitcnt vmcnt(9) lgkmcnt(2)
    v_mfma_f32_32x32x16_bf16 v[100:115], v[52:55], v[72:75], v[100:115]
    v_mfma_f32_32x32x16_bf16 v[132:147], v[56:59], v[72:75], v[132:147]
    v_mfma_f32_32x32x16_bf16 v[164:179], v[72:75], v[60:63], v[164:179]
    v_mfma_f32_32x32x16_bf16 v[116:131], v[52:55], v[76:79], v[116:131]
    v_mfma_f32_32x32x16_bf16 v[148:163], v[56:59], v[76:79], v[148:163]
    v_mfma_f32_32x32x16_bf16 v[180:195], v[76:79], v[60:63], v[180:195]
    buffer_load_dwordx4 v[52:55], v4, s[12:15], s19 offen
    buffer_load_dwordx4 v[56:59], v4, s[12:15], s20 offen
    buffer_load_dwordx4 v[60:63], v4, s[12:15], s21 offen
    s_add_u32 s19, s19, 1024
    s_add_u32 s20, s20, 1024
    s_add_u32 s21, s21, 1024
    ds_read_b128 v[64:67], v4 offset:9216
    ds_read_b128 v[68:71], v5 offset:9216
    s_waitcnt vmcnt(9) lgkmcnt(2)
    v_mfma_f32_32x32x16_bf16 v[100:115], v[16:19], v[80:83], v[100:115]
    v_mfma_f32_32x32x16_bf16 v[132:147], v[20:23], v[80:83], v[132:147]
    v_mfma_f32_32x32x16_bf16 v[164:179], v[80:83], v[24:27], v[164:179]
    v_mfma_f32_32x32x16_bf16 v[116:131], v[16:19], v[84:87], v[116:131]
    v_mfma_f32_32x32x16_bf16 v[148:163], v[20:23], v[84:87], v[148:163]
    v_mfma_f32_32x32x16_bf16 v[180:195], v[84:87], v[24:27], v[180:195]
    buffer_load_dwordx4 v[16:19], v4, s[12:15], s19 offen
    buffer_load_dwordx4 v[20:23], v4, s[12:15], s20 offen
    buffer_load_dwordx4 v[24:27], v4, s[12:15], s21 offen
    s_add_u32 s19, s19, 1024
    s_add_u32 s20, s20, 1024
    s_add_u32 s21, s21, 1024
    ds_read_b128 v[72:75], v4 offset:10240
    ds_read_b128 v[76:79], v5 offset:10240
    s_waitcnt vmcnt(9) lgkmcnt(2)
    v_mfma_f32_32x32x16_bf16 v[100:115], v[28:31], v[64:67], v[100:115]
    v_mfma_f32_32x32x16_bf16 v[132:147], v[32:35], v[64:67], v[132:147]
    v_mfma_f32_32x32x16_bf16 v[164:179], v[64:67], v[36:39], v[164:179]
    v_mfma_f32_32x32x16_bf16 v[116:131], v[28:31], v[68:71], v[116:131]
    v_mfma_f32_32x32x16_bf16 v[148:163], v[32:35], v[68:71], v[148:163]
    v_mfma_f32_32x32x16_bf16 v[180:195], v[68:71], v[36:39], v[180:195]
    buffer_load_dwordx4 v[28:31], v4, s[12:15], s19 offen
    buffer_load_dwordx4 v[32:35], v4, s[12:15], s20 offen
    buffer_load_dwordx4 v[36:39], v4, s[12:15], s21 offen
    s_add_u32 s19, s19, 1024
    s_add_u32 s20, s20, 1024
    s_add_u32 s21, s21, 1024
    ds_read_b128 v[80:83], v4 offset:11264
    ds_read_b128 v[84:87], v5 offset:11264
    s_waitcnt vmcnt(9) lgkmcnt(2)
    v_mfma_f32_32x32x16_bf16 v[100:115], v[40:43], v[72:75], v[100:115]
    v_mfma_f32_32x32x16_bf16 v[132:147], v[44:47], v[72:75], v[132:147]
    v_mfma_f32_32x32x16_bf16 v[164:179], v[72:75], v[48:51], v[164:179]
    v_mfma_f32_32x32x16_bf16 v[116:131], v[40:43], v[76:79], v[116:131]
    v_mfma_f32_32x32x16_bf16 v[148:163], v[44:47], v[76:79], v[148:163]
    v_mfma_f32_32x32x16_bf16 v[180:195], v[76:79], v[48:51], v[180:195]
    buffer_load_dwordx4 v[40:43], v4, s[12:15], s19 offen
    buffer_load_dwordx4 v[44:47], v4, s[12:15], s20 offen
    buffer_load_dwordx4 v[48:51], v4, s[12:15], s21 offen
    s_add_u32 s19, s19, 1024
    s_add_u32 s20, s20, 1024
    s_add_u32 s21, s21, 1024
    ds_read_b128 v[64:67], v4 offset:12288
    ds_read_b128 v[68:71], v5 offset:12288
    s_waitcnt vmcnt(9) lgkmcnt(2)
    v_mfma_f32_32x32x16_bf16 v[100:115], v[52:55], v[80:83], v[100:115]
    v_mfma_f32_32x32x16_bf16 v[132:147], v[56:59], v[80:83], v[132:147]
    v_mfma_f32_32x32x16_bf16 v[164:179], v[80:83], v[60:63], v[164:179]
    v_mfma_f32_32x32x16_bf16 v[116:131], v[52:55], v[84:87], v[116:131]
    v_mfma_f32_32x32x16_bf16 v[148:163], v[56:59], v[84:87], v[148:163]
    v_mfma_f32_32x32x16_bf16 v[180:195], v[84:87], v[60:63], v[180:195]
    buffer_load_dwordx4 v[52:55], v4, s[12:15], s19 offen
    buffer_load_dwordx4 v[56:59], v4, s[12:15], s20 offen
    buffer_load_dwordx4 v[60:63], v4, s[12:15], s21 offen
    s_add_u32 s19, s19, 1024
    s_add_u32 s20, s20, 1024
    s_add_u32 s21, s21, 1024
    ds_read_b128 v[72:75], v4 offset:13312
    ds_read_b128 v[76:79], v5 offset:13312
    s_waitcnt vmcnt(9) lgkmcnt(2)
    v_mfma_f32_32x32x16_bf16 v[100:115], v[16:19], v[64:67], v[100:115]
    v_mfma_f32_32x32x16_bf16 v[132:147], v[20:23], v[64:67], v[132:147]
    v_mfma_f32_32x32x16_bf16 v[164:179], v[64:67], v[24:27], v[164:179]
    v_mfma_f32_32x32x16_bf16 v[116:131], v[16:19], v[68:71], v[116:131]
    v_mfma_f32_32x32x16_bf16 v[148:163], v[20:23], v[68:71], v[148:163]
    v_mfma_f32_32x32x16_bf16 v[180:195], v[68:71], v[24:27], v[180:195]
    buffer_load_dwordx4 v[16:19], v4, s[12:15], s19 offen
    buffer_load_dwordx4 v[20:23], v4, s[12:15], s20 offen
    buffer_load_dwordx4 v[24:27], v4, s[12:15], s21 offen
    s_add_u32 s19, s19, 1024
    s_add_u32 s20, s20, 1024
    s_add_u32 s21, s21, 1024
    ds_read_b128 v[80:83], v4 offset:14336
    ds_read_b128 v[84:87], v5 offset:14336
    s_waitcnt vmcnt(9) lgkmcnt(2)
    v_mfma_f32_32x32x16_bf16 v[100:115], v[28:31], v[72:75], v[100:115]
    v_mfma_f32_32x32x16_bf16 v[132:147], v[32:35], v[72:75], v[132:147]
    v_mfma_f32_32x32x16_bf16 v[164:179], v[72:75], v[36:39], v[164:179]
    v_mfma_f32_32x32x16_bf16 v[116:131], v[28:31], v[76:79], v[116:131]
    v_mfma_f32_32x32x16_bf16 v[148:163], v[32:35], v[76:79], v[148:163]
    v_mfma_f32_32x32x16_bf16 v[180:195], v[76:79], v[36:39], v[180:195]
    buffer_load_dwordx4 v[28:31], v4, s[12:15], s19 offen
    buffer_load_dwordx4 v[32:35], v4, s[12:15], s20 offen
    buffer_load_dwordx4 v[36:39], v4, s[12:15], s21 offen
    s_add_u32 s19, s19, 1024
    s_add_u32 s20, s20, 1024
    s_add_u32 s21, s21, 1024
    ds_read_b128 v[64:67], v4 offset:15360
    ds_read_b128 v[68:71], v5 offset:15360
    s_waitcnt vmcnt(9) lgkmcnt(2)
    v_mfma_f32_32x32x16_bf16 v[100:115], v[40:43], v[80:83], v[100:115]
    v_mfma_f32_32x32x16_bf16 v[132:147], v[44:47], v[80:83], v[132:147]
    v_mfma_f32_32x32x16_bf16 v[164:179], v[80:83], v[48:51], v[164:179]
    v_mfma_f32_32x32x16_bf16 v[116:131], v[40:43], v[84:87], v[116:131]
    v_mfma_f32_32x32x16_bf16 v[148:163], v[44:47], v[84:87], v[148:163]
    v_mfma_f32_32x32x16_bf16 v[180:195], v[84:87], v[48:51], v[180:195]
    buffer_load_dwordx4 v[40:43], v4, s[12:15], s19 offen
    buffer_load_dwordx4 v[44:47], v4, s[12:15], s20 offen
    buffer_load_dwordx4 v[48:51], v4, s[12:15], s21 offen
    s_add_u32 s19, s19, 1024
    s_add_u32 s20, s20, 1024
    s_add_u32 s21, s21, 1024
    ds_read_b128 v[72:75], v4 offset:16384
    ds_read_b128 v[76:79], v5 offset:16384
    s_waitcnt vmcnt(9) lgkmcnt(2)
    v_mfma_f32_32x32x16_bf16 v[100:115], v[52:55], v[64:67], v[100:115]
    v_mfma_f32_32x32x16_bf16 v[132:147], v[56:59], v[64:67], v[132:147]
    v_mfma_f32_32x32x16_bf16 v[164:179], v[64:67], v[60:63], v[164:179]
    v_mfma_f32_32x32x16_bf16 v[116:131], v[52:55], v[68:71], v[116:131]
    v_mfma_f32_32x32x16_bf16 v[148:163], v[56:59], v[68:71], v[148:163]
    v_mfma_f32_32x32x16_bf16 v[180:195], v[68:71], v[60:63], v[180:195]
    buffer_load_dwordx4 v[52:55], v4, s[12:15], s19 offen
    buffer_load_dwordx4 v[56:59], v4, s[12:15], s20 offen
    buffer_load_dwordx4 v[60:63], v4, s[12:15], s21 offen
    s_add_u32 s19, s19, 1024
    s_add_u32 s20, s20, 1024
    s_add_u32 s21, s21, 1024
    ds_read_b128 v[80:83], v4 offset:17408
    ds_read_b128 v[84:87], v5 offset:17408
    s_waitcnt vmcnt(9) lgkmcnt(2)
    v_mfma_f32_32x32x16_bf16 v[100:115], v[16:19], v[72:75], v[100:115]
    v_mfma_f32_32x32x16_bf16 v[132:147], v[20:23], v[72:75], v[132:147]
    v_mfma_f32_32x32x16_bf16 v[164:179], v[72:75], v[24:27], v[164:179]
    v_mfma_f32_32x32x16_bf16 v[116:131], v[16:19], v[76:79], v[116:131]
    v_mfma_f32_32x32x16_bf16 v[148:163], v[20:23], v[76:79], v[148:163]
    v_mfma_f32_32x32x16_bf16 v[180:195], v[76:79], v[24:27], v[180:195]
    buffer_load_dwordx4 v[16:19], v4, s[12:15], s19 offen
    buffer_load_dwordx4 v[20:23], v4, s[12:15], s20 offen
    buffer_load_dwordx4 v[24:27], v4, s[12:15], s21 offen
    s_add_u32 s19, s19, 1024
    s_add_u32 s20, s20, 1024
    s_add_u32 s21, s21, 1024
    ds_read_b128 v[64:67], v4 offset:18432
    ds_read_b128 v[68:71], v5 offset:18432
    s_waitcnt vmcnt(9) lgkmcnt(2)
    v_mfma_f32_32x32x16_bf16 v[100:115], v[28:31], v[80:83], v[100:115]
    v_mfma_f32_32x32x16_bf16 v[132:147], v[32:35], v[80:83], v[132:147]
    v_mfma_f32_32x32x16_bf16 v[164:179], v[80:83], v[36:39], v[164:179]
    v_mfma_f32_32x32x16_bf16 v[116:131], v[28:31], v[84:87], v[116:131]
    v_mfma_f32_32x32x16_bf16 v[148:163], v[32:35], v[84:87], v[148:163]
    v_mfma_f32_32x32x16_bf16 v[180:195], v[84:87], v[36:39], v[180:195]
    buffer_load_dwordx4 v[28:31], v4, s[12:15], s19 offen
    buffer_load_dwordx4 v[32:35], v4, s[12:15], s20 offen
    buffer_load_dwordx4 v[36:39], v4, s[12:15], s21 offen
    s_add_u32 s19, s19, 1024
    s_add_u32 s20, s20, 1024
    s_add_u32 s21, s21, 1024
    ds_read_b128 v[72:75], v4 offset:19456
    ds_read_b128 v[76:79], v5 offset:19456
    s_waitcnt vmcnt(9) lgkmcnt(2)
    v_mfma_f32_32x32x16_bf16 v[100:115], v[40:43], v[64:67], v[100:115]
    v_mfma_f32_32x32x16_bf16 v[132:147], v[44:47], v[64:67], v[132:147]
    v_mfma_f32_32x32x16_bf16 v[164:179], v[64:67], v[48:51], v[164:179]
    v_mfma_f32_32x32x16_bf16 v[116:131], v[40:43], v[68:71], v[116:131]
    v_mfma_f32_32x32x16_bf16 v[148:163], v[44:47], v[68:71], v[148:163]
    v_mfma_f32_32x32x16_bf16 v[180:195], v[68:71], v[48:51], v[180:195]
    buffer_load_dwordx4 v[40:43], v4, s[12:15], s19 offen
    buffer_load_dwordx4 v[44:47], v4, s[12:15], s20 offen
    buffer_load_dwordx4 v[48:51], v4, s[12:15], s21 offen
    s_add_u32 s19, s19, 1024
    s_add_u32 s20, s20, 1024
    s_add_u32 s21, s21, 1024
    ds_read_b128 v[80:83], v4 offset:20480
    ds_read_b128 v[84:87], v5 offset:20480
    s_waitcnt vmcnt(9) lgkmcnt(2)
    v_mfma_f32_32x32x16_bf16 v[100:115], v[52:55], v[72:75], v[100:115]
    v_mfma_f32_32x32x16_bf16 v[132:147], v[56:59], v[72:75], v[132:147]
    v_mfma_f32_32x32x16_bf16 v[164:179], v[72:75], v[60:63], v[164:179]
    v_mfma_f32_32x32x16_bf16 v[116:131], v[52:55], v[76:79], v[116:131]
    v_mfma_f32_32x32x16_bf16 v[148:163], v[56:59], v[76:79], v[148:163]
    v_mfma_f32_32x32x16_bf16 v[180:195], v[76:79], v[60:63], v[180:195]
    buffer_load_dwordx4 v[52:55], v4, s[12:15], s19 offen
    buffer_load_dwordx4 v[56:59], v4, s[12:15], s20 offen
    buffer_load_dwordx4 v[60:63], v4, s[12:15], s21 offen
    s_add_u32 s19, s19, 1024
    s_add_u32 s20, s20, 1024
    s_add_u32 s21, s21, 1024
    ds_read_b128 v[64:67], v4 offset:21504
    ds_read_b128 v[68:71], v5 offset:21504
    s_waitcnt vmcnt(9) lgkmcnt(2)
    v_mfma_f32_32x32x16_bf16 v[100:115], v[16:19], v[80:83], v[100:115]
    v_mfma_f32_32x32x16_bf16 v[132:147], v[20:23], v[80:83], v[132:147]
    v_mfma_f32_32x32x16_bf16 v[164:179], v[80:83], v[24:27], v[164:179]
    v_mfma_f32_32x32x16_bf16 v[116:131], v[16:19], v[84:87], v[116:131]
    v_mfma_f32_32x32x16_bf16 v[148:163], v[20:23], v[84:87], v[148:163]
    v_mfma_f32_32x32x16_bf16 v[180:195], v[84:87], v[24:27], v[180:195]
    buffer_load_dwordx4 v[16:19], v4, s[12:15], s19 offen
    buffer_load_dwordx4 v[20:23], v4, s[12:15], s20 offen
    buffer_load_dwordx4 v[24:27], v4, s[12:15], s21 offen
    s_add_u32 s19, s19, 1024
    s_add_u32 s20, s20, 1024
    s_add_u32 s21, s21, 1024
    ds_read_b128 v[72:75], v4 offset:22528
    ds_read_b128 v[76:79], v5 offset:22528
    s_waitcnt vmcnt(9) lgkmcnt(2)
    v_mfma_f32_32x32x16_bf16 v[100:115], v[28:31], v[64:67], v[100:115]
    v_mfma_f32_32x32x16_bf16 v[132:147], v[32:35], v[64:67], v[132:147]
    v_mfma_f32_32x32x16_bf16 v[164:179], v[64:67], v[36:39], v[164:179]
    v_mfma_f32_32x32x16_bf16 v[116:131], v[28:31], v[68:71], v[116:131]
    v_mfma_f32_32x32x16_bf16 v[148:163], v[32:35], v[68:71], v[148:163]
    v_mfma_f32_32x32x16_bf16 v[180:195], v[68:71], v[36:39], v[180:195]
    buffer_load_dwordx4 v[28:31], v4, s[12:15], s19 offen
    buffer_load_dwordx4 v[32:35], v4, s[12:15], s20 offen
    buffer_load_dwordx4 v[36:39], v4, s[12:15], s21 offen
    s_add_u32 s19, s19, 1024
    s_add_u32 s20, s20, 1024
    s_add_u32 s21, s21, 1024
    ds_read_b128 v[80:83], v4 offset:23552
    ds_read_b128 v[84:87], v5 offset:23552
    s_waitcnt vmcnt(9) lgkmcnt(2)
    v_mfma_f32_32x32x16_bf16 v[100:115], v[40:43], v[72:75], v[100:115]
    v_mfma_f32_32x32x16_bf16 v[132:147], v[44:47], v[72:75], v[132:147]
    v_mfma_f32_32x32x16_bf16 v[164:179], v[72:75], v[48:51], v[164:179]
    v_mfma_f32_32x32x16_bf16 v[116:131], v[40:43], v[76:79], v[116:131]
    v_mfma_f32_32x32x16_bf16 v[148:163], v[44:47], v[76:79], v[148:163]
    v_mfma_f32_32x32x16_bf16 v[180:195], v[76:79], v[48:51], v[180:195]
    buffer_load_dwordx4 v[40:43], v4, s[12:15], s19 offen
    buffer_load_dwordx4 v[44:47], v4, s[12:15], s20 offen
    buffer_load_dwordx4 v[48:51], v4, s[12:15], s21 offen
    s_add_u32 s19, s19, 1024
    s_add_u32 s20, s20, 1024
    s_add_u32 s21, s21, 1024
    ds_read_b128 v[64:67], v4 offset:24576
    ds_read_b128 v[68:71], v5 offset:24576
    s_waitcnt vmcnt(9) lgkmcnt(2)
    v_mfma_f32_32x32x16_bf16 v[100:115], v[52:55], v[80:83], v[100:115]
    v_mfma_f32_32x32x16_bf16 v[132:147], v[56:59], v[80:83], v[132:147]
    v_mfma_f32_32x32x16_bf16 v[164:179], v[80:83], v[60:63], v[164:179]
    v_mfma_f32_32x32x16_bf16 v[116:131], v[52:55], v[84:87], v[116:131]
    v_mfma_f32_32x32x16_bf16 v[148:163], v[56:59], v[84:87], v[148:163]
    v_mfma_f32_32x32x16_bf16 v[180:195], v[84:87], v[60:63], v[180:195]
    buffer_load_dwordx4 v[52:55], v4, s[12:15], s19 offen
    buffer_load_dwordx4 v[56:59], v4, s[12:15], s20 offen
    buffer_load_dwordx4 v[60:63], v4, s[12:15], s21 offen
    s_add_u32 s19, s19, 1024
    s_add_u32 s20, s20, 1024
    s_add_u32 s21, s21, 1024
    ds_read_b128 v[72:75], v4 offset:25600
    ds_read_b128 v[76:79], v5 offset:25600
    s_waitcnt vmcnt(9) lgkmcnt(2)
    v_mfma_f32_32x32x16_bf16 v[100:115], v[16:19], v[64:67], v[100:115]
    v_mfma_f32_32x32x16_bf16 v[132:147], v[20:23], v[64:67], v[132:147]
    v_mfma_f32_32x32x16_bf16 v[164:179], v[64:67], v[24:27], v[164:179]
    v_mfma_f32_32x32x16_bf16 v[116:131], v[16:19], v[68:71], v[116:131]
    v_mfma_f32_32x32x16_bf16 v[148:163], v[20:23], v[68:71], v[148:163]
    v_mfma_f32_32x32x16_bf16 v[180:195], v[68:71], v[24:27], v[180:195]
    buffer_load_dwordx4 v[16:19], v4, s[12:15], s19 offen
    buffer_load_dwordx4 v[20:23], v4, s[12:15], s20 offen
    buffer_load_dwordx4 v[24:27], v4, s[12:15], s21 offen
    s_add_u32 s19, s19, 1024
    s_add_u32 s20, s20, 1024
    s_add_u32 s21, s21, 1024
    ds_read_b128 v[80:83], v4 offset:26624
    ds_read_b128 v[84:87], v5 offset:26624
    s_waitcnt vmcnt(9) lgkmcnt(2)
    v_mfma_f32_32x32x16_bf16 v[100:115], v[28:31], v[72:75], v[100:115]
    v_mfma_f32_32x32x16_bf16 v[132:147], v[32:35], v[72:75], v[132:147]
    v_mfma_f32_32x32x16_bf16 v[164:179], v[72:75], v[36:39], v[164:179]
    v_mfma_f32_32x32x16_bf16 v[116:131], v[28:31], v[76:79], v[116:131]
    v_mfma_f32_32x32x16_bf16 v[148:163], v[32:35], v[76:79], v[148:163]
    v_mfma_f32_32x32x16_bf16 v[180:195], v[76:79], v[36:39], v[180:195]
    buffer_load_dwordx4 v[28:31], v4, s[12:15], s19 offen
    buffer_load_dwordx4 v[32:35], v4, s[12:15], s20 offen
    buffer_load_dwordx4 v[36:39], v4, s[12:15], s21 offen
    s_add_u32 s19, s19, 1024
    s_add_u32 s20, s20, 1024
    s_add_u32 s21, s21, 1024
    ds_read_b128 v[64:67], v4 offset:27648
    ds_read_b128 v[68:71], v5 offset:27648
    s_waitcnt vmcnt(9) lgkmcnt(2)
    v_mfma_f32_32x32x16_bf16 v[100:115], v[40:43], v[80:83], v[100:115]
    v_mfma_f32_32x32x16_bf16 v[132:147], v[44:47], v[80:83], v[132:147]
    v_mfma_f32_32x32x16_bf16 v[164:179], v[80:83], v[48:51], v[164:179]
    v_mfma_f32_32x32x16_bf16 v[116:131], v[40:43], v[84:87], v[116:131]
    v_mfma_f32_32x32x16_bf16 v[148:163], v[44:47], v[84:87], v[148:163]
    v_mfma_f32_32x32x16_bf16 v[180:195], v[84:87], v[48:51], v[180:195]
    buffer_load_dwordx4 v[40:43], v4, s[12:15], s19 offen
    buffer_load_dwordx4 v[44:47], v4, s[12:15], s20 offen
    buffer_load_dwordx4 v[48:51], v4, s[12:15], s21 offen
    s_add_u32 s19, s19, 1024
    s_add_u32 s20, s20, 1024
    s_add_u32 s21, s21, 1024
    ds_read_b128 v[72:75], v4 offset:28672
    ds_read_b128 v[76:79], v5 offset:28672
    s_waitcnt vmcnt(9) lgkmcnt(2)
    v_mfma_f32_32x32x16_bf16 v[100:115], v[52:55], v[64:67], v[100:115]
    v_mfma_f32_32x32x16_bf16 v[132:147], v[56:59], v[64:67], v[132:147]
    v_mfma_f32_32x32x16_bf16 v[164:179], v[64:67], v[60:63], v[164:179]
    v_mfma_f32_32x32x16_bf16 v[116:131], v[52:55], v[68:71], v[116:131]
    v_mfma_f32_32x32x16_bf16 v[148:163], v[56:59], v[68:71], v[148:163]
    v_mfma_f32_32x32x16_bf16 v[180:195], v[68:71], v[60:63], v[180:195]
    buffer_load_dwordx4 v[52:55], v4, s[12:15], s19 offen
    buffer_load_dwordx4 v[56:59], v4, s[12:15], s20 offen
    buffer_load_dwordx4 v[60:63], v4, s[12:15], s21 offen
    s_add_u32 s19, s19, 1024
    s_add_u32 s20, s20, 1024
    s_add_u32 s21, s21, 1024
    ds_read_b128 v[80:83], v4 offset:29696
    ds_read_b128 v[84:87], v5 offset:29696
    s_waitcnt vmcnt(9) lgkmcnt(2)
    v_mfma_f32_32x32x16_bf16 v[100:115], v[16:19], v[72:75], v[100:115]
    v_mfma_f32_32x32x16_bf16 v[132:147], v[20:23], v[72:75], v[132:147]
    v_mfma_f32_32x32x16_bf16 v[164:179], v[72:75], v[24:27], v[164:179]
    v_mfma_f32_32x32x16_bf16 v[116:131], v[16:19], v[76:79], v[116:131]
    v_mfma_f32_32x32x16_bf16 v[148:163], v[20:23], v[76:79], v[148:163]
    v_mfma_f32_32x32x16_bf16 v[180:195], v[76:79], v[24:27], v[180:195]
    buffer_load_dwordx4 v[16:19], v4, s[12:15], s19 offen
    buffer_load_dwordx4 v[20:23], v4, s[12:15], s20 offen
    buffer_load_dwordx4 v[24:27], v4, s[12:15], s21 offen
    s_add_u32 s19, s19, 1024
    s_add_u32 s20, s20, 1024
    s_add_u32 s21, s21, 1024
    ds_read_b128 v[64:67], v4 offset:30720
    ds_read_b128 v[68:71], v5 offset:30720
    s_waitcnt vmcnt(9) lgkmcnt(2)
    v_mfma_f32_32x32x16_bf16 v[100:115], v[28:31], v[80:83], v[100:115]
    v_mfma_f32_32x32x16_bf16 v[132:147], v[32:35], v[80:83], v[132:147]
    v_mfma_f32_32x32x16_bf16 v[164:179], v[80:83], v[36:39], v[164:179]
    v_mfma_f32_32x32x16_bf16 v[116:131], v[28:31], v[84:87], v[116:131]
    v_mfma_f32_32x32x16_bf16 v[148:163], v[32:35], v[84:87], v[148:163]
    v_mfma_f32_32x32x16_bf16 v[180:195], v[84:87], v[36:39], v[180:195]
    buffer_load_dwordx4 v[28:31], v4, s[12:15], s19 offen
    buffer_load_dwordx4 v[32:35], v4, s[12:15], s20 offen
    buffer_load_dwordx4 v[36:39], v4, s[12:15], s21 offen
    s_add_u32 s19, s19, 1024
    s_add_u32 s20, s20, 1024
    s_add_u32 s21, s21, 1024
    ds_read_b128 v[72:75], v4 offset:31744
    ds_read_b128 v[76:79], v5 offset:31744
    s_waitcnt vmcnt(9) lgkmcnt(2)
    v_mfma_f32_32x32x16_bf16 v[100:115], v[40:43], v[64:67], v[100:115]
    v_mfma_f32_32x32x16_bf16 v[132:147], v[44:47], v[64:67], v[132:147]
    v_mfma_f32_32x32x16_bf16 v[164:179], v[64:67], v[48:51], v[164:179]
    v_mfma_f32_32x32x16_bf16 v[116:131], v[40:43], v[68:71], v[116:131]
    v_mfma_f32_32x32x16_bf16 v[148:163], v[44:47], v[68:71], v[148:163]
    v_mfma_f32_32x32x16_bf16 v[180:195], v[68:71], v[48:51], v[180:195]
    buffer_load_dwordx4 v[40:43], v4, s[12:15], s19 offen
    buffer_load_dwordx4 v[44:47], v4, s[12:15], s20 offen
    buffer_load_dwordx4 v[48:51], v4, s[12:15], s21 offen
    s_add_u32 s19, s19, 1024
    s_add_u32 s20, s20, 1024
    s_add_u32 s21, s21, 1024
    ds_read_b128 v[80:83], v4 offset:32768
    ds_read_b128 v[84:87], v5 offset:32768
    s_waitcnt vmcnt(9) lgkmcnt(2)
    v_mfma_f32_32x32x16_bf16 v[100:115], v[52:55], v[72:75], v[100:115]
    v_mfma_f32_32x32x16_bf16 v[132:147], v[56:59], v[72:75], v[132:147]
    v_mfma_f32_32x32x16_bf16 v[164:179], v[72:75], v[60:63], v[164:179]
    v_mfma_f32_32x32x16_bf16 v[116:131], v[52:55], v[76:79], v[116:131]
    v_mfma_f32_32x32x16_bf16 v[148:163], v[56:59], v[76:79], v[148:163]
    v_mfma_f32_32x32x16_bf16 v[180:195], v[76:79], v[60:63], v[180:195]
    buffer_load_dwordx4 v[52:55], v4, s[12:15], s19 offen
    buffer_load_dwordx4 v[56:59], v4, s[12:15], s20 offen
    buffer_load_dwordx4 v[60:63], v4, s[12:15], s21 offen
    s_add_u32 s19, s19, 1024
    s_add_u32 s20, s20, 1024
    s_add_u32 s21, s21, 1024
    ds_read_b128 v[64:67], v4 offset:33792
    ds_read_b128 v[68:71], v5 offset:33792
    s_waitcnt vmcnt(9) lgkmcnt(2)
    v_mfma_f32_32x32x16_bf16 v[100:115], v[16:19], v[80:83], v[100:115]
    v_mfma_f32_32x32x16_bf16 v[132:147], v[20:23], v[80:83], v[132:147]
    v_mfma_f32_32x32x16_bf16 v[164:179], v[80:83], v[24:27], v[164:179]
    v_mfma_f32_32x32x16_bf16 v[116:131], v[16:19], v[84:87], v[116:131]
    v_mfma_f32_32x32x16_bf16 v[148:163], v[20:23], v[84:87], v[148:163]
    v_mfma_f32_32x32x16_bf16 v[180:195], v[84:87], v[24:27], v[180:195]
    ds_read_b128 v[72:75], v4 offset:34816
    ds_read_b128 v[76:79], v5 offset:34816
    s_waitcnt vmcnt(6) lgkmcnt(2)
    v_mfma_f32_32x32x16_bf16 v[100:115], v[28:31], v[64:67], v[100:115]
    v_mfma_f32_32x32x16_bf16 v[132:147], v[32:35], v[64:67], v[132:147]
    v_mfma_f32_32x32x16_bf16 v[164:179], v[64:67], v[36:39], v[164:179]
    v_mfma_f32_32x32x16_bf16 v[116:131], v[28:31], v[68:71], v[116:131]
    v_mfma_f32_32x32x16_bf16 v[148:163], v[32:35], v[68:71], v[148:163]
    v_mfma_f32_32x32x16_bf16 v[180:195], v[68:71], v[36:39], v[180:195]
    ds_read_b128 v[80:83], v4 offset:35840
    ds_read_b128 v[84:87], v5 offset:35840
    s_waitcnt vmcnt(3) lgkmcnt(2)
    v_mfma_f32_32x32x16_bf16 v[100:115], v[40:43], v[72:75], v[100:115]
    v_mfma_f32_32x32x16_bf16 v[132:147], v[44:47], v[72:75], v[132:147]
    v_mfma_f32_32x32x16_bf16 v[164:179], v[72:75], v[48:51], v[164:179]
    v_mfma_f32_32x32x16_bf16 v[116:131], v[40:43], v[76:79], v[116:131]
    v_mfma_f32_32x32x16_bf16 v[148:163], v[44:47], v[76:79], v[148:163]
    v_mfma_f32_32x32x16_bf16 v[180:195], v[76:79], v[48:51], v[180:195]
    s_waitcnt vmcnt(0) lgkmcnt(0)
    v_mfma_f32_32x32x16_bf16 v[100:115], v[52:55], v[80:83], v[100:115]
    v_mfma_f32_32x32x16_bf16 v[132:147], v[56:59], v[80:83], v[132:147]
    v_mfma_f32_32x32x16_bf16 v[164:179], v[80:83], v[60:63], v[164:179]
    v_mfma_f32_32x32x16_bf16 v[116:131], v[52:55], v[84:87], v[116:131]
    v_mfma_f32_32x32x16_bf16 v[148:163], v[56:59], v[84:87], v[148:163]
    v_mfma_f32_32x32x16_bf16 v[180:195], v[84:87], v[60:63], v[180:195]
    s_nop 15
    v_cmp_eq_u32 s[34:35], 18, v2
    v_mov_b32 v6, 1.0
    s_nop 1
    v_cndmask_b32 v164, v164, v6, s[34:35]
    v_cndmask_b32 v165, v165, v6, s[34:35]
    v_cndmask_b32 v166, v166, v6, s[34:35]
    v_cndmask_b32 v167, v167, v6, s[34:35]
    v_cndmask_b32 v168, v168, v6, s[34:35]
    v_cndmask_b32 v169, v169, v6, s[34:35]
    v_cndmask_b32 v170, v170, v6, s[34:35]
    v_cndmask_b32 v171, v171, v6, s[34:35]
    v_cndmask_b32 v172, v172, v6, s[34:35]
    v_cndmask_b32 v173, v173, v6, s[34:35]
    v_cndmask_b32 v174, v174, v6, s[34:35]
    v_cndmask_b32 v175, v175, v6, s[34:35]
    v_cndmask_b32 v176, v176, v6, s[34:35]
    v_cndmask_b32 v177, v177, v6, s[34:35]
    v_cndmask_b32 v178, v178, v6, s[34:35]
    v_cndmask_b32 v179, v179, v6, s[34:35]
    v_cndmask_b32 v180, v180, v6, s[34:35]
    v_cndmask_b32 v181, v181, v6, s[34:35]
    v_cndmask_b32 v182, v182, v6, s[34:35]
    v_cndmask_b32 v183, v183, v6, s[34:35]
    v_cndmask_b32 v184, v184, v6, s[34:35]
    v_cndmask_b32 v185, v185, v6, s[34:35]
    v_cndmask_b32 v186, v186, v6, s[34:35]
    v_cndmask_b32 v187, v187, v6, s[34:35]
    v_cndmask_b32 v188, v188, v6, s[34:35]
    v_cndmask_b32 v189, v189, v6, s[34:35]
    v_cndmask_b32 v190, v190, v6, s[34:35]
    v_cndmask_b32 v191, v191, v6, s[34:35]
    v_cndmask_b32 v192, v192, v6, s[34:35]
    v_cndmask_b32 v193, v193, v6, s[34:35]
    v_cndmask_b32 v194, v194, v6, s[34:35]
    v_cndmask_b32 v195, v195, v6, s[34:35]
    v_lshlrev_b32 v7, 4, v2
    v_lshl_add_u32 v7, v3, 3, v7
    s_lshl_b32 s22, s18, 6
    s_lshl_b32 s23, s16, 1
    s_add_u32 s22, s22, s23
    s_add_u32 s22, s22, 0
    s_lshl_b32 s23, s22, 11
    s_add_u32 s23, s23, 34684928
    s_lshl_b32 s24, s22, 12
    s_add_u32 s24, s24, 38879232
    v_cvt_pk_bf16_f32 v16, v100, v101
    v_cvt_pk_bf16_f32 v17, v102, v103
    v_cvt_pk_bf16_f32 v18, v104, v105
    v_cvt_pk_bf16_f32 v19, v106, v107
    v_cvt_pk_bf16_f32 v20, v108, v109
    v_cvt_pk_bf16_f32 v21, v110, v111
    v_cvt_pk_bf16_f32 v22, v112, v113
    v_cvt_pk_bf16_f32 v23, v114, v115
    buffer_store_dwordx2 v[16:17], v7, s[12:15], s23 offen offset:0
    buffer_store_dwordx2 v[18:19], v7, s[12:15], s23 offen offset:512
    buffer_store_dwordx2 v[20:21], v7, s[12:15], s23 offen offset:1024
    buffer_store_dwordx2 v[22:23], v7, s[12:15], s23 offen offset:1536
    v_cvt_pk_bf16_f32 v32, v132, v133
    v_cvt_pk_bf16_f32 v33, v134, v135
    v_cvt_pk_bf16_f32 v34, v136, v137
    v_cvt_pk_bf16_f32 v35, v138, v139
    v_cvt_pk_bf16_f32 v36, v140, v141
    v_cvt_pk_bf16_f32 v37, v142, v143
    v_cvt_pk_bf16_f32 v38, v144, v145
    v_cvt_pk_bf16_f32 v39, v146, v147
    buffer_store_dwordx2 v[32:33], v7, s[12:15], s24 offen offset:0
    buffer_store_dwordx2 v[34:35], v7, s[12:15], s24 offen offset:512
    buffer_store_dwordx2 v[36:37], v7, s[12:15], s24 offen offset:1024
    buffer_store_dwordx2 v[38:39], v7, s[12:15], s24 offen offset:1536
    v_cvt_pk_bf16_f32 v48, v164, v165
    v_cvt_pk_bf16_f32 v49, v166, v167
    v_cvt_pk_bf16_f32 v50, v168, v169
    v_cvt_pk_bf16_f32 v51, v170, v171
    v_cvt_pk_bf16_f32 v52, v172, v173
    v_cvt_pk_bf16_f32 v53, v174, v175
    v_cvt_pk_bf16_f32 v54, v176, v177
    v_cvt_pk_bf16_f32 v55, v178, v179
    buffer_store_dwordx4 v[48:51], v4, s[12:15], s24 offen offset:2048
    buffer_store_dwordx4 v[52:55], v4, s[12:15], s24 offen offset:3072
    s_nop 4
    s_lshl_b32 s22, s18, 6
    s_lshl_b32 s23, s16, 1
    s_add_u32 s22, s22, s23
    s_add_u32 s22, s22, 1
    s_lshl_b32 s23, s22, 11
    s_add_u32 s23, s23, 34684928
    s_lshl_b32 s24, s22, 12
    s_add_u32 s24, s24, 38879232
    v_cvt_pk_bf16_f32 v16, v116, v117
    v_cvt_pk_bf16_f32 v17, v118, v119
    v_cvt_pk_bf16_f32 v18, v120, v121
    v_cvt_pk_bf16_f32 v19, v122, v123
    v_cvt_pk_bf16_f32 v20, v124, v125
    v_cvt_pk_bf16_f32 v21, v126, v127
    v_cvt_pk_bf16_f32 v22, v128, v129
    v_cvt_pk_bf16_f32 v23, v130, v131
    buffer_store_dwordx2 v[16:17], v7, s[12:15], s23 offen offset:0
    buffer_store_dwordx2 v[18:19], v7, s[12:15], s23 offen offset:512
    buffer_store_dwordx2 v[20:21], v7, s[12:15], s23 offen offset:1024
    buffer_store_dwordx2 v[22:23], v7, s[12:15], s23 offen offset:1536
    v_cvt_pk_bf16_f32 v32, v148, v149
    v_cvt_pk_bf16_f32 v33, v150, v151
    v_cvt_pk_bf16_f32 v34, v152, v153
    v_cvt_pk_bf16_f32 v35, v154, v155
    v_cvt_pk_bf16_f32 v36, v156, v157
    v_cvt_pk_bf16_f32 v37, v158, v159
    v_cvt_pk_bf16_f32 v38, v160, v161
    v_cvt_pk_bf16_f32 v39, v162, v163
    buffer_store_dwordx2 v[32:33], v7, s[12:15], s24 offen offset:0
    buffer_store_dwordx2 v[34:35], v7, s[12:15], s24 offen offset:512
    buffer_store_dwordx2 v[36:37], v7, s[12:15], s24 offen offset:1024
    buffer_store_dwordx2 v[38:39], v7, s[12:15], s24 offen offset:1536
    v_cvt_pk_bf16_f32 v48, v180, v181
    v_cvt_pk_bf16_f32 v49, v182, v183
    v_cvt_pk_bf16_f32 v50, v184, v185
    v_cvt_pk_bf16_f32 v51, v186, v187
    v_cvt_pk_bf16_f32 v52, v188, v189
    v_cvt_pk_bf16_f32 v53, v190, v191
    v_cvt_pk_bf16_f32 v54, v192, v193
    v_cvt_pk_bf16_f32 v55, v194, v195
    buffer_store_dwordx4 v[48:51], v4, s[12:15], s24 offen offset:2048
    buffer_store_dwordx4 v[52:55], v4, s[12:15], s24 offen offset:3072
    s_nop 4
L_b1_l1_kernel_end:
    s_endpgm
.globl b2_l1_kernel
.p2align 8
.type b2_l1_kernel,@function
b2_l1_kernel:
    s_cmp_ge_u32 s2, 256
    s_cbranch_scc1 L_b2_l1_kernel_end
    s_load_dwordx2 s[4:5], s[0:1], 72
    s_load_dwordx2 s[6:7], s[0:1], 0
    s_load_dwordx2 s[36:37], s[0:1], 56
    v_lshrrev_b32 v1, 6, v0
    s_nop 0
    v_readfirstlane_b32 s3, v1
    v_and_b32 v1, 63, v0
    v_and_b32 v2, 31, v1
    v_lshrrev_b32 v3, 5, v1
    v_lshlrev_b32 v4, 4, v1
    s_mov_b32 s30, -1
    s_mov_b32 s31, 0
    s_waitcnt lgkmcnt(0)
    s_mov_b32 s12, s4
    s_mov_b32 s13, s5
    s_mov_b32 s14, 268435456
    s_mov_b32 s15, 0x00020000
    s_lshr_b32 s18, s2, 3
    s_and_b32 s16, s2, 7
    s_mov_b32 s25, 15548416
    s_mov_b32 s33, 1051597459
    s_lshl_b32 s22, s16, 3
    s_add_u32 s22, s22, s3
    s_lshl_b32 s23, s18, 6
    s_add_u32 s23, s23, s22
    s_lshl_b32 s23, s23, 11
    s_add_u32 s23, s23, 34684928
    buffer_load_dwordx4 v[8:11], v4, s[12:15], s23 offen
    buffer_load_dwordx4 v[12:15], v4, s[12:15], s23 offen offset:1024
    s_lshl_b32 s19, s18, 18
    s_add_u32 s19, s19, 38879232
    v_lshlrev_b32 v5, 4, v0
    buffer_load_dwordx4 v[96:99], v5, s[12:15], s19 offen
    s_add_u32 s19, s19, 8192
    buffer_load_dwordx4 v[100:103], v5, s[12:15], s19 offen
    s_add_u32 s19, s19, 8192
    buffer_load_dwordx4 v[104:107], v5, s[12:15], s19 offen
    s_add_u32 s19, s19, 8192
    buffer_load_dwordx4 v[108:111], v5, s[12:15], s19 offen
    s_add_u32 s19, s19, 8192
    v_mov_b32 v48, 0
    v_mov_b32 v49, 0
    v_mov_b32 v50, 0
    v_mov_b32 v51, 0
    v_mov_b32 v52, 0
    v_mov_b32 v53, 0
    v_mov_b32 v54, 0
    v_mov_b32 v55, 0
    v_mov_b32 v56, 0
    v_mov_b32 v57, 0
    v_mov_b32 v58, 0
    v_mov_b32 v59, 0
    v_mov_b32 v60, 0
    v_mov_b32 v61, 0
    v_mov_b32 v62, 0
    v_mov_b32 v63, 0
    v_mov_b32 v16, 0xff800000
    v_mov_b32 v6, v5
    v_mov_b32 v7, v4
    s_waitcnt vmcnt(0)
    ds_write_b128 v6, v[96:99] offset:0
    ds_write_b128 v6, v[100:103] offset:8192
    ds_write_b128 v6, v[104:107] offset:16384
    ds_write_b128 v6, v[108:111] offset:24576
    s_waitcnt lgkmcnt(0)
    s_barrier
    v_xor_b32 v6, 0x8000, v6
    s_mov_b32 s20, 0
L_b2_l1_kernel_loop:
    s_cmp_eq_u32 s20, 7
    s_cbranch_scc1 L_b2_l1_kernel_nog
    buffer_load_dwordx4 v[96:99], v5, s[12:15], s19 offen
    s_add_u32 s19, s19, 8192
    buffer_load_dwordx4 v[100:103], v5, s[12:15], s19 offen
    s_add_u32 s19, s19, 8192
    buffer_load_dwordx4 v[104:107], v5, s[12:15], s19 offen
    s_add_u32 s19, s19, 8192
    buffer_load_dwordx4 v[108:111], v5, s[12:15], s19 offen
    s_add_u32 s19, s19, 8192
L_b2_l1_kernel_nog:
    ds_read_b128 v[72:75], v7 offset:0
    ds_read_b128 v[76:79], v7 offset:1024
    ds_read_b128 v[80:83], v7 offset:4096
    ds_read_b128 v[84:87], v7 offset:5120
    s_waitcnt lgkmcnt(2)
    v_mfma_f32_32x32x16_bf16 v[32:47], v[72:75], v[8:11], 0
    v_mfma_f32_32x32x16_bf16 v[32:47], v[76:79], v[12:15], v[32:47]
    s_nop 7
    ds_read_b128 v[88:91], v7 offset:2048
    ds_read_b128 v[92:95], v7 offset:3072
    s_waitcnt lgkmcnt(2)
    v_mfma_f32_32x32x16_bf16 v[112:127], v[80:83], v[8:11], 0
    v_mfma_f32_32x32x16_bf16 v[112:127], v[84:87], v[12:15], v[112:127]
    ds_read_b128 v[72:75], v7 offset:8192
    ds_read_b128 v[76:79], v7 offset:9216
    v_max3_f32 v17, v32, v33, v34
    v_max3_f32 v17, v17, v35, v36
    v_max3_f32 v17, v17, v37, v38
    v_max3_f32 v17, v17, v39, v40
    v_max3_f32 v17, v17, v41, v42
    v_max3_f32 v17, v17, v43, v44
    v_max3_f32 v17, v17, v45, v46
    v_max_f32 v17, v17, v47
    v_mov_b32 v18, v17
    s_nop 1
    v_permlane32_swap_b32 v17, v18
    v_max_f32 v17, v17, v18
    v_mul_f32 v17, s33, v17
    v_max_f32 v17, v16, v17
    v_sub_f32 v18, v16, v17
    v_mov_b32 v16, v17
    v_exp_f32 v18, v18
    v_fma_f32 v32, v32, s33, -v16
    v_fma_f32 v33, v33, s33, -v16
    v_fma_f32 v34, v34, s33, -v16
    v_fma_f32 v35, v35, s33, -v16
    v_fma_f32 v36, v36, s33, -v16
    v_fma_f32 v37, v37, s33, -v16
    v_fma_f32 v38, v38, s33, -v16
    v_fma_f32 v39, v39, s33, -v16
    v_fma_f32 v40, v40, s33, -v16
    v_fma_f32 v41, v41, s33, -v16
    v_fma_f32 v42, v42, s33, -v16
    v_fma_f32 v43, v43, s33, -v16
    v_fma_f32 v44, v44, s33, -v16
    v_fma_f32 v45, v45, s33, -v16
    v_fma_f32 v46, v46, s33, -v16
    v_fma_f32 v47, v47, s33, -v16
    v_exp_f32 v32, v32
    v_exp_f32 v33, v33
    v_exp_f32 v34, v34
    v_exp_f32 v35, v35
    v_exp_f32 v36, v36
    v_exp_f32 v37, v37
    v_exp_f32 v38, v38
    v_exp_f32 v39, v39
    v_exp_f32 v40, v40
    v_exp_f32 v41, v41
    v_exp_f32 v42, v42
    v_exp_f32 v43, v43
    v_exp_f32 v44, v44
    v_exp_f32 v45, v45
    v_exp_f32 v46, v46
    v_exp_f32 v47, v47
    v_mul_f32 v48, v48, v18
    v_mul_f32 v49, v49, v18
    v_mul_f32 v50, v50, v18
    v_mul_f32 v51, v51, v18
    v_mul_f32 v52, v52, v18
    v_mul_f32 v53, v53, v18
    v_mul_f32 v54, v54, v18
    v_mul_f32 v55, v55, v18
    v_mul_f32 v56, v56, v18
    v_mul_f32 v57, v57, v18
    v_mul_f32 v58, v58, v18
    v_mul_f32 v59, v59, v18
    v_cvt_pk_bf16_f32 v64, v32, v33
    v_cvt_pk_bf16_f32 v65, v34, v35
    v_cvt_pk_bf16_f32 v66, v36, v37
    v_cvt_pk_bf16_f32 v67, v38, v39
    v_cvt_pk_bf16_f32 v68, v40, v41
    v_cvt_pk_bf16_f32 v69, v42, v43
    v_cvt_pk_bf16_f32 v70, v44, v45
    v_cvt_pk_bf16_f32 v71, v46, v47
    s_waitcnt lgkmcnt(2)
    s_nop 1
    v_mfma_f32_32x32x16_bf16 v[48:63], v[88:91], v[64:67], v[48:63]
    v_mfma_f32_32x32x16_bf16 v[48:63], v[92:95], v[68:71], v[48:63]
    ds_read_b128 v[88:91], v7 offset:6144
    ds_read_b128 v[92:95], v7 offset:7168
    s_waitcnt lgkmcnt(2)
    v_mfma_f32_32x32x16_bf16 v[32:47], v[72:75], v[8:11], 0
    v_mfma_f32_32x32x16_bf16 v[32:47], v[76:79], v[12:15], v[32:47]
    ds_read_b128 v[80:83], v7 offset:12288
    ds_read_b128 v[84:87], v7 offset:13312
    v_max3_f32 v17, v112, v113, v114
    v_max3_f32 v17, v17, v115, v116
    v_max3_f32 v17, v17, v117, v118
    v_max3_f32 v17, v17, v119, v120
    v_max3_f32 v17, v17, v121, v122
    v_max3_f32 v17, v17, v123, v124
    v_max3_f32 v17, v17, v125, v126
    v_max_f32 v17, v17, v127
    v_mov_b32 v18, v17
    s_nop 1
    v_permlane32_swap_b32 v17, v18
    v_max_f32 v17, v17, v18
    v_mul_f32 v17, s33, v17
    v_max_f32 v17, v16, v17
    v_sub_f32 v18, v16, v17
    v_mov_b32 v16, v17
    v_exp_f32 v18, v18
    v_fma_f32 v112, v112, s33, -v16
    v_fma_f32 v113, v113, s33, -v16
    v_fma_f32 v114, v114, s33, -v16
    v_fma_f32 v115, v115, s33, -v16
    v_fma_f32 v116, v116, s33, -v16
    v_fma_f32 v117, v117, s33, -v16
    v_fma_f32 v118, v118, s33, -v16
    v_fma_f32 v119, v119, s33, -v16
    v_fma_f32 v120, v120, s33, -v16
    v_fma_f32 v121, v121, s33, -v16
    v_fma_f32 v122, v122, s33, -v16
    v_fma_f32 v123, v123, s33, -v16
    v_fma_f32 v124, v124, s33, -v16
    v_fma_f32 v125, v125, s33, -v16
    v_fma_f32 v126, v126, s33, -v16
    v_fma_f32 v127, v127, s33, -v16
    v_exp_f32 v112, v112
    v_exp_f32 v113, v113
    v_exp_f32 v114, v114
    v_exp_f32 v115, v115
    v_exp_f32 v116, v116
    v_exp_f32 v117, v117
    v_exp_f32 v118, v118
    v_exp_f32 v119, v119
    v_exp_f32 v120, v120
    v_exp_f32 v121, v121
    v_exp_f32 v122, v122
    v_exp_f32 v123, v123
    v_exp_f32 v124, v124
    v_exp_f32 v125, v125
    v_exp_f32 v126, v126
    v_exp_f32 v127, v127
    v_mul_f32 v48, v48, v18
    v_mul_f32 v49, v49, v18
    v_mul_f32 v50, v50, v18
    v_mul_f32 v51, v51, v18
    v_mul_f32 v52, v52, v18
    v_mul_f32 v53, v53, v18
    v_mul_f32 v54, v54, v18
    v_mul_f32 v55, v55, v18
    v_mul_f32 v56, v56, v18
    v_mul_f32 v57, v57, v18
    v_mul_f32 v58, v58, v18
    v_mul_f32 v59, v59, v18
    v_cvt_pk_bf16_f32 v64, v112, v113
    v_cvt_pk_bf16_f32 v65, v114, v115
    v_cvt_pk_bf16_f32 v66, v116, v117
    v_cvt_pk_bf16_f32 v67, v118, v119
    v_cvt_pk_bf16_f32 v68, v120, v121
    v_cvt_pk_bf16_f32 v69, v122, v123
    v_cvt_pk_bf16_f32 v70, v124, v125
    v_cvt_pk_bf16_f32 v71, v126, v127
    s_waitcnt lgkmcnt(2)
    s_nop 1
    v_mfma_f32_32x32x16_bf16 v[48:63], v[88:91], v[64:67], v[48:63]
    v_mfma_f32_32x32x16_bf16 v[48:63], v[92:95], v[68:71], v[48:63]
    ds_read_b128 v[88:91], v7 offset:10240
    ds_read_b128 v[92:95], v7 offset:11264
    s_waitcnt lgkmcnt(2)
    v_mfma_f32_32x32x16_bf16 v[112:127], v[80:83], v[8:11], 0
    v_mfma_f32_32x32x16_bf16 v[112:127], v[84:87], v[12:15], v[112:127]
    ds_read_b128 v[72:75], v7 offset:16384
    ds_read_b128 v[76:79], v7 offset:17408
    v_max3_f32 v17, v32, v33, v34
    v_max3_f32 v17, v17, v35, v36
    v_max3_f32 v17, v17, v37, v38
    v_max3_f32 v17, v17, v39, v40
    v_max3_f32 v17, v17, v41, v42
    v_max3_f32 v17, v17, v43, v44
    v_max3_f32 v17, v17, v45, v46
    v_max_f32 v17, v17, v47
    v_mov_b32 v18, v17
    s_nop 1
    v_permlane32_swap_b32 v17, v18
    v_max_f32 v17, v17, v18
    v_mul_f32 v17, s33, v17
    v_max_f32 v17, v16, v17
    v_sub_f32 v18, v16, v17
    v_mov_b32 v16, v17
    v_exp_f32 v18, v18
    v_fma_f32 v32, v32, s33, -v16
    v_fma_f32 v33, v33, s33, -v16
    v_fma_f32 v34, v34, s33, -v16
    v_fma_f32 v35, v35, s33, -v16
    v_fma_f32 v36, v36, s33, -v16
    v_fma_f32 v37, v37, s33, -v16
    v_fma_f32 v38, v38, s33, -v16
    v_fma_f32 v39, v39, s33, -v16
    v_fma_f32 v40, v40, s33, -v16
    v_fma_f32 v41, v41, s33, -v16
    v_fma_f32 v42, v42, s33, -v16
    v_fma_f32 v43, v43, s33, -v16
    v_fma_f32 v44, v44, s33, -v16
    v_fma_f32 v45, v45, s33, -v16
    v_fma_f32 v46, v46, s33, -v16
    v_fma_f32 v47, v47, s33, -v16
    v_exp_f32 v32, v32
    v_exp_f32 v33, v33
    v_exp_f32 v34, v34
    v_exp_f32 v35, v35
    v_exp_f32 v36, v36
    v_exp_f32 v37, v37
    v_exp_f32 v38, v38
    v_exp_f32 v39, v39
    v_exp_f32 v40, v40
    v_exp_f32 v41, v41
    v_exp_f32 v42, v42
    v_exp_f32 v43, v43
    v_exp_f32 v44, v44
    v_exp_f32 v45, v45
    v_exp_f32 v46, v46
    v_exp_f32 v47, v47
    v_mul_f32 v48, v48, v18
    v_mul_f32 v49, v49, v18
    v_mul_f32 v50, v50, v18
    v_mul_f32 v51, v51, v18
    v_mul_f32 v52, v52, v18
    v_mul_f32 v53, v53, v18
    v_mul_f32 v54, v54, v18
    v_mul_f32 v55, v55, v18
    v_mul_f32 v56, v56, v18
    v_mul_f32 v57, v57, v18
    v_mul_f32 v58, v58, v18
    v_mul_f32 v59, v59, v18
    v_cvt_pk_bf16_f32 v64, v32, v33
    v_cvt_pk_bf16_f32 v65, v34, v35
    v_cvt_pk_bf16_f32 v66, v36, v37
    v_cvt_pk_bf16_f32 v67, v38, v39
    v_cvt_pk_bf16_f32 v68, v40, v41
    v_cvt_pk_bf16_f32 v69, v42, v43
    v_cvt_pk_bf16_f32 v70, v44, v45
    v_cvt_pk_bf16_f32 v71, v46, v47
    s_waitcnt lgkmcnt(2)
    s_nop 1
    v_mfma_f32_32x32x16_bf16 v[48:63], v[88:91], v[64:67], v[48:63]
    v_mfma_f32_32x32x16_bf16 v[48:63], v[92:95], v[68:71], v[48:63]
    ds_read_b128 v[88:91], v7 offset:14336
    ds_read_b128 v[92:95], v7 offset:15360
    s_waitcnt lgkmcnt(2)
    v_mfma_f32_32x32x16_bf16 v[32:47], v[72:75], v[8:11], 0
    v_mfma_f32_32x32x16_bf16 v[32:47], v[76:79], v[12:15], v[32:47]
    ds_read_b128 v[80:83], v7 offset:20480
    ds_read_b128 v[84:87], v7 offset:21504
    v_max3_f32 v17, v112, v113, v114
    v_max3_f32 v17, v17, v115, v116
    v_max3_f32 v17, v17, v117, v118
    v_max3_f32 v17, v17, v119, v120
    v_max3_f32 v17, v17, v121, v122
    v_max3_f32 v17, v17, v123, v124
    v_max3_f32 v17, v17, v125, v126
    v_max_f32 v17, v17, v127
    v_mov_b32 v18, v17
    s_nop 1
    v_permlane32_swap_b32 v17, v18
    v_max_f32 v17, v17, v18
    v_mul_f32 v17, s33, v17
    v_max_f32 v17, v16, v17
    v_sub_f32 v18, v16, v17
    v_mov_b32 v16, v17
    v_exp_f32 v18, v18
    v_fma_f32 v112, v112, s33, -v16
    v_fma_f32 v113, v113, s33, -v16
    v_fma_f32 v114, v114, s33, -v16
    v_fma_f32 v115, v115, s33, -v16
    v_fma_f32 v116, v116, s33, -v16
    v_fma_f32 v117, v117, s33, -v16
    v_fma_f32 v118, v118, s33, -v16
    v_fma_f32 v119, v119, s33, -v16
    v_fma_f32 v120, v120, s33, -v16
    v_fma_f32 v121, v121, s33, -v16
    v_fma_f32 v122, v122, s33, -v16
    v_fma_f32 v123, v123, s33, -v16
    v_fma_f32 v124, v124, s33, -v16
    v_fma_f32 v125, v125, s33, -v16
    v_fma_f32 v126, v126, s33, -v16
    v_fma_f32 v127, v127, s33, -v16
    v_exp_f32 v112, v112
    v_exp_f32 v113, v113
    v_exp_f32 v114, v114
    v_exp_f32 v115, v115
    v_exp_f32 v116, v116
    v_exp_f32 v117, v117
    v_exp_f32 v118, v118
    v_exp_f32 v119, v119
    v_exp_f32 v120, v120
    v_exp_f32 v121, v121
    v_exp_f32 v122, v122
    v_exp_f32 v123, v123
    v_exp_f32 v124, v124
    v_exp_f32 v125, v125
    v_exp_f32 v126, v126
    v_exp_f32 v127, v127
    v_mul_f32 v48, v48, v18
    v_mul_f32 v49, v49, v18
    v_mul_f32 v50, v50, v18
    v_mul_f32 v51, v51, v18
    v_mul_f32 v52, v52, v18
    v_mul_f32 v53, v53, v18
    v_mul_f32 v54, v54, v18
    v_mul_f32 v55, v55, v18
    v_mul_f32 v56, v56, v18
    v_mul_f32 v57, v57, v18
    v_mul_f32 v58, v58, v18
    v_mul_f32 v59, v59, v18
    v_cvt_pk_bf16_f32 v64, v112, v113
    v_cvt_pk_bf16_f32 v65, v114, v115
    v_cvt_pk_bf16_f32 v66, v116, v117
    v_cvt_pk_bf16_f32 v67, v118, v119
    v_cvt_pk_bf16_f32 v68, v120, v121
    v_cvt_pk_bf16_f32 v69, v122, v123
    v_cvt_pk_bf16_f32 v70, v124, v125
    v_cvt_pk_bf16_f32 v71, v126, v127
    s_waitcnt lgkmcnt(2)
    s_nop 1
    v_mfma_f32_32x32x16_bf16 v[48:63], v[88:91], v[64:67], v[48:63]
    v_mfma_f32_32x32x16_bf16 v[48:63], v[92:95], v[68:71], v[48:63]
    ds_read_b128 v[88:91], v7 offset:18432
    ds_read_b128 v[92:95], v7 offset:19456
    s_waitcnt lgkmcnt(2)
    v_mfma_f32_32x32x16_bf16 v[112:127], v[80:83], v[8:11], 0
    v_mfma_f32_32x32x16_bf16 v[112:127], v[84:87], v[12:15], v[112:127]
    ds_read_b128 v[72:75], v7 offset:24576
    ds_read_b128 v[76:79], v7 offset:25600
    v_max3_f32 v17, v32, v33, v34
    v_max3_f32 v17, v17, v35, v36
    v_max3_f32 v17, v17, v37, v38
    v_max3_f32 v17, v17, v39, v40
    v_max3_f32 v17, v17, v41, v42
    v_max3_f32 v17, v17, v43, v44
    v_max3_f32 v17, v17, v45, v46
    v_max_f32 v17, v17, v47
    v_mov_b32 v18, v17
    s_nop 1
    v_permlane32_swap_b32 v17, v18
    v_max_f32 v17, v17, v18
    v_mul_f32 v17, s33, v17
    v_max_f32 v17, v16, v17
    v_sub_f32 v18, v16, v17
    v_mov_b32 v16, v17
    v_exp_f32 v18, v18
    v_fma_f32 v32, v32, s33, -v16
    v_fma_f32 v33, v33, s33, -v16
    v_fma_f32 v34, v34, s33, -v16
    v_fma_f32 v35, v35, s33, -v16
    v_fma_f32 v36, v36, s33, -v16
    v_fma_f32 v37, v37, s33, -v16
    v_fma_f32 v38, v38, s33, -v16
    v_fma_f32 v39, v39, s33, -v16
    v_fma_f32 v40, v40, s33, -v16
    v_fma_f32 v41, v41, s33, -v16
    v_fma_f32 v42, v42, s33, -v16
    v_fma_f32 v43, v43, s33, -v16
    v_fma_f32 v44, v44, s33, -v16
    v_fma_f32 v45, v45, s33, -v16
    v_fma_f32 v46, v46, s33, -v16
    v_fma_f32 v47, v47, s33, -v16
    v_exp_f32 v32, v32
    v_exp_f32 v33, v33
    v_exp_f32 v34, v34
    v_exp_f32 v35, v35
    v_exp_f32 v36, v36
    v_exp_f32 v37, v37
    v_exp_f32 v38, v38
    v_exp_f32 v39, v39
    v_exp_f32 v40, v40
    v_exp_f32 v41, v41
    v_exp_f32 v42, v42
    v_exp_f32 v43, v43
    v_exp_f32 v44, v44
    v_exp_f32 v45, v45
    v_exp_f32 v46, v46
    v_exp_f32 v47, v47
    v_mul_f32 v48, v48, v18
    v_mul_f32 v49, v49, v18
    v_mul_f32 v50, v50, v18
    v_mul_f32 v51, v51, v18
    v_mul_f32 v52, v52, v18
    v_mul_f32 v53, v53, v18
    v_mul_f32 v54, v54, v18
    v_mul_f32 v55, v55, v18
    v_mul_f32 v56, v56, v18
    v_mul_f32 v57, v57, v18
    v_mul_f32 v58, v58, v18
    v_mul_f32 v59, v59, v18
    v_cvt_pk_bf16_f32 v64, v32, v33
    v_cvt_pk_bf16_f32 v65, v34, v35
    v_cvt_pk_bf16_f32 v66, v36, v37
    v_cvt_pk_bf16_f32 v67, v38, v39
    v_cvt_pk_bf16_f32 v68, v40, v41
    v_cvt_pk_bf16_f32 v69, v42, v43
    v_cvt_pk_bf16_f32 v70, v44, v45
    v_cvt_pk_bf16_f32 v71, v46, v47
    s_waitcnt lgkmcnt(2)
    s_nop 1
    v_mfma_f32_32x32x16_bf16 v[48:63], v[88:91], v[64:67], v[48:63]
    v_mfma_f32_32x32x16_bf16 v[48:63], v[92:95], v[68:71], v[48:63]
    ds_read_b128 v[88:91], v7 offset:22528
    ds_read_b128 v[92:95], v7 offset:23552
    s_waitcnt lgkmcnt(2)
    v_mfma_f32_32x32x16_bf16 v[32:47], v[72:75], v[8:11], 0
    v_mfma_f32_32x32x16_bf16 v[32:47], v[76:79], v[12:15], v[32:47]
    ds_read_b128 v[80:83], v7 offset:28672
    ds_read_b128 v[84:87], v7 offset:29696
    v_max3_f32 v17, v112, v113, v114
    v_max3_f32 v17, v17, v115, v116
    v_max3_f32 v17, v17, v117, v118
    v_max3_f32 v17, v17, v119, v120
    v_max3_f32 v17, v17, v121, v122
    v_max3_f32 v17, v17, v123, v124
    v_max3_f32 v17, v17, v125, v126
    v_max_f32 v17, v17, v127
    v_mov_b32 v18, v17
    s_nop 1
    v_permlane32_swap_b32 v17, v18
    v_max_f32 v17, v17, v18
    v_mul_f32 v17, s33, v17
    v_max_f32 v17, v16, v17
    v_sub_f32 v18, v16, v17
    v_mov_b32 v16, v17
    v_exp_f32 v18, v18
    v_fma_f32 v112, v112, s33, -v16
    v_fma_f32 v113, v113, s33, -v16
    v_fma_f32 v114, v114, s33, -v16
    v_fma_f32 v115, v115, s33, -v16
    v_fma_f32 v116, v116, s33, -v16
    v_fma_f32 v117, v117, s33, -v16
    v_fma_f32 v118, v118, s33, -v16
    v_fma_f32 v119, v119, s33, -v16
    v_fma_f32 v120, v120, s33, -v16
    v_fma_f32 v121, v121, s33, -v16
    v_fma_f32 v122, v122, s33, -v16
    v_fma_f32 v123, v123, s33, -v16
    v_fma_f32 v124, v124, s33, -v16
    v_fma_f32 v125, v125, s33, -v16
    v_fma_f32 v126, v126, s33, -v16
    v_fma_f32 v127, v127, s33, -v16
    v_exp_f32 v112, v112
    v_exp_f32 v113, v113
    v_exp_f32 v114, v114
    v_exp_f32 v115, v115
    v_exp_f32 v116, v116
    v_exp_f32 v117, v117
    v_exp_f32 v118, v118
    v_exp_f32 v119, v119
    v_exp_f32 v120, v120
    v_exp_f32 v121, v121
    v_exp_f32 v122, v122
    v_exp_f32 v123, v123
    v_exp_f32 v124, v124
    v_exp_f32 v125, v125
    v_exp_f32 v126, v126
    v_exp_f32 v127, v127
    v_mul_f32 v48, v48, v18
    v_mul_f32 v49, v49, v18
    v_mul_f32 v50, v50, v18
    v_mul_f32 v51, v51, v18
    v_mul_f32 v52, v52, v18
    v_mul_f32 v53, v53, v18
    v_mul_f32 v54, v54, v18
    v_mul_f32 v55, v55, v18
    v_mul_f32 v56, v56, v18
    v_mul_f32 v57, v57, v18
    v_mul_f32 v58, v58, v18
    v_mul_f32 v59, v59, v18
    v_cvt_pk_bf16_f32 v64, v112, v113
    v_cvt_pk_bf16_f32 v65, v114, v115
    v_cvt_pk_bf16_f32 v66, v116, v117
    v_cvt_pk_bf16_f32 v67, v118, v119
    v_cvt_pk_bf16_f32 v68, v120, v121
    v_cvt_pk_bf16_f32 v69, v122, v123
    v_cvt_pk_bf16_f32 v70, v124, v125
    v_cvt_pk_bf16_f32 v71, v126, v127
    s_waitcnt lgkmcnt(2)
    s_nop 1
    v_mfma_f32_32x32x16_bf16 v[48:63], v[88:91], v[64:67], v[48:63]
    v_mfma_f32_32x32x16_bf16 v[48:63], v[92:95], v[68:71], v[48:63]
    ds_read_b128 v[88:91], v7 offset:26624
    ds_read_b128 v[92:95], v7 offset:27648
    s_waitcnt lgkmcnt(2)
    v_mfma_f32_32x32x16_bf16 v[112:127], v[80:83], v[8:11], 0
    v_mfma_f32_32x32x16_bf16 v[112:127], v[84:87], v[12:15], v[112:127]
    v_max3_f32 v17, v32, v33, v34
    v_max3_f32 v17, v17, v35, v36
    v_max3_f32 v17, v17, v37, v38
    v_max3_f32 v17, v17, v39, v40
    v_max3_f32 v17, v17, v41, v42
    v_max3_f32 v17, v17, v43, v44
    v_max3_f32 v17, v17, v45, v46
    v_max_f32 v17, v17, v47
    v_mov_b32 v18, v17
    s_nop 1
    v_permlane32_swap_b32 v17, v18
    v_max_f32 v17, v17, v18
    v_mul_f32 v17, s33, v17
    v_max_f32 v17, v16, v17
    v_sub_f32 v18, v16, v17
    v_mov_b32 v16, v17
    v_exp_f32 v18, v18
    v_fma_f32 v32, v32, s33, -v16
    v_fma_f32 v33, v33, s33, -v16
    v_fma_f32 v34, v34, s33, -v16
    v_fma_f32 v35, v35, s33, -v16
    v_fma_f32 v36, v36, s33, -v16
    v_fma_f32 v37, v37, s33, -v16
    v_fma_f32 v38, v38, s33, -v16
    v_fma_f32 v39, v39, s33, -v16
    v_fma_f32 v40, v40, s33, -v16
    v_fma_f32 v41, v41, s33, -v16
    v_fma_f32 v42, v42, s33, -v16
    v_fma_f32 v43, v43, s33, -v16
    v_fma_f32 v44, v44, s33, -v16
    v_fma_f32 v45, v45, s33, -v16
    v_fma_f32 v46, v46, s33, -v16
    v_fma_f32 v47, v47, s33, -v16
    v_exp_f32 v32, v32
    v_exp_f32 v33, v33
    v_exp_f32 v34, v34
    v_exp_f32 v35, v35
    v_exp_f32 v36, v36
    v_exp_f32 v37, v37
    v_exp_f32 v38, v38
    v_exp_f32 v39, v39
    v_exp_f32 v40, v40
    v_exp_f32 v41, v41
    v_exp_f32 v42, v42
    v_exp_f32 v43, v43
    v_exp_f32 v44, v44
    v_exp_f32 v45, v45
    v_exp_f32 v46, v46
    v_exp_f32 v47, v47
    v_mul_f32 v48, v48, v18
    v_mul_f32 v49, v49, v18
    v_mul_f32 v50, v50, v18
    v_mul_f32 v51, v51, v18
    v_mul_f32 v52, v52, v18
    v_mul_f32 v53, v53, v18
    v_mul_f32 v54, v54, v18
    v_mul_f32 v55, v55, v18
    v_mul_f32 v56, v56, v18
    v_mul_f32 v57, v57, v18
    v_mul_f32 v58, v58, v18
    v_mul_f32 v59, v59, v18
    v_cvt_pk_bf16_f32 v64, v32, v33
    v_cvt_pk_bf16_f32 v65, v34, v35
    v_cvt_pk_bf16_f32 v66, v36, v37
    v_cvt_pk_bf16_f32 v67, v38, v39
    v_cvt_pk_bf16_f32 v68, v40, v41
    v_cvt_pk_bf16_f32 v69, v42, v43
    v_cvt_pk_bf16_f32 v70, v44, v45
    v_cvt_pk_bf16_f32 v71, v46, v47
    s_waitcnt lgkmcnt(0)
    s_nop 1
    v_mfma_f32_32x32x16_bf16 v[48:63], v[88:91], v[64:67], v[48:63]
    v_mfma_f32_32x32x16_bf16 v[48:63], v[92:95], v[68:71], v[48:63]
    ds_read_b128 v[88:91], v7 offset:30720
    ds_read_b128 v[92:95], v7 offset:31744
    s_nop 7
    v_max3_f32 v17, v112, v113, v114
    v_max3_f32 v17, v17, v115, v116
    v_max3_f32 v17, v17, v117, v118
    v_max3_f32 v17, v17, v119, v120
    v_max3_f32 v17, v17, v121, v122
    v_max3_f32 v17, v17, v123, v124
    v_max3_f32 v17, v17, v125, v126
    v_max_f32 v17, v17, v127
    v_mov_b32 v18, v17
    s_nop 1
    v_permlane32_swap_b32 v17, v18
    v_max_f32 v17, v17, v18
    v_mul_f32 v17, s33, v17
    v_max_f32 v17, v16, v17
    v_sub_f32 v18, v16, v17
    v_mov_b32 v16, v17
    v_exp_f32 v18, v18
    v_fma_f32 v112, v112, s33, -v16
    v_fma_f32 v113, v113, s33, -v16
    v_fma_f32 v114, v114, s33, -v16
    v_fma_f32 v115, v115, s33, -v16
    v_fma_f32 v116, v116, s33, -v16
    v_fma_f32 v117, v117, s33, -v16
    v_fma_f32 v118, v118, s33, -v16
    v_fma_f32 v119, v119, s33, -v16
    v_fma_f32 v120, v120, s33, -v16
    v_fma_f32 v121, v121, s33, -v16
    v_fma_f32 v122, v122, s33, -v16
    v_fma_f32 v123, v123, s33, -v16
    v_fma_f32 v124, v124, s33, -v16
    v_fma_f32 v125, v125, s33, -v16
    v_fma_f32 v126, v126, s33, -v16
    v_fma_f32 v127, v127, s33, -v16
    v_exp_f32 v112, v112
    v_exp_f32 v113, v113
    v_exp_f32 v114, v114
    v_exp_f32 v115, v115
    v_exp_f32 v116, v116
    v_exp_f32 v117, v117
    v_exp_f32 v118, v118
    v_exp_f32 v119, v119
    v_exp_f32 v120, v120
    v_exp_f32 v121, v121
    v_exp_f32 v122, v122
    v_exp_f32 v123, v123
    v_exp_f32 v124, v124
    v_exp_f32 v125, v125
    v_exp_f32 v126, v126
    v_exp_f32 v127, v127
    v_mul_f32 v48, v48, v18
    v_mul_f32 v49, v49, v18
    v_mul_f32 v50, v50, v18
    v_mul_f32 v51, v51, v18
    v_mul_f32 v52, v52, v18
    v_mul_f32 v53, v53, v18
    v_mul_f32 v54, v54, v18
    v_mul_f32 v55, v55, v18
    v_mul_f32 v56, v56, v18
    v_mul_f32 v57, v57, v18
    v_mul_f32 v58, v58, v18
    v_mul_f32 v59, v59, v18
    v_cvt_pk_bf16_f32 v64, v112, v113
    v_cvt_pk_bf16_f32 v65, v114, v115
    v_cvt_pk_bf16_f32 v66, v116, v117
    v_cvt_pk_bf16_f32 v67, v118, v119
    v_cvt_pk_bf16_f32 v68, v120, v121
    v_cvt_pk_bf16_f32 v69, v122, v123
    v_cvt_pk_bf16_f32 v70, v124, v125
    v_cvt_pk_bf16_f32 v71, v126, v127
    s_waitcnt lgkmcnt(0)
    s_nop 1
    v_mfma_f32_32x32x16_bf16 v[48:63], v[88:91], v[64:67], v[48:63]
    v_mfma_f32_32x32x16_bf16 v[48:63], v[92:95], v[68:71], v[48:63]
    s_cmp_eq_u32 s20, 7
    s_cbranch_scc1 L_b2_l1_kernel_fin
    s_waitcnt vmcnt(0)
    ds_write_b128 v6, v[96:99] offset:0
    ds_write_b128 v6, v[100:103] offset:8192
    ds_write_b128 v6, v[104:107] offset:16384
    ds_write_b128 v6, v[108:111] offset:24576
    s_waitcnt lgkmcnt(0)
    s_barrier
    v_xor_b32 v6, 0x8000, v6
    v_xor_b32 v7, 0x8000, v7
    s_add_u32 s20, s20, 1
    s_branch L_b2_l1_kernel_loop
L_b2_l1_kernel_fin:
    s_nop 15
    v_mov_b32 v17, v58
    v_mov_b32 v18, v58
    s_nop 1
    v_permlane32_swap_b32 v17, v18
    v_rcp_f32 v17, v17
    s_nop 0
    v_mul_f32 v48, v48, v17
    v_mul_f32 v49, v49, v17
    v_cvt_pk_bf16_f32 v64, v48, v49
    v_mul_f32 v50, v50, v17
    v_mul_f32 v51, v51, v17
    v_cvt_pk_bf16_f32 v65, v50, v51
    v_mul_f32 v52, v52, v17
    v_mul_f32 v53, v53, v17
    v_cvt_pk_bf16_f32 v66, v52, v53
    v_mul_f32 v54, v54, v17
    v_mul_f32 v55, v55, v17
    v_cvt_pk_bf16_f32 v67, v54, v55
    v_mul_f32 v56, v56, v17
    v_mul_f32 v57, v57, v17
    v_cvt_pk_bf16_f32 v68, v56, v57
    s_mul_i32 s26, s22, 36864
    s_add_u32 s26, s26, 15548416
    s_mul_i32 s27, s18, 18
    v_lshlrev_b32 v22, 2, v3
    v_add_u32 v22, s27, v22
    v_add_u32 v20, 0, v22
    v_lshrrev_b32 v21, 4, v20
    v_lshlrev_b32 v21, 10, v21
    v_lshl_add_u32 v21, v2, 4, v21
    v_bfe_u32 v23, v20, 3, 1
    v_lshl_add_u32 v21, v23, 9, v21
    v_and_b32 v23, 7, v20
    v_lshl_add_u32 v21, v23, 1, v21
    buffer_store_dword v64, v21, s[12:15], s26 offen
    v_add_u32 v20, 2, v22
    v_lshrrev_b32 v21, 4, v20
    v_lshlrev_b32 v21, 10, v21
    v_lshl_add_u32 v21, v2, 4, v21
    v_bfe_u32 v23, v20, 3, 1
    v_lshl_add_u32 v21, v23, 9, v21
    v_and_b32 v23, 7, v20
    v_lshl_add_u32 v21, v23, 1, v21
    buffer_store_dword v65, v21, s[12:15], s26 offen
    v_add_u32 v20, 8, v22
    v_lshrrev_b32 v21, 4, v20
    v_lshlrev_b32 v21, 10, v21
    v_lshl_add_u32 v21, v2, 4, v21
    v_bfe_u32 v23, v20, 3, 1
    v_lshl_add_u32 v21, v23, 9, v21
    v_and_b32 v23, 7, v20
    v_lshl_add_u32 v21, v23, 1, v21
    buffer_store_dword v66, v21, s[12:15], s26 offen
    v_add_u32 v20, 10, v22
    v_lshrrev_b32 v21, 4, v20
    v_lshlrev_b32 v21, 10, v21
    v_lshl_add_u32 v21, v2, 4, v21
    v_bfe_u32 v23, v20, 3, 1
    v_lshl_add_u32 v21, v23, 9, v21
    v_and_b32 v23, 7, v20
    v_lshl_add_u32 v21, v23, 1, v21
    buffer_store_dword v67, v21, s[12:15], s26 offen
    v_add_u32 v20, 16, v22
    v_lshrrev_b32 v21, 4, v20
    v_lshlrev_b32 v21, 10, v21
    v_lshl_add_u32 v21, v2, 4, v21
    v_bfe_u32 v23, v20, 3, 1
    v_lshl_add_u32 v21, v23, 9, v21
    v_and_b32 v23, 7, v20
    v_lshl_add_u32 v21, v23, 1, v21
    s_mov_b64 exec, s[30:31]
    buffer_store_dword v68, v21, s[12:15], s26 offen
    s_mov_b64 exec, -1
L_b2_l1_kernel_end:
    s_endpgm
.globl outb_l1_kernel
.p2align 8
.type outb_l1_kernel,@function
outb_l1_kernel:
    s_cmp_ge_u32 s2, 288
    s_cbranch_scc1 L_outb_l1_kernel_end
    s_load_dwordx2 s[4:5], s[0:1], 72
    s_load_dwordx2 s[6:7], s[0:1], 0
    s_load_dwordx2 s[36:37], s[0:1], 56
    v_lshrrev_b32 v1, 6, v0
    s_nop 0
    v_readfirstlane_b32 s3, v1
    v_and_b32 v1, 63, v0
    v_and_b32 v2, 31, v1
    v_lshrrev_b32 v3, 5, v1
    v_lshlrev_b32 v4, 4, v1
    s_mov_b32 s30, -1
    s_mov_b32 s31, 0
    s_waitcnt lgkmcnt(0)
    s_mov_b32 s12, s4
    s_mov_b32 s13, s5
    s_mov_b32 s14, 268435456
    s_mov_b32 s15, 0x00020000
    s_add_u32 s8, s4, 13189120
    s_addc_u32 s9, s5, 0
    s_mov_b32 s10, 2359296
    s_mov_b32 s11, 0x00020000
    s_mov_b32 s40, s36
    s_mov_b32 s41, s37
    s_mov_b32 s42, 2359296
    s_mov_b32 s43, 0x00020000
    s_mul_i32 s16, s2, 7282
    s_lshr_b32 s16, s16, 16
    s_mul_i32 s17, s16, 9
    s_sub_u32 s17, s2, s17
    s_lshl_b32 s16, s16, 1
    s_and_b32 s18, s3, 1
    s_add_u32 s16, s16, s18
    s_lshl_b32 s17, s17, 1
    s_lshr_b32 s18, s3, 1
    s_add_u32 s17, s17, s18
    s_mul_i32 s19, s17, 36864
    s_add_u32 s19, s19, 7741440
    s_lshl_b32 s20, s16, 5
    v_add_u32 v5, s20, v2
    v_mul_u32_u24 v5, 1152, v5
    v_lshl_add_u32 v6, v3, 4, v5
    s_mul_i32 s21, s16, 36864
    s_add_u32 s21, s21, 15548416
    buffer_load_dwordx4 v[40:43], v4, s[12:15], s19 offen
    buffer_load_dwordx4 v[44:47], v4, s[12:15], s21 offen
    s_add_u32 s19, s19, 1024
    s_add_u32 s21, s21, 1024
    buffer_load_dwordx4 v[48:51], v4, s[12:15], s19 offen
    buffer_load_dwordx4 v[52:55], v4, s[12:15], s21 offen
    s_add_u32 s19, s19, 1024
    s_add_u32 s21, s21, 1024
    buffer_load_dwordx4 v[56:59], v4, s[12:15], s19 offen
    buffer_load_dwordx4 v[60:63], v4, s[12:15], s21 offen
    s_add_u32 s19, s19, 1024
    s_add_u32 s21, s21, 1024
    buffer_load_dwordx4 v[64:67], v4, s[12:15], s19 offen
    buffer_load_dwordx4 v[68:71], v4, s[12:15], s21 offen
    s_add_u32 s19, s19, 1024
    s_add_u32 s21, s21, 1024
    buffer_load_dwordx4 v[72:75], v4, s[12:15], s19 offen
    buffer_load_dwordx4 v[76:79], v4, s[12:15], s21 offen
    s_add_u32 s19, s19, 1024
    s_add_u32 s21, s21, 1024
    buffer_load_dwordx4 v[80:83], v4, s[12:15], s19 offen
    buffer_load_dwordx4 v[84:87], v4, s[12:15], s21 offen
    s_add_u32 s19, s19, 1024
    s_add_u32 s21, s21, 1024
    buffer_load_dwordx4 v[88:91], v4, s[12:15], s19 offen
    buffer_load_dwordx4 v[92:95], v4, s[12:15], s21 offen
    s_add_u32 s19, s19, 1024
    s_add_u32 s21, s21, 1024
    buffer_load_dwordx4 v[96:99], v4, s[12:15], s19 offen
    buffer_load_dwordx4 v[100:103], v4, s[12:15], s21 offen
    s_add_u32 s19, s19, 1024
    s_add_u32 s21, s21, 1024
    buffer_load_dwordx4 v[104:107], v4, s[12:15], s19 offen
    buffer_load_dwordx4 v[108:111], v4, s[12:15], s21 offen
    s_add_u32 s19, s19, 1024
    s_add_u32 s21, s21, 1024
    buffer_load_dwordx4 v[112:115], v4, s[12:15], s19 offen
    buffer_load_dwordx4 v[116:119], v4, s[12:15], s21 offen
    s_add_u32 s19, s19, 1024
    s_add_u32 s21, s21, 1024
    buffer_load_dwordx4 v[120:123], v4, s[12:15], s19 offen
    buffer_load_dwordx4 v[124:127], v4, s[12:15], s21 offen
    s_add_u32 s19, s19, 1024
    s_add_u32 s21, s21, 1024
    buffer_load_dwordx4 v[128:131], v4, s[12:15], s19 offen
    buffer_load_dwordx4 v[132:135], v4, s[12:15], s21 offen
    s_add_u32 s19, s19, 1024
    s_add_u32 s21, s21, 1024
    buffer_load_dwordx4 v[136:139], v4, s[12:15], s19 offen
    buffer_load_dwordx4 v[140:143], v4, s[12:15], s21 offen
    s_add_u32 s19, s19, 1024
    s_add_u32 s21, s21, 1024
    buffer_load_dwordx4 v[144:147], v4, s[12:15], s19 offen
    buffer_load_dwordx4 v[148:151], v4, s[12:15], s21 offen
    s_add_u32 s19, s19, 1024
    s_add_u32 s21, s21, 1024
    buffer_load_dwordx4 v[152:155], v4, s[12:15], s19 offen
    buffer_load_dwordx4 v[156:159], v4, s[12:15], s21 offen
    s_add_u32 s19, s19, 1024
    s_add_u32 s21, s21, 1024
    s_waitcnt vmcnt(28)
    v_mfma_f32_32x32x16_bf16 v[16:31], v[40:43], v[44:47], 0
    buffer_load_dwordx4 v[40:43], v4, s[12:15], s19 offen
    buffer_load_dwordx4 v[44:47], v4, s[12:15], s21 offen
    s_add_u32 s19, s19, 1024
    s_add_u32 s21, s21, 1024
    s_waitcnt vmcnt(28)
    v_mfma_f32_32x32x16_bf16 v[16:31], v[48:51], v[52:55], v[16:31]
    buffer_load_dwordx4 v[48:51], v4, s[12:15], s19 offen
    buffer_load_dwordx4 v[52:55], v4, s[12:15], s21 offen
    s_add_u32 s19, s19, 1024
    s_add_u32 s21, s21, 1024
    s_waitcnt vmcnt(28)
    v_mfma_f32_32x32x16_bf16 v[16:31], v[56:59], v[60:63], v[16:31]
    buffer_load_dwordx4 v[56:59], v4, s[12:15], s19 offen
    buffer_load_dwordx4 v[60:63], v4, s[12:15], s21 offen
    s_add_u32 s19, s19, 1024
    s_add_u32 s21, s21, 1024
    s_waitcnt vmcnt(28)
    v_mfma_f32_32x32x16_bf16 v[16:31], v[64:67], v[68:71], v[16:31]
    buffer_load_dwordx4 v[64:67], v4, s[12:15], s19 offen
    buffer_load_dwordx4 v[68:71], v4, s[12:15], s21 offen
    s_add_u32 s19, s19, 1024
    s_add_u32 s21, s21, 1024
    s_waitcnt vmcnt(28)
    v_mfma_f32_32x32x16_bf16 v[16:31], v[72:75], v[76:79], v[16:31]
    buffer_load_dwordx4 v[72:75], v4, s[12:15], s19 offen
    buffer_load_dwordx4 v[76:79], v4, s[12:15], s21 offen
    s_add_u32 s19, s19, 1024
    s_add_u32 s21, s21, 1024
    s_waitcnt vmcnt(28)
    v_mfma_f32_32x32x16_bf16 v[16:31], v[80:83], v[84:87], v[16:31]
    buffer_load_dwordx4 v[80:83], v4, s[12:15], s19 offen
    buffer_load_dwordx4 v[84:87], v4, s[12:15], s21 offen
    s_add_u32 s19, s19, 1024
    s_add_u32 s21, s21, 1024
    s_waitcnt vmcnt(28)
    v_mfma_f32_32x32x16_bf16 v[16:31], v[88:91], v[92:95], v[16:31]
    buffer_load_dwordx4 v[88:91], v4, s[12:15], s19 offen
    buffer_load_dwordx4 v[92:95], v4, s[12:15], s21 offen
    s_add_u32 s19, s19, 1024
    s_add_u32 s21, s21, 1024
    s_waitcnt vmcnt(28)
    v_mfma_f32_32x32x16_bf16 v[16:31], v[96:99], v[100:103], v[16:31]
    buffer_load_dwordx4 v[96:99], v4, s[12:15], s19 offen
    buffer_load_dwordx4 v[100:103], v4, s[12:15], s21 offen
    s_add_u32 s19, s19, 1024
    s_add_u32 s21, s21, 1024
    s_waitcnt vmcnt(28)
    v_mfma_f32_32x32x16_bf16 v[16:31], v[104:107], v[108:111], v[16:31]
    buffer_load_dwordx4 v[104:107], v4, s[12:15], s19 offen
    buffer_load_dwordx4 v[108:111], v4, s[12:15], s21 offen
    s_add_u32 s19, s19, 1024
    s_add_u32 s21, s21, 1024
    s_waitcnt vmcnt(28)
    v_mfma_f32_32x32x16_bf16 v[16:31], v[112:115], v[116:119], v[16:31]
    buffer_load_dwordx4 v[112:115], v4, s[12:15], s19 offen
    buffer_load_dwordx4 v[116:119], v4, s[12:15], s21 offen
    s_add_u32 s19, s19, 1024
    s_add_u32 s21, s21, 1024
    s_waitcnt vmcnt(28)
    v_mfma_f32_32x32x16_bf16 v[16:31], v[120:123], v[124:127], v[16:31]
    buffer_load_dwordx4 v[120:123], v4, s[12:15], s19 offen
    buffer_load_dwordx4 v[124:127], v4, s[12:15], s21 offen
    s_add_u32 s19, s19, 1024
    s_add_u32 s21, s21, 1024
    s_waitcnt vmcnt(28)
    v_mfma_f32_32x32x16_bf16 v[16:31], v[128:131], v[132:135], v[16:31]
    buffer_load_dwordx4 v[128:131], v4, s[12:15], s19 offen
    buffer_load_dwordx4 v[132:135], v4, s[12:15], s21 offen
    s_add_u32 s19, s19, 1024
    s_add_u32 s21, s21, 1024
    s_waitcnt vmcnt(28)
    v_mfma_f32_32x32x16_bf16 v[16:31], v[136:139], v[140:143], v[16:31]
    buffer_load_dwordx4 v[136:139], v4, s[12:15], s19 offen
    buffer_load_dwordx4 v[140:143], v4, s[12:15], s21 offen
    s_add_u32 s19, s19, 1024
    s_add_u32 s21, s21, 1024
    s_waitcnt vmcnt(28)
    v_mfma_f32_32x32x16_bf16 v[16:31], v[144:147], v[148:151], v[16:31]
    buffer_load_dwordx4 v[144:147], v4, s[12:15], s19 offen
    buffer_load_dwordx4 v[148:151], v4, s[12:15], s21 offen
    s_add_u32 s19, s19, 1024
    s_add_u32 s21, s21, 1024
    s_waitcnt vmcnt(28)
    v_mfma_f32_32x32x16_bf16 v[16:31], v[152:155], v[156:159], v[16:31]
    buffer_load_dwordx4 v[152:155], v4, s[12:15], s19 offen
    buffer_load_dwordx4 v[156:159], v4, s[12:15], s21 offen
    s_add_u32 s19, s19, 1024
    s_add_u32 s21, s21, 1024
    s_waitcnt vmcnt(28)
    v_mfma_f32_32x32x16_bf16 v[16:31], v[40:43], v[44:47], v[16:31]
    buffer_load_dwordx4 v[40:43], v4, s[12:15], s19 offen
    buffer_load_dwordx4 v[44:47], v4, s[12:15], s21 offen
    s_add_u32 s19, s19, 1024
    s_add_u32 s21, s21, 1024
    s_waitcnt vmcnt(28)
    v_mfma_f32_32x32x16_bf16 v[16:31], v[48:51], v[52:55], v[16:31]
    buffer_load_dwordx4 v[48:51], v4, s[12:15], s19 offen
    buffer_load_dwordx4 v[52:55], v4, s[12:15], s21 offen
    s_add_u32 s19, s19, 1024
    s_add_u32 s21, s21, 1024
    s_waitcnt vmcnt(28)
    v_mfma_f32_32x32x16_bf16 v[16:31], v[56:59], v[60:63], v[16:31]
    buffer_load_dwordx4 v[56:59], v4, s[12:15], s19 offen
    buffer_load_dwordx4 v[60:63], v4, s[12:15], s21 offen
    s_add_u32 s19, s19, 1024
    s_add_u32 s21, s21, 1024
    s_waitcnt vmcnt(28)
    v_mfma_f32_32x32x16_bf16 v[16:31], v[64:67], v[68:71], v[16:31]
    buffer_load_dwordx4 v[64:67], v4, s[12:15], s19 offen
    buffer_load_dwordx4 v[68:71], v4, s[12:15], s21 offen
    s_add_u32 s19, s19, 1024
    s_add_u32 s21, s21, 1024
    s_waitcnt vmcnt(28)
    v_mfma_f32_32x32x16_bf16 v[16:31], v[72:75], v[76:79], v[16:31]
    buffer_load_dwordx4 v[72:75], v4, s[12:15], s19 offen
    buffer_load_dwordx4 v[76:79], v4, s[12:15], s21 offen
    s_add_u32 s19, s19, 1024
    s_add_u32 s21, s21, 1024
    s_waitcnt vmcnt(28)
    v_mfma_f32_32x32x16_bf16 v[16:31], v[80:83], v[84:87], v[16:31]
    buffer_load_dwordx4 v[80:83], v4, s[12:15], s19 offen
    buffer_load_dwordx4 v[84:87], v4, s[12:15], s21 offen
    s_add_u32 s19, s19, 1024
    s_add_u32 s21, s21, 1024
    s_waitcnt vmcnt(28)
    v_mfma_f32_32x32x16_bf16 v[16:31], v[88:91], v[92:95], v[16:31]
    s_waitcnt vmcnt(26)
    v_mfma_f32_32x32x16_bf16 v[16:31], v[96:99], v[100:103], v[16:31]
    s_waitcnt vmcnt(24)
    v_mfma_f32_32x32x16_bf16 v[16:31], v[104:107], v[108:111], v[16:31]
    s_waitcnt vmcnt(22)
    v_mfma_f32_32x32x16_bf16 v[16:31], v[112:115], v[116:119], v[16:31]
    s_waitcnt vmcnt(20)
    v_mfma_f32_32x32x16_bf16 v[16:31], v[120:123], v[124:127], v[16:31]
    s_waitcnt vmcnt(18)
    v_mfma_f32_32x32x16_bf16 v[16:31], v[128:131], v[132:135], v[16:31]
    s_waitcnt vmcnt(16)
    v_mfma_f32_32x32x16_bf16 v[16:31], v[136:139], v[140:143], v[16:31]
    s_waitcnt vmcnt(14)
    v_mfma_f32_32x32x16_bf16 v[16:31], v[144:147], v[148:151], v[16:31]
    s_waitcnt vmcnt(12)
    v_mfma_f32_32x32x16_bf16 v[16:31], v[152:155], v[156:159], v[16:31]
    s_waitcnt vmcnt(10)
    v_mfma_f32_32x32x16_bf16 v[16:31], v[40:43], v[44:47], v[16:31]
    s_waitcnt vmcnt(8)
    v_mfma_f32_32x32x16_bf16 v[16:31], v[48:51], v[52:55], v[16:31]
    s_waitcnt vmcnt(6)
    v_mfma_f32_32x32x16_bf16 v[16:31], v[56:59], v[60:63], v[16:31]
    s_waitcnt vmcnt(4)
    v_mfma_f32_32x32x16_bf16 v[16:31], v[64:67], v[68:71], v[16:31]
    s_waitcnt vmcnt(2)
    v_mfma_f32_32x32x16_bf16 v[16:31], v[72:75], v[76:79], v[16:31]
    s_waitcnt vmcnt(0)
    v_mfma_f32_32x32x16_bf16 v[16:31], v[80:83], v[84:87], v[16:31]
    s_lshl_b32 s20, s17, 6
    v_lshl_add_u32 v7, v3, 3, v5
    v_add_u32 v7, s20, v7
    buffer_load_dwordx2 v[8:9], v7, s[8:11], 0 offen offset:0
    buffer_load_dwordx2 v[10:11], v7, s[8:11], 0 offen offset:16
    buffer_load_dwordx2 v[12:13], v7, s[8:11], 0 offen offset:32
    buffer_load_dwordx2 v[14:15], v7, s[8:11], 0 offen offset:48
    s_nop 15
    v_cvt_pk_bf16_f32 v90, v16, v17
    v_cvt_pk_bf16_f32 v91, v18, v19
    v_cvt_pk_bf16_f32 v92, v20, v21
    v_cvt_pk_bf16_f32 v93, v22, v23
    v_cvt_pk_bf16_f32 v94, v24, v25
    v_cvt_pk_bf16_f32 v95, v26, v27
    v_cvt_pk_bf16_f32 v96, v28, v29
    v_cvt_pk_bf16_f32 v97, v30, v31
    s_waitcnt vmcnt(0)
    v_lshlrev_b32 v100, 16, v90
    v_and_b32 v101, 0xffff0000, v90
    v_lshlrev_b32 v102, 16, v8
    v_and_b32 v103, 0xffff0000, v8
    v_add_f32 v100, v100, v102
    v_add_f32 v101, v101, v103
    v_cvt_pk_bf16_f32 v90, v100, v101
    v_lshlrev_b32 v100, 16, v91
    v_and_b32 v101, 0xffff0000, v91
    v_lshlrev_b32 v102, 16, v9
    v_and_b32 v103, 0xffff0000, v9
    v_add_f32 v100, v100, v102
    v_add_f32 v101, v101, v103
    v_cvt_pk_bf16_f32 v91, v100, v101
    v_lshlrev_b32 v100, 16, v92
    v_and_b32 v101, 0xffff0000, v92
    v_lshlrev_b32 v102, 16, v10
    v_and_b32 v103, 0xffff0000, v10
    v_add_f32 v100, v100, v102
    v_add_f32 v101, v101, v103
    v_cvt_pk_bf16_f32 v92, v100, v101
    v_lshlrev_b32 v100, 16, v93
    v_and_b32 v101, 0xffff0000, v93
    v_lshlrev_b32 v102, 16, v11
    v_and_b32 v103, 0xffff0000, v11
    v_add_f32 v100, v100, v102
    v_add_f32 v101, v101, v103
    v_cvt_pk_bf16_f32 v93, v100, v101
    v_lshlrev_b32 v100, 16, v94
    v_and_b32 v101, 0xffff0000, v94
    v_lshlrev_b32 v102, 16, v12
    v_and_b32 v103, 0xffff0000, v12
    v_add_f32 v100, v100, v102
    v_add_f32 v101, v101, v103
    v_cvt_pk_bf16_f32 v94, v100, v101
    v_lshlrev_b32 v100, 16, v95
    v_and_b32 v101, 0xffff0000, v95
    v_lshlrev_b32 v102, 16, v13
    v_and_b32 v103, 0xffff0000, v13
    v_add_f32 v100, v100, v102
    v_add_f32 v101, v101, v103
    v_cvt_pk_bf16_f32 v95, v100, v101
    v_lshlrev_b32 v100, 16, v96
    v_and_b32 v101, 0xffff0000, v96
    v_lshlrev_b32 v102, 16, v14
    v_and_b32 v103, 0xffff0000, v14
    v_add_f32 v100, v100, v102
    v_add_f32 v101, v101, v103
    v_cvt_pk_bf16_f32 v96, v100, v101
    v_lshlrev_b32 v100, 16, v97
    v_and_b32 v101, 0xffff0000, v97
    v_lshlrev_b32 v102, 16, v15
    v_and_b32 v103, 0xffff0000, v15
    v_add_f32 v100, v100, v102
    v_add_f32 v101, v101, v103
    v_cvt_pk_bf16_f32 v97, v100, v101
    buffer_store_dwordx2 v[90:91], v7, s[40:43], 0 offen offset:0
    buffer_store_dwordx2 v[92:93], v7, s[40:43], 0 offen offset:16
    buffer_store_dwordx2 v[94:95], v7, s[40:43], 0 offen offset:32
    buffer_store_dwordx2 v[96:97], v7, s[40:43], 0 offen offset:48
L_outb_l1_kernel_end:
    s_endpgm
.section .rodata,"a"
.p2align 6
.amdhsa_kernel prep_kernel
  .amdhsa_next_free_vgpr 32
  .amdhsa_next_free_sgpr 48
  .amdhsa_accum_offset 32
  .amdhsa_group_segment_fixed_size 0
  .amdhsa_kernarg_size 80
  .amdhsa_user_sgpr_count 2
  .amdhsa_user_sgpr_kernarg_segment_ptr 1
  .amdhsa_system_sgpr_workgroup_id_x 1
.end_amdhsa_kernel
.p2align 6
.amdhsa_kernel a1_l0_kernel
  .amdhsa_next_free_vgpr 256
  .amdhsa_next_free_sgpr 64
  .amdhsa_accum_offset 256
  .amdhsa_group_segment_fixed_size 0
  .amdhsa_kernarg_size 80
  .amdhsa_user_sgpr_count 2
  .amdhsa_user_sgpr_kernarg_segment_ptr 1
  .amdhsa_system_sgpr_workgroup_id_x 1
.end_amdhsa_kernel
.p2align 6
.amdhsa_kernel a2_l0_kernel
  .amdhsa_next_free_vgpr 256
  .amdhsa_next_free_sgpr 64
  .amdhsa_accum_offset 256
  .amdhsa_group_segment_fixed_size 0
  .amdhsa_kernarg_size 80
  .amdhsa_user_sgpr_count 2
  .amdhsa_user_sgpr_kernarg_segment_ptr 1
  .amdhsa_system_sgpr_workgroup_id_x 1
.end_amdhsa_kernel
.p2align 6
.amdhsa_kernel outa_l0_kernel
  .amdhsa_next_free_vgpr 168
  .amdhsa_next_free_sgpr 64
  .amdhsa_accum_offset 168
  .amdhsa_group_segment_fixed_size 0
  .amdhsa_kernarg_size 80
  .amdhsa_user_sgpr_count 2
  .amdhsa_user_sgpr_kernarg_segment_ptr 1
  .amdhsa_system_sgpr_workgroup_id_x 1
.end_amdhsa_kernel
.p2align 6
.amdhsa_kernel b1_l0_kernel
  .amdhsa_next_free_vgpr 256
  .amdhsa_next_free_sgpr 64
  .amdhsa_accum_offset 256
  .amdhsa_group_segment_fixed_size 0
  .amdhsa_kernarg_size 80
  .amdhsa_user_sgpr_count 2
  .amdhsa_user_sgpr_kernarg_segment_ptr 1
  .amdhsa_system_sgpr_workgroup_id_x 1
.end_amdhsa_kernel
.p2align 6
.amdhsa_kernel b2_l0_kernel
  .amdhsa_next_free_vgpr 128
  .amdhsa_next_free_sgpr 64
  .amdhsa_accum_offset 128
  .amdhsa_group_segment_fixed_size 0
  .amdhsa_kernarg_size 80
  .amdhsa_user_sgpr_count 2
  .amdhsa_user_sgpr_kernarg_segment_ptr 1
  .amdhsa_system_sgpr_workgroup_id_x 1
.end_amdhsa_kernel
.p2align 6
.amdhsa_kernel outb_l0_kernel
  .amdhsa_next_free_vgpr 168
  .amdhsa_next_free_sgpr 64
  .amdhsa_accum_offset 168
  .amdhsa_group_segment_fixed_size 0
  .amdhsa_kernarg_size 80
  .amdhsa_user_sgpr_count 2
  .amdhsa_user_sgpr_kernarg_segment_ptr 1
  .amdhsa_system_sgpr_workgroup_id_x 1
.end_amdhsa_kernel
.p2align 6
.amdhsa_kernel a1_l1_kernel
  .amdhsa_next_free_vgpr 256
  .amdhsa_next_free_sgpr 64
  .amdhsa_accum_offset 256
  .amdhsa_group_segment_fixed_size 0
  .amdhsa_kernarg_size 80
  .amdhsa_user_sgpr_count 2
  .amdhsa_user_sgpr_kernarg_segment_ptr 1
  .amdhsa_system_sgpr_workgroup_id_x 1
.end_amdhsa_kernel
.p2align 6
.amdhsa_kernel a2_l1_kernel
  .amdhsa_next_free_vgpr 256
  .amdhsa_next_free_sgpr 64
  .amdhsa_accum_offset 256
  .amdhsa_group_segment_fixed_size 0
  .amdhsa_kernarg_size 80
  .amdhsa_user_sgpr_count 2
  .amdhsa_user_sgpr_kernarg_segment_ptr 1
  .amdhsa_system_sgpr_workgroup_id_x 1
.end_amdhsa_kernel
.p2align 6
.amdhsa_kernel outa_l1_kernel
  .amdhsa_next_free_vgpr 168
  .amdhsa_next_free_sgpr 64
  .amdhsa_accum_offset 168
  .amdhsa_group_segment_fixed_size 0
  .amdhsa_kernarg_size 80
  .amdhsa_user_sgpr_count 2
  .amdhsa_user_sgpr_kernarg_segment_ptr 1
  .amdhsa_system_sgpr_workgroup_id_x 1
.end_amdhsa_kernel
.p2align 6
.amdhsa_kernel b1_l1_kernel
  .amdhsa_next_free_vgpr 256
  .amdhsa_next_free_sgpr 64
  .amdhsa_accum_offset 256
  .amdhsa_group_segment_fixed_size 0
  .amdhsa_kernarg_size 80
  .amdhsa_user_sgpr_count 2
  .amdhsa_user_sgpr_kernarg_segment_ptr 1
  .amdhsa_system_sgpr_workgroup_id_x 1
.end_amdhsa_kernel
.p2align 6
.amdhsa_kernel b2_l1_kernel
  .amdhsa_next_free_vgpr 128
  .amdhsa_next_free_sgpr 64
  .amdhsa_accum_offset 128
  .amdhsa_group_segment_fixed_size 0
  .amdhsa_kernarg_size 80
  .amdhsa_user_sgpr_count 2
  .amdhsa_user_sgpr_kernarg_segment_ptr 1
  .amdhsa_system_sgpr_workgroup_id_x 1
.end_amdhsa_kernel
.p2align 6
.amdhsa_kernel outb_l1_kernel
  .amdhsa_next_free_vgpr 168
  .amdhsa_next_free_sgpr 64
  .amdhsa_accum_offset 168
  .amdhsa_group_segment_fixed_size 0
  .amdhsa_kernarg_size 80
  .amdhsa_user_sgpr_count 2
  .amdhsa_user_sgpr_kernarg_segment_ptr 1
  .amdhsa_system_sgpr_workgroup_id_x 1
.end_amdhsa_kernel
```
